```python
import torch

def _softmax(x, axis=-1):
    return torch.softmax(x, dim=axis)
def _gelu(x):
    return torch.nn.functional.gelu(x, approximate="tanh")
def _silu(x):
    return torch.nn.functional.silu(x)
def _sigmoid(x):
    return torch.sigmoid(x)
def _layernorm(x, axis=-1, eps=1e-5):
    m = x.mean(dim=axis, keepdim=True)
    v = x.var(dim=axis, keepdim=True, unbiased=False)
    return (x - m) / torch.sqrt(v + eps)
def _scatter_add(tgt, idx, src, axis=0):
    return tgt.clone().index_add_(axis, idx, src)
def _segment_sum(src, seg, n):
    out = torch.zeros((n,) + src.shape[1:], dtype=src.dtype)
    return out.index_add_(0, seg, src)
def _pad(x, pw):
    flat = tuple(v for pair in reversed(pw) for v in pair)
    return torch.nn.functional.pad(x, flat)

kernel_name = 'concat_heads__mha_block_cached__gqa_block_cached__near_ridge'

def setup_inputs():

    _w = (lambda a: (lambda t: t.to(torch.bfloat16) if t.is_floating_point() else t)(torch.as_tensor(a)))
    def _A_setup():
        B, Sq, D = 8, 176, 1024
        H, Sk, Dh = 32, 512, 128
        return {
            "x": _w((lambda *s: torch.randn(*s, dtype=torch.bfloat16) * 0.8)(B, Sq, D)),
            "k_cache": _w((lambda *s: torch.randn(*s, dtype=torch.bfloat16) * 0.8)(B, H, Sk, Dh)),
            "v_cache": _w((lambda *s: torch.randn(*s, dtype=torch.bfloat16) * 0.05)(B, H, Sk, Dh)),
            "wq": _w((lambda *s: torch.randn(*s, dtype=torch.bfloat16) * 0.8)(D, H * Dh) * (D ** -0.5)),
            "wo": _w((lambda *s: torch.randn(*s, dtype=torch.bfloat16) * 0.05)(H * Dh, D) * ((H * Dh) ** -0.5)),
        }
    _A_in = _A_setup()

    def _B_setup():
        B, Sq, D = 8, 176, 1024
        Hq, Hkv, Sk, Dh = 32, 32, 512, 128
        assert Hq % Hkv == 0, (Hq, Hkv)
        return {
            "x": _w((lambda *s: torch.randn(*s, dtype=torch.bfloat16) * 0.8)(B, Sq, D)),
            "k_cache": _w((lambda *s: torch.randn(*s, dtype=torch.bfloat16) * 0.8)(B, Hkv, Sk, Dh)),
            "v_cache": _w((lambda *s: torch.randn(*s, dtype=torch.bfloat16) * 0.05)(B, Hkv, Sk, Dh)),
            "wq": _w((lambda *s: torch.randn(*s, dtype=torch.bfloat16) * 0.8)(D, Hq * Dh) * (D ** -0.5)),
            "wo": _w((lambda *s: torch.randn(*s, dtype=torch.bfloat16) * 0.05)(Hq * Dh, D) * ((Hq * Dh) ** -0.5)),
        }
    _B_in = _B_setup()

    return {
        "A_x": _A_in["x"],
        "A_k_cache": _A_in["k_cache"],
        "A_v_cache": _A_in["v_cache"],
        "A_wq": _A_in["wq"],
        "A_wo": _A_in["wo"],
        "B_x": _B_in["x"],
        "B_k_cache": _B_in["k_cache"],
        "B_v_cache": _B_in["v_cache"],
        "B_wq": _B_in["wq"],
        "B_wo": _B_in["wo"],
    }

def reference(A_x, A_k_cache, A_v_cache, A_wq, A_wo, B_x, B_k_cache, B_v_cache, B_wq, B_wo):
    def _A_ref(x, k_cache, v_cache, wq, wo):
        B, Sq, D = x.shape
        H, Dh = 32, 128
        q = (lambda x, *d: x.permute(*d))((x @ wq).reshape(B, Sq, H, Dh), 0, 2, 1, 3)
        scores = torch.einsum("bhqd,bhkd->bhqk", q, k_cache) * (Dh ** -0.5)
        p = _softmax(scores, axis=-1)
        o = torch.einsum("bhqk,bhkd->bhqd", p, v_cache)
        return (lambda x, *d: x.permute(*d))(o, 0, 2, 1, 3).reshape(B, Sq, H * Dh) @ wo

    def _B_ref(x, k_cache, v_cache, wq, wo):
        B, Sq, D = x.shape
        Hq, Dh = 32, 128
        Hkv = k_cache.shape[1]
        rep = Hq // Hkv
        q = (lambda x, *d: x.permute(*d))((x @ wq).reshape(B, Sq, Hq, Dh), 0, 2, 1, 3)
        k = (lambda x, n, axis: torch.repeat_interleave(x, n, dim=axis))(k_cache, rep, axis=1)
        v = (lambda x, n, axis: torch.repeat_interleave(x, n, dim=axis))(v_cache, rep, axis=1)
        scores = torch.einsum("bhqd,bhkd->bhqk", q, k) * (Dh ** -0.5)
        p = _softmax(scores, axis=-1)
        o = torch.einsum("bhqk,bhkd->bhqd", p, v)
        return (lambda x, *d: x.permute(*d))(o, 0, 2, 1, 3).reshape(B, Sq, Hq * Dh) @ wo

    a = _A_ref(A_x, A_k_cache, A_v_cache, A_wq, A_wo)
    b = _B_ref(B_x, B_k_cache, B_v_cache, B_wq, B_wo)
    return torch.concatenate([a, b], axis=-1)
```

```asm
; @launch grid=(256,1,1) block=(256,1,1) lds=163840
.amdgcn_target "amdgcn-amd-amdhsa--gfx950"
.macro m16 d, a, b, c
v_mfma_f32_16x16x32_bf16 \d, \a, \b, \c
.endm
.macro rtr d, a, o
ds_read_b64_tr_b16 \d, \a offset:\o
.endm
.macro r128 d, a, o
ds_read_b128 \d, \a offset:\o
.endm
.macro cvt d, a, b
v_cvt_pk_bf16_f32 \d, \a, \b
.endm
.text
.p2align 8
concat_heads__mha_block_cached__gqa_block_cached__near_ridge_kernel_codebeg:
concat_heads__mha_block_cached__gqa_block_cached__near_ridge_kernel_v1:
s_waitcnt vmcnt(12)
s_barrier
r128 a[64:67],v246,0
r128 a[68:71],v246,2048
r128 a[76:79],v247,0
r128 a[80:83],v247,2048
rtr a[0:1],v248,16400
rtr a[2:3],v248,17424
rtr a[4:5],v248,16408
rtr a[6:7],v248,17432
rtr a[8:9],v249,16400
rtr a[10:11],v249,17424
rtr a[12:13],v249,16408
rtr a[14:15],v249,17432
rtr a[16:17],v248,16912
rtr a[18:19],v248,17936
rtr a[20:21],v248,16920
rtr a[22:23],v248,17944
rtr a[24:25],v249,16912
rtr a[26:27],v249,17936
rtr a[28:29],v249,16920
rtr a[30:31],v249,17944
rtr a[32:33],v248,20496
rtr a[34:35],v248,21520
rtr a[36:37],v248,20504
rtr a[38:39],v248,21528
rtr a[40:41],v249,20496
rtr a[42:43],v249,21520
rtr a[44:45],v249,20504
rtr a[46:47],v249,21528
rtr a[48:49],v248,21008
rtr a[50:51],v248,22032
rtr a[52:53],v248,21016
rtr a[54:55],v248,22040
rtr a[56:57],v249,21008
rtr a[58:59],v249,22032
rtr a[60:61],v249,21016
rtr a[62:63],v249,22040
s_waitcnt vmcnt(8) lgkmcnt(0)
s_barrier
m16 v[112:115],a[0:3],a[64:67],0
rtr a[192:193],v248,32800
rtr a[194:195],v248,33824
s_add_u32 m0, s68, 16400
m16 v[144:147],a[0:3],a[68:71],0
s_lshl_b32 s96, s36, 9
rtr a[196:197],v248,32808
v_add_u32 v14, s96, v14
m16 v[116:119],a[4:7],a[64:67],0
rtr a[198:199],v248,33832
buffer_load_dwordx4 v244, s[12:15], s60 offen offset:0 lds
s_mul_i32 s100, s36, 2112
m16 v[148:151],a[4:7],a[68:71],0
rtr a[200:201],v249,32800
s_lshl_b32 s96, s32, 5
m16 v[120:123],a[8:11],a[64:67],0
rtr a[202:203],v249,33824
rtr a[204:205],v249,32808
buffer_load_dwordx4 v244, s[12:15], s61 offen offset:1024 lds
m16 v[152:155],a[8:11],a[68:71],0
rtr a[206:207],v249,33832
s_lshl_b32 s97, s33, 1
m16 v[124:127],a[12:15],a[64:67],0
rtr a[208:209],v248,33312
buffer_load_dwordx4 v244, s[12:15], s62 offen offset:2048 lds
s_add_u32 s96, s96, s97
m16 v[156:159],a[12:15],a[68:71],0
rtr a[210:211],v248,34336
s_lshl_b32 s96, s96, 17
m16 v[128:131],a[16:19],a[64:67],0
rtr a[212:213],v248,33320
rtr a[214:215],v248,34344
s_add_u32 s16, s42, s96
s_addc_u32 s17, s43, 0
m16 v[160:163],a[16:19],a[68:71],0
rtr a[216:217],v249,33312
buffer_load_dwordx4 v244, s[12:15], s63 offen offset:3072 lds
m16 v[132:135],a[20:23],a[64:67],0
rtr a[218:219],v249,34336
s_mov_b32 s18, 0x40000
m16 v[164:167],a[20:23],a[68:71],0
rtr a[220:221],v249,33320
v_add_u32 v244, 262144, v244
s_mov_b32 s19, 0x00020000
m16 v[136:139],a[24:27],a[64:67],0
rtr a[222:223],v249,34344
s_add_u32 s20, s44, s96
s_addc_u32 s21, s45, 0
m16 v[168:171],a[24:27],a[68:71],0
rtr a[224:225],v248,36896
rtr a[226:227],v248,37920
m16 v[140:143],a[28:31],a[64:67],0
s_add_u32 m0, s69, 0
s_mov_b32 s22, 0x40000
m16 v[172:175],a[28:31],a[68:71],0
rtr a[228:229],v248,36904
rtr a[230:231],v248,37928
m16 v[16:19],a[32:35],a[64:67],0
s_mov_b32 s23, 0x00020000
rtr a[232:233],v249,36896
m16 v[48:51],a[32:35],a[68:71],0
buffer_load_dwordx4 v245, s[8:11], s64 offen offset:0 lds
s_lshl_b32 s96, s31, 3
m16 v[20:23],a[36:39],a[64:67],0
rtr a[234:235],v249,37920
rtr a[236:237],v249,36904
s_add_u32 s96, s96, s32
m16 v[52:55],a[36:39],a[68:71],0
rtr a[238:239],v249,37928
buffer_load_dwordx4 v251, s[8:11], s64 offen offset:1024 lds
s_lshl_b32 s39, s96, 4
m16 v[24:27],a[40:43],a[64:67],0
rtr a[240:241],v248,37408
rtr a[242:243],v248,38432
m16 v[56:59],a[40:43],a[68:71],0
buffer_load_dwordx4 v245, s[8:11], s65 offen offset:2048 lds
s_add_u32 s39, s39, s33
m16 v[28:31],a[44:47],a[64:67],0
rtr a[244:245],v248,37416
rtr a[246:247],v248,38440
s_mul_i32 s96, s96, 2130944
m16 v[60:63],a[44:47],a[68:71],0
rtr a[248:249],v249,37408
s_add_u32 s24, s34, s96
s_addc_u32 s25, s35, 0
m16 v[32:35],a[48:51],a[64:67],0
rtr a[250:251],v249,38432
buffer_load_dwordx4 v251, s[8:11], s65 offen offset:3072 lds
s_mov_b32 s26, 0x200000
m16 v[64:67],a[48:51],a[68:71],0
rtr a[252:253],v249,37416
rtr a[254:255],v249,38440
m16 v[36:39],a[52:55],a[64:67],0
v_add_u32 v245, 128, v245
s_mov_b32 s27, 0x00020000
m16 v[68:71],a[52:55],a[68:71],0
s_mov_b32 s56, s4
v_add_u32 v251, 128, v251
m16 v[40:43],a[56:59],a[64:67],0
s_mov_b32 s57, s5
s_mov_b32 s58, 8388608
m16 v[72:75],a[56:59],a[68:71],0
m16 v[44:47],a[60:63],a[64:67],0
m16 v[76:79],a[60:63],a[68:71],0
s_waitcnt vmcnt(8) lgkmcnt(0)
s_barrier
m16 v[112:115],a[192:195],a[76:79],v[112:115]
r128 a[88:91],v246,22528
r128 a[92:95],v246,24576
s_add_u32 m0, s68, 32800
m16 v[144:147],a[192:195],a[80:83],v[144:147]
s_mov_b32 s59, 0x00020000
r128 a[64:67],v247,22528
s_mov_b32 s40, 0x3e0293ee
m16 v[116:119],a[196:199],a[76:79],v[116:119]
r128 a[68:71],v247,24576
rtr a[0:1],v248,0
buffer_load_dwordx4 v244, s[12:15], s60 offen offset:0 lds
m16 v[148:151],a[196:199],a[80:83],v[148:151]
s_mov_b32 s41, 0x3e0293ee
rtr a[2:3],v248,1024
s_mov_b32 s42, 1
m16 v[120:123],a[200:203],a[76:79],v[120:123]
rtr a[4:5],v248,8
m16 v[152:155],a[200:203],a[80:83],v[152:155]
rtr a[6:7],v248,1032
rtr a[8:9],v249,0
buffer_load_dwordx4 v244, s[12:15], s61 offen offset:1024 lds
m16 v[124:127],a[204:207],a[76:79],v[124:127]
s_mov_b32 s43, 0
rtr a[10:11],v249,1024
s_mov_b32 s37, s32
m16 v[156:159],a[204:207],a[80:83],v[156:159]
rtr a[12:13],v249,8
rtr a[14:15],v249,1032
buffer_load_dwordx4 v244, s[12:15], s62 offen offset:2048 lds
m16 v[128:131],a[208:211],a[76:79],v[128:131]
s_and_b32 s38, s3, 1
rtr a[16:17],v248,512
s_lshl_b32 s38, s38, 2
m16 v[160:163],a[208:211],a[80:83],v[160:163]
rtr a[18:19],v248,1536
m16 v[132:135],a[212:215],a[76:79],v[132:135]
rtr a[20:21],v248,520
rtr a[22:23],v248,1544
buffer_load_dwordx4 v244, s[12:15], s63 offen offset:3072 lds
m16 v[164:167],a[212:215],a[80:83],v[164:167]
s_lshr_b32 s96, s30, 3
rtr a[24:25],v249,512
s_add_u32 s38, s38, s96
m16 v[136:139],a[216:219],a[76:79],v[136:139]
rtr a[26:27],v249,1536
v_add_u32 v244, 262144, v244
s_bfe_u32 s67, s3, 0x10001
m16 v[168:171],a[216:219],a[80:83],v[168:171]
rtr a[28:29],v249,520
rtr a[30:31],v249,1544
s_mov_b32 s44, 31744
m16 v[140:143],a[220:223],a[76:79],v[140:143]
rtr a[32:33],v248,4096
m16 v[172:175],a[220:223],a[80:83],v[172:175]
rtr a[34:35],v248,5120
rtr a[36:37],v248,4104
s_add_u32 m0, s100, 0
m16 v[16:19],a[224:227],a[76:79],v[16:19]
s_mov_b32 s45, 14336
rtr a[38:39],v248,5128
m16 v[48:51],a[224:227],a[80:83],v[48:51]
s_mov_b32 s46, 46080
rtr a[40:41],v249,4096
m16 v[20:23],a[228:231],a[76:79],v[20:23]
s_mov_b32 s28, 0
s_mov_b32 s47, 11264
m16 v[52:55],a[228:231],a[80:83],v[52:55]
rtr a[42:43],v249,5120
rtr a[44:45],v249,4104
s_mov_b32 s4, 22528
m16 v[24:27],a[232:235],a[76:79],v[24:27]
rtr a[46:47],v249,5128
rtr a[48:49],v248,4608
m16 v[56:59],a[232:235],a[80:83],v[56:59]
rtr a[50:51],v248,5632
buffer_load_dwordx4 v14, s[16:19], s28 offen offset:0 nt lds
s_mov_b32 s5, 33792
m16 v[28:31],a[236:239],a[76:79],v[28:31]
rtr a[52:53],v248,4616
s_sub_u32 s70, s68, 114640
m16 v[60:63],a[236:239],a[80:83],v[60:63]
rtr a[54:55],v248,5640
s_add_u32 m0, s100, 800
s_cmp_eq_u32 s67, 0
s_cselect_b32 s6, 48, 4294967216
m16 v[32:35],a[240:243],a[76:79],v[32:35]
rtr a[56:57],v249,4608
rtr a[58:59],v249,5632
s_mul_i32 s7, s6, 11264
m16 v[64:67],a[240:243],a[80:83],v[64:67]
rtr a[60:61],v249,4616
rtr a[62:63],v249,5640
m16 v[36:39],a[244:247],a[76:79],v[36:39]
s_mov_b32 s28, 0
s_lshl_b32 s6, s6, 16
m16 v[68:71],a[244:247],a[80:83],v[68:71]
s_mov_b32 s3, s67
buffer_load_dwordx4 v14, s[16:19], s28 offen offset:256 nt lds
m16 v[40:43],a[248:251],a[76:79],v[40:43]
s_and_b32 s96, s2, 3
s_lshl_b32 s96, s96, 5
m16 v[72:75],a[248:251],a[80:83],v[72:75]
m16 v[44:47],a[252:255],a[76:79],v[44:47]
m16 v[76:79],a[252:255],a[80:83],v[76:79]
s_waitcnt vmcnt(10) lgkmcnt(0)
s_barrier
m16 v[112:115],a[0:3],a[88:91],v[112:115]
rtr a[192:193],v248,16400
rtr a[194:195],v248,17424
s_add_u32 m0, s68, 0
m16 v[144:147],a[0:3],a[92:95],v[144:147]
s_add_u32 s96, s96, s30
rtr a[196:197],v248,16408
buffer_load_dwordx4 v244, s[12:15], s60 offen offset:0 lds
m16 v[116:119],a[4:7],a[88:91],v[116:119]
s_lshl_b32 s96, s96, 2
rtr a[198:199],v248,17432
s_add_u32 s96, s96, s36
m16 v[148:151],a[4:7],a[92:95],v[148:151]
rtr a[200:201],v249,16400
buffer_load_dwordx4 v244, s[12:15], s61 offen offset:1024 lds
s_lshl_b32 s96, s96, 14
m16 v[120:123],a[8:11],a[88:91],v[120:123]
rtr a[202:203],v249,17424
rtr a[204:205],v249,16408
buffer_load_dwordx4 v244, s[12:15], s62 offen offset:2048 lds
m16 v[152:155],a[8:11],a[92:95],v[152:155]
rtr a[206:207],v249,17432
v_lshlrev_b32 v250, 7, v0
m16 v[124:127],a[12:15],a[88:91],v[124:127]
rtr a[208:209],v248,16912
buffer_load_dwordx4 v244, s[12:15], s63 offen offset:3072 lds
v_add_u32 v250, s96, v250
m16 v[156:159],a[12:15],a[92:95],v[156:159]
rtr a[210:211],v248,17936
v_add_u32 v244, 262144, v244
v_mov_b32 v208, 0x80000000
m16 v[128:131],a[16:19],a[88:91],v[128:131]
rtr a[212:213],v248,16920
rtr a[214:215],v248,17944
v_cmp_gt_u32 vcc, 5, v0
m16 v[160:163],a[16:19],a[92:95],v[160:163]
rtr a[216:217],v249,16912
s_add_u32 m0, s69, 22528
m16 v[132:135],a[20:23],a[88:91],v[132:135]
rtr a[218:219],v249,17936
s_lshl_b32 s97, s33, 2
m16 v[164:167],a[20:23],a[92:95],v[164:167]
rtr a[220:221],v249,16920
buffer_load_dwordx4 v245, s[8:11], s64 offen offset:0 lds
s_add_u32 s96, s97, 1974272
m16 v[136:139],a[24:27],a[88:91],v[136:139]
rtr a[222:223],v249,17944
buffer_load_dwordx4 v251, s[8:11], s64 offen offset:1024 lds
v_cndmask_b32 v250, v208, v250, vcc
m16 v[168:171],a[24:27],a[92:95],v[168:171]
rtr a[224:225],v248,20496
rtr a[226:227],v248,21520
s_add_u32 s97, s97, s36
m16 v[140:143],a[28:31],a[88:91],v[140:143]
rtr a[228:229],v248,20504
buffer_load_dwordx4 v245, s[8:11], s65 offen offset:2048 lds
m16 v[172:175],a[28:31],a[92:95],v[172:175]
rtr a[230:231],v248,21528
buffer_load_dwordx4 v251, s[8:11], s65 offen offset:3072 lds
s_lshl_b32 s97, s97, 7
m16 v[16:19],a[32:35],a[88:91],v[16:19]
rtr a[232:233],v249,20496
s_add_u32 s97, s97, 1966080
m16 v[48:51],a[32:35],a[92:95],v[48:51]
rtr a[234:235],v249,21520
rtr a[236:237],v249,20504
v_add_u32 v245, 128, v245
m16 v[20:23],a[36:39],a[88:91],v[20:23]
v_mov_b32 v214, s97
rtr a[238:239],v249,21528
m16 v[52:55],a[36:39],a[92:95],v[52:55]
v_add_u32 v251, 128, v251
v_mov_b32 v213, s96
m16 v[24:27],a[40:43],a[88:91],v[24:27]
rtr a[240:241],v248,21008
rtr a[242:243],v248,22032
m16 v[56:59],a[40:43],a[92:95],v[56:59]
s_add_u32 m0, s100, 8448
v_cmp_eq_u32 vcc, 0, v0
m16 v[28:31],a[44:47],a[88:91],v[28:31]
rtr a[244:245],v248,21016
rtr a[246:247],v248,22040
v_mov_b32 v215, 0
m16 v[60:63],a[44:47],a[92:95],v[60:63]
rtr a[248:249],v249,21008
s_mov_b32 s28, 8192
s_mov_b32 s52, s50
m16 v[32:35],a[48:51],a[88:91],v[32:35]
rtr a[250:251],v249,22032
buffer_load_dwordx4 v14, s[16:19], s28 offen offset:0 nt lds
s_mov_b32 s53, s51
m16 v[64:67],a[48:51],a[92:95],v[64:67]
rtr a[252:253],v249,21016
rtr a[254:255],v249,22040
m16 v[36:39],a[52:55],a[88:91],v[36:39]
s_add_u32 m0, s100, 9248
v_cndmask_b32 v214, v213, v214, vcc
m16 v[68:71],a[52:55],a[92:95],v[68:71]
s_mov_b32 s28, 8192
s_mov_b32 s54, 256
m16 v[40:43],a[56:59],a[88:91],v[40:43]
s_mov_b32 s55, 0x00020000
buffer_load_dwordx4 v14, s[16:19], s28 offen offset:256 nt lds
m16 v[72:75],a[56:59],a[92:95],v[72:75]
s_mov_b64 exec, 3
buffer_store_dword v215, v214, s[24:27], 0 offen sc1
s_mov_b64 exec, -1
s_nop 3
m16 v[44:47],a[60:63],a[88:91],v[44:47]
m16 v[76:79],a[60:63],a[92:95],v[76:79]
s_waitcnt vmcnt(13) lgkmcnt(0)
s_barrier
m16 v[112:115],a[192:195],a[64:67],v[112:115]
r128 a[76:79],v246,0
r128 a[80:83],v246,2048
s_add_u32 m0, s68, 16400
m16 v[144:147],a[192:195],a[68:71],v[144:147]
s_mov_b32 s50, 5767168
r128 a[88:91],v247,0
s_mov_b32 s51, 0x00020000
m16 v[116:119],a[196:199],a[64:67],v[116:119]
r128 a[92:95],v247,2048
rtr a[0:1],v248,32800
s_lshl_b32 s71, s33, 2
m16 v[148:151],a[196:199],a[68:71],v[148:151]
rtr a[2:3],v248,33824
buffer_load_dwordx4 v244, s[12:15], s60 offen offset:0 lds
s_add_u32 s71, s71, 1974272
m16 v[120:123],a[200:203],a[64:67],v[120:123]
rtr a[4:5],v248,32808
m16 v[152:155],a[200:203],a[68:71],v[152:155]
rtr a[6:7],v248,33832
rtr a[8:9],v249,32800
v_lshlrev_b32 v15, 4, v0
m16 v[124:127],a[204:207],a[64:67],v[124:127]
rtr a[10:11],v249,33824
buffer_load_dwordx4 v244, s[12:15], s61 offen offset:1024 lds
v_add_u32 v15, s100, v15
m16 v[156:159],a[204:207],a[68:71],v[156:159]
rtr a[12:13],v249,32808
rtr a[14:15],v249,33832
v_add_u32 v253, 67584, v15
m16 v[128:131],a[208:211],a[64:67],v[128:131]
rtr a[16:17],v248,33312
v_and_b32 v208, 7, v0
m16 v[160:163],a[208:211],a[68:71],v[160:163]
rtr a[18:19],v248,34336
m16 v[132:135],a[212:215],a[64:67],v[132:135]
rtr a[20:21],v248,33320
rtr a[22:23],v248,34344
buffer_load_dwordx4 v244, s[12:15], s62 offen offset:2048 lds
m16 v[164:167],a[212:215],a[68:71],v[164:167]
v_mul_u32_u24 v208, 1056, v208
rtr a[24:25],v249,33312
v_bfe_u32 v209, v0, 3, 1
m16 v[136:139],a[216:219],a[64:67],v[136:139]
rtr a[26:27],v249,34336
v_lshl_add_u32 v208, v209, 8, v208
m16 v[168:171],a[216:219],a[68:71],v[168:171]
rtr a[28:29],v249,33320
rtr a[30:31],v249,34344
m16 v[140:143],a[220:223],a[64:67],v[140:143]
buffer_load_dwordx4 v244, s[12:15], s63 offen offset:3072 lds
v_lshrrev_b32 v209, 4, v0
m16 v[172:175],a[220:223],a[68:71],v[172:175]
rtr a[32:33],v248,36896
rtr a[34:35],v248,37920
m16 v[16:19],a[224:227],a[64:67],v[16:19]
rtr a[36:37],v248,36904
v_lshl_add_u32 v3, v209, 4, v208
m16 v[48:51],a[224:227],a[68:71],v[48:51]
rtr a[38:39],v248,37928
v_add_u32 v244, 262144, v244
v_add_u32 v1, 67584, v3
m16 v[20:23],a[228:231],a[64:67],v[20:23]
rtr a[40:41],v249,36896
v_bfe_u32 v208, v0, 2, 3
m16 v[52:55],a[228:231],a[68:71],v[52:55]
rtr a[42:43],v249,37920
rtr a[44:45],v249,36904
v_mul_u32_u24 v208, 1056, v208
m16 v[24:27],a[232:235],a[64:67],v[24:27]
rtr a[46:47],v249,37928
rtr a[48:49],v248,37408
m16 v[56:59],a[232:235],a[68:71],v[56:59]
rtr a[50:51],v248,38432
s_add_u32 m0, s100, 16896
v_lshrrev_b32 v209, 5, v0
m16 v[28:31],a[236:239],a[64:67],v[28:31]
rtr a[52:53],v248,37416
v_lshl_add_u32 v208, v209, 8, v208
m16 v[60:63],a[236:239],a[68:71],v[60:63]
rtr a[54:55],v248,38440
v_and_b32 v210, 3, v0
m16 v[32:35],a[240:243],a[64:67],v[32:35]
rtr a[56:57],v249,37408
rtr a[58:59],v249,38432
s_mov_b32 s28, 0
v_lshl_add_u32 v208, v210, 3, v208
m16 v[64:67],a[240:243],a[68:71],v[64:67]
rtr a[60:61],v249,37416
rtr a[62:63],v249,38440
m16 v[36:39],a[244:247],a[64:67],v[36:39]
v_add_u32 v4, 16896, v208
buffer_load_dwordx4 v14, s[20:23], s28 offen offset:0 nt lds
m16 v[68:71],a[244:247],a[68:71],v[68:71]
v_add_u32 v2, 67584, v4
s_mul_i32 s96, s33, 90112
m16 v[40:43],a[248:251],a[64:67],v[40:43]
s_mul_i32 s97, s36, 3072
m16 v[72:75],a[248:251],a[68:71],v[72:75]
m16 v[44:47],a[252:255],a[64:67],v[44:47]
m16 v[76:79],a[252:255],a[68:71],v[76:79]
s_waitcnt vmcnt(12) lgkmcnt(0)
s_barrier
m16 v[112:115],a[0:3],a[76:79],v[112:115]
rtr a[192:193],v248,0
rtr a[194:195],v248,1024
s_add_u32 m0, s68, 32800
m16 v[144:147],a[0:3],a[80:83],v[144:147]
s_add_u32 s96, s96, s97
rtr a[196:197],v248,8
buffer_load_dwordx4 v244, s[12:15], s60 offen offset:0 lds
m16 v[116:119],a[4:7],a[76:79],v[116:119]
v_lshlrev_b32 v5, 4, v0
rtr a[198:199],v248,1032
v_add_u32 v5, s96, v5
m16 v[148:151],a[4:7],a[80:83],v[148:151]
rtr a[200:201],v249,0
buffer_load_dwordx4 v244, s[12:15], s61 offen offset:1024 lds
v_bfe_u32 v211, v0, 2, 2
m16 v[120:123],a[8:11],a[76:79],v[120:123]
rtr a[202:203],v249,1024
rtr a[204:205],v249,8
buffer_load_dwordx4 v244, s[12:15], s62 offen offset:2048 lds
m16 v[152:155],a[8:11],a[80:83],v[152:155]
rtr a[206:207],v249,1032
v_bfe_u32 v212, v0, 4, 1
m16 v[124:127],a[12:15],a[76:79],v[124:127]
rtr a[208:209],v248,512
buffer_load_dwordx4 v244, s[12:15], s63 offen offset:3072 lds
v_mul_u32_u24 v208, 8200, v212
m16 v[156:159],a[12:15],a[80:83],v[156:159]
rtr a[210:211],v248,1536
v_add_u32 v244, 262144, v244
v_lshl_add_u32 v208, v209, 11, v208
m16 v[128:131],a[16:19],a[76:79],v[128:131]
rtr a[212:213],v248,520
rtr a[214:215],v248,1544
v_lshl_add_u32 v208, v211, 6, v208
m16 v[160:163],a[16:19],a[80:83],v[160:163]
rtr a[216:217],v249,512
s_add_u32 m0, s69, 0
m16 v[132:135],a[20:23],a[76:79],v[132:135]
rtr a[218:219],v249,1536
v_lshl_add_u32 v208, v210, 4, v208
m16 v[164:167],a[20:23],a[80:83],v[164:167]
rtr a[220:221],v249,520
buffer_load_dwordx4 v245, s[8:11], s64 offen offset:0 lds
v_mov_b32 v10, v208
m16 v[136:139],a[24:27],a[76:79],v[136:139]
rtr a[222:223],v249,1544
buffer_load_dwordx4 v251, s[8:11], s64 offen offset:1024 lds
v_add_u32 v11, 67584, v208
m16 v[168:171],a[24:27],a[80:83],v[168:171]
rtr a[224:225],v248,4096
rtr a[226:227],v248,5120
v_add_u32 v12, 147424, v208
m16 v[140:143],a[28:31],a[76:79],v[140:143]
rtr a[228:229],v248,4104
buffer_load_dwordx4 v245, s[8:11], s65 offen offset:2048 lds
m16 v[172:175],a[28:31],a[80:83],v[172:175]
rtr a[230:231],v248,5128
buffer_load_dwordx4 v251, s[8:11], s65 offen offset:3072 lds
s_lshl_b32 s96, s31, 3
m16 v[16:19],a[32:35],a[76:79],v[16:19]
rtr a[232:233],v249,4096
s_add_u32 s96, s96, s37
m16 v[48:51],a[32:35],a[80:83],v[48:51]
rtr a[234:235],v249,5120
rtr a[236:237],v249,4104
v_add_u32 v245, 128, v245
m16 v[20:23],a[36:39],a[76:79],v[20:23]
s_lshl_b32 s97, s96, 4
rtr a[238:239],v249,5128
m16 v[52:55],a[36:39],a[80:83],v[52:55]
v_add_u32 v251, 128, v251
v_lshl_add_u32 v9, v210, 2, s97
m16 v[24:27],a[40:43],a[76:79],v[24:27]
rtr a[240:241],v248,4608
rtr a[242:243],v248,5632
m16 v[56:59],a[40:43],a[80:83],v[56:59]
s_add_u32 m0, s100, 17696
s_mov_b32 s97, 1974272
m16 v[28:31],a[44:47],a[76:79],v[28:31]
rtr a[244:245],v248,4616
rtr a[246:247],v248,5640
v_and_b32 v13, 15, v0
m16 v[60:63],a[44:47],a[80:83],v[60:63]
rtr a[248:249],v249,4608
s_mov_b32 s28, 0
v_lshl_add_u32 v13, v13, 2, s97
m16 v[32:35],a[48:51],a[76:79],v[32:35]
rtr a[250:251],v249,5632
buffer_load_dwordx4 v14, s[20:23], s28 offen offset:256 nt lds
v_bfe_u32 v211, v0, 2, 2
m16 v[64:67],a[48:51],a[80:83],v[64:67]
rtr a[252:253],v249,4616
rtr a[254:255],v249,5640
m16 v[36:39],a[52:55],a[76:79],v[36:39]
s_add_u32 m0, s100, 25344
v_and_b32 v210, 3, v0
m16 v[68:71],a[52:55],a[80:83],v[68:71]
s_mov_b32 s28, 8192
v_lshlrev_b32 v208, 11, v211
m16 v[40:43],a[56:59],a[76:79],v[40:43]
v_lshl_add_u32 v208, v210, 4, v208
buffer_load_dwordx4 v14, s[20:23], s28 offen offset:0 nt lds
m16 v[72:75],a[56:59],a[80:83],v[72:75]
s_and_b32 s96, s36, 1
m16 v[44:47],a[60:63],a[76:79],v[44:47]
m16 v[76:79],a[60:63],a[80:83],v[76:79]
s_waitcnt vmcnt(11) lgkmcnt(0)
s_barrier
m16 v[112:115],a[192:195],a[88:91],v[112:115]
r128 a[64:67],v246,22528
r128 a[68:71],v246,24576
s_add_u32 m0, s68, 0
m16 v[144:147],a[192:195],a[92:95],v[144:147]
s_lshl_b32 s96, s96, 13
r128 a[76:79],v247,22528
s_lshl_b32 s97, s38, 8
m16 v[116:119],a[196:199],a[88:91],v[116:119]
r128 a[80:83],v247,24576
rtr a[0:1],v248,16400
s_add_u32 s96, s96, s97
m16 v[148:151],a[196:199],a[92:95],v[148:151]
rtr a[2:3],v248,17424
buffer_load_dwordx4 v244, s[12:15], s60 offen offset:0 lds
s_lshl_b32 s97, s3, 22
m16 v[120:123],a[200:203],a[88:91],v[120:123]
rtr a[4:5],v248,16408
m16 v[152:155],a[200:203],a[92:95],v[152:155]
rtr a[6:7],v248,17432
rtr a[8:9],v249,16400
s_add_u32 s96, s96, s97
m16 v[124:127],a[204:207],a[88:91],v[124:127]
rtr a[10:11],v249,17424
buffer_load_dwordx4 v244, s[12:15], s61 offen offset:1024 lds
v_add_u32 v208, s96, v208
m16 v[156:159],a[204:207],a[92:95],v[156:159]
rtr a[12:13],v249,16408
rtr a[14:15],v249,17432
v_lshrrev_b32 v209, 4, v0
m16 v[128:131],a[208:211],a[88:91],v[128:131]
rtr a[16:17],v248,16912
s_lshl_b32 s97, s3, 1
m16 v[160:163],a[208:211],a[92:95],v[160:163]
rtr a[18:19],v248,17936
m16 v[132:135],a[212:215],a[88:91],v[132:135]
rtr a[20:21],v248,16920
rtr a[22:23],v248,17944
buffer_load_dwordx4 v244, s[12:15], s62 offen offset:2048 lds
m16 v[164:167],a[212:215],a[92:95],v[164:167]
v_xor_b32 v212, s97, v209
rtr a[24:25],v249,16912
v_lshl_add_u32 v6, v212, 6, v208
m16 v[136:139],a[216:219],a[88:91],v[136:139]
rtr a[26:27],v249,17936
s_lshr_b32 s96, s36, 1
m16 v[168:171],a[216:219],a[92:95],v[168:171]
rtr a[28:29],v249,16920
rtr a[30:31],v249,17944
m16 v[140:143],a[220:223],a[88:91],v[140:143]
buffer_load_dwordx4 v244, s[12:15], s63 offen offset:3072 lds
s_lshl_b32 s97, s96, 16
m16 v[172:175],a[220:223],a[92:95],v[172:175]
rtr a[32:33],v248,20496
rtr a[34:35],v248,21520
m16 v[16:19],a[224:227],a[88:91],v[16:19]
rtr a[36:37],v248,20504
v_add_u32 v6, s97, v6
m16 v[48:51],a[224:227],a[92:95],v[48:51]
rtr a[38:39],v248,21528
v_add_u32 v244, 262144, v244
v_and_b32 v212, 1, v209
m16 v[20:23],a[228:231],a[88:91],v[20:23]
rtr a[40:41],v249,20496
v_lshl_add_u32 v8, v212, 6, v208
m16 v[52:55],a[228:231],a[92:95],v[52:55]
rtr a[42:43],v249,21520
rtr a[44:45],v249,20504
v_lshrrev_b32 v212, 1, v209
m16 v[24:27],a[232:235],a[88:91],v[24:27]
rtr a[46:47],v249,21528
rtr a[48:49],v248,21008
m16 v[56:59],a[232:235],a[92:95],v[56:59]
rtr a[50:51],v248,22032
s_add_u32 m0, s100, 26144
v_lshl_add_u32 v8, v212, 16, v8
m16 v[28:31],a[236:239],a[88:91],v[28:31]
rtr a[52:53],v248,21016
s_lshl_b32 s97, s96, 17
m16 v[60:63],a[236:239],a[92:95],v[60:63]
rtr a[54:55],v248,22040
s_lshl_b32 s96, s3, 7
m16 v[32:35],a[240:243],a[88:91],v[32:35]
rtr a[56:57],v249,21008
rtr a[58:59],v249,22032
s_mov_b32 s28, 8192
s_add_u32 s97, s97, s96
m16 v[64:67],a[240:243],a[92:95],v[64:67]
rtr a[60:61],v249,21016
rtr a[62:63],v249,22040
m16 v[36:39],a[244:247],a[88:91],v[36:39]
v_add_u32 v8, s97, v8
buffer_load_dwordx4 v14, s[20:23], s28 offen offset:256 nt lds
m16 v[68:71],a[244:247],a[92:95],v[68:71]
s_mul_i32 s96, s36, 3072
s_mul_i32 s97, s3, 720896
m16 v[40:43],a[248:251],a[88:91],v[40:43]
s_add_u32 s96, s96, s97
m16 v[72:75],a[248:251],a[92:95],v[72:75]
m16 v[44:47],a[252:255],a[88:91],v[44:47]
m16 v[76:79],a[252:255],a[92:95],v[76:79]
s_waitcnt vmcnt(11) lgkmcnt(0)
s_barrier
m16 v[112:115],a[0:3],a[64:67],v[112:115]
rtr a[192:193],v248,32800
rtr a[194:195],v248,33824
m16 v[144:147],a[0:3],a[68:71],v[144:147]
s_add_u32 m0, s68, 16400
v_lshlrev_b32 v7, 4, v0
m16 v[116:119],a[4:7],a[64:67],v[116:119]
rtr a[196:197],v248,32808
buffer_load_dwordx4 v244, s[12:15], s60 offen offset:0 lds
m16 v[148:151],a[4:7],a[68:71],v[148:151]
rtr a[198:199],v248,33832
rtr a[200:201],v249,32800
m16 v[120:123],a[8:11],a[64:67],v[120:123]
buffer_load_dwordx4 v244, s[12:15], s61 offen offset:1024 lds
rtr a[202:203],v249,33824
m16 v[152:155],a[8:11],a[68:71],v[152:155]
rtr a[204:205],v249,32808
buffer_load_dwordx4 v244, s[12:15], s62 offen offset:2048 lds
m16 v[124:127],a[12:15],a[64:67],v[124:127]
rtr a[206:207],v249,33832
rtr a[208:209],v248,33312
m16 v[156:159],a[12:15],a[68:71],v[156:159]
buffer_load_dwordx4 v244, s[12:15], s63 offen offset:3072 lds
rtr a[210:211],v248,34336
m16 v[128:131],a[16:19],a[64:67],v[128:131]
v_add_u32 v244, 262144, v244
rtr a[212:213],v248,33320
m16 v[160:163],a[16:19],a[68:71],v[160:163]
rtr a[214:215],v248,34344
rtr a[216:217],v249,33312
m16 v[132:135],a[20:23],a[64:67],v[132:135]
s_add_u32 m0, s69, 22528
rtr a[218:219],v249,34336
m16 v[164:167],a[20:23],a[68:71],v[164:167]
rtr a[220:221],v249,33320
buffer_load_dwordx4 v245, s[8:11], s64 offen offset:0 lds
m16 v[136:139],a[24:27],a[64:67],v[136:139]
rtr a[222:223],v249,34344
buffer_load_dwordx4 v251, s[8:11], s64 offen offset:1024 lds
m16 v[168:171],a[24:27],a[68:71],v[168:171]
rtr a[224:225],v248,36896
rtr a[226:227],v248,37920
m16 v[140:143],a[28:31],a[64:67],v[140:143]
rtr a[228:229],v248,36904
buffer_load_dwordx4 v245, s[8:11], s65 offen offset:2048 lds
m16 v[172:175],a[28:31],a[68:71],v[172:175]
rtr a[230:231],v248,37928
buffer_load_dwordx4 v251, s[8:11], s65 offen offset:3072 lds
m16 v[16:19],a[32:35],a[64:67],v[16:19]
v_add_u32 v7, s96, v7
rtr a[232:233],v249,36896
m16 v[48:51],a[32:35],a[68:71],v[48:51]
rtr a[234:235],v249,37920
rtr a[236:237],v249,36904
m16 v[20:23],a[36:39],a[64:67],v[20:23]
v_add_u32 v245, 128, v245
rtr a[238:239],v249,37928
m16 v[52:55],a[36:39],a[68:71],v[52:55]
v_add_u32 v251, 128, v251
rtr a[240:241],v248,37408
m16 v[24:27],a[40:43],a[64:67],v[24:27]
rtr a[242:243],v248,38432
s_add_u32 m0, s100, 33792
m16 v[56:59],a[40:43],a[68:71],v[56:59]
rtr a[244:245],v248,37416
rtr a[246:247],v248,38440
m16 v[28:31],a[44:47],a[64:67],v[28:31]
rtr a[248:249],v249,37408
s_mov_b32 s28, 16384
m16 v[60:63],a[44:47],a[68:71],v[60:63]
rtr a[250:251],v249,38432
buffer_load_dwordx4 v14, s[16:19], s28 offen offset:0 nt lds
m16 v[32:35],a[48:51],a[64:67],v[32:35]
rtr a[252:253],v249,37416
m16 v[64:67],a[48:51],a[68:71],v[64:67]
rtr a[254:255],v249,38440
s_add_u32 m0, s100, 34592
m16 v[36:39],a[52:55],a[64:67],v[36:39]
s_mov_b32 s28, 16384
m16 v[68:71],a[52:55],a[68:71],v[68:71]
m16 v[40:43],a[56:59],a[64:67],v[40:43]
buffer_load_dwordx4 v14, s[16:19], s28 offen offset:256 nt lds
m16 v[72:75],a[56:59],a[68:71],v[72:75]
m16 v[44:47],a[60:63],a[64:67],v[44:47]
m16 v[76:79],a[60:63],a[68:71],v[76:79]
s_waitcnt vmcnt(11) lgkmcnt(0)
s_barrier
m16 v[112:115],a[192:195],a[76:79],v[112:115]
r128 a[88:91],v246,0
r128 a[92:95],v246,2048
m16 v[144:147],a[192:195],a[80:83],v[144:147]
s_add_u32 m0, s68, 32800
r128 a[64:67],v247,0
m16 v[116:119],a[196:199],a[76:79],v[116:119]
r128 a[68:71],v247,2048
rtr a[0:1],v248,0
m16 v[148:151],a[196:199],a[80:83],v[148:151]
rtr a[2:3],v248,1024
buffer_load_dwordx4 v244, s[12:15], s60 offen offset:0 lds
m16 v[120:123],a[200:203],a[76:79],v[120:123]
rtr a[4:5],v248,8
m16 v[152:155],a[200:203],a[80:83],v[152:155]
rtr a[6:7],v248,1032
rtr a[8:9],v249,0
m16 v[124:127],a[204:207],a[76:79],v[124:127]
rtr a[10:11],v249,1024
buffer_load_dwordx4 v244, s[12:15], s61 offen offset:1024 lds
m16 v[156:159],a[204:207],a[80:83],v[156:159]
rtr a[12:13],v249,8
rtr a[14:15],v249,1032
m16 v[128:131],a[208:211],a[76:79],v[128:131]
rtr a[16:17],v248,512
m16 v[160:163],a[208:211],a[80:83],v[160:163]
rtr a[18:19],v248,1536
m16 v[132:135],a[212:215],a[76:79],v[132:135]
rtr a[20:21],v248,520
rtr a[22:23],v248,1544
m16 v[164:167],a[212:215],a[80:83],v[164:167]
buffer_load_dwordx4 v244, s[12:15], s62 offen offset:2048 lds
rtr a[24:25],v249,512
m16 v[136:139],a[216:219],a[76:79],v[136:139]
rtr a[26:27],v249,1536
m16 v[168:171],a[216:219],a[80:83],v[168:171]
rtr a[28:29],v249,520
rtr a[30:31],v249,1544
m16 v[140:143],a[220:223],a[76:79],v[140:143]
buffer_load_dwordx4 v244, s[12:15], s63 offen offset:3072 lds
rtr a[32:33],v248,4096
m16 v[172:175],a[220:223],a[80:83],v[172:175]
rtr a[34:35],v248,5120
rtr a[36:37],v248,4104
m16 v[16:19],a[224:227],a[76:79],v[16:19]
rtr a[38:39],v248,5128
v_add_u32 v244, 262144, v244
m16 v[48:51],a[224:227],a[80:83],v[48:51]
rtr a[40:41],v249,4096
m16 v[20:23],a[228:231],a[76:79],v[20:23]
rtr a[42:43],v249,5120
rtr a[44:45],v249,4104
m16 v[52:55],a[228:231],a[80:83],v[52:55]
rtr a[46:47],v249,5128
m16 v[24:27],a[232:235],a[76:79],v[24:27]
rtr a[48:49],v248,4608
rtr a[50:51],v248,5632
m16 v[56:59],a[232:235],a[80:83],v[56:59]
s_add_u32 m0, s100, 42240
rtr a[52:53],v248,4616
m16 v[28:31],a[236:239],a[76:79],v[28:31]
rtr a[54:55],v248,5640
m16 v[60:63],a[236:239],a[80:83],v[60:63]
rtr a[56:57],v249,4608
rtr a[58:59],v249,5632
m16 v[32:35],a[240:243],a[76:79],v[32:35]
s_mov_b32 s28, 24576
rtr a[60:61],v249,4616
m16 v[64:67],a[240:243],a[80:83],v[64:67]
rtr a[62:63],v249,5640
m16 v[36:39],a[244:247],a[76:79],v[36:39]
buffer_load_dwordx4 v14, s[16:19], s28 offen offset:0 nt lds
m16 v[68:71],a[244:247],a[80:83],v[68:71]
m16 v[40:43],a[248:251],a[76:79],v[40:43]
m16 v[72:75],a[248:251],a[80:83],v[72:75]
m16 v[44:47],a[252:255],a[76:79],v[44:47]
m16 v[76:79],a[252:255],a[80:83],v[76:79]
s_waitcnt vmcnt(11) lgkmcnt(0)
s_barrier
m16 v[112:115],a[0:3],a[88:91],v[112:115]
rtr a[192:193],v248,16400
rtr a[194:195],v248,17424
m16 v[144:147],a[0:3],a[92:95],v[144:147]
s_add_u32 m0, s68, 0
rtr a[196:197],v248,16408
m16 v[116:119],a[4:7],a[88:91],v[116:119]
buffer_load_dwordx4 v244, s[12:15], s60 offen offset:0 lds
rtr a[198:199],v248,17432
m16 v[148:151],a[4:7],a[92:95],v[148:151]
rtr a[200:201],v249,16400
buffer_load_dwordx4 v244, s[12:15], s61 offen offset:1024 lds
m16 v[120:123],a[8:11],a[88:91],v[120:123]
rtr a[202:203],v249,17424
rtr a[204:205],v249,16408
m16 v[152:155],a[8:11],a[92:95],v[152:155]
buffer_load_dwordx4 v244, s[12:15], s62 offen offset:2048 lds
rtr a[206:207],v249,17432
m16 v[124:127],a[12:15],a[88:91],v[124:127]
rtr a[208:209],v248,16912
buffer_load_dwordx4 v244, s[12:15], s63 offen offset:3072 lds
m16 v[156:159],a[12:15],a[92:95],v[156:159]
rtr a[210:211],v248,17936
v_add_u32 v244, 262144, v244
m16 v[128:131],a[16:19],a[88:91],v[128:131]
rtr a[212:213],v248,16920
rtr a[214:215],v248,17944
m16 v[160:163],a[16:19],a[92:95],v[160:163]
rtr a[216:217],v249,16912
s_add_u32 m0, s69, 0
m16 v[132:135],a[20:23],a[88:91],v[132:135]
rtr a[218:219],v249,17936
m16 v[164:167],a[20:23],a[92:95],v[164:167]
rtr a[220:221],v249,16920
buffer_load_dwordx4 v245, s[8:11], s64 offen offset:0 lds
m16 v[136:139],a[24:27],a[88:91],v[136:139]
rtr a[222:223],v249,17944
buffer_load_dwordx4 v251, s[8:11], s64 offen offset:1024 lds
m16 v[168:171],a[24:27],a[92:95],v[168:171]
rtr a[224:225],v248,20496
rtr a[226:227],v248,21520
m16 v[140:143],a[28:31],a[88:91],v[140:143]
rtr a[228:229],v248,20504
buffer_load_dwordx4 v245, s[8:11], s65 offen offset:2048 lds
m16 v[172:175],a[28:31],a[92:95],v[172:175]
rtr a[230:231],v248,21528
buffer_load_dwordx4 v251, s[8:11], s65 offen offset:3072 lds
m16 v[16:19],a[32:35],a[88:91],v[16:19]
rtr a[232:233],v249,20496
m16 v[48:51],a[32:35],a[92:95],v[48:51]
rtr a[234:235],v249,21520
rtr a[236:237],v249,20504
m16 v[20:23],a[36:39],a[88:91],v[20:23]
v_add_u32 v245, 128, v245
rtr a[238:239],v249,21528
m16 v[52:55],a[36:39],a[92:95],v[52:55]
v_add_u32 v251, 128, v251
rtr a[240:241],v248,21008
m16 v[24:27],a[40:43],a[88:91],v[24:27]
rtr a[242:243],v248,22032
s_add_u32 m0, s100, 43040
m16 v[56:59],a[40:43],a[92:95],v[56:59]
rtr a[244:245],v248,21016
rtr a[246:247],v248,22040
m16 v[28:31],a[44:47],a[88:91],v[28:31]
rtr a[248:249],v249,21008
s_mov_b32 s28, 24576
m16 v[60:63],a[44:47],a[92:95],v[60:63]
rtr a[250:251],v249,22032
buffer_load_dwordx4 v14, s[16:19], s28 offen offset:256 nt lds
m16 v[32:35],a[48:51],a[88:91],v[32:35]
rtr a[252:253],v249,21016
m16 v[64:67],a[48:51],a[92:95],v[64:67]
rtr a[254:255],v249,22040
s_add_u32 m0, s100, 50688
m16 v[36:39],a[52:55],a[88:91],v[36:39]
s_mov_b32 s28, 16384
m16 v[68:71],a[52:55],a[92:95],v[68:71]
m16 v[40:43],a[56:59],a[88:91],v[40:43]
buffer_load_dwordx4 v14, s[20:23], s28 offen offset:0 nt lds
m16 v[72:75],a[56:59],a[92:95],v[72:75]
m16 v[44:47],a[60:63],a[88:91],v[44:47]
m16 v[76:79],a[60:63],a[92:95],v[76:79]
s_waitcnt vmcnt(11) lgkmcnt(0)
s_barrier
m16 v[112:115],a[192:195],a[64:67],v[112:115]
r128 a[76:79],v246,22528
r128 a[80:83],v246,24576
m16 v[144:147],a[192:195],a[68:71],v[144:147]
s_add_u32 m0, s68, 16400
r128 a[88:91],v247,22528
m16 v[116:119],a[196:199],a[64:67],v[116:119]
r128 a[92:95],v247,24576
rtr a[0:1],v248,32800
m16 v[148:151],a[196:199],a[68:71],v[148:151]
rtr a[2:3],v248,33824
buffer_load_dwordx4 v244, s[12:15], s60 offen offset:0 lds
m16 v[120:123],a[200:203],a[64:67],v[120:123]
rtr a[4:5],v248,32808
m16 v[152:155],a[200:203],a[68:71],v[152:155]
rtr a[6:7],v248,33832
rtr a[8:9],v249,32800
m16 v[124:127],a[204:207],a[64:67],v[124:127]
rtr a[10:11],v249,33824
buffer_load_dwordx4 v244, s[12:15], s61 offen offset:1024 lds
m16 v[156:159],a[204:207],a[68:71],v[156:159]
rtr a[12:13],v249,32808
rtr a[14:15],v249,33832
m16 v[128:131],a[208:211],a[64:67],v[128:131]
rtr a[16:17],v248,33312
m16 v[160:163],a[208:211],a[68:71],v[160:163]
rtr a[18:19],v248,34336
m16 v[132:135],a[212:215],a[64:67],v[132:135]
rtr a[20:21],v248,33320
rtr a[22:23],v248,34344
m16 v[164:167],a[212:215],a[68:71],v[164:167]
buffer_load_dwordx4 v244, s[12:15], s62 offen offset:2048 lds
rtr a[24:25],v249,33312
m16 v[136:139],a[216:219],a[64:67],v[136:139]
rtr a[26:27],v249,34336
m16 v[168:171],a[216:219],a[68:71],v[168:171]
rtr a[28:29],v249,33320
rtr a[30:31],v249,34344
m16 v[140:143],a[220:223],a[64:67],v[140:143]
buffer_load_dwordx4 v244, s[12:15], s63 offen offset:3072 lds
rtr a[32:33],v248,36896
m16 v[172:175],a[220:223],a[68:71],v[172:175]
rtr a[34:35],v248,37920
rtr a[36:37],v248,36904
m16 v[16:19],a[224:227],a[64:67],v[16:19]
rtr a[38:39],v248,37928
v_add_u32 v244, 262144, v244
m16 v[48:51],a[224:227],a[68:71],v[48:51]
rtr a[40:41],v249,36896
m16 v[20:23],a[228:231],a[64:67],v[20:23]
rtr a[42:43],v249,37920
rtr a[44:45],v249,36904
m16 v[52:55],a[228:231],a[68:71],v[52:55]
rtr a[46:47],v249,37928
m16 v[24:27],a[232:235],a[64:67],v[24:27]
rtr a[48:49],v248,37408
rtr a[50:51],v248,38432
m16 v[56:59],a[232:235],a[68:71],v[56:59]
s_add_u32 m0, s100, 51488
rtr a[52:53],v248,37416
m16 v[28:31],a[236:239],a[64:67],v[28:31]
rtr a[54:55],v248,38440
m16 v[60:63],a[236:239],a[68:71],v[60:63]
rtr a[56:57],v249,37408
rtr a[58:59],v249,38432
m16 v[32:35],a[240:243],a[64:67],v[32:35]
s_mov_b32 s28, 16384
rtr a[60:61],v249,37416
m16 v[64:67],a[240:243],a[68:71],v[64:67]
rtr a[62:63],v249,38440
m16 v[36:39],a[244:247],a[64:67],v[36:39]
buffer_load_dwordx4 v14, s[20:23], s28 offen offset:256 nt lds
m16 v[68:71],a[244:247],a[68:71],v[68:71]
m16 v[40:43],a[248:251],a[64:67],v[40:43]
m16 v[72:75],a[248:251],a[68:71],v[72:75]
m16 v[44:47],a[252:255],a[64:67],v[44:47]
m16 v[76:79],a[252:255],a[68:71],v[76:79]
s_waitcnt vmcnt(11) lgkmcnt(0)
s_barrier
m16 v[112:115],a[0:3],a[76:79],v[112:115]
rtr a[192:193],v248,0
rtr a[194:195],v248,1024
m16 v[144:147],a[0:3],a[80:83],v[144:147]
s_add_u32 m0, s68, 32800
rtr a[196:197],v248,8
m16 v[116:119],a[4:7],a[76:79],v[116:119]
buffer_load_dwordx4 v244, s[12:15], s60 offen offset:0 lds
rtr a[198:199],v248,1032
m16 v[148:151],a[4:7],a[80:83],v[148:151]
buffer_load_dwordx4 v244, s[12:15], s61 offen offset:1024 lds
rtr a[200:201],v249,0
m16 v[120:123],a[8:11],a[76:79],v[120:123]
rtr a[202:203],v249,1024
rtr a[204:205],v249,8
m16 v[152:155],a[8:11],a[80:83],v[152:155]
buffer_load_dwordx4 v244, s[12:15], s62 offen offset:2048 lds
rtr a[206:207],v249,1032
m16 v[124:127],a[12:15],a[76:79],v[124:127]
buffer_load_dwordx4 v244, s[12:15], s63 offen offset:3072 lds
rtr a[208:209],v248,512
m16 v[156:159],a[12:15],a[80:83],v[156:159]
rtr a[210:211],v248,1536
v_add_u32 v244, 262144, v244
m16 v[128:131],a[16:19],a[76:79],v[128:131]
rtr a[212:213],v248,520
rtr a[214:215],v248,1544
m16 v[160:163],a[16:19],a[80:83],v[160:163]
s_add_u32 m0, s69, 22528
rtr a[216:217],v249,512
m16 v[132:135],a[20:23],a[76:79],v[132:135]
rtr a[218:219],v249,1536
buffer_load_dwordx4 v245, s[8:11], s64 offen offset:0 lds
m16 v[164:167],a[20:23],a[80:83],v[164:167]
rtr a[220:221],v249,520
buffer_load_dwordx4 v251, s[8:11], s64 offen offset:1024 lds
m16 v[136:139],a[24:27],a[76:79],v[136:139]
rtr a[222:223],v249,1544
buffer_load_dwordx4 v245, s[8:11], s65 offen offset:2048 lds
m16 v[168:171],a[24:27],a[80:83],v[168:171]
rtr a[224:225],v248,4096
rtr a[226:227],v248,5120
m16 v[140:143],a[28:31],a[76:79],v[140:143]
rtr a[228:229],v248,4104
buffer_load_dwordx4 v251, s[8:11], s65 offen offset:3072 lds
m16 v[172:175],a[28:31],a[80:83],v[172:175]
rtr a[230:231],v248,5128
v_add_u32 v245, 128, v245
m16 v[16:19],a[32:35],a[76:79],v[16:19]
rtr a[232:233],v249,4096
m16 v[48:51],a[32:35],a[80:83],v[48:51]
rtr a[234:235],v249,5120
rtr a[236:237],v249,4104
m16 v[20:23],a[36:39],a[76:79],v[20:23]
v_add_u32 v251, 128, v251
rtr a[238:239],v249,5128
m16 v[52:55],a[36:39],a[80:83],v[52:55]
s_add_u32 m0, s100, 59136
rtr a[240:241],v248,4608
m16 v[24:27],a[40:43],a[76:79],v[24:27]
rtr a[242:243],v248,5632
s_mov_b32 s28, 24576
m16 v[56:59],a[40:43],a[80:83],v[56:59]
rtr a[244:245],v248,4616
rtr a[246:247],v248,5640
m16 v[28:31],a[44:47],a[76:79],v[28:31]
buffer_load_dwordx4 v14, s[20:23], s28 offen offset:0 nt lds
rtr a[248:249],v249,4608
m16 v[60:63],a[44:47],a[80:83],v[60:63]
s_add_u32 m0, s100, 59936
rtr a[250:251],v249,5632
m16 v[32:35],a[48:51],a[76:79],v[32:35]
rtr a[252:253],v249,4616
s_mov_b32 s28, 24576
m16 v[64:67],a[48:51],a[80:83],v[64:67]
rtr a[254:255],v249,5640
buffer_load_dwordx4 v14, s[20:23], s28 offen offset:256 nt lds
m16 v[36:39],a[52:55],a[76:79],v[36:39]
m16 v[68:71],a[52:55],a[80:83],v[68:71]
buffer_load_dword v255, v250, s[56:59], 0 offen
m16 v[40:43],a[56:59],a[76:79],v[40:43]
v_add_u32 v250, 640, v250
m16 v[72:75],a[56:59],a[80:83],v[72:75]
m16 v[44:47],a[60:63],a[76:79],v[44:47]
m16 v[76:79],a[60:63],a[80:83],v[76:79]
s_waitcnt vmcnt(12) lgkmcnt(0)
s_barrier
m16 v[112:115],a[192:195],a[88:91],v[112:115]
r128 a[64:67],v246,0
r128 a[68:71],v246,2048
m16 v[144:147],a[192:195],a[92:95],v[144:147]
s_add_u32 m0, s68, 0
r128 a[76:79],v247,0
m16 v[116:119],a[196:199],a[88:91],v[116:119]
r128 a[80:83],v247,2048
rtr a[0:1],v248,16400
m16 v[148:151],a[196:199],a[92:95],v[148:151]
buffer_load_dwordx4 v244, s[12:15], s60 offen offset:0 lds
rtr a[2:3],v248,17424
m16 v[120:123],a[200:203],a[88:91],v[120:123]
rtr a[4:5],v248,16408
m16 v[152:155],a[200:203],a[92:95],v[152:155]
rtr a[6:7],v248,17432
rtr a[8:9],v249,16400
m16 v[124:127],a[204:207],a[88:91],v[124:127]
buffer_load_dwordx4 v244, s[12:15], s61 offen offset:1024 lds
rtr a[10:11],v249,17424
m16 v[156:159],a[204:207],a[92:95],v[156:159]
rtr a[12:13],v249,16408
rtr a[14:15],v249,17432
m16 v[128:131],a[208:211],a[88:91],v[128:131]
buffer_load_dwordx4 v244, s[12:15], s62 offen offset:2048 lds
rtr a[16:17],v248,16912
m16 v[160:163],a[208:211],a[92:95],v[160:163]
rtr a[18:19],v248,17936
m16 v[132:135],a[212:215],a[88:91],v[132:135]
rtr a[20:21],v248,16920
rtr a[22:23],v248,17944
m16 v[164:167],a[212:215],a[92:95],v[164:167]
buffer_load_dwordx4 v244, s[12:15], s63 offen offset:3072 lds
rtr a[24:25],v249,16912
m16 v[136:139],a[216:219],a[88:91],v[136:139]
rtr a[26:27],v249,17936
v_add_u32 v244, 262144, v244
m16 v[168:171],a[216:219],a[92:95],v[168:171]
rtr a[28:29],v249,16920
rtr a[30:31],v249,17944
m16 v[140:143],a[220:223],a[88:91],v[140:143]
rtr a[32:33],v248,20496
m16 v[172:175],a[220:223],a[92:95],v[172:175]
rtr a[34:35],v248,21520
rtr a[36:37],v248,20504
m16 v[16:19],a[224:227],a[88:91],v[16:19]
s_mov_b32 s28, 32768
rtr a[38:39],v248,21528
m16 v[48:51],a[224:227],a[92:95],v[48:51]
rtr a[40:41],v249,20496
buffer_load_dwordx4 v[208:211], v14, s[16:19], s28 offen offset:0 nt
m16 v[20:23],a[228:231],a[88:91],v[20:23]
rtr a[42:43],v249,21520
rtr a[44:45],v249,20504
m16 v[52:55],a[228:231],a[92:95],v[52:55]
rtr a[46:47],v249,21528
m16 v[24:27],a[232:235],a[88:91],v[24:27]
rtr a[48:49],v248,21008
rtr a[50:51],v248,22032
m16 v[56:59],a[232:235],a[92:95],v[56:59]
s_mov_b32 s28, 32768
rtr a[52:53],v248,21016
m16 v[28:31],a[236:239],a[88:91],v[28:31]
rtr a[54:55],v248,22040
buffer_load_dwordx4 v[212:215], v14, s[16:19], s28 offen offset:256 nt
m16 v[60:63],a[236:239],a[92:95],v[60:63]
rtr a[56:57],v249,21008
rtr a[58:59],v249,22032
m16 v[32:35],a[240:243],a[88:91],v[32:35]
rtr a[60:61],v249,21016
m16 v[64:67],a[240:243],a[92:95],v[64:67]
rtr a[62:63],v249,22040
buffer_load_dword v255, v250, s[56:59], 0 offen
m16 v[36:39],a[244:247],a[88:91],v[36:39]
m16 v[68:71],a[244:247],a[92:95],v[68:71]
v_add_u32 v250, 640, v250
m16 v[40:43],a[248:251],a[88:91],v[40:43]
m16 v[72:75],a[248:251],a[92:95],v[72:75]
m16 v[44:47],a[252:255],a[88:91],v[44:47]
m16 v[76:79],a[252:255],a[92:95],v[76:79]
s_waitcnt vmcnt(14) lgkmcnt(0)
s_barrier
m16 v[112:115],a[0:3],a[64:67],v[112:115]
rtr a[192:193],v248,32800
rtr a[194:195],v248,33824
m16 v[144:147],a[0:3],a[68:71],v[144:147]
s_add_u32 m0, s68, 16400
rtr a[196:197],v248,32808
m16 v[116:119],a[4:7],a[64:67],v[116:119]
buffer_load_dwordx4 v244, s[12:15], s60 offen offset:0 lds
rtr a[198:199],v248,33832
m16 v[148:151],a[4:7],a[68:71],v[148:151]
rtr a[200:201],v249,32800
buffer_load_dwordx4 v244, s[12:15], s61 offen offset:1024 lds
m16 v[120:123],a[8:11],a[64:67],v[120:123]
rtr a[202:203],v249,33824
rtr a[204:205],v249,32808
m16 v[152:155],a[8:11],a[68:71],v[152:155]
rtr a[206:207],v249,33832
buffer_load_dwordx4 v244, s[12:15], s62 offen offset:2048 lds
m16 v[124:127],a[12:15],a[64:67],v[124:127]
rtr a[208:209],v248,33312
m16 v[156:159],a[12:15],a[68:71],v[156:159]
rtr a[210:211],v248,34336
buffer_load_dwordx4 v244, s[12:15], s63 offen offset:3072 lds
m16 v[128:131],a[16:19],a[64:67],v[128:131]
rtr a[212:213],v248,33320
rtr a[214:215],v248,34344
m16 v[160:163],a[16:19],a[68:71],v[160:163]
v_add_u32 v244, 262144, v244
rtr a[216:217],v249,33312
m16 v[132:135],a[20:23],a[64:67],v[132:135]
rtr a[218:219],v249,34336
s_add_u32 m0, s69, 0
m16 v[164:167],a[20:23],a[68:71],v[164:167]
rtr a[220:221],v249,33320
m16 v[136:139],a[24:27],a[64:67],v[136:139]
rtr a[222:223],v249,34344
buffer_load_dwordx4 v245, s[8:11], s64 offen offset:0 lds
m16 v[168:171],a[24:27],a[68:71],v[168:171]
rtr a[224:225],v248,36896
rtr a[226:227],v248,37920
m16 v[140:143],a[28:31],a[64:67],v[140:143]
rtr a[228:229],v248,36904
buffer_load_dwordx4 v251, s[8:11], s64 offen offset:1024 lds
m16 v[172:175],a[28:31],a[68:71],v[172:175]
rtr a[230:231],v248,37928
buffer_load_dwordx4 v245, s[8:11], s65 offen offset:2048 lds
m16 v[16:19],a[32:35],a[64:67],v[16:19]
rtr a[232:233],v249,36896
m16 v[48:51],a[32:35],a[68:71],v[48:51]
rtr a[234:235],v249,37920
rtr a[236:237],v249,36904
m16 v[20:23],a[36:39],a[64:67],v[20:23]
buffer_load_dwordx4 v251, s[8:11], s65 offen offset:3072 lds
rtr a[238:239],v249,37928
m16 v[52:55],a[36:39],a[68:71],v[52:55]
rtr a[240:241],v248,37408
v_add_u32 v245, 128, v245
m16 v[24:27],a[40:43],a[64:67],v[24:27]
rtr a[242:243],v248,38432
m16 v[56:59],a[40:43],a[68:71],v[56:59]
rtr a[244:245],v248,37416
rtr a[246:247],v248,38440
m16 v[28:31],a[44:47],a[64:67],v[28:31]
v_add_u32 v251, 128, v251
rtr a[248:249],v249,37408
m16 v[60:63],a[44:47],a[68:71],v[60:63]
s_mov_b32 s28, 40960
rtr a[250:251],v249,38432
m16 v[32:35],a[48:51],a[64:67],v[32:35]
rtr a[252:253],v249,37416
buffer_load_dwordx4 v[216:219], v14, s[16:19], s28 offen offset:0 nt
m16 v[64:67],a[48:51],a[68:71],v[64:67]
rtr a[254:255],v249,38440
m16 v[36:39],a[52:55],a[64:67],v[36:39]
buffer_load_dword v255, v250, s[56:59], 0 offen
m16 v[68:71],a[52:55],a[68:71],v[68:71]
m16 v[40:43],a[56:59],a[64:67],v[40:43]
v_add_u32 v250, 640, v250
m16 v[72:75],a[56:59],a[68:71],v[72:75]
m16 v[44:47],a[60:63],a[64:67],v[44:47]
m16 v[76:79],a[60:63],a[68:71],v[76:79]
s_waitcnt vmcnt(13) lgkmcnt(0)
s_barrier
m16 v[112:115],a[192:195],a[76:79],v[112:115]
r128 a[88:91],v246,22528
r128 a[92:95],v246,24576
m16 v[144:147],a[192:195],a[80:83],v[144:147]
s_add_u32 m0, s68, 32800
r128 a[64:67],v247,22528
m16 v[116:119],a[196:199],a[76:79],v[116:119]
r128 a[68:71],v247,24576
rtr a[0:1],v248,0
m16 v[148:151],a[196:199],a[80:83],v[148:151]
buffer_load_dwordx4 v244, s[12:15], s60 offen offset:0 lds
rtr a[2:3],v248,1024
m16 v[120:123],a[200:203],a[76:79],v[120:123]
rtr a[4:5],v248,8
m16 v[152:155],a[200:203],a[80:83],v[152:155]
rtr a[6:7],v248,1032
rtr a[8:9],v249,0
m16 v[124:127],a[204:207],a[76:79],v[124:127]
buffer_load_dwordx4 v244, s[12:15], s61 offen offset:1024 lds
rtr a[10:11],v249,1024
m16 v[156:159],a[204:207],a[80:83],v[156:159]
rtr a[12:13],v249,8
rtr a[14:15],v249,1032
m16 v[128:131],a[208:211],a[76:79],v[128:131]
buffer_load_dwordx4 v244, s[12:15], s62 offen offset:2048 lds
rtr a[16:17],v248,512
m16 v[160:163],a[208:211],a[80:83],v[160:163]
rtr a[18:19],v248,1536
m16 v[132:135],a[212:215],a[76:79],v[132:135]
rtr a[20:21],v248,520
rtr a[22:23],v248,1544
m16 v[164:167],a[212:215],a[80:83],v[164:167]
buffer_load_dwordx4 v244, s[12:15], s63 offen offset:3072 lds
rtr a[24:25],v249,512
m16 v[136:139],a[216:219],a[76:79],v[136:139]
rtr a[26:27],v249,1536
v_add_u32 v244, 262144, v244
m16 v[168:171],a[216:219],a[80:83],v[168:171]
rtr a[28:29],v249,520
rtr a[30:31],v249,1544
m16 v[140:143],a[220:223],a[76:79],v[140:143]
rtr a[32:33],v248,4096
m16 v[172:175],a[220:223],a[80:83],v[172:175]
rtr a[34:35],v248,5120
rtr a[36:37],v248,4104
m16 v[16:19],a[224:227],a[76:79],v[16:19]
s_mov_b32 s28, 40960
rtr a[38:39],v248,5128
m16 v[48:51],a[224:227],a[80:83],v[48:51]
rtr a[40:41],v249,4096
buffer_load_dwordx4 v[220:223], v14, s[16:19], s28 offen offset:256 nt
m16 v[20:23],a[228:231],a[76:79],v[20:23]
rtr a[42:43],v249,5120
rtr a[44:45],v249,4104
m16 v[52:55],a[228:231],a[80:83],v[52:55]
rtr a[46:47],v249,5128
m16 v[24:27],a[232:235],a[76:79],v[24:27]
rtr a[48:49],v248,4608
rtr a[50:51],v248,5632
m16 v[56:59],a[232:235],a[80:83],v[56:59]
s_mov_b32 s28, 32768
rtr a[52:53],v248,4616
m16 v[28:31],a[236:239],a[76:79],v[28:31]
rtr a[54:55],v248,5640
buffer_load_dwordx4 v[224:227], v14, s[20:23], s28 offen offset:0 nt
m16 v[60:63],a[236:239],a[80:83],v[60:63]
rtr a[56:57],v249,4608
rtr a[58:59],v249,5632
m16 v[32:35],a[240:243],a[76:79],v[32:35]
rtr a[60:61],v249,4616
m16 v[64:67],a[240:243],a[80:83],v[64:67]
rtr a[62:63],v249,5640
buffer_load_dword v255, v250, s[56:59], 0 offen
m16 v[36:39],a[244:247],a[76:79],v[36:39]
m16 v[68:71],a[244:247],a[80:83],v[68:71]
v_add_u32 v250, 640, v250
m16 v[40:43],a[248:251],a[76:79],v[40:43]
m16 v[72:75],a[248:251],a[80:83],v[72:75]
m16 v[44:47],a[252:255],a[76:79],v[44:47]
m16 v[76:79],a[252:255],a[80:83],v[76:79]
s_waitcnt vmcnt(13) lgkmcnt(0)
s_barrier
m16 v[112:115],a[0:3],a[88:91],v[112:115]
rtr a[192:193],v248,16400
rtr a[194:195],v248,17424
m16 v[144:147],a[0:3],a[92:95],v[144:147]
s_add_u32 m0, s68, 0
rtr a[196:197],v248,16408
m16 v[116:119],a[4:7],a[88:91],v[116:119]
buffer_load_dwordx4 v244, s[12:15], s60 offen offset:0 lds
rtr a[198:199],v248,17432
m16 v[148:151],a[4:7],a[92:95],v[148:151]
rtr a[200:201],v249,16400
buffer_load_dwordx4 v244, s[12:15], s61 offen offset:1024 lds
m16 v[120:123],a[8:11],a[88:91],v[120:123]
rtr a[202:203],v249,17424
rtr a[204:205],v249,16408
m16 v[152:155],a[8:11],a[92:95],v[152:155]
rtr a[206:207],v249,17432
buffer_load_dwordx4 v244, s[12:15], s62 offen offset:2048 lds
m16 v[124:127],a[12:15],a[88:91],v[124:127]
rtr a[208:209],v248,16912
m16 v[156:159],a[12:15],a[92:95],v[156:159]
rtr a[210:211],v248,17936
buffer_load_dwordx4 v244, s[12:15], s63 offen offset:3072 lds
m16 v[128:131],a[16:19],a[88:91],v[128:131]
rtr a[212:213],v248,16920
rtr a[214:215],v248,17944
m16 v[160:163],a[16:19],a[92:95],v[160:163]
v_add_u32 v244, 262144, v244
rtr a[216:217],v249,16912
m16 v[132:135],a[20:23],a[88:91],v[132:135]
rtr a[218:219],v249,17936
s_add_u32 m0, s69, 22528
m16 v[164:167],a[20:23],a[92:95],v[164:167]
rtr a[220:221],v249,16920
m16 v[136:139],a[24:27],a[88:91],v[136:139]
rtr a[222:223],v249,17944
buffer_load_dwordx4 v245, s[8:11], s64 offen offset:0 lds
m16 v[168:171],a[24:27],a[92:95],v[168:171]
rtr a[224:225],v248,20496
rtr a[226:227],v248,21520
m16 v[140:143],a[28:31],a[88:91],v[140:143]
rtr a[228:229],v248,20504
buffer_load_dwordx4 v251, s[8:11], s64 offen offset:1024 lds
m16 v[172:175],a[28:31],a[92:95],v[172:175]
rtr a[230:231],v248,21528
buffer_load_dwordx4 v245, s[8:11], s65 offen offset:2048 lds
m16 v[16:19],a[32:35],a[88:91],v[16:19]
rtr a[232:233],v249,20496
m16 v[48:51],a[32:35],a[92:95],v[48:51]
rtr a[234:235],v249,21520
rtr a[236:237],v249,20504
m16 v[20:23],a[36:39],a[88:91],v[20:23]
buffer_load_dwordx4 v251, s[8:11], s65 offen offset:3072 lds
rtr a[238:239],v249,21528
m16 v[52:55],a[36:39],a[92:95],v[52:55]
rtr a[240:241],v248,21008
v_add_u32 v245, 128, v245
m16 v[24:27],a[40:43],a[88:91],v[24:27]
rtr a[242:243],v248,22032
m16 v[56:59],a[40:43],a[92:95],v[56:59]
rtr a[244:245],v248,21016
rtr a[246:247],v248,22040
m16 v[28:31],a[44:47],a[88:91],v[28:31]
v_add_u32 v251, 128, v251
rtr a[248:249],v249,21008
m16 v[60:63],a[44:47],a[92:95],v[60:63]
s_mov_b32 s28, 32768
rtr a[250:251],v249,22032
m16 v[32:35],a[48:51],a[88:91],v[32:35]
rtr a[252:253],v249,21016
buffer_load_dwordx4 v[228:231], v14, s[20:23], s28 offen offset:256 nt
m16 v[64:67],a[48:51],a[92:95],v[64:67]
rtr a[254:255],v249,22040
m16 v[36:39],a[52:55],a[88:91],v[36:39]
buffer_load_dword v255, v250, s[56:59], 0 offen
m16 v[68:71],a[52:55],a[92:95],v[68:71]
m16 v[40:43],a[56:59],a[88:91],v[40:43]
v_add_u32 v250, 640, v250
m16 v[72:75],a[56:59],a[92:95],v[72:75]
m16 v[44:47],a[60:63],a[88:91],v[44:47]
m16 v[76:79],a[60:63],a[92:95],v[76:79]
s_waitcnt vmcnt(13) lgkmcnt(0)
s_barrier
m16 v[112:115],a[192:195],a[64:67],v[112:115]
r128 a[76:79],v246,0
r128 a[80:83],v246,2048
m16 v[144:147],a[192:195],a[68:71],v[144:147]
s_add_u32 m0, s68, 16400
r128 a[88:91],v247,0
m16 v[116:119],a[196:199],a[64:67],v[116:119]
r128 a[92:95],v247,2048
rtr a[0:1],v248,32800
m16 v[148:151],a[196:199],a[68:71],v[148:151]
buffer_load_dwordx4 v244, s[12:15], s60 offen offset:0 lds
rtr a[2:3],v248,33824
m16 v[120:123],a[200:203],a[64:67],v[120:123]
rtr a[4:5],v248,32808
m16 v[152:155],a[200:203],a[68:71],v[152:155]
rtr a[6:7],v248,33832
rtr a[8:9],v249,32800
m16 v[124:127],a[204:207],a[64:67],v[124:127]
buffer_load_dwordx4 v244, s[12:15], s61 offen offset:1024 lds
rtr a[10:11],v249,33824
m16 v[156:159],a[204:207],a[68:71],v[156:159]
rtr a[12:13],v249,32808
rtr a[14:15],v249,33832
m16 v[128:131],a[208:211],a[64:67],v[128:131]
buffer_load_dwordx4 v244, s[12:15], s62 offen offset:2048 lds
rtr a[16:17],v248,33312
m16 v[160:163],a[208:211],a[68:71],v[160:163]
rtr a[18:19],v248,34336
m16 v[132:135],a[212:215],a[64:67],v[132:135]
rtr a[20:21],v248,33320
rtr a[22:23],v248,34344
m16 v[164:167],a[212:215],a[68:71],v[164:167]
buffer_load_dwordx4 v244, s[12:15], s63 offen offset:3072 lds
rtr a[24:25],v249,33312
m16 v[136:139],a[216:219],a[64:67],v[136:139]
rtr a[26:27],v249,34336
v_add_u32 v244, 262144, v244
m16 v[168:171],a[216:219],a[68:71],v[168:171]
rtr a[28:29],v249,33320
rtr a[30:31],v249,34344
m16 v[140:143],a[220:223],a[64:67],v[140:143]
rtr a[32:33],v248,36896
m16 v[172:175],a[220:223],a[68:71],v[172:175]
rtr a[34:35],v248,37920
rtr a[36:37],v248,36904
m16 v[16:19],a[224:227],a[64:67],v[16:19]
s_mov_b32 s28, 40960
rtr a[38:39],v248,37928
m16 v[48:51],a[224:227],a[68:71],v[48:51]
rtr a[40:41],v249,36896
buffer_load_dwordx4 v[232:235], v14, s[20:23], s28 offen offset:0 nt
m16 v[20:23],a[228:231],a[64:67],v[20:23]
rtr a[42:43],v249,37920
rtr a[44:45],v249,36904
m16 v[52:55],a[228:231],a[68:71],v[52:55]
rtr a[46:47],v249,37928
m16 v[24:27],a[232:235],a[64:67],v[24:27]
rtr a[48:49],v248,37408
rtr a[50:51],v248,38432
m16 v[56:59],a[232:235],a[68:71],v[56:59]
s_mov_b32 s28, 40960
rtr a[52:53],v248,37416
m16 v[28:31],a[236:239],a[64:67],v[28:31]
rtr a[54:55],v248,38440
buffer_load_dwordx4 v[236:239], v14, s[20:23], s28 offen offset:256 nt
m16 v[60:63],a[236:239],a[68:71],v[60:63]
rtr a[56:57],v249,37408
rtr a[58:59],v249,38432
m16 v[32:35],a[240:243],a[64:67],v[32:35]
rtr a[60:61],v249,37416
m16 v[64:67],a[240:243],a[68:71],v[64:67]
rtr a[62:63],v249,38440
buffer_load_dword v255, v250, s[56:59], 0 offen
m16 v[36:39],a[244:247],a[64:67],v[36:39]
m16 v[68:71],a[244:247],a[68:71],v[68:71]
v_add_u32 v250, 640, v250
m16 v[40:43],a[248:251],a[64:67],v[40:43]
m16 v[72:75],a[248:251],a[68:71],v[72:75]
m16 v[44:47],a[252:255],a[64:67],v[44:47]
m16 v[76:79],a[252:255],a[68:71],v[76:79]
s_waitcnt vmcnt(13) lgkmcnt(0)
s_barrier
m16 v[112:115],a[0:3],a[76:79],v[112:115]
rtr a[192:193],v248,0
rtr a[194:195],v248,1024
m16 v[144:147],a[0:3],a[80:83],v[144:147]
s_add_u32 m0, s68, 32800
rtr a[196:197],v248,8
m16 v[116:119],a[4:7],a[76:79],v[116:119]
buffer_load_dwordx4 v244, s[12:15], s60 offen offset:0 lds
rtr a[198:199],v248,1032
m16 v[148:151],a[4:7],a[80:83],v[148:151]
rtr a[200:201],v249,0
buffer_load_dwordx4 v244, s[12:15], s61 offen offset:1024 lds
m16 v[120:123],a[8:11],a[76:79],v[120:123]
rtr a[202:203],v249,1024
rtr a[204:205],v249,8
m16 v[152:155],a[8:11],a[80:83],v[152:155]
rtr a[206:207],v249,1032
buffer_load_dwordx4 v244, s[12:15], s62 offen offset:2048 lds
m16 v[124:127],a[12:15],a[76:79],v[124:127]
rtr a[208:209],v248,512
m16 v[156:159],a[12:15],a[80:83],v[156:159]
rtr a[210:211],v248,1536
buffer_load_dwordx4 v244, s[12:15], s63 offen offset:3072 lds
m16 v[128:131],a[16:19],a[76:79],v[128:131]
rtr a[212:213],v248,520
rtr a[214:215],v248,1544
m16 v[160:163],a[16:19],a[80:83],v[160:163]
v_add_u32 v244, 262144, v244
rtr a[216:217],v249,512
m16 v[132:135],a[20:23],a[76:79],v[132:135]
rtr a[218:219],v249,1536
s_add_u32 m0, s69, 0
m16 v[164:167],a[20:23],a[80:83],v[164:167]
rtr a[220:221],v249,520
m16 v[136:139],a[24:27],a[76:79],v[136:139]
rtr a[222:223],v249,1544
buffer_load_dwordx4 v245, s[8:11], s64 offen offset:0 lds
m16 v[168:171],a[24:27],a[80:83],v[168:171]
rtr a[224:225],v248,4096
rtr a[226:227],v248,5120
m16 v[140:143],a[28:31],a[76:79],v[140:143]
rtr a[228:229],v248,4104
buffer_load_dwordx4 v251, s[8:11], s64 offen offset:1024 lds
m16 v[172:175],a[28:31],a[80:83],v[172:175]
rtr a[230:231],v248,5128
buffer_load_dwordx4 v245, s[8:11], s65 offen offset:2048 lds
m16 v[16:19],a[32:35],a[76:79],v[16:19]
rtr a[232:233],v249,4096
m16 v[48:51],a[32:35],a[80:83],v[48:51]
rtr a[234:235],v249,5120
rtr a[236:237],v249,4104
m16 v[20:23],a[36:39],a[76:79],v[20:23]
buffer_load_dwordx4 v251, s[8:11], s65 offen offset:3072 lds
rtr a[238:239],v249,5128
m16 v[52:55],a[36:39],a[80:83],v[52:55]
rtr a[240:241],v248,4608
v_add_u32 v245, 128, v245
m16 v[24:27],a[40:43],a[76:79],v[24:27]
rtr a[242:243],v248,5632
m16 v[56:59],a[40:43],a[80:83],v[56:59]
rtr a[244:245],v248,4616
rtr a[246:247],v248,5640
m16 v[28:31],a[44:47],a[76:79],v[28:31]
v_add_u32 v251, 128, v251
rtr a[248:249],v249,4608
m16 v[60:63],a[44:47],a[80:83],v[60:63]
s_mov_b32 s28, 81920
rtr a[250:251],v249,5632
m16 v[32:35],a[48:51],a[76:79],v[32:35]
rtr a[252:253],v249,4616
buffer_load_dwordx4 a[96:99], v14, s[16:19], s28 offen offset:0 nt
m16 v[64:67],a[48:51],a[80:83],v[64:67]
rtr a[254:255],v249,5640
m16 v[36:39],a[52:55],a[76:79],v[36:39]
buffer_load_dword v255, v250, s[56:59], 0 offen
m16 v[68:71],a[52:55],a[80:83],v[68:71]
m16 v[40:43],a[56:59],a[76:79],v[40:43]
v_add_u32 v250, 640, v250
m16 v[72:75],a[56:59],a[80:83],v[72:75]
m16 v[44:47],a[60:63],a[76:79],v[44:47]
m16 v[76:79],a[60:63],a[80:83],v[76:79]
s_waitcnt vmcnt(13) lgkmcnt(0)
s_barrier
m16 v[112:115],a[192:195],a[88:91],v[112:115]
r128 a[64:67],v246,22528
r128 a[68:71],v246,24576
m16 v[144:147],a[192:195],a[92:95],v[144:147]
s_add_u32 m0, s68, 0
r128 a[76:79],v247,22528
m16 v[116:119],a[196:199],a[88:91],v[116:119]
r128 a[80:83],v247,24576
rtr a[0:1],v248,16400
m16 v[148:151],a[196:199],a[92:95],v[148:151]
buffer_load_dwordx4 v244, s[12:15], s60 offen offset:0 lds
rtr a[2:3],v248,17424
m16 v[120:123],a[200:203],a[88:91],v[120:123]
rtr a[4:5],v248,16408
m16 v[152:155],a[200:203],a[92:95],v[152:155]
rtr a[6:7],v248,17432
rtr a[8:9],v249,16400
m16 v[124:127],a[204:207],a[88:91],v[124:127]
buffer_load_dwordx4 v244, s[12:15], s61 offen offset:1024 lds
rtr a[10:11],v249,17424
m16 v[156:159],a[204:207],a[92:95],v[156:159]
rtr a[12:13],v249,16408
rtr a[14:15],v249,17432
m16 v[128:131],a[208:211],a[88:91],v[128:131]
buffer_load_dwordx4 v244, s[12:15], s62 offen offset:2048 lds
rtr a[16:17],v248,16912
m16 v[160:163],a[208:211],a[92:95],v[160:163]
rtr a[18:19],v248,17936
m16 v[132:135],a[212:215],a[88:91],v[132:135]
rtr a[20:21],v248,16920
rtr a[22:23],v248,17944
m16 v[164:167],a[212:215],a[92:95],v[164:167]
buffer_load_dwordx4 v244, s[12:15], s63 offen offset:3072 lds
rtr a[24:25],v249,16912
m16 v[136:139],a[216:219],a[88:91],v[136:139]
rtr a[26:27],v249,17936
v_add_u32 v244, 262144, v244
m16 v[168:171],a[216:219],a[92:95],v[168:171]
rtr a[28:29],v249,16920
rtr a[30:31],v249,17944
m16 v[140:143],a[220:223],a[88:91],v[140:143]
rtr a[32:33],v248,20496
m16 v[172:175],a[220:223],a[92:95],v[172:175]
rtr a[34:35],v248,21520
rtr a[36:37],v248,20504
m16 v[16:19],a[224:227],a[88:91],v[16:19]
s_mov_b32 s28, 81920
rtr a[38:39],v248,21528
m16 v[48:51],a[224:227],a[92:95],v[48:51]
rtr a[40:41],v249,20496
buffer_load_dwordx4 a[100:103], v14, s[16:19], s28 offen offset:256 nt
m16 v[20:23],a[228:231],a[88:91],v[20:23]
rtr a[42:43],v249,21520
rtr a[44:45],v249,20504
m16 v[52:55],a[228:231],a[92:95],v[52:55]
rtr a[46:47],v249,21528
m16 v[24:27],a[232:235],a[88:91],v[24:27]
rtr a[48:49],v248,21008
rtr a[50:51],v248,22032
m16 v[56:59],a[232:235],a[92:95],v[56:59]
s_mov_b32 s28, 90112
rtr a[52:53],v248,21016
m16 v[28:31],a[236:239],a[88:91],v[28:31]
rtr a[54:55],v248,22040
buffer_load_dwordx4 a[104:107], v14, s[16:19], s28 offen offset:0 nt
m16 v[60:63],a[236:239],a[92:95],v[60:63]
rtr a[56:57],v249,21008
rtr a[58:59],v249,22032
m16 v[32:35],a[240:243],a[88:91],v[32:35]
rtr a[60:61],v249,21016
m16 v[64:67],a[240:243],a[92:95],v[64:67]
rtr a[62:63],v249,22040
buffer_load_dword v255, v250, s[56:59], 0 offen
m16 v[36:39],a[244:247],a[88:91],v[36:39]
m16 v[68:71],a[244:247],a[92:95],v[68:71]
v_add_u32 v250, 640, v250
m16 v[40:43],a[248:251],a[88:91],v[40:43]
m16 v[72:75],a[248:251],a[92:95],v[72:75]
m16 v[44:47],a[252:255],a[88:91],v[44:47]
m16 v[76:79],a[252:255],a[92:95],v[76:79]
s_waitcnt vmcnt(13) lgkmcnt(0)
s_barrier
m16 v[112:115],a[0:3],a[64:67],v[112:115]
rtr a[192:193],v248,32800
rtr a[194:195],v248,33824
m16 v[144:147],a[0:3],a[68:71],v[144:147]
s_add_u32 m0, s68, 16400
rtr a[196:197],v248,32808
m16 v[116:119],a[4:7],a[64:67],v[116:119]
buffer_load_dwordx4 v244, s[12:15], s60 offen offset:0 lds
rtr a[198:199],v248,33832
m16 v[148:151],a[4:7],a[68:71],v[148:151]
rtr a[200:201],v249,32800
buffer_load_dwordx4 v244, s[12:15], s61 offen offset:1024 lds
m16 v[120:123],a[8:11],a[64:67],v[120:123]
rtr a[202:203],v249,33824
rtr a[204:205],v249,32808
m16 v[152:155],a[8:11],a[68:71],v[152:155]
rtr a[206:207],v249,33832
buffer_load_dwordx4 v244, s[12:15], s62 offen offset:2048 lds
m16 v[124:127],a[12:15],a[64:67],v[124:127]
rtr a[208:209],v248,33312
m16 v[156:159],a[12:15],a[68:71],v[156:159]
rtr a[210:211],v248,34336
buffer_load_dwordx4 v244, s[12:15], s63 offen offset:3072 lds
m16 v[128:131],a[16:19],a[64:67],v[128:131]
rtr a[212:213],v248,33320
rtr a[214:215],v248,34344
m16 v[160:163],a[16:19],a[68:71],v[160:163]
v_add_u32 v244, 262144, v244
rtr a[216:217],v249,33312
m16 v[132:135],a[20:23],a[64:67],v[132:135]
rtr a[218:219],v249,34336
s_add_u32 m0, s69, 22528
m16 v[164:167],a[20:23],a[68:71],v[164:167]
rtr a[220:221],v249,33320
m16 v[136:139],a[24:27],a[64:67],v[136:139]
rtr a[222:223],v249,34344
buffer_load_dwordx4 v245, s[8:11], s64 offen offset:0 lds
m16 v[168:171],a[24:27],a[68:71],v[168:171]
rtr a[224:225],v248,36896
rtr a[226:227],v248,37920
m16 v[140:143],a[28:31],a[64:67],v[140:143]
rtr a[228:229],v248,36904
buffer_load_dwordx4 v251, s[8:11], s64 offen offset:1024 lds
m16 v[172:175],a[28:31],a[68:71],v[172:175]
rtr a[230:231],v248,37928
buffer_load_dwordx4 v245, s[8:11], s65 offen offset:2048 lds
m16 v[16:19],a[32:35],a[64:67],v[16:19]
rtr a[232:233],v249,36896
m16 v[48:51],a[32:35],a[68:71],v[48:51]
rtr a[234:235],v249,37920
rtr a[236:237],v249,36904
m16 v[20:23],a[36:39],a[64:67],v[20:23]
buffer_load_dwordx4 v251, s[8:11], s65 offen offset:3072 lds
rtr a[238:239],v249,37928
m16 v[52:55],a[36:39],a[68:71],v[52:55]
rtr a[240:241],v248,37408
v_add_u32 v245, 128, v245
m16 v[24:27],a[40:43],a[64:67],v[24:27]
rtr a[242:243],v248,38432
m16 v[56:59],a[40:43],a[68:71],v[56:59]
rtr a[244:245],v248,37416
rtr a[246:247],v248,38440
m16 v[28:31],a[44:47],a[64:67],v[28:31]
v_add_u32 v251, 128, v251
rtr a[248:249],v249,37408
m16 v[60:63],a[44:47],a[68:71],v[60:63]
s_mov_b32 s28, 90112
rtr a[250:251],v249,38432
m16 v[32:35],a[48:51],a[64:67],v[32:35]
rtr a[252:253],v249,37416
buffer_load_dwordx4 a[108:111], v14, s[16:19], s28 offen offset:256 nt
m16 v[64:67],a[48:51],a[68:71],v[64:67]
rtr a[254:255],v249,38440
m16 v[36:39],a[52:55],a[64:67],v[36:39]
buffer_load_dword v255, v250, s[56:59], 0 offen
m16 v[68:71],a[52:55],a[68:71],v[68:71]
m16 v[40:43],a[56:59],a[64:67],v[40:43]
v_add_u32 v250, 640, v250
m16 v[72:75],a[56:59],a[68:71],v[72:75]
m16 v[44:47],a[60:63],a[64:67],v[44:47]
m16 v[76:79],a[60:63],a[68:71],v[76:79]
s_waitcnt vmcnt(13) lgkmcnt(0)
s_barrier
m16 v[112:115],a[192:195],a[76:79],v[112:115]
r128 a[88:91],v246,0
r128 a[92:95],v246,2048
m16 v[144:147],a[192:195],a[80:83],v[144:147]
s_add_u32 m0, s68, 32800
r128 a[64:67],v247,0
m16 v[116:119],a[196:199],a[76:79],v[116:119]
r128 a[68:71],v247,2048
rtr a[0:1],v248,0
m16 v[148:151],a[196:199],a[80:83],v[148:151]
buffer_load_dwordx4 v244, s[12:15], s60 offen offset:0 lds
rtr a[2:3],v248,1024
m16 v[120:123],a[200:203],a[76:79],v[120:123]
rtr a[4:5],v248,8
m16 v[152:155],a[200:203],a[80:83],v[152:155]
rtr a[6:7],v248,1032
rtr a[8:9],v249,0
m16 v[124:127],a[204:207],a[76:79],v[124:127]
buffer_load_dwordx4 v244, s[12:15], s61 offen offset:1024 lds
rtr a[10:11],v249,1024
m16 v[156:159],a[204:207],a[80:83],v[156:159]
rtr a[12:13],v249,8
rtr a[14:15],v249,1032
m16 v[128:131],a[208:211],a[76:79],v[128:131]
buffer_load_dwordx4 v244, s[12:15], s62 offen offset:2048 lds
rtr a[16:17],v248,512
m16 v[160:163],a[208:211],a[80:83],v[160:163]
rtr a[18:19],v248,1536
m16 v[132:135],a[212:215],a[76:79],v[132:135]
rtr a[20:21],v248,520
rtr a[22:23],v248,1544
m16 v[164:167],a[212:215],a[80:83],v[164:167]
buffer_load_dwordx4 v244, s[12:15], s63 offen offset:3072 lds
rtr a[24:25],v249,512
m16 v[136:139],a[216:219],a[76:79],v[136:139]
rtr a[26:27],v249,1536
v_add_u32 v244, 262144, v244
m16 v[168:171],a[216:219],a[80:83],v[168:171]
rtr a[28:29],v249,520
rtr a[30:31],v249,1544
m16 v[140:143],a[220:223],a[76:79],v[140:143]
rtr a[32:33],v248,4096
m16 v[172:175],a[220:223],a[80:83],v[172:175]
rtr a[34:35],v248,5120
rtr a[36:37],v248,4104
m16 v[16:19],a[224:227],a[76:79],v[16:19]
s_mov_b32 s28, 114688
rtr a[38:39],v248,5128
m16 v[48:51],a[224:227],a[80:83],v[48:51]
rtr a[40:41],v249,4096
buffer_load_dwordx4 a[112:115], v14, s[16:19], s28 offen offset:0 nt
m16 v[20:23],a[228:231],a[76:79],v[20:23]
rtr a[42:43],v249,5120
rtr a[44:45],v249,4104
m16 v[52:55],a[228:231],a[80:83],v[52:55]
rtr a[46:47],v249,5128
m16 v[24:27],a[232:235],a[76:79],v[24:27]
rtr a[48:49],v248,4608
rtr a[50:51],v248,5632
m16 v[56:59],a[232:235],a[80:83],v[56:59]
s_mov_b32 s28, 114688
rtr a[52:53],v248,4616
m16 v[28:31],a[236:239],a[76:79],v[28:31]
rtr a[54:55],v248,5640
buffer_load_dwordx4 a[116:119], v14, s[16:19], s28 offen offset:256 nt
m16 v[60:63],a[236:239],a[80:83],v[60:63]
rtr a[56:57],v249,4608
rtr a[58:59],v249,5632
m16 v[32:35],a[240:243],a[76:79],v[32:35]
rtr a[60:61],v249,4616
m16 v[64:67],a[240:243],a[80:83],v[64:67]
rtr a[62:63],v249,5640
buffer_load_dword v255, v250, s[56:59], 0 offen
m16 v[36:39],a[244:247],a[76:79],v[36:39]
m16 v[68:71],a[244:247],a[80:83],v[68:71]
v_add_u32 v250, 640, v250
m16 v[40:43],a[248:251],a[76:79],v[40:43]
m16 v[72:75],a[248:251],a[80:83],v[72:75]
m16 v[44:47],a[252:255],a[76:79],v[44:47]
m16 v[76:79],a[252:255],a[80:83],v[76:79]
s_waitcnt vmcnt(13) lgkmcnt(0)
s_barrier
m16 v[112:115],a[0:3],a[88:91],v[112:115]
rtr a[192:193],v248,16400
rtr a[194:195],v248,17424
m16 v[144:147],a[0:3],a[92:95],v[144:147]
s_add_u32 m0, s68, 0
rtr a[196:197],v248,16408
m16 v[116:119],a[4:7],a[88:91],v[116:119]
buffer_load_dwordx4 v244, s[12:15], s60 offen offset:0 lds
rtr a[198:199],v248,17432
m16 v[148:151],a[4:7],a[92:95],v[148:151]
rtr a[200:201],v249,16400
buffer_load_dwordx4 v244, s[12:15], s61 offen offset:1024 lds
m16 v[120:123],a[8:11],a[88:91],v[120:123]
rtr a[202:203],v249,17424
rtr a[204:205],v249,16408
m16 v[152:155],a[8:11],a[92:95],v[152:155]
rtr a[206:207],v249,17432
buffer_load_dwordx4 v244, s[12:15], s62 offen offset:2048 lds
m16 v[124:127],a[12:15],a[88:91],v[124:127]
rtr a[208:209],v248,16912
m16 v[156:159],a[12:15],a[92:95],v[156:159]
rtr a[210:211],v248,17936
buffer_load_dwordx4 v244, s[12:15], s63 offen offset:3072 lds
m16 v[128:131],a[16:19],a[88:91],v[128:131]
rtr a[212:213],v248,16920
rtr a[214:215],v248,17944
m16 v[160:163],a[16:19],a[92:95],v[160:163]
v_add_u32 v244, 262144, v244
rtr a[216:217],v249,16912
m16 v[132:135],a[20:23],a[88:91],v[132:135]
rtr a[218:219],v249,17936
s_add_u32 m0, s69, 0
m16 v[164:167],a[20:23],a[92:95],v[164:167]
rtr a[220:221],v249,16920
m16 v[136:139],a[24:27],a[88:91],v[136:139]
rtr a[222:223],v249,17944
buffer_load_dwordx4 v245, s[8:11], s64 offen offset:0 lds
m16 v[168:171],a[24:27],a[92:95],v[168:171]
rtr a[224:225],v248,20496
rtr a[226:227],v248,21520
m16 v[140:143],a[28:31],a[88:91],v[140:143]
rtr a[228:229],v248,20504
buffer_load_dwordx4 v251, s[8:11], s64 offen offset:1024 lds
m16 v[172:175],a[28:31],a[92:95],v[172:175]
rtr a[230:231],v248,21528
buffer_load_dwordx4 v245, s[8:11], s65 offen offset:2048 lds
m16 v[16:19],a[32:35],a[88:91],v[16:19]
rtr a[232:233],v249,20496
m16 v[48:51],a[32:35],a[92:95],v[48:51]
rtr a[234:235],v249,21520
rtr a[236:237],v249,20504
m16 v[20:23],a[36:39],a[88:91],v[20:23]
buffer_load_dwordx4 v251, s[8:11], s65 offen offset:3072 lds
rtr a[238:239],v249,21528
m16 v[52:55],a[36:39],a[92:95],v[52:55]
rtr a[240:241],v248,21008
v_add_u32 v245, 128, v245
m16 v[24:27],a[40:43],a[88:91],v[24:27]
rtr a[242:243],v248,22032
m16 v[56:59],a[40:43],a[92:95],v[56:59]
rtr a[244:245],v248,21016
rtr a[246:247],v248,22040
m16 v[28:31],a[44:47],a[88:91],v[28:31]
v_add_u32 v251, 128, v251
rtr a[248:249],v249,21008
m16 v[60:63],a[44:47],a[92:95],v[60:63]
s_mov_b32 s28, 122880
rtr a[250:251],v249,22032
m16 v[32:35],a[48:51],a[88:91],v[32:35]
rtr a[252:253],v249,21016
buffer_load_dwordx4 a[120:123], v14, s[16:19], s28 offen offset:0 nt
m16 v[64:67],a[48:51],a[92:95],v[64:67]
rtr a[254:255],v249,22040
m16 v[36:39],a[52:55],a[88:91],v[36:39]
buffer_load_dword v255, v250, s[56:59], 0 offen
m16 v[68:71],a[52:55],a[92:95],v[68:71]
m16 v[40:43],a[56:59],a[88:91],v[40:43]
v_add_u32 v250, 640, v250
m16 v[72:75],a[56:59],a[92:95],v[72:75]
m16 v[44:47],a[60:63],a[88:91],v[44:47]
m16 v[76:79],a[60:63],a[92:95],v[76:79]
s_waitcnt vmcnt(13) lgkmcnt(0)
s_barrier
m16 v[112:115],a[192:195],a[64:67],v[112:115]
r128 a[76:79],v246,22528
r128 a[80:83],v246,24576
m16 v[144:147],a[192:195],a[68:71],v[144:147]
s_add_u32 m0, s68, 16400
r128 a[88:91],v247,22528
m16 v[116:119],a[196:199],a[64:67],v[116:119]
r128 a[92:95],v247,24576
rtr a[0:1],v248,32800
m16 v[148:151],a[196:199],a[68:71],v[148:151]
buffer_load_dwordx4 v244, s[12:15], s60 offen offset:0 lds
rtr a[2:3],v248,33824
m16 v[120:123],a[200:203],a[64:67],v[120:123]
rtr a[4:5],v248,32808
m16 v[152:155],a[200:203],a[68:71],v[152:155]
rtr a[6:7],v248,33832
rtr a[8:9],v249,32800
m16 v[124:127],a[204:207],a[64:67],v[124:127]
buffer_load_dwordx4 v244, s[12:15], s61 offen offset:1024 lds
rtr a[10:11],v249,33824
m16 v[156:159],a[204:207],a[68:71],v[156:159]
rtr a[12:13],v249,32808
rtr a[14:15],v249,33832
m16 v[128:131],a[208:211],a[64:67],v[128:131]
buffer_load_dwordx4 v244, s[12:15], s62 offen offset:2048 lds
rtr a[16:17],v248,33312
m16 v[160:163],a[208:211],a[68:71],v[160:163]
rtr a[18:19],v248,34336
m16 v[132:135],a[212:215],a[64:67],v[132:135]
rtr a[20:21],v248,33320
rtr a[22:23],v248,34344
m16 v[164:167],a[212:215],a[68:71],v[164:167]
buffer_load_dwordx4 v244, s[12:15], s63 offen offset:3072 lds
rtr a[24:25],v249,33312
m16 v[136:139],a[216:219],a[64:67],v[136:139]
rtr a[26:27],v249,34336
v_add_u32 v244, 262144, v244
m16 v[168:171],a[216:219],a[68:71],v[168:171]
rtr a[28:29],v249,33320
rtr a[30:31],v249,34344
m16 v[140:143],a[220:223],a[64:67],v[140:143]
rtr a[32:33],v248,36896
m16 v[172:175],a[220:223],a[68:71],v[172:175]
rtr a[34:35],v248,37920
rtr a[36:37],v248,36904
m16 v[16:19],a[224:227],a[64:67],v[16:19]
s_mov_b32 s28, 122880
rtr a[38:39],v248,37928
m16 v[48:51],a[224:227],a[68:71],v[48:51]
rtr a[40:41],v249,36896
buffer_load_dwordx4 a[124:127], v14, s[16:19], s28 offen offset:256 nt
m16 v[20:23],a[228:231],a[64:67],v[20:23]
rtr a[42:43],v249,37920
rtr a[44:45],v249,36904
m16 v[52:55],a[228:231],a[68:71],v[52:55]
rtr a[46:47],v249,37928
m16 v[24:27],a[232:235],a[64:67],v[24:27]
rtr a[48:49],v248,37408
rtr a[50:51],v248,38432
m16 v[56:59],a[232:235],a[68:71],v[56:59]
s_mov_b32 s28, 131072
rtr a[52:53],v248,37416
m16 v[28:31],a[236:239],a[64:67],v[28:31]
rtr a[54:55],v248,38440
buffer_load_dwordx4 a[128:131], v14, s[20:23], s28 offen offset:0 nt
m16 v[60:63],a[236:239],a[68:71],v[60:63]
rtr a[56:57],v249,37408
rtr a[58:59],v249,38432
m16 v[32:35],a[240:243],a[64:67],v[32:35]
rtr a[60:61],v249,37416
m16 v[64:67],a[240:243],a[68:71],v[64:67]
rtr a[62:63],v249,38440
buffer_load_dword v255, v250, s[56:59], 0 offen
m16 v[36:39],a[244:247],a[64:67],v[36:39]
m16 v[68:71],a[244:247],a[68:71],v[68:71]
v_add_u32 v250, 640, v250
m16 v[40:43],a[248:251],a[64:67],v[40:43]
m16 v[72:75],a[248:251],a[68:71],v[72:75]
m16 v[44:47],a[252:255],a[64:67],v[44:47]
m16 v[76:79],a[252:255],a[68:71],v[76:79]
s_waitcnt vmcnt(13) lgkmcnt(0)
s_barrier
m16 v[112:115],a[0:3],a[76:79],v[112:115]
rtr a[192:193],v248,0
rtr a[194:195],v248,1024
m16 v[144:147],a[0:3],a[80:83],v[144:147]
s_add_u32 m0, s68, 32800
rtr a[196:197],v248,8
m16 v[116:119],a[4:7],a[76:79],v[116:119]
buffer_load_dwordx4 v244, s[12:15], s60 offen offset:0 lds
rtr a[198:199],v248,1032
m16 v[148:151],a[4:7],a[80:83],v[148:151]
rtr a[200:201],v249,0
buffer_load_dwordx4 v244, s[12:15], s61 offen offset:1024 lds
m16 v[120:123],a[8:11],a[76:79],v[120:123]
rtr a[202:203],v249,1024
rtr a[204:205],v249,8
m16 v[152:155],a[8:11],a[80:83],v[152:155]
buffer_load_dwordx4 v244, s[12:15], s62 offen offset:2048 lds
rtr a[206:207],v249,1032
m16 v[124:127],a[12:15],a[76:79],v[124:127]
rtr a[208:209],v248,512
buffer_load_dwordx4 v244, s[12:15], s63 offen offset:3072 lds
m16 v[156:159],a[12:15],a[80:83],v[156:159]
rtr a[210:211],v248,1536
v_add_u32 v244, 262144, v244
m16 v[128:131],a[16:19],a[76:79],v[128:131]
rtr a[212:213],v248,520
rtr a[214:215],v248,1544
m16 v[160:163],a[16:19],a[80:83],v[160:163]
rtr a[216:217],v249,512
s_add_u32 m0, s69, 22528
m16 v[132:135],a[20:23],a[76:79],v[132:135]
rtr a[218:219],v249,1536
m16 v[164:167],a[20:23],a[80:83],v[164:167]
rtr a[220:221],v249,520
buffer_load_dwordx4 v245, s[8:11], s64 offen offset:0 lds
m16 v[136:139],a[24:27],a[76:79],v[136:139]
rtr a[222:223],v249,1544
buffer_load_dwordx4 v251, s[8:11], s64 offen offset:1024 lds
m16 v[168:171],a[24:27],a[80:83],v[168:171]
rtr a[224:225],v248,4096
rtr a[226:227],v248,5120
m16 v[140:143],a[28:31],a[76:79],v[140:143]
rtr a[228:229],v248,4104
buffer_load_dwordx4 v245, s[8:11], s65 offen offset:2048 lds
m16 v[172:175],a[28:31],a[80:83],v[172:175]
rtr a[230:231],v248,5128
buffer_load_dwordx4 v251, s[8:11], s65 offen offset:3072 lds
m16 v[16:19],a[32:35],a[76:79],v[16:19]
rtr a[232:233],v249,4096
m16 v[48:51],a[32:35],a[80:83],v[48:51]
rtr a[234:235],v249,5120
rtr a[236:237],v249,4104
m16 v[20:23],a[36:39],a[76:79],v[20:23]
v_add_u32 v245, 128, v245
rtr a[238:239],v249,5128
m16 v[52:55],a[36:39],a[80:83],v[52:55]
v_add_u32 v251, 128, v251
rtr a[240:241],v248,4608
m16 v[24:27],a[40:43],a[76:79],v[24:27]
rtr a[242:243],v248,5632
s_mov_b32 s28, 131072
m16 v[56:59],a[40:43],a[80:83],v[56:59]
rtr a[244:245],v248,4616
rtr a[246:247],v248,5640
m16 v[28:31],a[44:47],a[76:79],v[28:31]
rtr a[248:249],v249,4608
buffer_load_dwordx4 a[132:135], v14, s[20:23], s28 offen offset:256 nt
m16 v[60:63],a[44:47],a[80:83],v[60:63]
rtr a[250:251],v249,5632
s_mov_b32 s28, 139264
m16 v[32:35],a[48:51],a[76:79],v[32:35]
rtr a[252:253],v249,4616
m16 v[64:67],a[48:51],a[80:83],v[64:67]
rtr a[254:255],v249,5640
buffer_load_dwordx4 a[136:139], v14, s[20:23], s28 offen offset:0 nt
m16 v[36:39],a[52:55],a[76:79],v[36:39]
buffer_load_dword v255, v250, s[56:59], 0 offen
m16 v[68:71],a[52:55],a[80:83],v[68:71]
m16 v[40:43],a[56:59],a[76:79],v[40:43]
v_add_u32 v250, 640, v250
m16 v[72:75],a[56:59],a[80:83],v[72:75]
m16 v[44:47],a[60:63],a[76:79],v[44:47]
m16 v[76:79],a[60:63],a[80:83],v[76:79]
s_waitcnt vmcnt(14) lgkmcnt(0)
s_barrier
m16 v[112:115],a[192:195],a[88:91],v[112:115]
r128 a[64:67],v246,0
r128 a[68:71],v246,2048
m16 v[144:147],a[192:195],a[92:95],v[144:147]
s_add_u32 m0, s68, 0
r128 a[76:79],v247,0
m16 v[116:119],a[196:199],a[88:91],v[116:119]
r128 a[80:83],v247,2048
rtr a[0:1],v248,16400
m16 v[148:151],a[196:199],a[92:95],v[148:151]
rtr a[2:3],v248,17424
buffer_load_dwordx4 v244, s[12:15], s60 offen offset:0 lds
m16 v[120:123],a[200:203],a[88:91],v[120:123]
rtr a[4:5],v248,16408
m16 v[152:155],a[200:203],a[92:95],v[152:155]
rtr a[6:7],v248,17432
rtr a[8:9],v249,16400
m16 v[124:127],a[204:207],a[88:91],v[124:127]
rtr a[10:11],v249,17424
buffer_load_dwordx4 v244, s[12:15], s61 offen offset:1024 lds
m16 v[156:159],a[204:207],a[92:95],v[156:159]
rtr a[12:13],v249,16408
rtr a[14:15],v249,17432
m16 v[128:131],a[208:211],a[88:91],v[128:131]
rtr a[16:17],v248,16912
m16 v[160:163],a[208:211],a[92:95],v[160:163]
rtr a[18:19],v248,17936
buffer_load_dwordx4 v244, s[12:15], s62 offen offset:2048 lds
m16 v[132:135],a[212:215],a[88:91],v[132:135]
rtr a[20:21],v248,16920
rtr a[22:23],v248,17944
m16 v[164:167],a[212:215],a[92:95],v[164:167]
rtr a[24:25],v249,16912
m16 v[136:139],a[216:219],a[88:91],v[136:139]
rtr a[26:27],v249,17936
buffer_load_dwordx4 v244, s[12:15], s63 offen offset:3072 lds
m16 v[168:171],a[216:219],a[92:95],v[168:171]
rtr a[28:29],v249,16920
rtr a[30:31],v249,17944
m16 v[140:143],a[220:223],a[88:91],v[140:143]
rtr a[32:33],v248,20496
m16 v[172:175],a[220:223],a[92:95],v[172:175]
rtr a[34:35],v248,21520
rtr a[36:37],v248,20504
m16 v[16:19],a[224:227],a[88:91],v[16:19]
v_add_u32 v244, 262144, v244
rtr a[38:39],v248,21528
m16 v[48:51],a[224:227],a[92:95],v[48:51]
rtr a[40:41],v249,20496
m16 v[20:23],a[228:231],a[88:91],v[20:23]
rtr a[42:43],v249,21520
rtr a[44:45],v249,20504
m16 v[52:55],a[228:231],a[92:95],v[52:55]
s_mov_b32 s28, 139264
rtr a[46:47],v249,21528
m16 v[24:27],a[232:235],a[88:91],v[24:27]
rtr a[48:49],v248,21008
rtr a[50:51],v248,22032
m16 v[56:59],a[232:235],a[92:95],v[56:59]
rtr a[52:53],v248,21016
buffer_load_dwordx4 a[140:143], v14, s[20:23], s28 offen offset:256 nt
m16 v[28:31],a[236:239],a[88:91],v[28:31]
rtr a[54:55],v248,22040
m16 v[60:63],a[236:239],a[92:95],v[60:63]
rtr a[56:57],v249,21008
rtr a[58:59],v249,22032
m16 v[32:35],a[240:243],a[88:91],v[32:35]
rtr a[60:61],v249,21016
buffer_load_dword v255, v250, s[56:59], 0 offen
m16 v[64:67],a[240:243],a[92:95],v[64:67]
rtr a[62:63],v249,22040
m16 v[36:39],a[244:247],a[88:91],v[36:39]
m16 v[68:71],a[244:247],a[92:95],v[68:71]
v_add_u32 v250, 640, v250
m16 v[40:43],a[248:251],a[88:91],v[40:43]
m16 v[72:75],a[248:251],a[92:95],v[72:75]
m16 v[44:47],a[252:255],a[88:91],v[44:47]
m16 v[76:79],a[252:255],a[92:95],v[76:79]
s_waitcnt vmcnt(13) lgkmcnt(0)
s_barrier
m16 v[112:115],a[0:3],a[64:67],v[112:115]
rtr a[192:193],v248,32800
rtr a[194:195],v248,33824
m16 v[144:147],a[0:3],a[68:71],v[144:147]
s_add_u32 m0, s68, 16400
rtr a[196:197],v248,32808
m16 v[116:119],a[4:7],a[64:67],v[116:119]
buffer_load_dwordx4 v244, s[12:15], s60 offen offset:0 lds
rtr a[198:199],v248,33832
m16 v[148:151],a[4:7],a[68:71],v[148:151]
rtr a[200:201],v249,32800
buffer_load_dwordx4 v244, s[12:15], s61 offen offset:1024 lds
m16 v[120:123],a[8:11],a[64:67],v[120:123]
rtr a[202:203],v249,33824
rtr a[204:205],v249,32808
m16 v[152:155],a[8:11],a[68:71],v[152:155]
buffer_load_dwordx4 v244, s[12:15], s62 offen offset:2048 lds
rtr a[206:207],v249,33832
m16 v[124:127],a[12:15],a[64:67],v[124:127]
rtr a[208:209],v248,33312
buffer_load_dwordx4 v244, s[12:15], s63 offen offset:3072 lds
m16 v[156:159],a[12:15],a[68:71],v[156:159]
rtr a[210:211],v248,34336
v_add_u32 v244, 262144, v244
m16 v[128:131],a[16:19],a[64:67],v[128:131]
rtr a[212:213],v248,33320
rtr a[214:215],v248,34344
m16 v[160:163],a[16:19],a[68:71],v[160:163]
rtr a[216:217],v249,33312
s_add_u32 m0, s69, 0
m16 v[132:135],a[20:23],a[64:67],v[132:135]
rtr a[218:219],v249,34336
m16 v[164:167],a[20:23],a[68:71],v[164:167]
rtr a[220:221],v249,33320
buffer_load_dwordx4 v245, s[8:11], s64 offen offset:0 lds
m16 v[136:139],a[24:27],a[64:67],v[136:139]
rtr a[222:223],v249,34344
buffer_load_dwordx4 v251, s[8:11], s64 offen offset:1024 lds
m16 v[168:171],a[24:27],a[68:71],v[168:171]
rtr a[224:225],v248,36896
rtr a[226:227],v248,37920
m16 v[140:143],a[28:31],a[64:67],v[140:143]
rtr a[228:229],v248,36904
buffer_load_dwordx4 v245, s[8:11], s65 offen offset:2048 lds
m16 v[172:175],a[28:31],a[68:71],v[172:175]
rtr a[230:231],v248,37928
buffer_load_dwordx4 v251, s[8:11], s65 offen offset:3072 lds
m16 v[16:19],a[32:35],a[64:67],v[16:19]
rtr a[232:233],v249,36896
m16 v[48:51],a[32:35],a[68:71],v[48:51]
rtr a[234:235],v249,37920
rtr a[236:237],v249,36904
m16 v[20:23],a[36:39],a[64:67],v[20:23]
v_add_u32 v245, 128, v245
rtr a[238:239],v249,37928
m16 v[52:55],a[36:39],a[68:71],v[52:55]
v_add_u32 v251, 128, v251
rtr a[240:241],v248,37408
m16 v[24:27],a[40:43],a[64:67],v[24:27]
rtr a[242:243],v248,38432
s_mov_b32 s28, 163840
m16 v[56:59],a[40:43],a[68:71],v[56:59]
rtr a[244:245],v248,37416
rtr a[246:247],v248,38440
m16 v[28:31],a[44:47],a[64:67],v[28:31]
rtr a[248:249],v249,37408
buffer_load_dwordx4 a[144:147], v14, s[16:19], s28 offen offset:0 nt
m16 v[60:63],a[44:47],a[68:71],v[60:63]
rtr a[250:251],v249,38432
s_mov_b32 s28, 163840
m16 v[32:35],a[48:51],a[64:67],v[32:35]
rtr a[252:253],v249,37416
m16 v[64:67],a[48:51],a[68:71],v[64:67]
rtr a[254:255],v249,38440
buffer_load_dwordx4 a[148:151], v14, s[16:19], s28 offen offset:256 nt
m16 v[36:39],a[52:55],a[64:67],v[36:39]
buffer_load_dword v255, v250, s[56:59], 0 offen
m16 v[68:71],a[52:55],a[68:71],v[68:71]
m16 v[40:43],a[56:59],a[64:67],v[40:43]
v_add_u32 v250, 640, v250
m16 v[72:75],a[56:59],a[68:71],v[72:75]
m16 v[44:47],a[60:63],a[64:67],v[44:47]
m16 v[76:79],a[60:63],a[68:71],v[76:79]
s_waitcnt vmcnt(13) lgkmcnt(0)
s_barrier
m16 v[112:115],a[192:195],a[76:79],v[112:115]
r128 a[88:91],v246,22528
r128 a[92:95],v246,24576
m16 v[144:147],a[192:195],a[80:83],v[144:147]
s_add_u32 m0, s68, 32800
r128 a[64:67],v247,22528
m16 v[116:119],a[196:199],a[76:79],v[116:119]
r128 a[68:71],v247,24576
rtr a[0:1],v248,0
m16 v[148:151],a[196:199],a[80:83],v[148:151]
rtr a[2:3],v248,1024
buffer_load_dwordx4 v244, s[12:15], s60 offen offset:0 lds
m16 v[120:123],a[200:203],a[76:79],v[120:123]
rtr a[4:5],v248,8
m16 v[152:155],a[200:203],a[80:83],v[152:155]
rtr a[6:7],v248,1032
rtr a[8:9],v249,0
m16 v[124:127],a[204:207],a[76:79],v[124:127]
rtr a[10:11],v249,1024
buffer_load_dwordx4 v244, s[12:15], s61 offen offset:1024 lds
m16 v[156:159],a[204:207],a[80:83],v[156:159]
rtr a[12:13],v249,8
rtr a[14:15],v249,1032
m16 v[128:131],a[208:211],a[76:79],v[128:131]
rtr a[16:17],v248,512
m16 v[160:163],a[208:211],a[80:83],v[160:163]
rtr a[18:19],v248,1536
buffer_load_dwordx4 v244, s[12:15], s62 offen offset:2048 lds
m16 v[132:135],a[212:215],a[76:79],v[132:135]
rtr a[20:21],v248,520
rtr a[22:23],v248,1544
m16 v[164:167],a[212:215],a[80:83],v[164:167]
rtr a[24:25],v249,512
m16 v[136:139],a[216:219],a[76:79],v[136:139]
rtr a[26:27],v249,1536
buffer_load_dwordx4 v244, s[12:15], s63 offen offset:3072 lds
m16 v[168:171],a[216:219],a[80:83],v[168:171]
rtr a[28:29],v249,520
rtr a[30:31],v249,1544
m16 v[140:143],a[220:223],a[76:79],v[140:143]
rtr a[32:33],v248,4096
m16 v[172:175],a[220:223],a[80:83],v[172:175]
rtr a[34:35],v248,5120
rtr a[36:37],v248,4104
m16 v[16:19],a[224:227],a[76:79],v[16:19]
v_add_u32 v244, 262144, v244
rtr a[38:39],v248,5128
m16 v[48:51],a[224:227],a[80:83],v[48:51]
rtr a[40:41],v249,4096
m16 v[20:23],a[228:231],a[76:79],v[20:23]
rtr a[42:43],v249,5120
rtr a[44:45],v249,4104
m16 v[52:55],a[228:231],a[80:83],v[52:55]
s_mov_b32 s28, 172032
rtr a[46:47],v249,5128
m16 v[24:27],a[232:235],a[76:79],v[24:27]
rtr a[48:49],v248,4608
rtr a[50:51],v248,5632
m16 v[56:59],a[232:235],a[80:83],v[56:59]
rtr a[52:53],v248,4616
buffer_load_dwordx4 a[152:155], v14, s[16:19], s28 offen offset:0 nt
m16 v[28:31],a[236:239],a[76:79],v[28:31]
rtr a[54:55],v248,5640
m16 v[60:63],a[236:239],a[80:83],v[60:63]
rtr a[56:57],v249,4608
rtr a[58:59],v249,5632
m16 v[32:35],a[240:243],a[76:79],v[32:35]
rtr a[60:61],v249,4616
buffer_load_dword v255, v250, s[56:59], 0 offen
m16 v[64:67],a[240:243],a[80:83],v[64:67]
rtr a[62:63],v249,5640
m16 v[36:39],a[244:247],a[76:79],v[36:39]
m16 v[68:71],a[244:247],a[80:83],v[68:71]
v_add_u32 v250, 640, v250
m16 v[40:43],a[248:251],a[76:79],v[40:43]
m16 v[72:75],a[248:251],a[80:83],v[72:75]
m16 v[44:47],a[252:255],a[76:79],v[44:47]
m16 v[76:79],a[252:255],a[80:83],v[76:79]
s_waitcnt vmcnt(13) lgkmcnt(0)
s_barrier
m16 v[112:115],a[0:3],a[88:91],v[112:115]
rtr a[192:193],v248,16400
rtr a[194:195],v248,17424
m16 v[144:147],a[0:3],a[92:95],v[144:147]
s_add_u32 m0, s68, 0
rtr a[196:197],v248,16408
m16 v[116:119],a[4:7],a[88:91],v[116:119]
buffer_load_dwordx4 v244, s[12:15], s60 offen offset:0 lds
rtr a[198:199],v248,17432
m16 v[148:151],a[4:7],a[92:95],v[148:151]
rtr a[200:201],v249,16400
buffer_load_dwordx4 v244, s[12:15], s61 offen offset:1024 lds
m16 v[120:123],a[8:11],a[88:91],v[120:123]
rtr a[202:203],v249,17424
rtr a[204:205],v249,16408
m16 v[152:155],a[8:11],a[92:95],v[152:155]
buffer_load_dwordx4 v244, s[12:15], s62 offen offset:2048 lds
rtr a[206:207],v249,17432
m16 v[124:127],a[12:15],a[88:91],v[124:127]
rtr a[208:209],v248,16912
buffer_load_dwordx4 v244, s[12:15], s63 offen offset:3072 lds
m16 v[156:159],a[12:15],a[92:95],v[156:159]
rtr a[210:211],v248,17936
v_add_u32 v244, 262144, v244
m16 v[128:131],a[16:19],a[88:91],v[128:131]
rtr a[212:213],v248,16920
rtr a[214:215],v248,17944
m16 v[160:163],a[16:19],a[92:95],v[160:163]
rtr a[216:217],v249,16912
s_add_u32 m0, s69, 22528
m16 v[132:135],a[20:23],a[88:91],v[132:135]
rtr a[218:219],v249,17936
m16 v[164:167],a[20:23],a[92:95],v[164:167]
rtr a[220:221],v249,16920
buffer_load_dwordx4 v245, s[8:11], s64 offen offset:0 lds
m16 v[136:139],a[24:27],a[88:91],v[136:139]
rtr a[222:223],v249,17944
buffer_load_dwordx4 v251, s[8:11], s64 offen offset:1024 lds
m16 v[168:171],a[24:27],a[92:95],v[168:171]
rtr a[224:225],v248,20496
rtr a[226:227],v248,21520
m16 v[140:143],a[28:31],a[88:91],v[140:143]
rtr a[228:229],v248,20504
buffer_load_dwordx4 v245, s[8:11], s65 offen offset:2048 lds
m16 v[172:175],a[28:31],a[92:95],v[172:175]
rtr a[230:231],v248,21528
buffer_load_dwordx4 v251, s[8:11], s65 offen offset:3072 lds
m16 v[16:19],a[32:35],a[88:91],v[16:19]
rtr a[232:233],v249,20496
m16 v[48:51],a[32:35],a[92:95],v[48:51]
rtr a[234:235],v249,21520
rtr a[236:237],v249,20504
m16 v[20:23],a[36:39],a[88:91],v[20:23]
v_add_u32 v245, 128, v245
rtr a[238:239],v249,21528
m16 v[52:55],a[36:39],a[92:95],v[52:55]
v_add_u32 v251, 128, v251
rtr a[240:241],v248,21008
m16 v[24:27],a[40:43],a[88:91],v[24:27]
rtr a[242:243],v248,22032
s_mov_b32 s28, 172032
m16 v[56:59],a[40:43],a[92:95],v[56:59]
rtr a[244:245],v248,21016
rtr a[246:247],v248,22040
m16 v[28:31],a[44:47],a[88:91],v[28:31]
rtr a[248:249],v249,21008
buffer_load_dwordx4 a[156:159], v14, s[16:19], s28 offen offset:256 nt
m16 v[60:63],a[44:47],a[92:95],v[60:63]
rtr a[250:251],v249,22032
s_mov_b32 s28, 180224
m16 v[32:35],a[48:51],a[88:91],v[32:35]
rtr a[252:253],v249,21016
m16 v[64:67],a[48:51],a[92:95],v[64:67]
rtr a[254:255],v249,22040
buffer_load_dwordx4 a[160:163], v14, s[20:23], s28 offen offset:0 nt
m16 v[36:39],a[52:55],a[88:91],v[36:39]
buffer_load_dword v255, v250, s[56:59], 0 offen
m16 v[68:71],a[52:55],a[92:95],v[68:71]
m16 v[40:43],a[56:59],a[88:91],v[40:43]
v_add_u32 v250, 640, v250
m16 v[72:75],a[56:59],a[92:95],v[72:75]
m16 v[44:47],a[60:63],a[88:91],v[44:47]
m16 v[76:79],a[60:63],a[92:95],v[76:79]
s_waitcnt vmcnt(13) lgkmcnt(0)
s_barrier
m16 v[112:115],a[192:195],a[64:67],v[112:115]
r128 a[76:79],v246,0
r128 a[80:83],v246,2048
m16 v[144:147],a[192:195],a[68:71],v[144:147]
s_add_u32 m0, s68, 16400
r128 a[88:91],v247,0
m16 v[116:119],a[196:199],a[64:67],v[116:119]
r128 a[92:95],v247,2048
rtr a[0:1],v248,32800
m16 v[148:151],a[196:199],a[68:71],v[148:151]
rtr a[2:3],v248,33824
buffer_load_dwordx4 v244, s[12:15], s60 offen offset:0 lds
m16 v[120:123],a[200:203],a[64:67],v[120:123]
rtr a[4:5],v248,32808
m16 v[152:155],a[200:203],a[68:71],v[152:155]
rtr a[6:7],v248,33832
rtr a[8:9],v249,32800
m16 v[124:127],a[204:207],a[64:67],v[124:127]
rtr a[10:11],v249,33824
buffer_load_dwordx4 v244, s[12:15], s61 offen offset:1024 lds
m16 v[156:159],a[204:207],a[68:71],v[156:159]
rtr a[12:13],v249,32808
rtr a[14:15],v249,33832
m16 v[128:131],a[208:211],a[64:67],v[128:131]
rtr a[16:17],v248,33312
m16 v[160:163],a[208:211],a[68:71],v[160:163]
rtr a[18:19],v248,34336
buffer_load_dwordx4 v244, s[12:15], s62 offen offset:2048 lds
m16 v[132:135],a[212:215],a[64:67],v[132:135]
rtr a[20:21],v248,33320
rtr a[22:23],v248,34344
m16 v[164:167],a[212:215],a[68:71],v[164:167]
rtr a[24:25],v249,33312
m16 v[136:139],a[216:219],a[64:67],v[136:139]
rtr a[26:27],v249,34336
buffer_load_dwordx4 v244, s[12:15], s63 offen offset:3072 lds
m16 v[168:171],a[216:219],a[68:71],v[168:171]
rtr a[28:29],v249,33320
rtr a[30:31],v249,34344
m16 v[140:143],a[220:223],a[64:67],v[140:143]
rtr a[32:33],v248,36896
m16 v[172:175],a[220:223],a[68:71],v[172:175]
rtr a[34:35],v248,37920
rtr a[36:37],v248,36904
m16 v[16:19],a[224:227],a[64:67],v[16:19]
v_add_u32 v244, 262144, v244
rtr a[38:39],v248,37928
m16 v[48:51],a[224:227],a[68:71],v[48:51]
rtr a[40:41],v249,36896
m16 v[20:23],a[228:231],a[64:67],v[20:23]
rtr a[42:43],v249,37920
rtr a[44:45],v249,36904
m16 v[52:55],a[228:231],a[68:71],v[52:55]
s_mov_b32 s28, 180224
rtr a[46:47],v249,37928
m16 v[24:27],a[232:235],a[64:67],v[24:27]
rtr a[48:49],v248,37408
rtr a[50:51],v248,38432
m16 v[56:59],a[232:235],a[68:71],v[56:59]
rtr a[52:53],v248,37416
buffer_load_dwordx4 a[164:167], v14, s[20:23], s28 offen offset:256 nt
m16 v[28:31],a[236:239],a[64:67],v[28:31]
rtr a[54:55],v248,38440
m16 v[60:63],a[236:239],a[68:71],v[60:63]
rtr a[56:57],v249,37408
rtr a[58:59],v249,38432
m16 v[32:35],a[240:243],a[64:67],v[32:35]
rtr a[60:61],v249,37416
buffer_load_dword v255, v250, s[56:59], 0 offen
m16 v[64:67],a[240:243],a[68:71],v[64:67]
rtr a[62:63],v249,38440
m16 v[36:39],a[244:247],a[64:67],v[36:39]
m16 v[68:71],a[244:247],a[68:71],v[68:71]
v_add_u32 v250, 640, v250
m16 v[40:43],a[248:251],a[64:67],v[40:43]
m16 v[72:75],a[248:251],a[68:71],v[72:75]
m16 v[44:47],a[252:255],a[64:67],v[44:47]
m16 v[76:79],a[252:255],a[68:71],v[76:79]
s_waitcnt vmcnt(13) lgkmcnt(0)
s_barrier
m16 v[112:115],a[0:3],a[76:79],v[112:115]
rtr a[192:193],v248,0
rtr a[194:195],v248,1024
m16 v[144:147],a[0:3],a[80:83],v[144:147]
s_add_u32 m0, s68, 32800
rtr a[196:197],v248,8
m16 v[116:119],a[4:7],a[76:79],v[116:119]
rtr a[198:199],v248,1032
buffer_load_dwordx4 v244, s[12:15], s60 offen offset:0 lds
m16 v[148:151],a[4:7],a[80:83],v[148:151]
ds_write_b128 v253, v[208:211] offset:0
rtr a[200:201],v249,0
m16 v[120:123],a[8:11],a[76:79],v[120:123]
rtr a[202:203],v249,1024
rtr a[204:205],v249,8
m16 v[152:155],a[8:11],a[80:83],v[152:155]
buffer_load_dwordx4 v244, s[12:15], s61 offen offset:1024 lds
rtr a[206:207],v249,1032
m16 v[124:127],a[12:15],a[76:79],v[124:127]
rtr a[208:209],v248,512
buffer_load_dwordx4 v244, s[12:15], s62 offen offset:2048 lds
m16 v[156:159],a[12:15],a[80:83],v[156:159]
rtr a[210:211],v248,1536
m16 v[128:131],a[16:19],a[76:79],v[128:131]
rtr a[212:213],v248,520
rtr a[214:215],v248,1544
m16 v[160:163],a[16:19],a[80:83],v[160:163]
buffer_load_dwordx4 v244, s[12:15], s63 offen offset:3072 lds
ds_write_b128 v253, v[212:215] offset:1056
m16 v[132:135],a[20:23],a[76:79],v[132:135]
rtr a[216:217],v249,512
rtr a[218:219],v249,1536
m16 v[164:167],a[20:23],a[80:83],v[164:167]
v_add_u32 v244, 262144, v244
rtr a[220:221],v249,520
m16 v[136:139],a[24:27],a[76:79],v[136:139]
rtr a[222:223],v249,1544
s_mov_b32 s28, 188416
m16 v[168:171],a[24:27],a[80:83],v[168:171]
rtr a[224:225],v248,4096
rtr a[226:227],v248,5120
m16 v[140:143],a[28:31],a[76:79],v[140:143]
rtr a[228:229],v248,4104
ds_write_b128 v253, v[216:219] offset:8448
m16 v[172:175],a[28:31],a[80:83],v[172:175]
rtr a[230:231],v248,5128
buffer_load_dwordx4 a[168:171], v14, s[20:23], s28 offen offset:0 nt
m16 v[16:19],a[32:35],a[76:79],v[16:19]
rtr a[232:233],v249,4096
m16 v[48:51],a[32:35],a[80:83],v[48:51]
rtr a[234:235],v249,5120
rtr a[236:237],v249,4104
m16 v[20:23],a[36:39],a[76:79],v[20:23]
s_mov_b32 s28, 188416
rtr a[238:239],v249,5128
m16 v[52:55],a[36:39],a[80:83],v[52:55]
rtr a[240:241],v248,4608
buffer_load_dwordx4 a[172:175], v14, s[20:23], s28 offen offset:256 nt
m16 v[24:27],a[40:43],a[76:79],v[24:27]
rtr a[242:243],v248,5632
ds_write_b128 v253, v[220:223] offset:9504
m16 v[56:59],a[40:43],a[80:83],v[56:59]
rtr a[244:245],v248,4616
rtr a[246:247],v248,5640
m16 v[28:31],a[44:47],a[76:79],v[28:31]
buffer_load_dword v255, v250, s[56:59], 0 offen
rtr a[248:249],v249,4608
m16 v[60:63],a[44:47],a[80:83],v[60:63]
rtr a[250:251],v249,5632
v_add_u32 v250, 640, v250
m16 v[32:35],a[48:51],a[76:79],v[32:35]
rtr a[252:253],v249,4616
m16 v[64:67],a[48:51],a[80:83],v[64:67]
rtr a[254:255],v249,5640
buffer_load_dword v255, v250, s[56:59], 0 offen
m16 v[36:39],a[52:55],a[76:79],v[36:39]
m16 v[68:71],a[52:55],a[80:83],v[68:71]
v_add_u32 v250, 640, v250
m16 v[40:43],a[56:59],a[76:79],v[40:43]
m16 v[72:75],a[56:59],a[80:83],v[72:75]
m16 v[44:47],a[60:63],a[76:79],v[44:47]
m16 v[76:79],a[60:63],a[80:83],v[76:79]
s_waitcnt vmcnt(10) lgkmcnt(0)
s_barrier
m16 v[112:115],a[192:195],a[88:91],v[112:115]
r128 a[64:67],v246,22528
r128 a[68:71],v246,24576
m16 v[144:147],a[192:195],a[92:95],v[144:147]
s_mov_b32 s28, 212992
r128 a[76:79],v247,22528
m16 v[116:119],a[196:199],a[88:91],v[116:119]
r128 a[80:83],v247,24576
rtr a[0:1],v248,16400
m16 v[148:151],a[196:199],a[92:95],v[148:151]
rtr a[2:3],v248,17424
m16 v[120:123],a[200:203],a[88:91],v[120:123]
rtr a[4:5],v248,16408
m16 v[152:155],a[200:203],a[92:95],v[152:155]
rtr a[6:7],v248,17432
rtr a[8:9],v249,16400
m16 v[124:127],a[204:207],a[88:91],v[124:127]
buffer_load_dwordx4 a[176:179], v14, s[16:19], s28 offen offset:0 nt
rtr a[10:11],v249,17424
m16 v[156:159],a[204:207],a[92:95],v[156:159]
rtr a[12:13],v249,16408
rtr a[14:15],v249,17432
m16 v[128:131],a[208:211],a[88:91],v[128:131]
rtr a[16:17],v248,16912
m16 v[160:163],a[208:211],a[92:95],v[160:163]
rtr a[18:19],v248,17936
m16 v[132:135],a[212:215],a[88:91],v[132:135]
rtr a[20:21],v248,16920
rtr a[22:23],v248,17944
m16 v[164:167],a[212:215],a[92:95],v[164:167]
buffer_load_dword v255, v250, s[56:59], 0 offen
rtr a[24:25],v249,16912
m16 v[136:139],a[216:219],a[88:91],v[136:139]
rtr a[26:27],v249,17936
m16 v[168:171],a[216:219],a[92:95],v[168:171]
rtr a[28:29],v249,16920
rtr a[30:31],v249,17944
m16 v[140:143],a[220:223],a[88:91],v[140:143]
rtr a[32:33],v248,20496
m16 v[172:175],a[220:223],a[92:95],v[172:175]
rtr a[34:35],v248,21520
rtr a[36:37],v248,20504
m16 v[16:19],a[224:227],a[88:91],v[16:19]
v_add_u32 v250, 640, v250
rtr a[38:39],v248,21528
m16 v[48:51],a[224:227],a[92:95],v[48:51]
rtr a[40:41],v249,20496
m16 v[20:23],a[228:231],a[88:91],v[20:23]
rtr a[42:43],v249,21520
rtr a[44:45],v249,20504
m16 v[52:55],a[228:231],a[92:95],v[52:55]
rtr a[46:47],v249,21528
m16 v[24:27],a[232:235],a[88:91],v[24:27]
rtr a[48:49],v248,21008
rtr a[50:51],v248,22032
m16 v[56:59],a[232:235],a[92:95],v[56:59]
buffer_load_dword v255, v250, s[56:59], 0 offen
rtr a[52:53],v248,21016
m16 v[28:31],a[236:239],a[88:91],v[28:31]
rtr a[54:55],v248,22040
m16 v[60:63],a[236:239],a[92:95],v[60:63]
rtr a[56:57],v249,21008
rtr a[58:59],v249,22032
m16 v[32:35],a[240:243],a[88:91],v[32:35]
rtr a[60:61],v249,21016
m16 v[64:67],a[240:243],a[92:95],v[64:67]
rtr a[62:63],v249,22040
v_add_u32 v250, 640, v250
m16 v[36:39],a[244:247],a[88:91],v[36:39]
m16 v[68:71],a[244:247],a[92:95],v[68:71]
m16 v[40:43],a[248:251],a[88:91],v[40:43]
m16 v[72:75],a[248:251],a[92:95],v[72:75]
m16 v[44:47],a[252:255],a[88:91],v[44:47]
m16 v[76:79],a[252:255],a[92:95],v[76:79]
s_waitcnt vmcnt(7) lgkmcnt(0)
s_barrier
m16 v[112:115],a[0:3],a[64:67],v[112:115]
rtr a[192:193],v248,32800
rtr a[194:195],v248,33824
m16 v[144:147],a[0:3],a[68:71],v[144:147]
s_mov_b32 s28, 212992
rtr a[196:197],v248,32808
m16 v[116:119],a[4:7],a[64:67],v[116:119]
buffer_load_dwordx4 a[180:183], v14, s[16:19], s28 offen offset:256 nt
rtr a[198:199],v248,33832
m16 v[148:151],a[4:7],a[68:71],v[148:151]
ds_write_b128 v253, v[224:227] offset:16896
rtr a[200:201],v249,32800
m16 v[120:123],a[8:11],a[64:67],v[120:123]
s_mov_b32 s28, 221184
rtr a[202:203],v249,33824
m16 v[152:155],a[8:11],a[68:71],v[152:155]
rtr a[204:205],v249,32808
buffer_load_dwordx4 a[184:187], v14, s[16:19], s28 offen offset:0 nt
m16 v[124:127],a[12:15],a[64:67],v[124:127]
rtr a[206:207],v249,33832
rtr a[208:209],v248,33312
m16 v[156:159],a[12:15],a[68:71],v[156:159]
s_add_u32 m0, s100, 101376
rtr a[210:211],v248,34336
m16 v[128:131],a[16:19],a[64:67],v[128:131]
s_mov_b32 s28, 49152
rtr a[212:213],v248,33320
m16 v[160:163],a[16:19],a[68:71],v[160:163]
rtr a[214:215],v248,34344
ds_write_b128 v253, v[228:231] offset:17952
m16 v[132:135],a[20:23],a[64:67],v[132:135]
rtr a[216:217],v249,33312
buffer_load_dwordx4 v14, s[16:19], s28 offen offset:0 nt lds
m16 v[164:167],a[20:23],a[68:71],v[164:167]
rtr a[218:219],v249,34336
s_add_u32 m0, s100, 102176
m16 v[136:139],a[24:27],a[64:67],v[136:139]
rtr a[220:221],v249,33320
rtr a[222:223],v249,34344
m16 v[168:171],a[24:27],a[68:71],v[168:171]
s_mov_b32 s28, 49152
rtr a[224:225],v248,36896
m16 v[140:143],a[28:31],a[64:67],v[140:143]
rtr a[226:227],v248,37920
buffer_load_dwordx4 v14, s[16:19], s28 offen offset:256 nt lds
m16 v[172:175],a[28:31],a[68:71],v[172:175]
rtr a[228:229],v248,36904
ds_write_b128 v253, v[232:235] offset:25344
m16 v[16:19],a[32:35],a[64:67],v[16:19]
rtr a[230:231],v248,37928
s_add_u32 m0, s100, 109824
m16 v[48:51],a[32:35],a[68:71],v[48:51]
rtr a[232:233],v249,36896
s_mov_b32 s28, 57344
m16 v[20:23],a[36:39],a[64:67],v[20:23]
rtr a[234:235],v249,37920
rtr a[236:237],v249,36904
m16 v[52:55],a[36:39],a[68:71],v[52:55]
rtr a[238:239],v249,37928
buffer_load_dwordx4 v14, s[16:19], s28 offen offset:0 nt lds
m16 v[24:27],a[40:43],a[64:67],v[24:27]
rtr a[240:241],v248,37408
s_add_u32 m0, s100, 110624
m16 v[56:59],a[40:43],a[68:71],v[56:59]
rtr a[242:243],v248,38432
ds_write_b128 v253, v[236:239] offset:26400
m16 v[28:31],a[44:47],a[64:67],v[28:31]
rtr a[244:245],v248,37416
rtr a[246:247],v248,38440
s_mov_b32 s28, 57344
m16 v[60:63],a[44:47],a[68:71],v[60:63]
rtr a[248:249],v249,37408
buffer_load_dwordx4 v14, s[16:19], s28 offen offset:256 nt lds
m16 v[32:35],a[48:51],a[64:67],v[32:35]
rtr a[250:251],v249,38432
rtr a[252:253],v249,37416
m16 v[64:67],a[48:51],a[68:71],v[64:67]
buffer_load_dword v255, v250, s[56:59], 0 offen
rtr a[254:255],v249,38440
m16 v[36:39],a[52:55],a[64:67],v[36:39]
v_add_u32 v250, 640, v250
m16 v[68:71],a[52:55],a[68:71],v[68:71]
buffer_load_dword v255, v250, s[56:59], 0 offen
m16 v[40:43],a[56:59],a[64:67],v[40:43]
v_add_u32 v250, 640, v250
m16 v[72:75],a[56:59],a[68:71],v[72:75]
m16 v[44:47],a[60:63],a[64:67],v[44:47]
m16 v[76:79],a[60:63],a[68:71],v[76:79]
s_waitcnt lgkmcnt(0)
s_barrier
m16 v[112:115],a[192:195],a[76:79],v[112:115]
s_mov_b32 s28, 221184
m16 v[144:147],a[192:195],a[80:83],v[144:147]
buffer_load_dwordx4 a[188:191], v14, s[16:19], s28 offen offset:256 nt
m16 v[116:119],a[196:199],a[76:79],v[116:119]
m16 v[148:151],a[196:199],a[80:83],v[148:151]
s_add_u32 m0, s100, 118272
m16 v[120:123],a[200:203],a[76:79],v[120:123]
m16 v[152:155],a[200:203],a[80:83],v[152:155]
s_mov_b32 s28, 49152
m16 v[124:127],a[204:207],a[76:79],v[124:127]
buffer_load_dwordx4 v14, s[20:23], s28 offen offset:0 nt lds
m16 v[156:159],a[204:207],a[80:83],v[156:159]
v_mul_f32 v112, s40, v112
v_mul_f32 v113, s40, v113
v_mul_f32 v114, s40, v114
m16 v[128:131],a[208:211],a[76:79],v[128:131]
s_add_u32 m0, s100, 119072
v_mul_f32 v115, s40, v115
v_mul_f32 v116, s40, v116
m16 v[160:163],a[208:211],a[80:83],v[160:163]
v_mul_f32 v117, s40, v117
v_mul_f32 v118, s40, v118
v_mul_f32 v119, s40, v119
m16 v[132:135],a[212:215],a[76:79],v[132:135]
s_mov_b32 s28, 49152
cvt v112,v112,v113
cvt v113,v114,v115
m16 v[164:167],a[212:215],a[80:83],v[164:167]
buffer_load_dwordx4 v14, s[20:23], s28 offen offset:256 nt lds
cvt v114,v116,v117
cvt v115,v118,v119
m16 v[136:139],a[216:219],a[76:79],v[136:139]
v_accvgpr_write_b32 a0, v112
v_accvgpr_write_b32 a1, v113
v_accvgpr_write_b32 a2, v114
m16 v[168:171],a[216:219],a[80:83],v[168:171]
s_add_u32 m0, s100, 126720
v_accvgpr_write_b32 a3, v115
v_mul_f32 v144, s40, v144
m16 v[140:143],a[220:223],a[76:79],v[140:143]
v_mul_f32 v145, s40, v145
v_mul_f32 v146, s40, v146
v_mul_f32 v147, s40, v147
m16 v[172:175],a[220:223],a[80:83],v[172:175]
s_mov_b32 s28, 57344
v_mul_f32 v148, s40, v148
v_mul_f32 v149, s40, v149
m16 v[16:19],a[224:227],a[76:79],v[16:19]
buffer_load_dwordx4 v14, s[20:23], s28 offen offset:0 nt lds
v_mul_f32 v150, s40, v150
v_mul_f32 v151, s40, v151
m16 v[48:51],a[224:227],a[80:83],v[48:51]
cvt v144,v144,v145
cvt v145,v146,v147
cvt v146,v148,v149
m16 v[20:23],a[228:231],a[76:79],v[20:23]
s_add_u32 m0, s100, 127520
cvt v147,v150,v151
v_accvgpr_write_b32 a16, v144
m16 v[52:55],a[228:231],a[80:83],v[52:55]
v_accvgpr_write_b32 a17, v145
v_accvgpr_write_b32 a18, v146
v_accvgpr_write_b32 a19, v147
m16 v[24:27],a[232:235],a[76:79],v[24:27]
s_mov_b32 s28, 57344
v_mul_f32 v120, s40, v120
v_mul_f32 v121, s40, v121
m16 v[56:59],a[232:235],a[80:83],v[56:59]
buffer_load_dwordx4 v14, s[20:23], s28 offen offset:256 nt lds
v_mul_f32 v122, s40, v122
v_mul_f32 v123, s40, v123
m16 v[28:31],a[236:239],a[76:79],v[28:31]
v_mul_f32 v124, s40, v124
v_mul_f32 v125, s40, v125
v_mul_f32 v126, s40, v126
m16 v[60:63],a[236:239],a[80:83],v[60:63]
buffer_load_dword v255, v250, s[56:59], 0 offen
v_mul_f32 v127, s40, v127
cvt v120,v120,v121
m16 v[32:35],a[240:243],a[76:79],v[32:35]
cvt v121,v122,v123
cvt v122,v124,v125
cvt v123,v126,v127
m16 v[64:67],a[240:243],a[80:83],v[64:67]
v_add_u32 v250, 640, v250
v_accvgpr_write_b32 a4, v120
v_accvgpr_write_b32 a5, v121
m16 v[36:39],a[244:247],a[76:79],v[36:39]
buffer_load_dword v255, v250, s[56:59], 0 offen
v_accvgpr_write_b32 a6, v122
v_accvgpr_write_b32 a7, v123
m16 v[68:71],a[244:247],a[80:83],v[68:71]
v_mul_f32 v152, s40, v152
v_mul_f32 v153, s40, v153
v_mul_f32 v154, s40, v154
m16 v[40:43],a[248:251],a[76:79],v[40:43]
v_add_u32 v250, 640, v250
v_mul_f32 v155, s40, v155
v_mul_f32 v156, s40, v156
m16 v[72:75],a[248:251],a[80:83],v[72:75]
v_mul_f32 v157, s40, v157
v_mul_f32 v158, s40, v158
v_mul_f32 v159, s40, v159
m16 v[44:47],a[252:255],a[76:79],v[44:47]
cvt v152,v152,v153
cvt v153,v154,v155
cvt v154,v156,v157
m16 v[76:79],a[252:255],a[80:83],v[76:79]
cvt v155,v158,v159
v_accvgpr_write_b32 a20, v152
v_accvgpr_write_b32 a21, v153
v_accvgpr_write_b32 a22, v154
v_accvgpr_write_b32 a23, v155
r128 a[192:195],v3,0
r128 a[196:199],v3,512
r128 a[200:203],v3,64
r128 a[204:207],v3,576
r128 a[208:211],v3,128
r128 a[212:215],v3,640
r128 a[216:219],v3,192
r128 a[220:223],v3,704
v_pk_mul_f32 v[128:129], v[128:129], s[40:41]
v_pk_mul_f32 v[130:131], v[130:131], s[40:41]
v_pk_mul_f32 v[132:133], v[132:133], s[40:41]
v_pk_mul_f32 v[134:135], v[134:135], s[40:41]
cvt v128,v128,v129
cvt v129,v130,v131
cvt v130,v132,v133
cvt v131,v134,v135
v_accvgpr_write_b32 a8, v128
v_accvgpr_write_b32 a9, v129
v_accvgpr_write_b32 a10, v130
v_accvgpr_write_b32 a11, v131
v_pk_mul_f32 v[160:161], v[160:161], s[40:41]
v_pk_mul_f32 v[162:163], v[162:163], s[40:41]
v_pk_mul_f32 v[164:165], v[164:165], s[40:41]
v_pk_mul_f32 v[166:167], v[166:167], s[40:41]
cvt v160,v160,v161
cvt v161,v162,v163
cvt v162,v164,v165
cvt v163,v166,v167
v_accvgpr_write_b32 a24, v160
v_accvgpr_write_b32 a25, v161
v_accvgpr_write_b32 a26, v162
v_accvgpr_write_b32 a27, v163
v_pk_mul_f32 v[136:137], v[136:137], s[40:41]
v_pk_mul_f32 v[138:139], v[138:139], s[40:41]
v_pk_mul_f32 v[140:141], v[140:141], s[40:41]
v_pk_mul_f32 v[142:143], v[142:143], s[40:41]
cvt v136,v136,v137
cvt v137,v138,v139
cvt v138,v140,v141
cvt v139,v142,v143
v_accvgpr_write_b32 a12, v136
v_accvgpr_write_b32 a13, v137
v_accvgpr_write_b32 a14, v138
v_accvgpr_write_b32 a15, v139
v_pk_mul_f32 v[168:169], v[168:169], s[40:41]
v_pk_mul_f32 v[170:171], v[170:171], s[40:41]
v_pk_mul_f32 v[172:173], v[172:173], s[40:41]
v_pk_mul_f32 v[174:175], v[174:175], s[40:41]
cvt v168,v168,v169
cvt v169,v170,v171
cvt v170,v172,v173
cvt v171,v174,v175
v_accvgpr_write_b32 a28, v168
v_accvgpr_write_b32 a29, v169
v_accvgpr_write_b32 a30, v170
v_accvgpr_write_b32 a31, v171
s_waitcnt lgkmcnt(0)
m16 v[112:115],a[192:195],a[0:3],0
v_pk_mul_f32 v[16:17], v[16:17], s[40:41]
v_pk_mul_f32 v[18:19], v[18:19], s[40:41]
m16 v[120:123],a[192:195],a[16:19],0
v_pk_mul_f32 v[20:21], v[20:21], s[40:41]
v_pk_mul_f32 v[22:23], v[22:23], s[40:41]
m16 v[116:119],a[196:199],a[0:3],0
cvt v16,v16,v17
cvt v17,v18,v19
m16 v[124:127],a[196:199],a[16:19],0
cvt v18,v20,v21
cvt v19,v22,v23
m16 v[112:115],a[200:203],a[4:7],v[112:115]
v_accvgpr_write_b32 a48, v16
v_accvgpr_write_b32 a49, v17
m16 v[120:123],a[200:203],a[20:23],v[120:123]
v_accvgpr_write_b32 a50, v18
v_accvgpr_write_b32 a51, v19
m16 v[116:119],a[204:207],a[4:7],v[116:119]
v_pk_mul_f32 v[48:49], v[48:49], s[40:41]
v_pk_mul_f32 v[50:51], v[50:51], s[40:41]
m16 v[124:127],a[204:207],a[20:23],v[124:127]
v_pk_mul_f32 v[52:53], v[52:53], s[40:41]
v_pk_mul_f32 v[54:55], v[54:55], s[40:41]
m16 v[112:115],a[208:211],a[8:11],v[112:115]
cvt v48,v48,v49
cvt v49,v50,v51
m16 v[120:123],a[208:211],a[24:27],v[120:123]
cvt v50,v52,v53
cvt v51,v54,v55
m16 v[116:119],a[212:215],a[8:11],v[116:119]
v_accvgpr_write_b32 a64, v48
v_accvgpr_write_b32 a65, v49
m16 v[124:127],a[212:215],a[24:27],v[124:127]
v_accvgpr_write_b32 a66, v50
v_accvgpr_write_b32 a67, v51
m16 v[112:115],a[216:219],a[12:15],v[112:115]
v_pk_mul_f32 v[24:25], v[24:25], s[40:41]
v_pk_mul_f32 v[26:27], v[26:27], s[40:41]
m16 v[120:123],a[216:219],a[28:31],v[120:123]
v_pk_mul_f32 v[28:29], v[28:29], s[40:41]
v_pk_mul_f32 v[30:31], v[30:31], s[40:41]
m16 v[116:119],a[220:223],a[12:15],v[116:119]
cvt v24,v24,v25
cvt v25,v26,v27
m16 v[124:127],a[220:223],a[28:31],v[124:127]
cvt v26,v28,v29
cvt v27,v30,v31
r128 a[192:195],v3,8448
r128 a[196:199],v3,8960
r128 a[200:203],v3,8512
r128 a[204:207],v3,9024
r128 a[208:211],v3,8576
r128 a[212:215],v3,9088
r128 a[216:219],v3,8640
r128 a[220:223],v3,9152
v_accvgpr_write_b32 a52, v24
v_accvgpr_write_b32 a53, v25
v_accvgpr_write_b32 a54, v26
v_accvgpr_write_b32 a55, v27
v_pk_mul_f32 v[56:57], v[56:57], s[40:41]
v_pk_mul_f32 v[58:59], v[58:59], s[40:41]
v_pk_mul_f32 v[60:61], v[60:61], s[40:41]
v_pk_mul_f32 v[62:63], v[62:63], s[40:41]
cvt v56,v56,v57
cvt v57,v58,v59
cvt v58,v60,v61
cvt v59,v62,v63
v_accvgpr_write_b32 a68, v56
v_accvgpr_write_b32 a69, v57
v_accvgpr_write_b32 a70, v58
v_accvgpr_write_b32 a71, v59
v_pk_mul_f32 v[32:33], v[32:33], s[40:41]
v_pk_mul_f32 v[34:35], v[34:35], s[40:41]
v_pk_mul_f32 v[36:37], v[36:37], s[40:41]
v_pk_mul_f32 v[38:39], v[38:39], s[40:41]
cvt v32,v32,v33
cvt v33,v34,v35
cvt v34,v36,v37
cvt v35,v38,v39
v_accvgpr_write_b32 a56, v32
v_accvgpr_write_b32 a57, v33
v_accvgpr_write_b32 a58, v34
v_accvgpr_write_b32 a59, v35
v_pk_mul_f32 v[64:65], v[64:65], s[40:41]
v_pk_mul_f32 v[66:67], v[66:67], s[40:41]
v_pk_mul_f32 v[68:69], v[68:69], s[40:41]
v_pk_mul_f32 v[70:71], v[70:71], s[40:41]
cvt v64,v64,v65
cvt v65,v66,v67
cvt v66,v68,v69
cvt v67,v70,v71
v_accvgpr_write_b32 a72, v64
v_accvgpr_write_b32 a73, v65
v_accvgpr_write_b32 a74, v66
v_accvgpr_write_b32 a75, v67
v_pk_mul_f32 v[40:41], v[40:41], s[40:41]
v_pk_mul_f32 v[42:43], v[42:43], s[40:41]
v_pk_mul_f32 v[44:45], v[44:45], s[40:41]
v_pk_mul_f32 v[46:47], v[46:47], s[40:41]
cvt v40,v40,v41
cvt v41,v42,v43
cvt v42,v44,v45
cvt v43,v46,v47
v_accvgpr_write_b32 a60, v40
v_accvgpr_write_b32 a61, v41
v_accvgpr_write_b32 a62, v42
v_accvgpr_write_b32 a63, v43
v_pk_mul_f32 v[72:73], v[72:73], s[40:41]
v_pk_mul_f32 v[74:75], v[74:75], s[40:41]
v_pk_mul_f32 v[76:77], v[76:77], s[40:41]
v_pk_mul_f32 v[78:79], v[78:79], s[40:41]
cvt v72,v72,v73
cvt v73,v74,v75
cvt v74,v76,v77
cvt v75,v78,v79
v_accvgpr_write_b32 a76, v72
v_accvgpr_write_b32 a77, v73
v_accvgpr_write_b32 a78, v74
v_accvgpr_write_b32 a79, v75
v_mov_b32 v241, 163824
v_mov_b32 v242, 0
v_mov_b32 v243, 0
ds_write_b64 v241, v[242:243]
v_add_u32 v209, 67584, v15
v_mov_b32 v220, 0x3f803f80
v_mov_b32 v221, 0x3f803f80
v_mov_b32 v222, 0x3f803f80
v_mov_b32 v223, 0x3f803f80
v_mov_b32 v224, 0xff800000
v_mov_b32 v225, 0xff800000
v_mov_b32 v226, 0xff800000
v_mov_b32 v227, 0xff800000
v_mov_b32 v228, 0xff800000
v_mov_b32 v229, 0xff800000
Lb_attn:
v_max3_f32 v230, v112, v113, v224
v_max3_f32 v232, v120, v121, v225
v_max3_f32 v230, v230, v114, v115
v_max3_f32 v232, v232, v122, v123
v_max3_f32 v230, v230, v116, v117
v_max3_f32 v232, v232, v124, v125
v_max3_f32 v230, v230, v118, v119
v_max3_f32 v232, v232, v126, v127
v_mov_b32 v231, v230
v_mov_b32 v233, v232
s_nop 0
v_permlane16_swap_b32 v230, v231
v_permlane16_swap_b32 v232, v233
v_max_f32 v230, v230, v231
v_max_f32 v232, v232, v233
v_mov_b32 v231, v230
v_mov_b32 v233, v232
s_nop 0
v_permlane32_swap_b32 v230, v231
v_permlane32_swap_b32 v232, v233
v_max_f32 v230, v230, v231
v_max_f32 v232, v232, v233
v_sub_f32 v184, 0, v230
v_sub_f32 v188, 0, v232
v_sub_f32 v185, 0, v230
v_sub_f32 v189, 0, v232
v_sub_f32 v186, 0, v230
v_sub_f32 v190, 0, v232
v_sub_f32 v187, 0, v230
v_sub_f32 v191, 0, v232
v_sub_f32 v112, v112, v230
v_sub_f32 v120, v120, v232
v_sub_f32 v113, v113, v230
v_sub_f32 v121, v121, v232
v_sub_f32 v114, v114, v230
v_sub_f32 v122, v122, v232
v_sub_f32 v115, v115, v230
v_sub_f32 v123, v123, v232
v_sub_f32 v116, v116, v230
v_sub_f32 v124, v124, v232
v_sub_f32 v117, v117, v230
v_sub_f32 v125, v125, v232
v_sub_f32 v118, v118, v230
v_sub_f32 v126, v126, v232
v_sub_f32 v119, v119, v230
v_sub_f32 v127, v127, v232
s_waitcnt lgkmcnt(1)
m16 v[136:139],a[192:195],a[0:3],v[184:187]
v_exp_f32 v112, v112
m16 v[144:147],a[192:195],a[16:19],v[188:191]
v_exp_f32 v113, v113
m16 v[140:143],a[196:199],a[0:3],v[184:187]
v_exp_f32 v114, v114
m16 v[148:151],a[196:199],a[16:19],v[188:191]
v_exp_f32 v115, v115
m16 v[136:139],a[200:203],a[4:7],v[136:139]
v_exp_f32 v116, v116
m16 v[144:147],a[200:203],a[20:23],v[144:147]
v_exp_f32 v117, v117
m16 v[140:143],a[204:207],a[4:7],v[140:143]
v_exp_f32 v118, v118
m16 v[148:151],a[204:207],a[20:23],v[148:151]
v_exp_f32 v119, v119
m16 v[136:139],a[208:211],a[8:11],v[136:139]
v_exp_f32 v120, v120
m16 v[144:147],a[208:211],a[24:27],v[144:147]
v_exp_f32 v121, v121
m16 v[140:143],a[212:215],a[8:11],v[140:143]
v_exp_f32 v122, v122
m16 v[148:151],a[212:215],a[24:27],v[148:151]
v_exp_f32 v123, v123
m16 v[136:139],a[216:219],a[12:15],v[136:139]
v_exp_f32 v124, v124
m16 v[144:147],a[216:219],a[28:31],v[144:147]
v_exp_f32 v125, v125
m16 v[140:143],a[220:223],a[12:15],v[140:143]
v_exp_f32 v126, v126
m16 v[148:151],a[220:223],a[28:31],v[148:151]
v_exp_f32 v127, v127
cvt v160,v112,v113
cvt v161,v114,v115
cvt v162,v116,v117
cvt v163,v118,v119
cvt v164,v120,v121
cvt v165,v122,v123
s_waitcnt lgkmcnt(0)
s_barrier
cvt v166,v124,v125
cvt v167,v126,v127
r128 a[192:195],v3,33792
s_add_u32 m0, s100, 0
r128 a[196:199],v3,34304
r128 a[200:203],v3,33856
r128 a[204:207],v3,34368
r128 a[208:211],v3,33920
s_mov_b32 s28, 65536
r128 a[212:215],v3,34432
r128 a[216:219],v3,33984
r128 a[220:223],v3,34496
buffer_load_dwordx4 v14, s[16:19], s28 offen offset:0 nt lds
s_waitcnt lgkmcnt(0)
m16 v[112:115],a[192:195],a[0:3],v[184:187]
v_exp_f32 v136, v136
rtr a[224:225],v4,0
m16 v[120:123],a[192:195],a[16:19],v[188:191]
rtr a[226:227],v4,512
s_add_u32 m0, s100, 800
rtr a[228:229],v4,32
m16 v[116:119],a[196:199],a[0:3],v[184:187]
v_exp_f32 v137, v137
rtr a[230:231],v4,544
m16 v[124:127],a[196:199],a[16:19],v[188:191]
v_exp_f32 v138, v138
rtr a[232:233],v4,64
m16 v[112:115],a[200:203],a[4:7],v[112:115]
rtr a[234:235],v4,576
s_mov_b32 s28, 65536
rtr a[236:237],v4,96
m16 v[120:123],a[200:203],a[20:23],v[120:123]
v_exp_f32 v139, v139
rtr a[238:239],v4,608
m16 v[116:119],a[204:207],a[4:7],v[116:119]
rtr a[240:241],v4,128
rtr a[242:243],v4,640
cvt v172,v136,v137
m16 v[124:127],a[204:207],a[20:23],v[124:127]
v_exp_f32 v140, v140
rtr a[244:245],v4,160
m16 v[112:115],a[208:211],a[8:11],v[112:115]
buffer_load_dwordx4 v14, s[16:19], s28 offen offset:256 nt lds
rtr a[246:247],v4,672
m16 v[120:123],a[208:211],a[24:27],v[120:123]
v_exp_f32 v141, v141
m16 v[116:119],a[212:215],a[8:11],v[116:119]
rtr a[248:249],v4,192
rtr a[250:251],v4,704
m16 v[124:127],a[212:215],a[24:27],v[124:127]
rtr a[252:253],v4,224
s_add_u32 m0, s100, 8448
m16 v[112:115],a[216:219],a[12:15],v[112:115]
v_exp_f32 v142, v142
m16 v[120:123],a[216:219],a[28:31],v[120:123]
rtr a[254:255],v4,736
cvt v173,v138,v139
m16 v[116:119],a[220:223],a[12:15],v[116:119]
v_exp_f32 v143, v143
m16 v[124:127],a[220:223],a[28:31],v[124:127]
s_mov_b32 s28, 73728
r128 a[192:195],v3,42240
m16 v[196:199],v[220:223],v[160:163],0
v_exp_f32 v144, v144
m16 v[200:203],v[220:223],v[164:167],0
r128 a[196:199],v3,42752
s_waitcnt lgkmcnt(10)
m16 v[16:19],a[224:227],v[160:163],0
v_exp_f32 v145, v145
m16 v[48:51],a[224:227],v[164:167],0
buffer_load_dwordx4 v14, s[16:19], s28 offen offset:0 nt lds
r128 a[200:203],v3,42304
m16 v[20:23],a[228:231],v[160:163],0
r128 a[204:207],v3,42816
cvt v174,v140,v141
m16 v[52:55],a[228:231],v[164:167],0
v_exp_f32 v146, v146
m16 v[24:27],a[232:235],v[160:163],0
r128 a[208:211],v3,42368
s_add_u32 m0, s100, 9248
m16 v[56:59],a[232:235],v[164:167],0
v_exp_f32 v147, v147
m16 v[28:31],a[236:239],v[160:163],0
r128 a[212:215],v3,42880
s_mov_b32 s28, 73728
m16 v[60:63],a[236:239],v[164:167],0
v_exp_f32 v148, v148
r128 a[216:219],v3,42432
s_waitcnt lgkmcnt(7)
m16 v[32:35],a[240:243],v[160:163],0
v_exp_f32 v149, v149
m16 v[64:67],a[240:243],v[164:167],0
r128 a[220:223],v3,42944
cvt v175,v142,v143
m16 v[36:39],a[244:247],v[160:163],0
v_exp_f32 v150, v150
m16 v[68:71],a[244:247],v[164:167],0
buffer_load_dwordx4 v14, s[16:19], s28 offen offset:256 nt lds
cvt v176,v144,v145
m16 v[40:43],a[248:251],v[160:163],0
v_exp_f32 v151, v151
m16 v[72:75],a[248:251],v[164:167],0
cvt v177,v146,v147
cvt v178,v148,v149
m16 v[44:47],a[252:255],v[160:163],0
cvt v179,v150,v151
m16 v[76:79],a[252:255],v[164:167],0
s_waitcnt lgkmcnt(0)
m16 v[136:139],a[192:195],a[0:3],v[184:187]
v_exp_f32 v112, v112
rtr a[224:225],v4,8448
m16 v[144:147],a[192:195],a[16:19],v[188:191]
rtr a[226:227],v4,8960
v_exp_f32 v113, v113
m16 v[140:143],a[196:199],a[0:3],v[184:187]
rtr a[228:229],v4,8480
rtr a[230:231],v4,8992
m16 v[148:151],a[196:199],a[16:19],v[188:191]
v_exp_f32 v114, v114
m16 v[136:139],a[200:203],a[4:7],v[136:139]
rtr a[232:233],v4,8512
rtr a[234:235],v4,9024
m16 v[144:147],a[200:203],a[20:23],v[144:147]
rtr a[236:237],v4,8544
rtr a[238:239],v4,9056
m16 v[140:143],a[204:207],a[4:7],v[140:143]
v_exp_f32 v115, v115
m16 v[148:151],a[204:207],a[20:23],v[148:151]
rtr a[240:241],v4,8576
rtr a[242:243],v4,9088
m16 v[136:139],a[208:211],a[8:11],v[136:139]
v_exp_f32 v116, v116
m16 v[144:147],a[208:211],a[24:27],v[144:147]
rtr a[244:245],v4,8608
rtr a[246:247],v4,9120
m16 v[140:143],a[212:215],a[8:11],v[140:143]
v_exp_f32 v117, v117
m16 v[148:151],a[212:215],a[24:27],v[148:151]
rtr a[248:249],v4,8640
rtr a[250:251],v4,9152
m16 v[136:139],a[216:219],a[12:15],v[136:139]
rtr a[252:253],v4,8672
rtr a[254:255],v4,9184
m16 v[144:147],a[216:219],a[28:31],v[144:147]
v_exp_f32 v118, v118
m16 v[140:143],a[220:223],a[12:15],v[140:143]
v_exp_f32 v119, v119
m16 v[148:151],a[220:223],a[28:31],v[148:151]
v_exp_f32 v120, v120
m16 v[196:199],v[220:223],v[172:175],v[196:199]
v_exp_f32 v121, v121
m16 v[200:203],v[220:223],v[176:179],v[200:203]
s_waitcnt lgkmcnt(0)
s_barrier
m16 v[16:19],a[224:227],v[172:175],v[16:19]
v_exp_f32 v122, v122
m16 v[48:51],a[224:227],v[176:179],v[48:51]
r128 a[192:195],v1,0
s_add_u32 m0, s100, 16896
m16 v[20:23],a[228:231],v[172:175],v[20:23]
r128 a[196:199],v1,512
cvt v160,v112,v113
m16 v[52:55],a[228:231],v[176:179],v[52:55]
r128 a[200:203],v1,64
cvt v161,v114,v115
m16 v[24:27],a[232:235],v[172:175],v[24:27]
v_exp_f32 v123, v123
m16 v[56:59],a[232:235],v[176:179],v[56:59]
r128 a[204:207],v1,576
s_mov_b32 s28, 65536
m16 v[28:31],a[236:239],v[172:175],v[28:31]
r128 a[208:211],v1,128
cvt v162,v116,v117
m16 v[60:63],a[236:239],v[176:179],v[60:63]
v_exp_f32 v124, v124
r128 a[212:215],v1,640
m16 v[32:35],a[240:243],v[172:175],v[32:35]
r128 a[216:219],v1,192
cvt v163,v118,v119
m16 v[64:67],a[240:243],v[176:179],v[64:67]
v_exp_f32 v125, v125
r128 a[220:223],v1,704
m16 v[36:39],a[244:247],v[172:175],v[36:39]
v_exp_f32 v126, v126
m16 v[68:71],a[244:247],v[176:179],v[68:71]
buffer_load_dwordx4 v14, s[20:23], s28 offen offset:0 nt lds
cvt v164,v120,v121
m16 v[40:43],a[248:251],v[172:175],v[40:43]
v_exp_f32 v127, v127
m16 v[72:75],a[248:251],v[176:179],v[72:75]
cvt v165,v122,v123
cvt v166,v124,v125
m16 v[44:47],a[252:255],v[172:175],v[44:47]
cvt v167,v126,v127
m16 v[76:79],a[252:255],v[176:179],v[76:79]
s_waitcnt lgkmcnt(0)
m16 v[112:115],a[192:195],a[0:3],v[184:187]
v_exp_f32 v136, v136
rtr a[224:225],v4,33792
m16 v[120:123],a[192:195],a[16:19],v[188:191]
rtr a[226:227],v4,34304
s_add_u32 m0, s100, 17696
rtr a[228:229],v4,33824
m16 v[116:119],a[196:199],a[0:3],v[184:187]
v_exp_f32 v137, v137
rtr a[230:231],v4,34336
m16 v[124:127],a[196:199],a[16:19],v[188:191]
v_exp_f32 v138, v138
rtr a[232:233],v4,33856
m16 v[112:115],a[200:203],a[4:7],v[112:115]
rtr a[234:235],v4,34368
s_mov_b32 s28, 65536
ds_write_b128 v15, a[96:99] offset:33792
m16 v[120:123],a[200:203],a[20:23],v[120:123]
rtr a[236:237],v4,33888
v_exp_f32 v139, v139
m16 v[116:119],a[204:207],a[4:7],v[116:119]
rtr a[238:239],v4,34400
rtr a[240:241],v4,33920
rtr a[242:243],v4,34432
m16 v[124:127],a[204:207],a[20:23],v[124:127]
v_exp_f32 v140, v140
rtr a[244:245],v4,33952
m16 v[112:115],a[208:211],a[8:11],v[112:115]
buffer_load_dwordx4 v14, s[20:23], s28 offen offset:256 nt lds
rtr a[246:247],v4,34464
cvt v172,v136,v137
m16 v[120:123],a[208:211],a[24:27],v[120:123]
v_exp_f32 v141, v141
rtr a[248:249],v4,33984
m16 v[116:119],a[212:215],a[8:11],v[116:119]
rtr a[250:251],v4,34496
ds_write_b128 v15, a[100:103] offset:34848
rtr a[252:253],v4,34016
m16 v[124:127],a[212:215],a[24:27],v[124:127]
s_add_u32 m0, s100, 25344
v_exp_f32 v142, v142
m16 v[112:115],a[216:219],a[12:15],v[112:115]
rtr a[254:255],v4,34528
cvt v173,v138,v139
m16 v[120:123],a[216:219],a[28:31],v[120:123]
v_exp_f32 v143, v143
m16 v[116:119],a[220:223],a[12:15],v[116:119]
s_mov_b32 s28, 73728
cvt v174,v140,v141
m16 v[124:127],a[220:223],a[28:31],v[124:127]
r128 a[192:195],v1,8448
cvt v175,v142,v143
m16 v[196:199],v[220:223],v[160:163],v[196:199]
v_exp_f32 v144, v144
m16 v[200:203],v[220:223],v[164:167],v[200:203]
r128 a[196:199],v1,8960
s_waitcnt lgkmcnt(11)
m16 v[16:19],a[224:227],v[160:163],v[16:19]
ds_write_b128 v15, a[104:107] offset:42240
buffer_load_dwordx4 v14, s[20:23], s28 offen offset:0 nt lds
m16 v[48:51],a[224:227],v[164:167],v[48:51]
v_exp_f32 v145, v145
r128 a[200:203],v1,8512
m16 v[20:23],a[228:231],v[160:163],v[20:23]
r128 a[204:207],v1,9024
cvt v176,v144,v145
m16 v[52:55],a[228:231],v[164:167],v[52:55]
v_exp_f32 v146, v146
m16 v[24:27],a[232:235],v[160:163],v[24:27]
r128 a[208:211],v1,8576
s_add_u32 m0, s100, 26144
m16 v[56:59],a[232:235],v[164:167],v[56:59]
v_exp_f32 v147, v147
m16 v[28:31],a[236:239],v[160:163],v[28:31]
ds_write_b128 v15, a[108:111] offset:43296
r128 a[212:215],v1,9088
m16 v[60:63],a[236:239],v[164:167],v[60:63]
v_exp_f32 v148, v148
r128 a[216:219],v1,8640
s_waitcnt lgkmcnt(9)
m16 v[32:35],a[240:243],v[160:163],v[32:35]
s_mov_b32 s28, 73728
r128 a[220:223],v1,9152
m16 v[64:67],a[240:243],v[164:167],v[64:67]
v_exp_f32 v149, v149
m16 v[36:39],a[244:247],v[160:163],v[36:39]
v_exp_f32 v150, v150
m16 v[68:71],a[244:247],v[164:167],v[68:71]
buffer_load_dwordx4 v14, s[20:23], s28 offen offset:256 nt lds
cvt v177,v146,v147
m16 v[40:43],a[248:251],v[160:163],v[40:43]
v_exp_f32 v151, v151
m16 v[72:75],a[248:251],v[164:167],v[72:75]
cvt v178,v148,v149
cvt v179,v150,v151
m16 v[44:47],a[252:255],v[160:163],v[44:47]
m16 v[76:79],a[252:255],v[164:167],v[76:79]
s_waitcnt lgkmcnt(0)
m16 v[136:139],a[192:195],a[0:3],v[184:187]
v_exp_f32 v112, v112
rtr a[224:225],v4,42240
m16 v[144:147],a[192:195],a[16:19],v[188:191]
rtr a[226:227],v4,42752
v_exp_f32 v113, v113
m16 v[140:143],a[196:199],a[0:3],v[184:187]
rtr a[228:229],v4,42272
rtr a[230:231],v4,42784
m16 v[148:151],a[196:199],a[16:19],v[188:191]
v_exp_f32 v114, v114
m16 v[136:139],a[200:203],a[4:7],v[136:139]
rtr a[232:233],v4,42304
rtr a[234:235],v4,42816
m16 v[144:147],a[200:203],a[20:23],v[144:147]
rtr a[236:237],v4,42336
rtr a[238:239],v4,42848
m16 v[140:143],a[204:207],a[4:7],v[140:143]
v_exp_f32 v115, v115
m16 v[148:151],a[204:207],a[20:23],v[148:151]
rtr a[240:241],v4,42368
rtr a[242:243],v4,42880
m16 v[136:139],a[208:211],a[8:11],v[136:139]
v_exp_f32 v116, v116
m16 v[144:147],a[208:211],a[24:27],v[144:147]
rtr a[244:245],v4,42400
rtr a[246:247],v4,42912
m16 v[140:143],a[212:215],a[8:11],v[140:143]
v_exp_f32 v117, v117
m16 v[148:151],a[212:215],a[24:27],v[148:151]
rtr a[248:249],v4,42432
rtr a[250:251],v4,42944
m16 v[136:139],a[216:219],a[12:15],v[136:139]
rtr a[252:253],v4,42464
rtr a[254:255],v4,42976
m16 v[144:147],a[216:219],a[28:31],v[144:147]
v_exp_f32 v118, v118
m16 v[140:143],a[220:223],a[12:15],v[140:143]
v_exp_f32 v119, v119
m16 v[148:151],a[220:223],a[28:31],v[148:151]
v_exp_f32 v120, v120
m16 v[196:199],v[220:223],v[172:175],v[196:199]
v_exp_f32 v121, v121
m16 v[200:203],v[220:223],v[176:179],v[200:203]
s_waitcnt vmcnt(17) lgkmcnt(0)
s_barrier
m16 v[16:19],a[224:227],v[172:175],v[16:19]
v_exp_f32 v122, v122
m16 v[48:51],a[224:227],v[176:179],v[48:51]
r128 a[192:195],v1,33792
s_add_u32 m0, s100, 50688
m16 v[20:23],a[228:231],v[172:175],v[20:23]
r128 a[196:199],v1,34304
cvt v160,v112,v113
m16 v[52:55],a[228:231],v[176:179],v[52:55]
r128 a[200:203],v1,33856
cvt v161,v114,v115
m16 v[24:27],a[232:235],v[172:175],v[24:27]
v_exp_f32 v123, v123
m16 v[56:59],a[232:235],v[176:179],v[56:59]
r128 a[204:207],v1,34368
s_mov_b32 s28, 81920
m16 v[28:31],a[236:239],v[172:175],v[28:31]
r128 a[208:211],v1,33920
cvt v162,v116,v117
m16 v[60:63],a[236:239],v[176:179],v[60:63]
v_exp_f32 v124, v124
r128 a[212:215],v1,34432
m16 v[32:35],a[240:243],v[172:175],v[32:35]
r128 a[216:219],v1,33984
cvt v163,v118,v119
m16 v[64:67],a[240:243],v[176:179],v[64:67]
v_exp_f32 v125, v125
r128 a[220:223],v1,34496
m16 v[36:39],a[244:247],v[172:175],v[36:39]
v_exp_f32 v126, v126
m16 v[68:71],a[244:247],v[176:179],v[68:71]
buffer_load_dwordx4 v14, s[20:23], s28 offen offset:0 nt lds
cvt v164,v120,v121
m16 v[40:43],a[248:251],v[172:175],v[40:43]
v_exp_f32 v127, v127
m16 v[72:75],a[248:251],v[176:179],v[72:75]
cvt v165,v122,v123
cvt v166,v124,v125
m16 v[44:47],a[252:255],v[172:175],v[44:47]
cvt v167,v126,v127
m16 v[76:79],a[252:255],v[176:179],v[76:79]
s_waitcnt lgkmcnt(0)
m16 v[112:115],a[192:195],a[0:3],v[184:187]
v_exp_f32 v136, v136
rtr a[224:225],v2,0
m16 v[120:123],a[192:195],a[16:19],v[188:191]
rtr a[226:227],v2,512
s_add_u32 m0, s100, 51488
rtr a[228:229],v2,32
m16 v[116:119],a[196:199],a[0:3],v[184:187]
v_exp_f32 v137, v137
rtr a[230:231],v2,544
m16 v[124:127],a[196:199],a[16:19],v[188:191]
s_mov_b32 s28, 81920
v_exp_f32 v138, v138
m16 v[112:115],a[200:203],a[4:7],v[112:115]
rtr a[232:233],v2,64
rtr a[234:235],v2,576
rtr a[236:237],v2,96
m16 v[120:123],a[200:203],a[20:23],v[120:123]
v_exp_f32 v139, v139
rtr a[238:239],v2,608
m16 v[116:119],a[204:207],a[4:7],v[116:119]
buffer_load_dwordx4 v14, s[20:23], s28 offen offset:256 nt lds
rtr a[240:241],v2,128
rtr a[242:243],v2,640
m16 v[124:127],a[204:207],a[20:23],v[124:127]
v_exp_f32 v140, v140
rtr a[244:245],v2,160
m16 v[112:115],a[208:211],a[8:11],v[112:115]
rtr a[246:247],v2,672
s_add_u32 m0, s100, 59136
cvt v172,v136,v137
m16 v[120:123],a[208:211],a[24:27],v[120:123]
v_exp_f32 v141, v141
rtr a[248:249],v2,192
m16 v[116:119],a[212:215],a[8:11],v[116:119]
rtr a[250:251],v2,704
rtr a[252:253],v2,224
s_mov_b32 s28, 90112
m16 v[124:127],a[212:215],a[24:27],v[124:127]
v_exp_f32 v142, v142
m16 v[112:115],a[216:219],a[12:15],v[112:115]
rtr a[254:255],v2,736
cvt v173,v138,v139
m16 v[120:123],a[216:219],a[28:31],v[120:123]
v_exp_f32 v143, v143
m16 v[116:119],a[220:223],a[12:15],v[116:119]
buffer_load_dwordx4 v14, s[20:23], s28 offen offset:0 nt lds
cvt v174,v140,v141
m16 v[124:127],a[220:223],a[28:31],v[124:127]
r128 a[192:195],v1,42240
cvt v175,v142,v143
m16 v[196:199],v[220:223],v[160:163],v[196:199]
v_exp_f32 v144, v144
m16 v[200:203],v[220:223],v[164:167],v[200:203]
r128 a[196:199],v1,42752
s_waitcnt lgkmcnt(10)
m16 v[16:19],a[224:227],v[160:163],v[16:19]
s_add_u32 m0, s100, 59936
r128 a[200:203],v1,42304
m16 v[48:51],a[224:227],v[164:167],v[48:51]
v_exp_f32 v145, v145
m16 v[20:23],a[228:231],v[160:163],v[20:23]
s_mov_b32 s28, 90112
r128 a[204:207],v1,42816
m16 v[52:55],a[228:231],v[164:167],v[52:55]
v_exp_f32 v146, v146
m16 v[24:27],a[232:235],v[160:163],v[24:27]
r128 a[208:211],v1,42368
buffer_load_dwordx4 v14, s[20:23], s28 offen offset:256 nt lds
m16 v[56:59],a[232:235],v[164:167],v[56:59]
v_exp_f32 v147, v147
m16 v[28:31],a[236:239],v[160:163],v[28:31]
r128 a[212:215],v1,42880
s_add_u32 m0, s100, 67584
m16 v[60:63],a[236:239],v[164:167],v[60:63]
v_exp_f32 v148, v148
r128 a[216:219],v1,42432
s_waitcnt lgkmcnt(7)
m16 v[32:35],a[240:243],v[160:163],v[32:35]
v_exp_f32 v149, v149
m16 v[64:67],a[240:243],v[164:167],v[64:67]
r128 a[220:223],v1,42944
s_mov_b32 s28, 98304
m16 v[36:39],a[244:247],v[160:163],v[36:39]
v_exp_f32 v150, v150
m16 v[68:71],a[244:247],v[164:167],v[68:71]
v_exp_f32 v151, v151
m16 v[40:43],a[248:251],v[160:163],v[40:43]
buffer_load_dwordx4 v14, s[16:19], s28 offen offset:0 nt lds
cvt v176,v144,v145
m16 v[72:75],a[248:251],v[164:167],v[72:75]
cvt v177,v146,v147
cvt v178,v148,v149
m16 v[44:47],a[252:255],v[160:163],v[44:47]
cvt v179,v150,v151
m16 v[76:79],a[252:255],v[164:167],v[76:79]
s_waitcnt lgkmcnt(0)
m16 v[136:139],a[192:195],a[0:3],v[184:187]
v_exp_f32 v112, v112
rtr a[224:225],v2,8448
m16 v[144:147],a[192:195],a[16:19],v[188:191]
rtr a[226:227],v2,8960
v_exp_f32 v113, v113
m16 v[140:143],a[196:199],a[0:3],v[184:187]
rtr a[228:229],v2,8480
rtr a[230:231],v2,8992
m16 v[148:151],a[196:199],a[16:19],v[188:191]
v_exp_f32 v114, v114
m16 v[136:139],a[200:203],a[4:7],v[136:139]
rtr a[232:233],v2,8512
rtr a[234:235],v2,9024
m16 v[144:147],a[200:203],a[20:23],v[144:147]
rtr a[236:237],v2,8544
rtr a[238:239],v2,9056
m16 v[140:143],a[204:207],a[4:7],v[140:143]
v_exp_f32 v115, v115
m16 v[148:151],a[204:207],a[20:23],v[148:151]
rtr a[240:241],v2,8576
rtr a[242:243],v2,9088
m16 v[136:139],a[208:211],a[8:11],v[136:139]
v_exp_f32 v116, v116
m16 v[144:147],a[208:211],a[24:27],v[144:147]
rtr a[244:245],v2,8608
rtr a[246:247],v2,9120
m16 v[140:143],a[212:215],a[8:11],v[140:143]
v_exp_f32 v117, v117
m16 v[148:151],a[212:215],a[24:27],v[148:151]
rtr a[248:249],v2,8640
rtr a[250:251],v2,9152
m16 v[136:139],a[216:219],a[12:15],v[136:139]
rtr a[252:253],v2,8672
rtr a[254:255],v2,9184
m16 v[144:147],a[216:219],a[28:31],v[144:147]
v_exp_f32 v118, v118
m16 v[140:143],a[220:223],a[12:15],v[140:143]
v_exp_f32 v119, v119
m16 v[148:151],a[220:223],a[28:31],v[148:151]
v_exp_f32 v120, v120
m16 v[196:199],v[220:223],v[172:175],v[196:199]
v_exp_f32 v121, v121
m16 v[200:203],v[220:223],v[176:179],v[200:203]
s_waitcnt vmcnt(9) lgkmcnt(0)
s_barrier
m16 v[16:19],a[224:227],v[172:175],v[16:19]
v_exp_f32 v122, v122
m16 v[48:51],a[224:227],v[176:179],v[48:51]
r128 a[192:195],v3,0
s_add_u32 m0, s100, 68384
m16 v[20:23],a[228:231],v[172:175],v[20:23]
r128 a[196:199],v3,512
cvt v160,v112,v113
m16 v[52:55],a[228:231],v[176:179],v[52:55]
r128 a[200:203],v3,64
cvt v161,v114,v115
m16 v[24:27],a[232:235],v[172:175],v[24:27]
v_exp_f32 v123, v123
m16 v[56:59],a[232:235],v[176:179],v[56:59]
r128 a[204:207],v3,576
s_mov_b32 s28, 98304
m16 v[28:31],a[236:239],v[172:175],v[28:31]
r128 a[208:211],v3,128
cvt v162,v116,v117
m16 v[60:63],a[236:239],v[176:179],v[60:63]
v_exp_f32 v124, v124
r128 a[212:215],v3,640
m16 v[32:35],a[240:243],v[172:175],v[32:35]
r128 a[216:219],v3,192
cvt v163,v118,v119
m16 v[64:67],a[240:243],v[176:179],v[64:67]
v_exp_f32 v125, v125
r128 a[220:223],v3,704
m16 v[36:39],a[244:247],v[172:175],v[36:39]
v_exp_f32 v126, v126
m16 v[68:71],a[244:247],v[176:179],v[68:71]
buffer_load_dwordx4 v14, s[16:19], s28 offen offset:256 nt lds
cvt v164,v120,v121
m16 v[40:43],a[248:251],v[172:175],v[40:43]
v_exp_f32 v127, v127
m16 v[72:75],a[248:251],v[176:179],v[72:75]
cvt v165,v122,v123
cvt v166,v124,v125
m16 v[44:47],a[252:255],v[172:175],v[44:47]
cvt v167,v126,v127
m16 v[76:79],a[252:255],v[176:179],v[76:79]
s_waitcnt lgkmcnt(0)
m16 v[112:115],a[192:195],a[0:3],v[184:187]
v_exp_f32 v136, v136
rtr a[224:225],v2,33792
m16 v[120:123],a[192:195],a[16:19],v[188:191]
rtr a[226:227],v2,34304
s_add_u32 m0, s100, 76032
rtr a[228:229],v2,33824
m16 v[116:119],a[196:199],a[0:3],v[184:187]
v_exp_f32 v137, v137
rtr a[230:231],v2,34336
m16 v[124:127],a[196:199],a[16:19],v[188:191]
s_mov_b32 s28, 106496
v_exp_f32 v138, v138
m16 v[112:115],a[200:203],a[4:7],v[112:115]
rtr a[232:233],v2,33856
rtr a[234:235],v2,34368
ds_write_b128 v209, a[112:115] offset:33792
m16 v[120:123],a[200:203],a[20:23],v[120:123]
rtr a[236:237],v2,33888
v_exp_f32 v139, v139
m16 v[116:119],a[204:207],a[4:7],v[116:119]
rtr a[238:239],v2,34400
buffer_load_dwordx4 v14, s[16:19], s28 offen offset:0 nt lds
rtr a[240:241],v2,33920
m16 v[124:127],a[204:207],a[20:23],v[124:127]
rtr a[242:243],v2,34432
v_exp_f32 v140, v140
m16 v[112:115],a[208:211],a[8:11],v[112:115]
rtr a[244:245],v2,33952
rtr a[246:247],v2,34464
s_add_u32 m0, s100, 76832
m16 v[120:123],a[208:211],a[24:27],v[120:123]
v_exp_f32 v141, v141
rtr a[248:249],v2,33984
m16 v[116:119],a[212:215],a[8:11],v[116:119]
rtr a[250:251],v2,34496
ds_write_b128 v209, a[116:119] offset:34848
rtr a[252:253],v2,34016
m16 v[124:127],a[212:215],a[24:27],v[124:127]
s_mov_b32 s28, 106496
v_exp_f32 v142, v142
m16 v[112:115],a[216:219],a[12:15],v[112:115]
rtr a[254:255],v2,34528
v_exp_f32 v143, v143
m16 v[120:123],a[216:219],a[28:31],v[120:123]
buffer_load_dwordx4 v14, s[16:19], s28 offen offset:256 nt lds
v_exp_f32 v144, v144
m16 v[116:119],a[220:223],a[12:15],v[116:119]
v_exp_f32 v145, v145
cvt v172,v136,v137
m16 v[124:127],a[220:223],a[28:31],v[124:127]
r128 a[192:195],v3,8448
cvt v173,v138,v139
m16 v[196:199],v[220:223],v[160:163],v[196:199]
r128 a[196:199],v3,8960
s_add_u32 m0, s100, 84480
m16 v[200:203],v[220:223],v[164:167],v[200:203]
ds_write_b128 v209, a[120:123] offset:42240
s_waitcnt lgkmcnt(12)
m16 v[16:19],a[224:227],v[160:163],v[16:19]
r128 a[200:203],v3,8512
s_mov_b32 s28, 98304
m16 v[48:51],a[224:227],v[164:167],v[48:51]
r128 a[204:207],v3,9024
cvt v174,v140,v141
m16 v[20:23],a[228:231],v[160:163],v[20:23]
v_exp_f32 v146, v146
m16 v[52:55],a[228:231],v[164:167],v[52:55]
r128 a[208:211],v3,8576
buffer_load_dwordx4 v14, s[20:23], s28 offen offset:0 nt lds
m16 v[24:27],a[232:235],v[160:163],v[24:27]
v_exp_f32 v147, v147
m16 v[56:59],a[232:235],v[164:167],v[56:59]
ds_write_b128 v209, a[124:127] offset:43296
r128 a[212:215],v3,9088
m16 v[28:31],a[236:239],v[160:163],v[28:31]
v_exp_f32 v148, v148
m16 v[60:63],a[236:239],v[164:167],v[60:63]
r128 a[216:219],v3,8640
s_waitcnt lgkmcnt(9)
m16 v[32:35],a[240:243],v[160:163],v[32:35]
s_add_u32 m0, s100, 85280
r128 a[220:223],v3,9152
m16 v[64:67],a[240:243],v[164:167],v[64:67]
v_exp_f32 v149, v149
m16 v[36:39],a[244:247],v[160:163],v[36:39]
s_mov_b32 s28, 98304
cvt v175,v142,v143
m16 v[68:71],a[244:247],v[164:167],v[68:71]
v_exp_f32 v150, v150
m16 v[40:43],a[248:251],v[160:163],v[40:43]
v_exp_f32 v151, v151
m16 v[72:75],a[248:251],v[164:167],v[72:75]
buffer_load_dwordx4 v14, s[20:23], s28 offen offset:256 nt lds
cvt v176,v144,v145
m16 v[44:47],a[252:255],v[160:163],v[44:47]
cvt v177,v146,v147
cvt v178,v148,v149
m16 v[76:79],a[252:255],v[164:167],v[76:79]
cvt v179,v150,v151
s_waitcnt lgkmcnt(0)
m16 v[136:139],a[192:195],a[0:3],v[184:187]
v_exp_f32 v112, v112
rtr a[224:225],v2,42240
m16 v[144:147],a[192:195],a[16:19],v[188:191]
rtr a[226:227],v2,42752
v_exp_f32 v113, v113
m16 v[140:143],a[196:199],a[0:3],v[184:187]
rtr a[228:229],v2,42272
rtr a[230:231],v2,42784
m16 v[148:151],a[196:199],a[16:19],v[188:191]
v_exp_f32 v114, v114
m16 v[136:139],a[200:203],a[4:7],v[136:139]
rtr a[232:233],v2,42304
rtr a[234:235],v2,42816
m16 v[144:147],a[200:203],a[20:23],v[144:147]
rtr a[236:237],v2,42336
rtr a[238:239],v2,42848
m16 v[140:143],a[204:207],a[4:7],v[140:143]
v_exp_f32 v115, v115
m16 v[148:151],a[204:207],a[20:23],v[148:151]
rtr a[240:241],v2,42368
rtr a[242:243],v2,42880
m16 v[136:139],a[208:211],a[8:11],v[136:139]
v_exp_f32 v116, v116
m16 v[144:147],a[208:211],a[24:27],v[144:147]
rtr a[244:245],v2,42400
rtr a[246:247],v2,42912
m16 v[140:143],a[212:215],a[8:11],v[140:143]
v_exp_f32 v117, v117
m16 v[148:151],a[212:215],a[24:27],v[148:151]
rtr a[248:249],v2,42432
rtr a[250:251],v2,42944
m16 v[136:139],a[216:219],a[12:15],v[136:139]
rtr a[252:253],v2,42464
rtr a[254:255],v2,42976
m16 v[144:147],a[216:219],a[28:31],v[144:147]
v_exp_f32 v118, v118
m16 v[140:143],a[220:223],a[12:15],v[140:143]
v_exp_f32 v119, v119
m16 v[148:151],a[220:223],a[28:31],v[148:151]
v_exp_f32 v120, v120
m16 v[196:199],v[220:223],v[172:175],v[196:199]
v_exp_f32 v121, v121
m16 v[200:203],v[220:223],v[176:179],v[200:203]
s_waitcnt vmcnt(10) lgkmcnt(0)
s_barrier
m16 v[16:19],a[224:227],v[172:175],v[16:19]
v_exp_f32 v122, v122
m16 v[48:51],a[224:227],v[176:179],v[48:51]
r128 a[192:195],v3,33792
s_add_u32 m0, s100, 92928
m16 v[20:23],a[228:231],v[172:175],v[20:23]
r128 a[196:199],v3,34304
cvt v160,v112,v113
m16 v[52:55],a[228:231],v[176:179],v[52:55]
r128 a[200:203],v3,33856
cvt v161,v114,v115
m16 v[24:27],a[232:235],v[172:175],v[24:27]
v_exp_f32 v123, v123
m16 v[56:59],a[232:235],v[176:179],v[56:59]
r128 a[204:207],v3,34368
s_mov_b32 s28, 106496
m16 v[28:31],a[236:239],v[172:175],v[28:31]
r128 a[208:211],v3,33920
cvt v162,v116,v117
m16 v[60:63],a[236:239],v[176:179],v[60:63]
v_exp_f32 v124, v124
r128 a[212:215],v3,34432
m16 v[32:35],a[240:243],v[172:175],v[32:35]
r128 a[216:219],v3,33984
cvt v163,v118,v119
m16 v[64:67],a[240:243],v[176:179],v[64:67]
v_exp_f32 v125, v125
r128 a[220:223],v3,34496
m16 v[36:39],a[244:247],v[172:175],v[36:39]
v_exp_f32 v126, v126
m16 v[68:71],a[244:247],v[176:179],v[68:71]
buffer_load_dwordx4 v14, s[20:23], s28 offen offset:0 nt lds
cvt v164,v120,v121
m16 v[40:43],a[248:251],v[172:175],v[40:43]
v_exp_f32 v127, v127
m16 v[72:75],a[248:251],v[176:179],v[72:75]
cvt v165,v122,v123
cvt v166,v124,v125
m16 v[44:47],a[252:255],v[172:175],v[44:47]
cvt v167,v126,v127
m16 v[76:79],a[252:255],v[176:179],v[76:79]
s_waitcnt lgkmcnt(0)
m16 v[112:115],a[192:195],a[0:3],v[184:187]
v_exp_f32 v136, v136
rtr a[224:225],v4,0
m16 v[120:123],a[192:195],a[16:19],v[188:191]
rtr a[226:227],v4,512
s_add_u32 m0, s100, 93728
rtr a[228:229],v4,32
m16 v[116:119],a[196:199],a[0:3],v[184:187]
v_exp_f32 v137, v137
rtr a[230:231],v4,544
m16 v[124:127],a[196:199],a[16:19],v[188:191]
s_mov_b32 s28, 106496
v_exp_f32 v138, v138
m16 v[112:115],a[200:203],a[4:7],v[112:115]
rtr a[232:233],v4,64
rtr a[234:235],v4,576
rtr a[236:237],v4,96
m16 v[120:123],a[200:203],a[20:23],v[120:123]
v_exp_f32 v139, v139
rtr a[238:239],v4,608
m16 v[116:119],a[204:207],a[4:7],v[116:119]
buffer_load_dwordx4 v14, s[20:23], s28 offen offset:256 nt lds
rtr a[240:241],v4,128
rtr a[242:243],v4,640
m16 v[124:127],a[204:207],a[20:23],v[124:127]
v_exp_f32 v140, v140
rtr a[244:245],v4,160
m16 v[112:115],a[208:211],a[8:11],v[112:115]
rtr a[246:247],v4,672
s_add_u32 m0, s100, 118272
cvt v172,v136,v137
m16 v[120:123],a[208:211],a[24:27],v[120:123]
v_exp_f32 v141, v141
rtr a[248:249],v4,192
m16 v[116:119],a[212:215],a[8:11],v[116:119]
rtr a[250:251],v4,704
rtr a[252:253],v4,224
s_mov_b32 s28, 114688
m16 v[124:127],a[212:215],a[24:27],v[124:127]
v_exp_f32 v142, v142
m16 v[112:115],a[216:219],a[12:15],v[112:115]
rtr a[254:255],v4,736
cvt v173,v138,v139
m16 v[120:123],a[216:219],a[28:31],v[120:123]
v_exp_f32 v143, v143
m16 v[116:119],a[220:223],a[12:15],v[116:119]
buffer_load_dwordx4 v14, s[20:23], s28 offen offset:0 nt lds
cvt v174,v140,v141
m16 v[124:127],a[220:223],a[28:31],v[124:127]
r128 a[192:195],v3,42240
cvt v175,v142,v143
m16 v[196:199],v[220:223],v[160:163],v[196:199]
v_exp_f32 v144, v144
m16 v[200:203],v[220:223],v[164:167],v[200:203]
r128 a[196:199],v3,42752
s_waitcnt lgkmcnt(10)
m16 v[16:19],a[224:227],v[160:163],v[16:19]
s_add_u32 m0, s100, 119072
r128 a[200:203],v3,42304
m16 v[48:51],a[224:227],v[164:167],v[48:51]
v_exp_f32 v145, v145
m16 v[20:23],a[228:231],v[160:163],v[20:23]
s_mov_b32 s28, 114688
r128 a[204:207],v3,42816
m16 v[52:55],a[228:231],v[164:167],v[52:55]
v_exp_f32 v146, v146
m16 v[24:27],a[232:235],v[160:163],v[24:27]
r128 a[208:211],v3,42368
buffer_load_dwordx4 v14, s[20:23], s28 offen offset:256 nt lds
m16 v[56:59],a[232:235],v[164:167],v[56:59]
v_exp_f32 v147, v147
m16 v[28:31],a[236:239],v[160:163],v[28:31]
r128 a[212:215],v3,42880
s_add_u32 m0, s100, 126720
m16 v[60:63],a[236:239],v[164:167],v[60:63]
v_exp_f32 v148, v148
r128 a[216:219],v3,42432
s_waitcnt lgkmcnt(7)
m16 v[32:35],a[240:243],v[160:163],v[32:35]
v_exp_f32 v149, v149
m16 v[64:67],a[240:243],v[164:167],v[64:67]
r128 a[220:223],v3,42944
s_mov_b32 s28, 122880
m16 v[36:39],a[244:247],v[160:163],v[36:39]
v_exp_f32 v150, v150
m16 v[68:71],a[244:247],v[164:167],v[68:71]
v_exp_f32 v151, v151
m16 v[40:43],a[248:251],v[160:163],v[40:43]
buffer_load_dwordx4 v14, s[20:23], s28 offen offset:0 nt lds
cvt v176,v144,v145
m16 v[72:75],a[248:251],v[164:167],v[72:75]
cvt v177,v146,v147
cvt v178,v148,v149
m16 v[44:47],a[252:255],v[160:163],v[44:47]
cvt v179,v150,v151
m16 v[76:79],a[252:255],v[164:167],v[76:79]
s_waitcnt lgkmcnt(0)
m16 v[136:139],a[192:195],a[0:3],v[184:187]
v_exp_f32 v112, v112
rtr a[224:225],v4,8448
m16 v[144:147],a[192:195],a[16:19],v[188:191]
rtr a[226:227],v4,8960
v_exp_f32 v113, v113
m16 v[140:143],a[196:199],a[0:3],v[184:187]
rtr a[228:229],v4,8480
rtr a[230:231],v4,8992
m16 v[148:151],a[196:199],a[16:19],v[188:191]
v_exp_f32 v114, v114
m16 v[136:139],a[200:203],a[4:7],v[136:139]
rtr a[232:233],v4,8512
rtr a[234:235],v4,9024
m16 v[144:147],a[200:203],a[20:23],v[144:147]
rtr a[236:237],v4,8544
rtr a[238:239],v4,9056
m16 v[140:143],a[204:207],a[4:7],v[140:143]
v_exp_f32 v115, v115
m16 v[148:151],a[204:207],a[20:23],v[148:151]
rtr a[240:241],v4,8576
rtr a[242:243],v4,9088
m16 v[136:139],a[208:211],a[8:11],v[136:139]
v_exp_f32 v116, v116
m16 v[144:147],a[208:211],a[24:27],v[144:147]
rtr a[244:245],v4,8608
rtr a[246:247],v4,9120
m16 v[140:143],a[212:215],a[8:11],v[140:143]
v_exp_f32 v117, v117
m16 v[148:151],a[212:215],a[24:27],v[148:151]
rtr a[248:249],v4,8640
rtr a[250:251],v4,9152
m16 v[136:139],a[216:219],a[12:15],v[136:139]
rtr a[252:253],v4,8672
rtr a[254:255],v4,9184
m16 v[144:147],a[216:219],a[28:31],v[144:147]
v_exp_f32 v118, v118
m16 v[140:143],a[220:223],a[12:15],v[140:143]
v_exp_f32 v119, v119
m16 v[148:151],a[220:223],a[28:31],v[148:151]
v_exp_f32 v120, v120
m16 v[196:199],v[220:223],v[172:175],v[196:199]
v_exp_f32 v121, v121
m16 v[200:203],v[220:223],v[176:179],v[200:203]
s_waitcnt vmcnt(7) lgkmcnt(0)
s_barrier
m16 v[16:19],a[224:227],v[172:175],v[16:19]
v_exp_f32 v122, v122
m16 v[48:51],a[224:227],v[176:179],v[48:51]
r128 a[192:195],v1,0
s_add_u32 m0, s100, 127520
m16 v[20:23],a[228:231],v[172:175],v[20:23]
r128 a[196:199],v1,512
cvt v160,v112,v113
m16 v[52:55],a[228:231],v[176:179],v[52:55]
r128 a[200:203],v1,64
cvt v161,v114,v115
m16 v[24:27],a[232:235],v[172:175],v[24:27]
v_exp_f32 v123, v123
m16 v[56:59],a[232:235],v[176:179],v[56:59]
r128 a[204:207],v1,576
s_mov_b32 s28, 122880
m16 v[28:31],a[236:239],v[172:175],v[28:31]
r128 a[208:211],v1,128
cvt v162,v116,v117
m16 v[60:63],a[236:239],v[176:179],v[60:63]
v_exp_f32 v124, v124
r128 a[212:215],v1,640
m16 v[32:35],a[240:243],v[172:175],v[32:35]
r128 a[216:219],v1,192
cvt v163,v118,v119
m16 v[64:67],a[240:243],v[176:179],v[64:67]
v_exp_f32 v125, v125
r128 a[220:223],v1,704
m16 v[36:39],a[244:247],v[172:175],v[36:39]
v_exp_f32 v126, v126
m16 v[68:71],a[244:247],v[176:179],v[68:71]
buffer_load_dwordx4 v14, s[20:23], s28 offen offset:256 nt lds
cvt v164,v120,v121
m16 v[40:43],a[248:251],v[172:175],v[40:43]
v_exp_f32 v127, v127
m16 v[72:75],a[248:251],v[176:179],v[72:75]
cvt v165,v122,v123
cvt v166,v124,v125
m16 v[44:47],a[252:255],v[172:175],v[44:47]
cvt v167,v126,v127
m16 v[76:79],a[252:255],v[176:179],v[76:79]
s_waitcnt lgkmcnt(0)
m16 v[112:115],a[192:195],a[0:3],v[184:187]
v_exp_f32 v136, v136
rtr a[224:225],v4,33792
m16 v[120:123],a[192:195],a[16:19],v[188:191]
rtr a[226:227],v4,34304
s_add_u32 m0, s100, 0
rtr a[228:229],v4,33824
m16 v[116:119],a[196:199],a[0:3],v[184:187]
v_exp_f32 v137, v137
rtr a[230:231],v4,34336
m16 v[124:127],a[196:199],a[16:19],v[188:191]
s_mov_b32 s28, 131072
v_exp_f32 v138, v138
m16 v[112:115],a[200:203],a[4:7],v[112:115]
rtr a[232:233],v4,33856
rtr a[234:235],v4,34368
ds_write_b128 v15, a[128:131] offset:16896
m16 v[120:123],a[200:203],a[20:23],v[120:123]
rtr a[236:237],v4,33888
v_exp_f32 v139, v139
m16 v[116:119],a[204:207],a[4:7],v[116:119]
rtr a[238:239],v4,34400
buffer_load_dwordx4 v14, s[16:19], s28 offen offset:0 nt lds
rtr a[240:241],v4,33920
m16 v[124:127],a[204:207],a[20:23],v[124:127]
rtr a[242:243],v4,34432
v_exp_f32 v140, v140
m16 v[112:115],a[208:211],a[8:11],v[112:115]
rtr a[244:245],v4,33952
rtr a[246:247],v4,34464
s_add_u32 m0, s100, 800
m16 v[120:123],a[208:211],a[24:27],v[120:123]
v_exp_f32 v141, v141
rtr a[248:249],v4,33984
m16 v[116:119],a[212:215],a[8:11],v[116:119]
rtr a[250:251],v4,34496
ds_write_b128 v15, a[132:135] offset:17952
rtr a[252:253],v4,34016
m16 v[124:127],a[212:215],a[24:27],v[124:127]
s_mov_b32 s28, 131072
v_exp_f32 v142, v142
m16 v[112:115],a[216:219],a[12:15],v[112:115]
rtr a[254:255],v4,34528
v_exp_f32 v143, v143
m16 v[120:123],a[216:219],a[28:31],v[120:123]
buffer_load_dwordx4 v14, s[16:19], s28 offen offset:256 nt lds
v_exp_f32 v144, v144
m16 v[116:119],a[220:223],a[12:15],v[116:119]
v_exp_f32 v145, v145
cvt v172,v136,v137
m16 v[124:127],a[220:223],a[28:31],v[124:127]
r128 a[192:195],v1,8448
cvt v173,v138,v139
m16 v[196:199],v[220:223],v[160:163],v[196:199]
r128 a[196:199],v1,8960
s_add_u32 m0, s100, 8448
m16 v[200:203],v[220:223],v[164:167],v[200:203]
ds_write_b128 v15, a[136:139] offset:25344
s_waitcnt lgkmcnt(12)
m16 v[16:19],a[224:227],v[160:163],v[16:19]
r128 a[200:203],v1,8512
s_mov_b32 s28, 139264
m16 v[48:51],a[224:227],v[164:167],v[48:51]
r128 a[204:207],v1,9024
cvt v174,v140,v141
m16 v[20:23],a[228:231],v[160:163],v[20:23]
v_exp_f32 v146, v146
m16 v[52:55],a[228:231],v[164:167],v[52:55]
r128 a[208:211],v1,8576
buffer_load_dwordx4 v14, s[16:19], s28 offen offset:0 nt lds
m16 v[24:27],a[232:235],v[160:163],v[24:27]
v_exp_f32 v147, v147
m16 v[56:59],a[232:235],v[164:167],v[56:59]
ds_write_b128 v15, a[140:143] offset:26400
r128 a[212:215],v1,9088
m16 v[28:31],a[236:239],v[160:163],v[28:31]
v_exp_f32 v148, v148
m16 v[60:63],a[236:239],v[164:167],v[60:63]
r128 a[216:219],v1,8640
s_waitcnt lgkmcnt(9)
m16 v[32:35],a[240:243],v[160:163],v[32:35]
s_add_u32 m0, s100, 9248
r128 a[220:223],v1,9152
m16 v[64:67],a[240:243],v[164:167],v[64:67]
v_exp_f32 v149, v149
m16 v[36:39],a[244:247],v[160:163],v[36:39]
s_mov_b32 s28, 139264
cvt v175,v142,v143
m16 v[68:71],a[244:247],v[164:167],v[68:71]
v_exp_f32 v150, v150
m16 v[40:43],a[248:251],v[160:163],v[40:43]
v_exp_f32 v151, v151
m16 v[72:75],a[248:251],v[164:167],v[72:75]
buffer_load_dwordx4 v14, s[16:19], s28 offen offset:256 nt lds
cvt v176,v144,v145
m16 v[44:47],a[252:255],v[160:163],v[44:47]
cvt v177,v146,v147
cvt v178,v148,v149
m16 v[76:79],a[252:255],v[164:167],v[76:79]
cvt v179,v150,v151
s_waitcnt lgkmcnt(0)
m16 v[136:139],a[192:195],a[0:3],v[184:187]
v_exp_f32 v112, v112
rtr a[224:225],v4,42240
m16 v[144:147],a[192:195],a[16:19],v[188:191]
rtr a[226:227],v4,42752
v_exp_f32 v113, v113
m16 v[140:143],a[196:199],a[0:3],v[184:187]
rtr a[228:229],v4,42272
rtr a[230:231],v4,42784
m16 v[148:151],a[196:199],a[16:19],v[188:191]
v_exp_f32 v114, v114
m16 v[136:139],a[200:203],a[4:7],v[136:139]
rtr a[232:233],v4,42304
rtr a[234:235],v4,42816
m16 v[144:147],a[200:203],a[20:23],v[144:147]
rtr a[236:237],v4,42336
rtr a[238:239],v4,42848
m16 v[140:143],a[204:207],a[4:7],v[140:143]
v_exp_f32 v115, v115
m16 v[148:151],a[204:207],a[20:23],v[148:151]
rtr a[240:241],v4,42368
rtr a[242:243],v4,42880
m16 v[136:139],a[208:211],a[8:11],v[136:139]
v_exp_f32 v116, v116
m16 v[144:147],a[208:211],a[24:27],v[144:147]
rtr a[244:245],v4,42400
rtr a[246:247],v4,42912
m16 v[140:143],a[212:215],a[8:11],v[140:143]
v_exp_f32 v117, v117
m16 v[148:151],a[212:215],a[24:27],v[148:151]
rtr a[248:249],v4,42432
rtr a[250:251],v4,42944
m16 v[136:139],a[216:219],a[12:15],v[136:139]
rtr a[252:253],v4,42464
rtr a[254:255],v4,42976
m16 v[144:147],a[216:219],a[28:31],v[144:147]
v_exp_f32 v118, v118
m16 v[140:143],a[220:223],a[12:15],v[140:143]
v_exp_f32 v119, v119
m16 v[148:151],a[220:223],a[28:31],v[148:151]
v_exp_f32 v120, v120
m16 v[196:199],v[220:223],v[172:175],v[196:199]
v_exp_f32 v121, v121
m16 v[200:203],v[220:223],v[176:179],v[200:203]
s_waitcnt vmcnt(8) lgkmcnt(0)
s_barrier
m16 v[16:19],a[224:227],v[172:175],v[16:19]
v_exp_f32 v122, v122
m16 v[48:51],a[224:227],v[176:179],v[48:51]
r128 a[192:195],v1,33792
s_add_u32 m0, s100, 33792
m16 v[20:23],a[228:231],v[172:175],v[20:23]
r128 a[196:199],v1,34304
cvt v160,v112,v113
m16 v[52:55],a[228:231],v[176:179],v[52:55]
r128 a[200:203],v1,33856
cvt v161,v114,v115
m16 v[24:27],a[232:235],v[172:175],v[24:27]
v_exp_f32 v123, v123
m16 v[56:59],a[232:235],v[176:179],v[56:59]
r128 a[204:207],v1,34368
s_mov_b32 s28, 147456
m16 v[28:31],a[236:239],v[172:175],v[28:31]
r128 a[208:211],v1,33920
cvt v162,v116,v117
m16 v[60:63],a[236:239],v[176:179],v[60:63]
v_exp_f32 v124, v124
r128 a[212:215],v1,34432
m16 v[32:35],a[240:243],v[172:175],v[32:35]
r128 a[216:219],v1,33984
cvt v163,v118,v119
m16 v[64:67],a[240:243],v[176:179],v[64:67]
v_exp_f32 v125, v125
r128 a[220:223],v1,34496
m16 v[36:39],a[244:247],v[172:175],v[36:39]
v_exp_f32 v126, v126
m16 v[68:71],a[244:247],v[176:179],v[68:71]
buffer_load_dwordx4 v14, s[16:19], s28 offen offset:0 nt lds
cvt v164,v120,v121
m16 v[40:43],a[248:251],v[172:175],v[40:43]
v_exp_f32 v127, v127
m16 v[72:75],a[248:251],v[176:179],v[72:75]
cvt v165,v122,v123
cvt v166,v124,v125
m16 v[44:47],a[252:255],v[172:175],v[44:47]
cvt v167,v126,v127
m16 v[76:79],a[252:255],v[176:179],v[76:79]
s_waitcnt lgkmcnt(0)
m16 v[112:115],a[192:195],a[0:3],v[184:187]
v_exp_f32 v136, v136
rtr a[224:225],v2,0
m16 v[120:123],a[192:195],a[16:19],v[188:191]
rtr a[226:227],v2,512
s_add_u32 m0, s100, 34592
rtr a[228:229],v2,32
m16 v[116:119],a[196:199],a[0:3],v[184:187]
v_exp_f32 v137, v137
rtr a[230:231],v2,544
m16 v[124:127],a[196:199],a[16:19],v[188:191]
s_mov_b32 s28, 147456
v_exp_f32 v138, v138
m16 v[112:115],a[200:203],a[4:7],v[112:115]
rtr a[232:233],v2,64
rtr a[234:235],v2,576
ds_write_b128 v209, a[144:147] offset:0
m16 v[120:123],a[200:203],a[20:23],v[120:123]
rtr a[236:237],v2,96
v_exp_f32 v139, v139
m16 v[116:119],a[204:207],a[4:7],v[116:119]
rtr a[238:239],v2,608
buffer_load_dwordx4 v14, s[16:19], s28 offen offset:256 nt lds
rtr a[240:241],v2,128
m16 v[124:127],a[204:207],a[20:23],v[124:127]
rtr a[242:243],v2,640
v_exp_f32 v140, v140
m16 v[112:115],a[208:211],a[8:11],v[112:115]
rtr a[244:245],v2,160
rtr a[246:247],v2,672
s_add_u32 m0, s100, 42240
m16 v[120:123],a[208:211],a[24:27],v[120:123]
v_exp_f32 v141, v141
rtr a[248:249],v2,192
m16 v[116:119],a[212:215],a[8:11],v[116:119]
rtr a[250:251],v2,704
ds_write_b128 v209, a[148:151] offset:1056
rtr a[252:253],v2,224
m16 v[124:127],a[212:215],a[24:27],v[124:127]
s_mov_b32 s28, 155648
v_exp_f32 v142, v142
m16 v[112:115],a[216:219],a[12:15],v[112:115]
rtr a[254:255],v2,736
v_exp_f32 v143, v143
m16 v[120:123],a[216:219],a[28:31],v[120:123]
buffer_load_dwordx4 v14, s[16:19], s28 offen offset:0 nt lds
v_exp_f32 v144, v144
m16 v[116:119],a[220:223],a[12:15],v[116:119]
v_exp_f32 v145, v145
cvt v172,v136,v137
m16 v[124:127],a[220:223],a[28:31],v[124:127]
r128 a[192:195],v1,42240
cvt v173,v138,v139
m16 v[196:199],v[220:223],v[160:163],v[196:199]
r128 a[196:199],v1,42752
s_add_u32 m0, s100, 43040
m16 v[200:203],v[220:223],v[164:167],v[200:203]
ds_write_b128 v209, a[152:155] offset:8448
s_waitcnt lgkmcnt(12)
m16 v[16:19],a[224:227],v[160:163],v[16:19]
r128 a[200:203],v1,42304
s_mov_b32 s28, 155648
m16 v[48:51],a[224:227],v[164:167],v[48:51]
r128 a[204:207],v1,42816
cvt v174,v140,v141
m16 v[20:23],a[228:231],v[160:163],v[20:23]
v_exp_f32 v146, v146
m16 v[52:55],a[228:231],v[164:167],v[52:55]
r128 a[208:211],v1,42368
buffer_load_dwordx4 v14, s[16:19], s28 offen offset:256 nt lds
m16 v[24:27],a[232:235],v[160:163],v[24:27]
v_exp_f32 v147, v147
m16 v[56:59],a[232:235],v[164:167],v[56:59]
ds_write_b128 v209, a[156:159] offset:9504
r128 a[212:215],v1,42880
m16 v[28:31],a[236:239],v[160:163],v[28:31]
v_exp_f32 v148, v148
m16 v[60:63],a[236:239],v[164:167],v[60:63]
r128 a[216:219],v1,42432
s_waitcnt lgkmcnt(9)
m16 v[32:35],a[240:243],v[160:163],v[32:35]
s_add_u32 m0, s100, 50688
r128 a[220:223],v1,42944
m16 v[64:67],a[240:243],v[164:167],v[64:67]
v_exp_f32 v149, v149
m16 v[36:39],a[244:247],v[160:163],v[36:39]
s_mov_b32 s28, 147456
cvt v175,v142,v143
m16 v[68:71],a[244:247],v[164:167],v[68:71]
v_exp_f32 v150, v150
m16 v[40:43],a[248:251],v[160:163],v[40:43]
v_exp_f32 v151, v151
m16 v[72:75],a[248:251],v[164:167],v[72:75]
buffer_load_dwordx4 v14, s[20:23], s28 offen offset:0 nt lds
cvt v176,v144,v145
m16 v[44:47],a[252:255],v[160:163],v[44:47]
cvt v177,v146,v147
cvt v178,v148,v149
m16 v[76:79],a[252:255],v[164:167],v[76:79]
cvt v179,v150,v151
s_waitcnt lgkmcnt(0)
m16 v[136:139],a[192:195],a[0:3],v[184:187]
v_exp_f32 v112, v112
rtr a[224:225],v2,8448
m16 v[144:147],a[192:195],a[16:19],v[188:191]
rtr a[226:227],v2,8960
v_exp_f32 v113, v113
m16 v[140:143],a[196:199],a[0:3],v[184:187]
rtr a[228:229],v2,8480
rtr a[230:231],v2,8992
m16 v[148:151],a[196:199],a[16:19],v[188:191]
v_exp_f32 v114, v114
m16 v[136:139],a[200:203],a[4:7],v[136:139]
rtr a[232:233],v2,8512
rtr a[234:235],v2,9024
m16 v[144:147],a[200:203],a[20:23],v[144:147]
rtr a[236:237],v2,8544
rtr a[238:239],v2,9056
m16 v[140:143],a[204:207],a[4:7],v[140:143]
v_exp_f32 v115, v115
m16 v[148:151],a[204:207],a[20:23],v[148:151]
rtr a[240:241],v2,8576
rtr a[242:243],v2,9088
m16 v[136:139],a[208:211],a[8:11],v[136:139]
v_exp_f32 v116, v116
m16 v[144:147],a[208:211],a[24:27],v[144:147]
rtr a[244:245],v2,8608
rtr a[246:247],v2,9120
m16 v[140:143],a[212:215],a[8:11],v[140:143]
v_exp_f32 v117, v117
m16 v[148:151],a[212:215],a[24:27],v[148:151]
rtr a[248:249],v2,8640
rtr a[250:251],v2,9152
m16 v[136:139],a[216:219],a[12:15],v[136:139]
rtr a[252:253],v2,8672
rtr a[254:255],v2,9184
m16 v[144:147],a[216:219],a[28:31],v[144:147]
v_exp_f32 v118, v118
m16 v[140:143],a[220:223],a[12:15],v[140:143]
v_exp_f32 v119, v119
m16 v[148:151],a[220:223],a[28:31],v[148:151]
v_exp_f32 v120, v120
m16 v[196:199],v[220:223],v[172:175],v[196:199]
v_exp_f32 v121, v121
m16 v[200:203],v[220:223],v[176:179],v[200:203]
s_waitcnt vmcnt(5) lgkmcnt(0)
s_barrier
m16 v[16:19],a[224:227],v[172:175],v[16:19]
v_exp_f32 v122, v122
m16 v[48:51],a[224:227],v[176:179],v[48:51]
r128 a[192:195],v3,0
s_add_u32 m0, s100, 51488
m16 v[20:23],a[228:231],v[172:175],v[20:23]
r128 a[196:199],v3,512
cvt v160,v112,v113
m16 v[52:55],a[228:231],v[176:179],v[52:55]
r128 a[200:203],v3,64
cvt v161,v114,v115
m16 v[24:27],a[232:235],v[172:175],v[24:27]
v_exp_f32 v123, v123
m16 v[56:59],a[232:235],v[176:179],v[56:59]
r128 a[204:207],v3,576
s_mov_b32 s28, 147456
m16 v[28:31],a[236:239],v[172:175],v[28:31]
r128 a[208:211],v3,128
cvt v162,v116,v117
m16 v[60:63],a[236:239],v[176:179],v[60:63]
v_exp_f32 v124, v124
r128 a[212:215],v3,640
m16 v[32:35],a[240:243],v[172:175],v[32:35]
r128 a[216:219],v3,192
cvt v163,v118,v119
m16 v[64:67],a[240:243],v[176:179],v[64:67]
v_exp_f32 v125, v125
r128 a[220:223],v3,704
m16 v[36:39],a[244:247],v[172:175],v[36:39]
v_exp_f32 v126, v126
m16 v[68:71],a[244:247],v[176:179],v[68:71]
buffer_load_dwordx4 v14, s[20:23], s28 offen offset:256 nt lds
cvt v164,v120,v121
m16 v[40:43],a[248:251],v[172:175],v[40:43]
v_exp_f32 v127, v127
m16 v[72:75],a[248:251],v[176:179],v[72:75]
cvt v165,v122,v123
cvt v166,v124,v125
m16 v[44:47],a[252:255],v[172:175],v[44:47]
cvt v167,v126,v127
m16 v[76:79],a[252:255],v[176:179],v[76:79]
s_waitcnt lgkmcnt(0)
m16 v[112:115],a[192:195],a[48:51],0
v_exp_f32 v136, v136
rtr a[224:225],v2,33792
m16 v[120:123],a[192:195],a[64:67],0
rtr a[226:227],v2,34304
s_add_u32 m0, s100, 59136
rtr a[228:229],v2,33824
m16 v[116:119],a[196:199],a[48:51],0
v_exp_f32 v137, v137
rtr a[230:231],v2,34336
m16 v[124:127],a[196:199],a[64:67],0
s_mov_b32 s28, 155648
v_exp_f32 v138, v138
m16 v[112:115],a[200:203],a[52:55],v[112:115]
rtr a[232:233],v2,33856
rtr a[234:235],v2,34368
rtr a[236:237],v2,33888
m16 v[120:123],a[200:203],a[68:71],v[120:123]
v_exp_f32 v139, v139
rtr a[238:239],v2,34400
m16 v[116:119],a[204:207],a[52:55],v[116:119]
buffer_load_dwordx4 v14, s[20:23], s28 offen offset:0 nt lds
rtr a[240:241],v2,33920
rtr a[242:243],v2,34432
m16 v[124:127],a[204:207],a[68:71],v[124:127]
v_exp_f32 v140, v140
rtr a[244:245],v2,33952
m16 v[112:115],a[208:211],a[56:59],v[112:115]
rtr a[246:247],v2,34464
s_add_u32 m0, s100, 59936
cvt v172,v136,v137
m16 v[120:123],a[208:211],a[72:75],v[120:123]
v_exp_f32 v141, v141
rtr a[248:249],v2,33984
m16 v[116:119],a[212:215],a[56:59],v[116:119]
rtr a[250:251],v2,34496
rtr a[252:253],v2,34016
s_mov_b32 s28, 155648
m16 v[124:127],a[212:215],a[72:75],v[124:127]
v_exp_f32 v142, v142
rtr a[254:255],v2,34528
m16 v[112:115],a[216:219],a[60:63],v[112:115]
v_exp_f32 v143, v143
cvt v173,v138,v139
m16 v[120:123],a[216:219],a[76:79],v[120:123]
buffer_load_dwordx4 v14, s[20:23], s28 offen offset:256 nt lds
v_exp_f32 v144, v144
m16 v[116:119],a[220:223],a[60:63],v[116:119]
v_exp_f32 v145, v145
cvt v174,v140,v141
m16 v[124:127],a[220:223],a[76:79],v[124:127]
r128 a[192:195],v3,8448
v_exp_f32 v146, v146
m16 v[196:199],v[220:223],v[160:163],v[196:199]
r128 a[196:199],v3,8960
s_add_u32 m0, s100, 84480
cvt v175,v142,v143
m16 v[200:203],v[220:223],v[164:167],v[200:203]
v_exp_f32 v147, v147
s_waitcnt lgkmcnt(10)
m16 v[16:19],a[224:227],v[160:163],v[16:19]
r128 a[200:203],v3,8512
s_mov_b32 s28, 163840
cvt v176,v144,v145
m16 v[48:51],a[224:227],v[164:167],v[48:51]
r128 a[204:207],v3,9024
v_exp_f32 v148, v148
m16 v[20:23],a[228:231],v[160:163],v[20:23]
v_max3_f32 v230, v112, v113, v227
v_max3_f32 v232, v120, v121, v228
v_max3_f32 v230, v230, v114, v115
m16 v[52:55],a[228:231],v[164:167],v[52:55]
v_max3_f32 v232, v232, v122, v123
v_max3_f32 v230, v230, v116, v117
v_max3_f32 v232, v232, v124, v125
v_max3_f32 v230, v230, v118, v119
m16 v[24:27],a[232:235],v[160:163],v[24:27]
r128 a[208:211],v3,8576
v_max3_f32 v232, v232, v126, v127
v_mov_b32 v231, v230
v_mov_b32 v233, v232
m16 v[56:59],a[232:235],v[164:167],v[56:59]
buffer_load_dwordx4 v14, s[20:23], s28 offen offset:0 nt lds
v_permlane16_swap_b32 v230, v231
v_permlane16_swap_b32 v232, v233
v_max_f32 v230, v230, v231
v_max_f32 v232, v232, v233
m16 v[28:31],a[236:239],v[160:163],v[28:31]
r128 a[212:215],v3,9088
v_mov_b32 v231, v230
v_mov_b32 v233, v232
s_nop 0
v_permlane32_swap_b32 v230, v231
v_permlane32_swap_b32 v232, v233
m16 v[60:63],a[236:239],v[164:167],v[60:63]
r128 a[216:219],v3,8640
v_max_f32 v230, v230, v231
v_max_f32 v232, v232, v233
v_sub_f32 v184, 0, v230
s_waitcnt lgkmcnt(7)
m16 v[32:35],a[240:243],v[160:163],v[32:35]
s_add_u32 m0, s100, 85280
v_sub_f32 v188, 0, v232
v_sub_f32 v185, 0, v230
v_sub_f32 v189, 0, v232
v_sub_f32 v186, 0, v230
m16 v[64:67],a[240:243],v[164:167],v[64:67]
v_exp_f32 v149, v149
r128 a[220:223],v3,9152
v_sub_f32 v190, 0, v232
v_sub_f32 v187, 0, v230
v_sub_f32 v191, 0, v232
v_sub_f32 v112, v112, v230
m16 v[36:39],a[244:247],v[160:163],v[36:39]
s_mov_b32 s28, 163840
v_sub_f32 v120, v120, v232
v_sub_f32 v113, v113, v230
v_sub_f32 v121, v121, v232
m16 v[68:71],a[244:247],v[164:167],v[68:71]
v_exp_f32 v150, v150
v_sub_f32 v114, v114, v230
v_sub_f32 v122, v122, v232
v_sub_f32 v115, v115, v230
v_sub_f32 v123, v123, v232
m16 v[40:43],a[248:251],v[160:163],v[40:43]
v_sub_f32 v116, v116, v230
v_sub_f32 v124, v124, v232
v_sub_f32 v117, v117, v230
v_sub_f32 v125, v125, v232
m16 v[72:75],a[248:251],v[164:167],v[72:75]
v_exp_f32 v151, v151
buffer_load_dwordx4 v14, s[20:23], s28 offen offset:256 nt lds
v_sub_f32 v118, v118, v230
v_sub_f32 v126, v126, v232
v_sub_f32 v119, v119, v230
m16 v[44:47],a[252:255],v[160:163],v[44:47]
v_sub_f32 v127, v127, v232
cvt v177,v146,v147
cvt v178,v148,v149
m16 v[76:79],a[252:255],v[164:167],v[76:79]
cvt v179,v150,v151
s_waitcnt lgkmcnt(0)
m16 v[136:139],a[192:195],a[48:51],v[184:187]
v_exp_f32 v112, v112
rtr a[224:225],v2,42240
m16 v[144:147],a[192:195],a[64:67],v[188:191]
rtr a[226:227],v2,42752
v_exp_f32 v113, v113
m16 v[140:143],a[196:199],a[48:51],v[184:187]
rtr a[228:229],v2,42272
rtr a[230:231],v2,42784
cvt v160,v112,v113
m16 v[148:151],a[196:199],a[64:67],v[188:191]
v_exp_f32 v114, v114
rtr a[232:233],v2,42304
m16 v[136:139],a[200:203],a[52:55],v[136:139]
rtr a[234:235],v2,42816
rtr a[236:237],v2,42336
m16 v[144:147],a[200:203],a[68:71],v[144:147]
v_exp_f32 v115, v115
rtr a[238:239],v2,42848
m16 v[140:143],a[204:207],a[52:55],v[140:143]
rtr a[240:241],v2,42368
rtr a[242:243],v2,42880
cvt v161,v114,v115
m16 v[148:151],a[204:207],a[68:71],v[148:151]
v_exp_f32 v116, v116
rtr a[244:245],v2,42400
m16 v[136:139],a[208:211],a[56:59],v[136:139]
rtr a[246:247],v2,42912
v_exp_f32 v117, v117
m16 v[144:147],a[208:211],a[72:75],v[144:147]
rtr a[248:249],v2,42432
rtr a[250:251],v2,42944
cvt v162,v116,v117
m16 v[140:143],a[212:215],a[56:59],v[140:143]
rtr a[252:253],v2,42464
v_exp_f32 v118, v118
m16 v[148:151],a[212:215],a[72:75],v[148:151]
rtr a[254:255],v2,42976
v_exp_f32 v119, v119
m16 v[136:139],a[216:219],a[60:63],v[136:139]
v_exp_f32 v120, v120
cvt v163,v118,v119
m16 v[144:147],a[216:219],a[76:79],v[144:147]
v_exp_f32 v121, v121
m16 v[140:143],a[220:223],a[60:63],v[140:143]
v_exp_f32 v122, v122
cvt v164,v120,v121
m16 v[148:151],a[220:223],a[76:79],v[148:151]
v_exp_f32 v123, v123
m16 v[196:199],v[220:223],v[172:175],v[196:199]
v_exp_f32 v124, v124
cvt v165,v122,v123
m16 v[200:203],v[220:223],v[176:179],v[200:203]
s_waitcnt vmcnt(6) lgkmcnt(0)
s_barrier
m16 v[16:19],a[224:227],v[172:175],v[16:19]
v_exp_f32 v125, v125
m16 v[48:51],a[224:227],v[176:179],v[48:51]
r128 a[192:195],v3,33792
s_add_u32 m0, s100, 92928
cvt v166,v124,v125
m16 v[20:23],a[228:231],v[172:175],v[20:23]
r128 a[196:199],v3,34304
v_exp_f32 v126, v126
m16 v[52:55],a[228:231],v[176:179],v[52:55]
r128 a[200:203],v3,33856
v_rcp_f32 v230, v196
m16 v[24:27],a[232:235],v[172:175],v[24:27]
r128 a[204:207],v3,34368
v_rcp_f32 v232, v200
m16 v[56:59],a[232:235],v[176:179],v[56:59]
r128 a[208:211],v3,33920
s_mov_b32 s28, 172032
v_add_f32 v236, v196, v200
m16 v[28:31],a[236:239],v[172:175],v[28:31]
r128 a[212:215],v3,34432
v_mov_b32 v231, v230
v_mov_b32 v233, v232
m16 v[60:63],a[236:239],v[176:179],v[60:63]
r128 a[216:219],v3,33984
v_mov_b32 v237, 0x53800000
v_cmp_nle_f32 vcc, v236, v237
m16 v[32:35],a[240:243],v[172:175],v[32:35]
v_mov_b32 v236, 163824
s_nop 0
v_cndmask_b32 v237, 0, 1, vcc
ds_or_b32 v236, v237
v_mul_f32 v16, v16, v230
v_mul_f32 v17, v17, v230
v_mul_f32 v18, v18, v230
m16 v[64:67],a[240:243],v[176:179],v[64:67]
r128 a[220:223],v3,34496
v_mul_f32 v19, v19, v230
v_mul_f32 v20, v20, v230
v_mul_f32 v21, v21, v230
v_mul_f32 v22, v22, v230
m16 v[36:39],a[244:247],v[172:175],v[36:39]
v_mul_f32 v23, v23, v230
s_mov_b32 s29, 0
cvt v238,v16,v17
cvt v239,v18,v19
m16 v[68:71],a[244:247],v[176:179],v[68:71]
buffer_load_dwordx4 v14, s[20:23], s28 offen offset:0 nt lds
cvt v240,v20,v21
cvt v241,v22,v23
buffer_store_dwordx4 v[238:241], v5, s[24:27], s29 offen offset:0 sc1
v_mul_f32 v48, v48, v232
m16 v[40:43],a[248:251],v[172:175],v[40:43]
v_mul_f32 v49, v49, v232
v_mul_f32 v50, v50, v232
v_mul_f32 v51, v51, v232
v_mul_f32 v52, v52, v232
m16 v[72:75],a[248:251],v[176:179],v[72:75]
v_exp_f32 v127, v127
v_mul_f32 v53, v53, v232
v_mul_f32 v54, v54, v232
v_mul_f32 v55, v55, v232
cvt v242,v48,v49
m16 v[44:47],a[252:255],v[172:175],v[44:47]
cvt v243,v50,v51
cvt v244,v52,v53
cvt v245,v54,v55
m16 v[76:79],a[252:255],v[176:179],v[76:79]
cvt v167,v126,v127
buffer_store_dwordx4 v[242:245], v5, s[24:27], s29 offen offset:1024 sc1
s_waitcnt lgkmcnt(0)
m16 v[112:115],a[192:195],a[48:51],v[184:187]
v_mul_f32 v24, v24, v230
v_mul_f32 v25, v25, v230
v_mul_f32 v26, v26, v230
m16 v[120:123],a[192:195],a[64:67],v[188:191]
v_exp_f32 v136, v136
v_mul_f32 v27, v27, v230
v_mul_f32 v28, v28, v230
m16 v[116:119],a[196:199],a[48:51],v[184:187]
rtr a[224:225],v4,0
rtr a[226:227],v4,512
s_add_u32 m0, s100, 93728
v_mul_f32 v29, v29, v230
v_mul_f32 v30, v30, v230
v_mul_f32 v31, v31, v230
m16 v[124:127],a[196:199],a[64:67],v[188:191]
v_exp_f32 v137, v137
rtr a[228:229],v4,32
s_mov_b32 s29, 11264
cvt v246,v24,v25
cvt v247,v26,v27
m16 v[112:115],a[200:203],a[52:55],v[112:115]
rtr a[230:231],v4,544
s_mov_b32 s28, 172032
cvt v248,v28,v29
cvt v249,v30,v31
m16 v[120:123],a[200:203],a[68:71],v[120:123]
v_exp_f32 v138, v138
rtr a[232:233],v4,64
rtr a[234:235],v4,576
ds_write_b128 v209, a[160:163] offset:50688
buffer_store_dwordx4 v[246:249], v5, s[24:27], s29 offen offset:0 sc1
v_mul_f32 v56, v56, v232
v_mul_f32 v57, v57, v232
m16 v[116:119],a[204:207],a[52:55],v[116:119]
rtr a[236:237],v4,96
v_mul_f32 v58, v58, v232
v_mul_f32 v59, v59, v232
v_mul_f32 v60, v60, v232
m16 v[124:127],a[204:207],a[68:71],v[124:127]
v_exp_f32 v139, v139
rtr a[238:239],v4,608
buffer_load_dwordx4 v14, s[20:23], s28 offen offset:256 nt lds
v_mul_f32 v61, v61, v232
v_mul_f32 v62, v62, v232
v_mul_f32 v63, v63, v232
m16 v[112:115],a[208:211],a[56:59],v[112:115]
rtr a[240:241],v4,128
rtr a[242:243],v4,640
cvt v250,v56,v57
cvt v251,v58,v59
cvt v252,v60,v61
m16 v[120:123],a[208:211],a[72:75],v[120:123]
v_exp_f32 v140, v140
rtr a[244:245],v4,160
cvt v253,v62,v63
buffer_store_dwordx4 v[250:253], v5, s[24:27], s29 offen offset:1024 sc1
m16 v[116:119],a[212:215],a[56:59],v[116:119]
rtr a[246:247],v4,672
s_add_u32 m0, s100, 101376
v_mul_f32 v32, v32, v230
v_mul_f32 v33, v33, v230
v_mul_f32 v34, v34, v230
m16 v[124:127],a[212:215],a[72:75],v[124:127]
v_exp_f32 v141, v141
rtr a[248:249],v4,192
rtr a[250:251],v4,704
ds_write_b128 v209, a[164:167] offset:51744
v_mul_f32 v35, v35, v230
v_mul_f32 v36, v36, v230
v_mul_f32 v37, v37, v230
m16 v[112:115],a[216:219],a[60:63],v[112:115]
rtr a[252:253],v4,224
s_mov_b32 s28, 180224
v_mul_f32 v38, v38, v230
v_mul_f32 v39, v39, v230
s_mov_b32 s29, 22528
m16 v[120:123],a[216:219],a[76:79],v[120:123]
v_exp_f32 v142, v142
rtr a[254:255],v4,736
cvt v238,v32,v33
cvt v239,v34,v35
cvt v240,v36,v37
m16 v[116:119],a[220:223],a[60:63],v[116:119]
cvt v241,v38,v39
buffer_store_dwordx4 v[238:241], v5, s[24:27], s29 offen offset:0 sc1
buffer_load_dwordx4 v14, s[16:19], s28 offen offset:0 nt lds
m16 v[124:127],a[220:223],a[76:79],v[124:127]
v_exp_f32 v143, v143
v_mul_f32 v64, v64, v232
v_mul_f32 v65, v65, v232
v_mul_f32 v66, v66, v232
m16 v[196:199],v[220:223],v[160:163],0
r128 a[192:195],v3,42240
v_mul_f32 v67, v67, v232
v_mul_f32 v68, v68, v232
v_mul_f32 v69, v69, v232
m16 v[200:203],v[220:223],v[164:167],0
v_exp_f32 v144, v144
r128 a[196:199],v3,42752
v_mul_f32 v70, v70, v232
v_mul_f32 v71, v71, v232
cvt v242,v64,v65
s_waitcnt lgkmcnt(11)
m16 v[16:19],a[224:227],v[160:163],0
s_add_u32 m0, s100, 102176
ds_write_b128 v209, a[168:171] offset:59136
cvt v243,v66,v67
cvt v244,v68,v69
cvt v245,v70,v71
m16 v[48:51],a[224:227],v[164:167],0
v_exp_f32 v145, v145
r128 a[200:203],v3,42304
buffer_store_dwordx4 v[242:245], v5, s[24:27], s29 offen offset:1024 sc1
v_mul_f32 v40, v40, v230
m16 v[20:23],a[228:231],v[160:163],0
s_mov_b32 s28, 180224
r128 a[204:207],v3,42816
v_mul_f32 v41, v41, v230
v_mul_f32 v42, v42, v230
v_mul_f32 v43, v43, v230
m16 v[52:55],a[228:231],v[164:167],0
v_exp_f32 v146, v146
v_mul_f32 v44, v44, v230
v_mul_f32 v45, v45, v230
v_mul_f32 v46, v46, v230
m16 v[24:27],a[232:235],v[160:163],0
r128 a[208:211],v3,42368
v_mul_f32 v47, v47, v230
s_mov_b32 s29, 33792
cvt v246,v40,v41
m16 v[56:59],a[232:235],v[164:167],0
v_exp_f32 v147, v147
buffer_load_dwordx4 v14, s[16:19], s28 offen offset:256 nt lds
cvt v247,v42,v43
cvt v248,v44,v45
cvt v249,v46,v47
m16 v[28:31],a[236:239],v[160:163],0
ds_write_b128 v209, a[172:175] offset:60192
r128 a[212:215],v3,42880
buffer_store_dwordx4 v[246:249], v5, s[24:27], s29 offen offset:0 sc1
v_mul_f32 v72, v72, v232
m16 v[60:63],a[236:239],v[164:167],0
v_exp_f32 v148, v148
r128 a[216:219],v3,42432
v_mul_f32 v73, v73, v232
v_mul_f32 v74, v74, v232
v_mul_f32 v75, v75, v232
s_waitcnt lgkmcnt(9)
m16 v[32:35],a[240:243],v[160:163],0
s_add_u32 m0, s100, 109824
v_mul_f32 v76, v76, v232
v_mul_f32 v77, v77, v232
v_mul_f32 v78, v78, v232
m16 v[64:67],a[240:243],v[164:167],0
v_exp_f32 v149, v149
r128 a[220:223],v3,42944
v_mul_f32 v79, v79, v232
cvt v250,v72,v73
cvt v251,v74,v75
m16 v[36:39],a[244:247],v[160:163],0
s_mov_b32 s28, 188416
cvt v252,v76,v77
cvt v253,v78,v79
m16 v[68:71],a[244:247],v[164:167],0
v_exp_f32 v150, v150
buffer_store_dwordx4 v[250:253], v5, s[24:27], s29 offen offset:1024 sc1
m16 v[40:43],a[248:251],v[160:163],0
v_exp_f32 v151, v151
buffer_load_dwordx4 v14, s[16:19], s28 offen offset:0 nt lds
m16 v[72:75],a[248:251],v[164:167],0
cvt v172,v136,v137
cvt v173,v138,v139
cvt v174,v140,v141
m16 v[44:47],a[252:255],v[160:163],0
cvt v175,v142,v143
cvt v176,v144,v145
cvt v177,v146,v147
m16 v[76:79],a[252:255],v[164:167],0
cvt v178,v148,v149
cvt v179,v150,v151
s_waitcnt lgkmcnt(0)
m16 v[136:139],a[192:195],a[48:51],v[184:187]
v_exp_f32 v112, v112
rtr a[224:225],v4,8448
m16 v[144:147],a[192:195],a[64:67],v[188:191]
rtr a[226:227],v4,8960
v_exp_f32 v113, v113
m16 v[140:143],a[196:199],a[48:51],v[184:187]
rtr a[228:229],v4,8480
rtr a[230:231],v4,8992
cvt v160,v112,v113
m16 v[148:151],a[196:199],a[64:67],v[188:191]
v_exp_f32 v114, v114
rtr a[232:233],v4,8512
m16 v[136:139],a[200:203],a[52:55],v[136:139]
rtr a[234:235],v4,9024
rtr a[236:237],v4,8544
m16 v[144:147],a[200:203],a[68:71],v[144:147]
v_exp_f32 v115, v115
rtr a[238:239],v4,9056
m16 v[140:143],a[204:207],a[52:55],v[140:143]
rtr a[240:241],v4,8576
rtr a[242:243],v4,9088
m16 v[148:151],a[204:207],a[68:71],v[148:151]
v_exp_f32 v116, v116
m16 v[136:139],a[208:211],a[56:59],v[136:139]
rtr a[244:245],v4,8608
rtr a[246:247],v4,9120
m16 v[144:147],a[208:211],a[72:75],v[144:147]
v_exp_f32 v117, v117
m16 v[140:143],a[212:215],a[56:59],v[140:143]
rtr a[248:249],v4,8640
rtr a[250:251],v4,9152
m16 v[148:151],a[212:215],a[72:75],v[148:151]
rtr a[252:253],v4,8672
rtr a[254:255],v4,9184
m16 v[136:139],a[216:219],a[60:63],v[136:139]
v_exp_f32 v118, v118
m16 v[144:147],a[216:219],a[76:79],v[144:147]
v_exp_f32 v119, v119
m16 v[140:143],a[220:223],a[60:63],v[140:143]
v_exp_f32 v120, v120
m16 v[148:151],a[220:223],a[76:79],v[148:151]
v_exp_f32 v121, v121
m16 v[196:199],v[220:223],v[172:175],v[196:199]
v_exp_f32 v122, v122
m16 v[200:203],v[220:223],v[176:179],v[200:203]
s_waitcnt vmcnt(15) lgkmcnt(0)
s_barrier
m16 v[16:19],a[224:227],v[172:175],v[16:19]
v_exp_f32 v123, v123
m16 v[48:51],a[224:227],v[176:179],v[48:51]
r128 a[192:195],v1,0
s_add_u32 m0, s100, 110624
m16 v[20:23],a[228:231],v[172:175],v[20:23]
r128 a[196:199],v1,512
cvt v161,v114,v115
m16 v[52:55],a[228:231],v[176:179],v[52:55]
r128 a[200:203],v1,64
s_mov_b32 s28, 188416
m16 v[24:27],a[232:235],v[172:175],v[24:27]
r128 a[204:207],v1,576
cvt v162,v116,v117
m16 v[56:59],a[232:235],v[176:179],v[56:59]
r128 a[208:211],v1,128
buffer_load_dwordx4 v14, s[16:19], s28 offen offset:256 nt lds
m16 v[28:31],a[236:239],v[172:175],v[28:31]
v_exp_f32 v124, v124
m16 v[60:63],a[236:239],v[176:179],v[60:63]
r128 a[212:215],v1,640
s_add_u32 m0, s100, 0
m16 v[32:35],a[240:243],v[172:175],v[32:35]
r128 a[216:219],v1,192
cvt v163,v118,v119
m16 v[64:67],a[240:243],v[176:179],v[64:67]
v_exp_f32 v125, v125
r128 a[220:223],v1,704
m16 v[36:39],a[244:247],v[172:175],v[36:39]
v_exp_f32 v126, v126
m16 v[68:71],a[244:247],v[176:179],v[68:71]
s_mov_b32 s28, 196608
cvt v164,v120,v121
m16 v[40:43],a[248:251],v[172:175],v[40:43]
v_exp_f32 v127, v127
m16 v[72:75],a[248:251],v[176:179],v[72:75]
buffer_load_dwordx4 v14, s[16:19], s28 offen offset:0 nt lds
cvt v165,v122,v123
m16 v[44:47],a[252:255],v[172:175],v[44:47]
cvt v166,v124,v125
cvt v167,v126,v127
m16 v[76:79],a[252:255],v[176:179],v[76:79]
s_waitcnt lgkmcnt(0)
m16 v[112:115],a[192:195],a[48:51],v[184:187]
v_exp_f32 v136, v136
rtr a[224:225],v4,33792
m16 v[120:123],a[192:195],a[64:67],v[188:191]
rtr a[226:227],v4,34304
s_add_u32 m0, s100, 800
rtr a[228:229],v4,33824
m16 v[116:119],a[196:199],a[48:51],v[184:187]
v_exp_f32 v137, v137
rtr a[230:231],v4,34336
m16 v[124:127],a[196:199],a[64:67],v[188:191]
s_mov_b32 s28, 196608
v_exp_f32 v138, v138
m16 v[112:115],a[200:203],a[52:55],v[112:115]
rtr a[232:233],v4,33856
rtr a[234:235],v4,34368
ds_write_b128 v15, a[176:179] offset:33792
m16 v[120:123],a[200:203],a[68:71],v[120:123]
rtr a[236:237],v4,33888
v_exp_f32 v139, v139
m16 v[116:119],a[204:207],a[52:55],v[116:119]
rtr a[238:239],v4,34400
buffer_load_dwordx4 v14, s[16:19], s28 offen offset:256 nt lds
rtr a[240:241],v4,33920
m16 v[124:127],a[204:207],a[68:71],v[124:127]
rtr a[242:243],v4,34432
v_exp_f32 v140, v140
m16 v[112:115],a[208:211],a[56:59],v[112:115]
rtr a[244:245],v4,33952
rtr a[246:247],v4,34464
s_add_u32 m0, s100, 8448
m16 v[120:123],a[208:211],a[72:75],v[120:123]
v_exp_f32 v141, v141
rtr a[248:249],v4,33984
m16 v[116:119],a[212:215],a[56:59],v[116:119]
rtr a[250:251],v4,34496
ds_write_b128 v15, a[180:183] offset:34848
rtr a[252:253],v4,34016
m16 v[124:127],a[212:215],a[72:75],v[124:127]
s_mov_b32 s28, 204800
v_exp_f32 v142, v142
m16 v[112:115],a[216:219],a[60:63],v[112:115]
rtr a[254:255],v4,34528
v_exp_f32 v143, v143
m16 v[120:123],a[216:219],a[76:79],v[120:123]
buffer_load_dwordx4 v14, s[16:19], s28 offen offset:0 nt lds
v_exp_f32 v144, v144
m16 v[116:119],a[220:223],a[60:63],v[116:119]
v_exp_f32 v145, v145
cvt v172,v136,v137
m16 v[124:127],a[220:223],a[76:79],v[124:127]
r128 a[192:195],v1,8448
cvt v173,v138,v139
m16 v[196:199],v[220:223],v[160:163],v[196:199]
r128 a[196:199],v1,8960
s_add_u32 m0, s100, 9248
m16 v[200:203],v[220:223],v[164:167],v[200:203]
ds_write_b128 v15, a[184:187] offset:42240
s_waitcnt lgkmcnt(12)
m16 v[16:19],a[224:227],v[160:163],v[16:19]
r128 a[200:203],v1,8512
s_mov_b32 s28, 204800
m16 v[48:51],a[224:227],v[164:167],v[48:51]
r128 a[204:207],v1,9024
cvt v174,v140,v141
m16 v[20:23],a[228:231],v[160:163],v[20:23]
v_exp_f32 v146, v146
m16 v[52:55],a[228:231],v[164:167],v[52:55]
r128 a[208:211],v1,8576
buffer_load_dwordx4 v14, s[16:19], s28 offen offset:256 nt lds
m16 v[24:27],a[232:235],v[160:163],v[24:27]
v_exp_f32 v147, v147
m16 v[56:59],a[232:235],v[164:167],v[56:59]
ds_write_b128 v15, a[188:191] offset:43296
r128 a[212:215],v1,9088
m16 v[28:31],a[236:239],v[160:163],v[28:31]
v_exp_f32 v148, v148
m16 v[60:63],a[236:239],v[164:167],v[60:63]
r128 a[216:219],v1,8640
s_waitcnt lgkmcnt(9)
m16 v[32:35],a[240:243],v[160:163],v[32:35]
s_add_u32 m0, s100, 16896
r128 a[220:223],v1,9152
m16 v[64:67],a[240:243],v[164:167],v[64:67]
v_exp_f32 v149, v149
m16 v[36:39],a[244:247],v[160:163],v[36:39]
s_mov_b32 s28, 196608
cvt v175,v142,v143
m16 v[68:71],a[244:247],v[164:167],v[68:71]
v_exp_f32 v150, v150
m16 v[40:43],a[248:251],v[160:163],v[40:43]
v_exp_f32 v151, v151
m16 v[72:75],a[248:251],v[164:167],v[72:75]
buffer_load_dwordx4 v14, s[20:23], s28 offen offset:0 nt lds
cvt v176,v144,v145
m16 v[44:47],a[252:255],v[160:163],v[44:47]
cvt v177,v146,v147
cvt v178,v148,v149
m16 v[76:79],a[252:255],v[164:167],v[76:79]
cvt v179,v150,v151
s_waitcnt lgkmcnt(0)
m16 v[136:139],a[192:195],a[48:51],v[184:187]
v_exp_f32 v112, v112
rtr a[224:225],v4,42240
m16 v[144:147],a[192:195],a[64:67],v[188:191]
rtr a[226:227],v4,42752
v_exp_f32 v113, v113
m16 v[140:143],a[196:199],a[48:51],v[184:187]
rtr a[228:229],v4,42272
rtr a[230:231],v4,42784
cvt v160,v112,v113
m16 v[148:151],a[196:199],a[64:67],v[188:191]
v_exp_f32 v114, v114
rtr a[232:233],v4,42304
m16 v[136:139],a[200:203],a[52:55],v[136:139]
rtr a[234:235],v4,42816
rtr a[236:237],v4,42336
m16 v[144:147],a[200:203],a[68:71],v[144:147]
v_exp_f32 v115, v115
rtr a[238:239],v4,42848
m16 v[140:143],a[204:207],a[52:55],v[140:143]
rtr a[240:241],v4,42368
rtr a[242:243],v4,42880
m16 v[148:151],a[204:207],a[68:71],v[148:151]
v_exp_f32 v116, v116
m16 v[136:139],a[208:211],a[56:59],v[136:139]
rtr a[244:245],v4,42400
rtr a[246:247],v4,42912
m16 v[144:147],a[208:211],a[72:75],v[144:147]
v_exp_f32 v117, v117
m16 v[140:143],a[212:215],a[56:59],v[140:143]
rtr a[248:249],v4,42432
rtr a[250:251],v4,42944
m16 v[148:151],a[212:215],a[72:75],v[148:151]
rtr a[252:253],v4,42464
rtr a[254:255],v4,42976
m16 v[136:139],a[216:219],a[60:63],v[136:139]
v_exp_f32 v118, v118
m16 v[144:147],a[216:219],a[76:79],v[144:147]
v_exp_f32 v119, v119
m16 v[140:143],a[220:223],a[60:63],v[140:143]
v_exp_f32 v120, v120
m16 v[148:151],a[220:223],a[76:79],v[148:151]
v_exp_f32 v121, v121
m16 v[196:199],v[220:223],v[172:175],v[196:199]
v_exp_f32 v122, v122
m16 v[200:203],v[220:223],v[176:179],v[200:203]
s_waitcnt vmcnt(5) lgkmcnt(0)
s_barrier
m16 v[16:19],a[224:227],v[172:175],v[16:19]
v_exp_f32 v123, v123
m16 v[48:51],a[224:227],v[176:179],v[48:51]
r128 a[192:195],v1,33792
s_add_u32 m0, s100, 17696
m16 v[20:23],a[228:231],v[172:175],v[20:23]
r128 a[196:199],v1,34304
cvt v161,v114,v115
m16 v[52:55],a[228:231],v[176:179],v[52:55]
r128 a[200:203],v1,33856
s_mov_b32 s28, 196608
m16 v[24:27],a[232:235],v[172:175],v[24:27]
r128 a[204:207],v1,34368
cvt v162,v116,v117
m16 v[56:59],a[232:235],v[176:179],v[56:59]
r128 a[208:211],v1,33920
buffer_load_dwordx4 v14, s[20:23], s28 offen offset:256 nt lds
m16 v[28:31],a[236:239],v[172:175],v[28:31]
v_exp_f32 v124, v124
m16 v[60:63],a[236:239],v[176:179],v[60:63]
r128 a[212:215],v1,34432
s_add_u32 m0, s100, 25344
m16 v[32:35],a[240:243],v[172:175],v[32:35]
r128 a[216:219],v1,33984
cvt v163,v118,v119
m16 v[64:67],a[240:243],v[176:179],v[64:67]
v_exp_f32 v125, v125
r128 a[220:223],v1,34496
m16 v[36:39],a[244:247],v[172:175],v[36:39]
v_exp_f32 v126, v126
m16 v[68:71],a[244:247],v[176:179],v[68:71]
s_mov_b32 s28, 204800
cvt v164,v120,v121
m16 v[40:43],a[248:251],v[172:175],v[40:43]
v_exp_f32 v127, v127
m16 v[72:75],a[248:251],v[176:179],v[72:75]
buffer_load_dwordx4 v14, s[20:23], s28 offen offset:0 nt lds
cvt v165,v122,v123
m16 v[44:47],a[252:255],v[172:175],v[44:47]
cvt v166,v124,v125
cvt v167,v126,v127
m16 v[76:79],a[252:255],v[176:179],v[76:79]
s_waitcnt lgkmcnt(0)
m16 v[112:115],a[192:195],a[48:51],v[184:187]
v_exp_f32 v136, v136
rtr a[224:225],v2,0
m16 v[120:123],a[192:195],a[64:67],v[188:191]
rtr a[226:227],v2,512
s_add_u32 m0, s100, 26144
rtr a[228:229],v2,32
m16 v[116:119],a[196:199],a[48:51],v[184:187]
v_exp_f32 v137, v137
rtr a[230:231],v2,544
m16 v[124:127],a[196:199],a[64:67],v[188:191]
s_mov_b32 s28, 204800
v_exp_f32 v138, v138
m16 v[112:115],a[200:203],a[52:55],v[112:115]
rtr a[232:233],v2,64
rtr a[234:235],v2,576
rtr a[236:237],v2,96
m16 v[120:123],a[200:203],a[68:71],v[120:123]
v_exp_f32 v139, v139
rtr a[238:239],v2,608
m16 v[116:119],a[204:207],a[52:55],v[116:119]
buffer_load_dwordx4 v14, s[20:23], s28 offen offset:256 nt lds
rtr a[240:241],v2,128
rtr a[242:243],v2,640
m16 v[124:127],a[204:207],a[68:71],v[124:127]
v_exp_f32 v140, v140
rtr a[244:245],v2,160
m16 v[112:115],a[208:211],a[56:59],v[112:115]
rtr a[246:247],v2,672
s_add_u32 m0, s100, 50688
cvt v172,v136,v137
m16 v[120:123],a[208:211],a[72:75],v[120:123]
v_exp_f32 v141, v141
rtr a[248:249],v2,192
m16 v[116:119],a[212:215],a[56:59],v[116:119]
rtr a[250:251],v2,704
rtr a[252:253],v2,224
s_mov_b32 s28, 212992
m16 v[124:127],a[212:215],a[72:75],v[124:127]
v_exp_f32 v142, v142
m16 v[112:115],a[216:219],a[60:63],v[112:115]
rtr a[254:255],v2,736
cvt v173,v138,v139
m16 v[120:123],a[216:219],a[76:79],v[120:123]
v_exp_f32 v143, v143
m16 v[116:119],a[220:223],a[60:63],v[116:119]
buffer_load_dwordx4 v14, s[20:23], s28 offen offset:0 nt lds
cvt v174,v140,v141
m16 v[124:127],a[220:223],a[76:79],v[124:127]
r128 a[192:195],v1,42240
cvt v175,v142,v143
m16 v[196:199],v[220:223],v[160:163],v[196:199]
v_exp_f32 v144, v144
m16 v[200:203],v[220:223],v[164:167],v[200:203]
r128 a[196:199],v1,42752
s_waitcnt lgkmcnt(10)
m16 v[16:19],a[224:227],v[160:163],v[16:19]
s_add_u32 m0, s100, 51488
r128 a[200:203],v1,42304
m16 v[48:51],a[224:227],v[164:167],v[48:51]
v_exp_f32 v145, v145
m16 v[20:23],a[228:231],v[160:163],v[20:23]
s_mov_b32 s28, 212992
r128 a[204:207],v1,42816
m16 v[52:55],a[228:231],v[164:167],v[52:55]
v_exp_f32 v146, v146
m16 v[24:27],a[232:235],v[160:163],v[24:27]
r128 a[208:211],v1,42368
buffer_load_dwordx4 v14, s[20:23], s28 offen offset:256 nt lds
m16 v[56:59],a[232:235],v[164:167],v[56:59]
v_exp_f32 v147, v147
m16 v[28:31],a[236:239],v[160:163],v[28:31]
r128 a[212:215],v1,42880
s_add_u32 m0, s100, 59136
m16 v[60:63],a[236:239],v[164:167],v[60:63]
v_exp_f32 v148, v148
r128 a[216:219],v1,42432
s_waitcnt lgkmcnt(7)
m16 v[32:35],a[240:243],v[160:163],v[32:35]
v_exp_f32 v149, v149
m16 v[64:67],a[240:243],v[164:167],v[64:67]
r128 a[220:223],v1,42944
s_mov_b32 s28, 221184
m16 v[36:39],a[244:247],v[160:163],v[36:39]
v_exp_f32 v150, v150
m16 v[68:71],a[244:247],v[164:167],v[68:71]
v_exp_f32 v151, v151
m16 v[40:43],a[248:251],v[160:163],v[40:43]
buffer_load_dwordx4 v14, s[20:23], s28 offen offset:0 nt lds
cvt v176,v144,v145
m16 v[72:75],a[248:251],v[164:167],v[72:75]
cvt v177,v146,v147
cvt v178,v148,v149
m16 v[44:47],a[252:255],v[160:163],v[44:47]
cvt v179,v150,v151
m16 v[76:79],a[252:255],v[164:167],v[76:79]
s_waitcnt lgkmcnt(0)
m16 v[136:139],a[192:195],a[48:51],v[184:187]
v_exp_f32 v112, v112
rtr a[224:225],v2,8448
m16 v[144:147],a[192:195],a[64:67],v[188:191]
rtr a[226:227],v2,8960
v_exp_f32 v113, v113
m16 v[140:143],a[196:199],a[48:51],v[184:187]
rtr a[228:229],v2,8480
rtr a[230:231],v2,8992
cvt v160,v112,v113
m16 v[148:151],a[196:199],a[64:67],v[188:191]
v_exp_f32 v114, v114
rtr a[232:233],v2,8512
m16 v[136:139],a[200:203],a[52:55],v[136:139]
rtr a[234:235],v2,9024
rtr a[236:237],v2,8544
m16 v[144:147],a[200:203],a[68:71],v[144:147]
v_exp_f32 v115, v115
rtr a[238:239],v2,9056
m16 v[140:143],a[204:207],a[52:55],v[140:143]
rtr a[240:241],v2,8576
rtr a[242:243],v2,9088
m16 v[148:151],a[204:207],a[68:71],v[148:151]
v_exp_f32 v116, v116
m16 v[136:139],a[208:211],a[56:59],v[136:139]
rtr a[244:245],v2,8608
rtr a[246:247],v2,9120
m16 v[144:147],a[208:211],a[72:75],v[144:147]
v_exp_f32 v117, v117
m16 v[140:143],a[212:215],a[56:59],v[140:143]
rtr a[248:249],v2,8640
rtr a[250:251],v2,9152
m16 v[148:151],a[212:215],a[72:75],v[148:151]
rtr a[252:253],v2,8672
rtr a[254:255],v2,9184
m16 v[136:139],a[216:219],a[60:63],v[136:139]
v_exp_f32 v118, v118
m16 v[144:147],a[216:219],a[76:79],v[144:147]
v_exp_f32 v119, v119
m16 v[140:143],a[220:223],a[60:63],v[140:143]
v_exp_f32 v120, v120
m16 v[148:151],a[220:223],a[76:79],v[148:151]
v_exp_f32 v121, v121
m16 v[196:199],v[220:223],v[172:175],v[196:199]
v_exp_f32 v122, v122
m16 v[200:203],v[220:223],v[176:179],v[200:203]
s_waitcnt vmcnt(7) lgkmcnt(0)
s_barrier
m16 v[16:19],a[224:227],v[172:175],v[16:19]
v_exp_f32 v123, v123
m16 v[48:51],a[224:227],v[176:179],v[48:51]
r128 a[192:195],v3,0
s_add_u32 m0, s100, 59936
m16 v[20:23],a[228:231],v[172:175],v[20:23]
r128 a[196:199],v3,512
cvt v161,v114,v115
m16 v[52:55],a[228:231],v[176:179],v[52:55]
r128 a[200:203],v3,64
s_mov_b32 s28, 221184
m16 v[24:27],a[232:235],v[172:175],v[24:27]
r128 a[204:207],v3,576
cvt v162,v116,v117
m16 v[56:59],a[232:235],v[176:179],v[56:59]
r128 a[208:211],v3,128
buffer_load_dwordx4 v14, s[20:23], s28 offen offset:256 nt lds
m16 v[28:31],a[236:239],v[172:175],v[28:31]
v_exp_f32 v124, v124
m16 v[60:63],a[236:239],v[176:179],v[60:63]
r128 a[212:215],v3,640
s_add_u32 m0, s100, 67584
m16 v[32:35],a[240:243],v[172:175],v[32:35]
r128 a[216:219],v3,192
cvt v163,v118,v119
m16 v[64:67],a[240:243],v[176:179],v[64:67]
v_exp_f32 v125, v125
r128 a[220:223],v3,704
m16 v[36:39],a[244:247],v[172:175],v[36:39]
v_exp_f32 v126, v126
m16 v[68:71],a[244:247],v[176:179],v[68:71]
s_mov_b32 s28, 229376
cvt v164,v120,v121
m16 v[40:43],a[248:251],v[172:175],v[40:43]
v_exp_f32 v127, v127
m16 v[72:75],a[248:251],v[176:179],v[72:75]
buffer_load_dwordx4 v14, s[16:19], s28 offen offset:0 nt lds
cvt v165,v122,v123
m16 v[44:47],a[252:255],v[172:175],v[44:47]
cvt v166,v124,v125
cvt v167,v126,v127
m16 v[76:79],a[252:255],v[176:179],v[76:79]
s_waitcnt lgkmcnt(0)
m16 v[112:115],a[192:195],a[48:51],v[184:187]
v_exp_f32 v136, v136
rtr a[224:225],v2,33792
m16 v[120:123],a[192:195],a[64:67],v[188:191]
rtr a[226:227],v2,34304
s_add_u32 m0, s100, 68384
rtr a[228:229],v2,33824
m16 v[116:119],a[196:199],a[48:51],v[184:187]
v_exp_f32 v137, v137
rtr a[230:231],v2,34336
m16 v[124:127],a[196:199],a[64:67],v[188:191]
s_mov_b32 s28, 229376
v_exp_f32 v138, v138
m16 v[112:115],a[200:203],a[52:55],v[112:115]
rtr a[232:233],v2,33856
rtr a[234:235],v2,34368
rtr a[236:237],v2,33888
m16 v[120:123],a[200:203],a[68:71],v[120:123]
v_exp_f32 v139, v139
rtr a[238:239],v2,34400
m16 v[116:119],a[204:207],a[52:55],v[116:119]
buffer_load_dwordx4 v14, s[16:19], s28 offen offset:256 nt lds
rtr a[240:241],v2,33920
rtr a[242:243],v2,34432
m16 v[124:127],a[204:207],a[68:71],v[124:127]
v_exp_f32 v140, v140
rtr a[244:245],v2,33952
m16 v[112:115],a[208:211],a[56:59],v[112:115]
rtr a[246:247],v2,34464
s_add_u32 m0, s100, 76032
cvt v172,v136,v137
m16 v[120:123],a[208:211],a[72:75],v[120:123]
v_exp_f32 v141, v141
rtr a[248:249],v2,33984
m16 v[116:119],a[212:215],a[56:59],v[116:119]
rtr a[250:251],v2,34496
rtr a[252:253],v2,34016
s_mov_b32 s28, 237568
m16 v[124:127],a[212:215],a[72:75],v[124:127]
v_exp_f32 v142, v142
m16 v[112:115],a[216:219],a[60:63],v[112:115]
rtr a[254:255],v2,34528
cvt v173,v138,v139
m16 v[120:123],a[216:219],a[76:79],v[120:123]
v_exp_f32 v143, v143
m16 v[116:119],a[220:223],a[60:63],v[116:119]
buffer_load_dwordx4 v14, s[16:19], s28 offen offset:0 nt lds
cvt v174,v140,v141
m16 v[124:127],a[220:223],a[76:79],v[124:127]
r128 a[192:195],v3,8448
cvt v175,v142,v143
m16 v[196:199],v[220:223],v[160:163],v[196:199]
v_exp_f32 v144, v144
m16 v[200:203],v[220:223],v[164:167],v[200:203]
r128 a[196:199],v3,8960
s_waitcnt lgkmcnt(10)
m16 v[16:19],a[224:227],v[160:163],v[16:19]
s_add_u32 m0, s100, 76832
r128 a[200:203],v3,8512
m16 v[48:51],a[224:227],v[164:167],v[48:51]
v_exp_f32 v145, v145
m16 v[20:23],a[228:231],v[160:163],v[20:23]
s_mov_b32 s28, 237568
r128 a[204:207],v3,9024
m16 v[52:55],a[228:231],v[164:167],v[52:55]
v_exp_f32 v146, v146
m16 v[24:27],a[232:235],v[160:163],v[24:27]
r128 a[208:211],v3,8576
buffer_load_dwordx4 v14, s[16:19], s28 offen offset:256 nt lds
m16 v[56:59],a[232:235],v[164:167],v[56:59]
v_exp_f32 v147, v147
m16 v[28:31],a[236:239],v[160:163],v[28:31]
r128 a[212:215],v3,9088
s_add_u32 m0, s100, 84480
m16 v[60:63],a[236:239],v[164:167],v[60:63]
v_exp_f32 v148, v148
r128 a[216:219],v3,8640
s_waitcnt lgkmcnt(7)
m16 v[32:35],a[240:243],v[160:163],v[32:35]
v_exp_f32 v149, v149
m16 v[64:67],a[240:243],v[164:167],v[64:67]
r128 a[220:223],v3,9152
s_mov_b32 s28, 229376
m16 v[36:39],a[244:247],v[160:163],v[36:39]
v_exp_f32 v150, v150
m16 v[68:71],a[244:247],v[164:167],v[68:71]
v_exp_f32 v151, v151
m16 v[40:43],a[248:251],v[160:163],v[40:43]
buffer_load_dwordx4 v14, s[20:23], s28 offen offset:0 nt lds
cvt v176,v144,v145
m16 v[72:75],a[248:251],v[164:167],v[72:75]
cvt v177,v146,v147
cvt v178,v148,v149
m16 v[44:47],a[252:255],v[160:163],v[44:47]
cvt v179,v150,v151
m16 v[76:79],a[252:255],v[164:167],v[76:79]
s_waitcnt lgkmcnt(0)
m16 v[136:139],a[192:195],a[48:51],v[184:187]
v_exp_f32 v112, v112
rtr a[224:225],v2,42240
m16 v[144:147],a[192:195],a[64:67],v[188:191]
rtr a[226:227],v2,42752
v_exp_f32 v113, v113
m16 v[140:143],a[196:199],a[48:51],v[184:187]
rtr a[228:229],v2,42272
rtr a[230:231],v2,42784
cvt v160,v112,v113
m16 v[148:151],a[196:199],a[64:67],v[188:191]
v_exp_f32 v114, v114
rtr a[232:233],v2,42304
m16 v[136:139],a[200:203],a[52:55],v[136:139]
rtr a[234:235],v2,42816
rtr a[236:237],v2,42336
m16 v[144:147],a[200:203],a[68:71],v[144:147]
v_exp_f32 v115, v115
rtr a[238:239],v2,42848
m16 v[140:143],a[204:207],a[52:55],v[140:143]
rtr a[240:241],v2,42368
rtr a[242:243],v2,42880
cvt v161,v114,v115
m16 v[148:151],a[204:207],a[68:71],v[148:151]
v_exp_f32 v116, v116
rtr a[244:245],v2,42400
m16 v[136:139],a[208:211],a[56:59],v[136:139]
rtr a[246:247],v2,42912
v_exp_f32 v117, v117
m16 v[144:147],a[208:211],a[72:75],v[144:147]
rtr a[248:249],v2,42432
rtr a[250:251],v2,42944
m16 v[140:143],a[212:215],a[56:59],v[140:143]
rtr a[252:253],v2,42464
cvt v162,v116,v117
m16 v[148:151],a[212:215],a[72:75],v[148:151]
v_exp_f32 v118, v118
m16 v[136:139],a[216:219],a[60:63],v[136:139]
rtr a[254:255],v2,42976
m16 v[144:147],a[216:219],a[76:79],v[144:147]
v_exp_f32 v119, v119
m16 v[140:143],a[220:223],a[60:63],v[140:143]
v_exp_f32 v120, v120
cvt v163,v118,v119
m16 v[148:151],a[220:223],a[76:79],v[148:151]
v_exp_f32 v121, v121
m16 v[196:199],v[220:223],v[172:175],v[196:199]
v_exp_f32 v122, v122
m16 v[200:203],v[220:223],v[176:179],v[200:203]
s_waitcnt vmcnt(9) lgkmcnt(0)
s_barrier
m16 v[16:19],a[224:227],v[172:175],v[16:19]
v_exp_f32 v123, v123
m16 v[48:51],a[224:227],v[176:179],v[48:51]
r128 a[192:195],v3,33792
s_add_u32 m0, s100, 85280
m16 v[20:23],a[228:231],v[172:175],v[20:23]
r128 a[196:199],v3,34304
s_mov_b32 s28, 229376
m16 v[52:55],a[228:231],v[176:179],v[52:55]
r128 a[200:203],v3,33856
buffer_load_dwordx4 v14, s[20:23], s28 offen offset:256 nt lds
m16 v[24:27],a[232:235],v[172:175],v[24:27]
r128 a[204:207],v3,34368
cvt v164,v120,v121
m16 v[56:59],a[232:235],v[176:179],v[56:59]
r128 a[208:211],v3,33920
s_add_u32 m0, s100, 92928
m16 v[28:31],a[236:239],v[172:175],v[28:31]
v_exp_f32 v124, v124
m16 v[60:63],a[236:239],v[176:179],v[60:63]
r128 a[212:215],v3,34432
s_mov_b32 s28, 237568
m16 v[32:35],a[240:243],v[172:175],v[32:35]
r128 a[216:219],v3,33984
buffer_load_dwordx4 v14, s[20:23], s28 offen offset:0 nt lds
m16 v[64:67],a[240:243],v[176:179],v[64:67]
v_exp_f32 v125, v125
r128 a[220:223],v3,34496
m16 v[36:39],a[244:247],v[172:175],v[36:39]
v_exp_f32 v126, v126
m16 v[68:71],a[244:247],v[176:179],v[68:71]
s_add_u32 m0, s100, 93728
cvt v165,v122,v123
m16 v[40:43],a[248:251],v[172:175],v[40:43]
v_exp_f32 v127, v127
m16 v[72:75],a[248:251],v[176:179],v[72:75]
s_mov_b32 s28, 237568
cvt v166,v124,v125
m16 v[44:47],a[252:255],v[172:175],v[44:47]
buffer_load_dwordx4 v14, s[20:23], s28 offen offset:256 nt lds
cvt v167,v126,v127
m16 v[76:79],a[252:255],v[176:179],v[76:79]
s_waitcnt lgkmcnt(0)
m16 v[112:115],a[192:195],a[48:51],v[184:187]
v_exp_f32 v136, v136
rtr a[224:225],v4,0
m16 v[120:123],a[192:195],a[64:67],v[188:191]
rtr a[226:227],v4,512
s_add_u32 m0, s100, 101376
rtr a[228:229],v4,32
m16 v[116:119],a[196:199],a[48:51],v[184:187]
v_exp_f32 v137, v137
s_mov_b32 s28, 245760
m16 v[124:127],a[196:199],a[64:67],v[188:191]
rtr a[230:231],v4,544
v_exp_f32 v138, v138
m16 v[112:115],a[200:203],a[52:55],v[112:115]
rtr a[232:233],v4,64
rtr a[234:235],v4,576
buffer_load_dwordx4 v14, s[16:19], s28 offen offset:0 nt lds
m16 v[120:123],a[200:203],a[68:71],v[120:123]
rtr a[236:237],v4,96
s_add_u32 m0, s100, 102176
rtr a[238:239],v4,608
m16 v[116:119],a[204:207],a[52:55],v[116:119]
v_exp_f32 v139, v139
rtr a[240:241],v4,128
m16 v[124:127],a[204:207],a[68:71],v[124:127]
rtr a[242:243],v4,640
s_mov_b32 s28, 245760
rtr a[244:245],v4,160
m16 v[112:115],a[208:211],a[56:59],v[112:115]
v_exp_f32 v140, v140
buffer_load_dwordx4 v14, s[16:19], s28 offen offset:256 nt lds
m16 v[120:123],a[208:211],a[72:75],v[120:123]
rtr a[246:247],v4,672
v_exp_f32 v141, v141
m16 v[116:119],a[212:215],a[56:59],v[116:119]
rtr a[248:249],v4,192
rtr a[250:251],v4,704
s_add_u32 m0, s100, 109824
m16 v[124:127],a[212:215],a[72:75],v[124:127]
rtr a[252:253],v4,224
s_mov_b32 s28, 253952
rtr a[254:255],v4,736
m16 v[112:115],a[216:219],a[60:63],v[112:115]
v_exp_f32 v142, v142
buffer_load_dwordx4 v14, s[16:19], s28 offen offset:0 nt lds
m16 v[120:123],a[216:219],a[76:79],v[120:123]
v_exp_f32 v143, v143
v_mov_b32 v210, v6
m16 v[116:119],a[220:223],a[60:63],v[116:119]
v_exp_f32 v144, v144
cvt v172,v136,v137
m16 v[124:127],a[220:223],a[76:79],v[124:127]
r128 a[192:195],v3,42240
s_add_u32 m0, s70, 147424
cvt v173,v138,v139
m16 v[196:199],v[220:223],v[160:163],v[196:199]
r128 a[196:199],v3,42752
buffer_load_dwordx4 v210, s[56:59], 0 offen offset:0 lds
cvt v174,v140,v141
m16 v[200:203],v[220:223],v[164:167],v[200:203]
v_exp_f32 v145, v145
s_waitcnt lgkmcnt(10)
m16 v[16:19],a[224:227],v[160:163],v[16:19]
r128 a[200:203],v3,42304
buffer_load_dwordx4 v210, s[56:59], s44 offen offset:1024 lds
cvt v175,v142,v143
m16 v[48:51],a[224:227],v[164:167],v[48:51]
r128 a[204:207],v3,42816
v_exp_f32 v146, v146
m16 v[20:23],a[228:231],v[160:163],v[20:23]
buffer_load_dwordx4 v210, s[56:59], s45 offen offset:2048 lds
cvt v176,v144,v145
m16 v[52:55],a[228:231],v[164:167],v[52:55]
r128 a[208:211],v3,42368
buffer_load_dwordx4 v210, s[56:59], s46 offen offset:3072 lds
m16 v[24:27],a[232:235],v[160:163],v[24:27]
v_exp_f32 v147, v147
m16 v[56:59],a[232:235],v[164:167],v[56:59]
v_add_u32 v210, 0x20000, v210
r128 a[212:215],v3,42880
m16 v[28:31],a[236:239],v[160:163],v[28:31]
v_exp_f32 v148, v148
m16 v[60:63],a[236:239],v[164:167],v[60:63]
r128 a[216:219],v3,42432
s_waitcnt lgkmcnt(7)
m16 v[32:35],a[240:243],v[160:163],v[32:35]
s_add_u32 m0, s70, 0
r128 a[220:223],v3,42944
m16 v[64:67],a[240:243],v[164:167],v[64:67]
v_exp_f32 v149, v149
buffer_load_dwordx4 v210, s[56:59], 0 offen offset:0 lds
m16 v[36:39],a[244:247],v[160:163],v[36:39]
v_exp_f32 v150, v150
m16 v[68:71],a[244:247],v[164:167],v[68:71]
buffer_load_dwordx4 v210, s[56:59], s44 offen offset:1024 lds
cvt v177,v146,v147
m16 v[40:43],a[248:251],v[160:163],v[40:43]
buffer_load_dwordx4 v210, s[56:59], s45 offen offset:2048 lds
cvt v178,v148,v149
m16 v[72:75],a[248:251],v[164:167],v[72:75]
v_exp_f32 v151, v151
m16 v[44:47],a[252:255],v[160:163],v[44:47]
buffer_load_dwordx4 v210, s[56:59], s46 offen offset:3072 lds
cvt v179,v150,v151
m16 v[76:79],a[252:255],v[164:167],v[76:79]
s_waitcnt lgkmcnt(0)
m16 v[136:139],a[192:195],a[48:51],v[184:187]
v_exp_f32 v112, v112
rtr a[224:225],v4,8448
m16 v[144:147],a[192:195],a[64:67],v[188:191]
rtr a[226:227],v4,8960
v_exp_f32 v113, v113
m16 v[140:143],a[196:199],a[48:51],v[184:187]
rtr a[228:229],v4,8480
rtr a[230:231],v4,8992
cvt v160,v112,v113
m16 v[148:151],a[196:199],a[64:67],v[188:191]
v_exp_f32 v114, v114
rtr a[232:233],v4,8512
m16 v[136:139],a[200:203],a[52:55],v[136:139]
rtr a[234:235],v4,9024
rtr a[236:237],v4,8544
m16 v[144:147],a[200:203],a[68:71],v[144:147]
v_exp_f32 v115, v115
rtr a[238:239],v4,9056
m16 v[140:143],a[204:207],a[52:55],v[140:143]
rtr a[240:241],v4,8576
rtr a[242:243],v4,9088
cvt v161,v114,v115
m16 v[148:151],a[204:207],a[68:71],v[148:151]
v_exp_f32 v116, v116
rtr a[244:245],v4,8608
m16 v[136:139],a[208:211],a[56:59],v[136:139]
rtr a[246:247],v4,9120
v_exp_f32 v117, v117
m16 v[144:147],a[208:211],a[72:75],v[144:147]
rtr a[248:249],v4,8640
rtr a[250:251],v4,9152
m16 v[140:143],a[212:215],a[56:59],v[140:143]
rtr a[252:253],v4,8672
cvt v162,v116,v117
m16 v[148:151],a[212:215],a[72:75],v[148:151]
v_exp_f32 v118, v118
m16 v[136:139],a[216:219],a[60:63],v[136:139]
rtr a[254:255],v4,9184
m16 v[144:147],a[216:219],a[76:79],v[144:147]
v_exp_f32 v119, v119
m16 v[140:143],a[220:223],a[60:63],v[140:143]
v_exp_f32 v120, v120
cvt v163,v118,v119
m16 v[148:151],a[220:223],a[76:79],v[148:151]
v_exp_f32 v121, v121
m16 v[196:199],v[220:223],v[172:175],v[196:199]
v_exp_f32 v122, v122
m16 v[200:203],v[220:223],v[176:179],v[200:203]
s_waitcnt vmcnt(15) lgkmcnt(0)
s_barrier
m16 v[16:19],a[224:227],v[172:175],v[16:19]
v_exp_f32 v123, v123
m16 v[48:51],a[224:227],v[176:179],v[48:51]
r128 a[192:195],v1,0
s_add_u32 m0, s100, 110624
m16 v[20:23],a[228:231],v[172:175],v[20:23]
r128 a[196:199],v1,512
s_mov_b32 s28, 253952
m16 v[52:55],a[228:231],v[176:179],v[52:55]
r128 a[200:203],v1,64
buffer_load_dwordx4 v14, s[16:19], s28 offen offset:256 nt lds
m16 v[24:27],a[232:235],v[172:175],v[24:27]
r128 a[204:207],v1,576
cvt v164,v120,v121
m16 v[56:59],a[232:235],v[176:179],v[56:59]
r128 a[208:211],v1,128
s_add_u32 m0, s100, 118272
m16 v[28:31],a[236:239],v[172:175],v[28:31]
v_exp_f32 v124, v124
m16 v[60:63],a[236:239],v[176:179],v[60:63]
r128 a[212:215],v1,640
s_mov_b32 s28, 245760
m16 v[32:35],a[240:243],v[172:175],v[32:35]
r128 a[216:219],v1,192
buffer_load_dwordx4 v14, s[20:23], s28 offen offset:0 nt lds
m16 v[64:67],a[240:243],v[176:179],v[64:67]
v_exp_f32 v125, v125
r128 a[220:223],v1,704
m16 v[36:39],a[244:247],v[172:175],v[36:39]
v_exp_f32 v126, v126
m16 v[68:71],a[244:247],v[176:179],v[68:71]
s_add_u32 m0, s100, 119072
cvt v165,v122,v123
m16 v[40:43],a[248:251],v[172:175],v[40:43]
v_exp_f32 v127, v127
m16 v[72:75],a[248:251],v[176:179],v[72:75]
s_mov_b32 s28, 245760
cvt v166,v124,v125
m16 v[44:47],a[252:255],v[172:175],v[44:47]
buffer_load_dwordx4 v14, s[20:23], s28 offen offset:256 nt lds
cvt v167,v126,v127
m16 v[76:79],a[252:255],v[176:179],v[76:79]
s_waitcnt lgkmcnt(0)
m16 v[112:115],a[192:195],a[48:51],v[184:187]
v_exp_f32 v136, v136
rtr a[224:225],v4,33792
m16 v[120:123],a[192:195],a[64:67],v[188:191]
rtr a[226:227],v4,34304
s_add_u32 m0, s100, 126720
rtr a[228:229],v4,33824
m16 v[116:119],a[196:199],a[48:51],v[184:187]
v_exp_f32 v137, v137
s_mov_b32 s28, 253952
m16 v[124:127],a[196:199],a[64:67],v[188:191]
rtr a[230:231],v4,34336
v_exp_f32 v138, v138
m16 v[112:115],a[200:203],a[52:55],v[112:115]
rtr a[232:233],v4,33856
rtr a[234:235],v4,34368
buffer_load_dwordx4 v14, s[20:23], s28 offen offset:0 nt lds
m16 v[120:123],a[200:203],a[68:71],v[120:123]
rtr a[236:237],v4,33888
v_exp_f32 v139, v139
m16 v[116:119],a[204:207],a[52:55],v[116:119]
rtr a[238:239],v4,34400
s_add_u32 m0, s100, 127520
rtr a[240:241],v4,33920
m16 v[124:127],a[204:207],a[68:71],v[124:127]
rtr a[242:243],v4,34432
v_exp_f32 v140, v140
m16 v[112:115],a[208:211],a[56:59],v[112:115]
rtr a[244:245],v4,33952
s_mov_b32 s28, 253952
rtr a[246:247],v4,34464
m16 v[120:123],a[208:211],a[72:75],v[120:123]
buffer_load_dwordx4 v14, s[20:23], s28 offen offset:256 nt lds
v_exp_f32 v141, v141
m16 v[116:119],a[212:215],a[56:59],v[116:119]
rtr a[248:249],v4,33984
rtr a[250:251],v4,34496
rtr a[252:253],v4,34016
m16 v[124:127],a[212:215],a[72:75],v[124:127]
v_add_u32 v210, 0x60000, v210
v_exp_f32 v142, v142
m16 v[112:115],a[216:219],a[60:63],v[112:115]
rtr a[254:255],v4,34528
s_add_u32 m0, s70, 33792
cvt v172,v136,v137
m16 v[120:123],a[216:219],a[76:79],v[120:123]
v_exp_f32 v143, v143
cvt v173,v138,v139
m16 v[116:119],a[220:223],a[60:63],v[116:119]
buffer_load_dwordx4 v210, s[56:59], 0 offen offset:0 lds
v_exp_f32 v144, v144
m16 v[124:127],a[220:223],a[76:79],v[124:127]
r128 a[192:195],v1,8448
v_exp_f32 v145, v145
m16 v[196:199],v[220:223],v[160:163],v[196:199]
r128 a[196:199],v1,8960
buffer_load_dwordx4 v210, s[56:59], s44 offen offset:1024 lds
cvt v174,v140,v141
m16 v[200:203],v[220:223],v[164:167],v[200:203]
buffer_load_dwordx4 v210, s[56:59], s45 offen offset:2048 lds
s_waitcnt lgkmcnt(10)
m16 v[16:19],a[224:227],v[160:163],v[16:19]
r128 a[200:203],v1,8512
cvt v175,v142,v143
m16 v[48:51],a[224:227],v[164:167],v[48:51]
r128 a[204:207],v1,9024
buffer_load_dwordx4 v210, s[56:59], s46 offen offset:3072 lds
m16 v[20:23],a[228:231],v[160:163],v[20:23]
v_exp_f32 v146, v146
m16 v[52:55],a[228:231],v[164:167],v[52:55]
r128 a[208:211],v1,8576
v_add_u32 v210, 0x20000, v210
m16 v[24:27],a[232:235],v[160:163],v[24:27]
v_exp_f32 v147, v147
m16 v[56:59],a[232:235],v[164:167],v[56:59]
r128 a[212:215],v1,9088
s_add_u32 m0, s70, 16896
m16 v[28:31],a[236:239],v[160:163],v[28:31]
v_exp_f32 v148, v148
m16 v[60:63],a[236:239],v[164:167],v[60:63]
r128 a[216:219],v1,8640
s_waitcnt lgkmcnt(7)
m16 v[32:35],a[240:243],v[160:163],v[32:35]
buffer_load_dwordx4 v210, s[56:59], 0 offen offset:0 lds
r128 a[220:223],v1,9152
m16 v[64:67],a[240:243],v[164:167],v[64:67]
v_exp_f32 v149, v149
m16 v[36:39],a[244:247],v[160:163],v[36:39]
buffer_load_dwordx4 v210, s[56:59], s44 offen offset:1024 lds
cvt v176,v144,v145
m16 v[68:71],a[244:247],v[164:167],v[68:71]
v_exp_f32 v150, v150
m16 v[40:43],a[248:251],v[160:163],v[40:43]
buffer_load_dwordx4 v210, s[56:59], s45 offen offset:2048 lds
cvt v177,v146,v147
m16 v[72:75],a[248:251],v[164:167],v[72:75]
v_exp_f32 v151, v151
m16 v[44:47],a[252:255],v[160:163],v[44:47]
buffer_load_dwordx4 v210, s[56:59], s46 offen offset:3072 lds
cvt v178,v148,v149
m16 v[76:79],a[252:255],v[164:167],v[76:79]
cvt v179,v150,v151
s_waitcnt lgkmcnt(0)
m16 v[136:139],a[192:195],a[48:51],v[184:187]
v_exp_f32 v112, v112
rtr a[224:225],v4,42240
m16 v[144:147],a[192:195],a[64:67],v[188:191]
rtr a[226:227],v4,42752
v_exp_f32 v113, v113
m16 v[140:143],a[196:199],a[48:51],v[184:187]
rtr a[228:229],v4,42272
rtr a[230:231],v4,42784
m16 v[148:151],a[196:199],a[64:67],v[188:191]
v_exp_f32 v114, v114
m16 v[136:139],a[200:203],a[52:55],v[136:139]
rtr a[232:233],v4,42304
rtr a[234:235],v4,42816
m16 v[144:147],a[200:203],a[68:71],v[144:147]
rtr a[236:237],v4,42336
rtr a[238:239],v4,42848
m16 v[140:143],a[204:207],a[52:55],v[140:143]
v_exp_f32 v115, v115
m16 v[148:151],a[204:207],a[68:71],v[148:151]
rtr a[240:241],v4,42368
rtr a[242:243],v4,42880
m16 v[136:139],a[208:211],a[56:59],v[136:139]
v_exp_f32 v116, v116
m16 v[144:147],a[208:211],a[72:75],v[144:147]
rtr a[244:245],v4,42400
rtr a[246:247],v4,42912
m16 v[140:143],a[212:215],a[56:59],v[140:143]
v_exp_f32 v117, v117
m16 v[148:151],a[212:215],a[72:75],v[148:151]
rtr a[248:249],v4,42432
rtr a[250:251],v4,42944
m16 v[136:139],a[216:219],a[60:63],v[136:139]
rtr a[252:253],v4,42464
rtr a[254:255],v4,42976
m16 v[144:147],a[216:219],a[76:79],v[144:147]
v_exp_f32 v118, v118
m16 v[140:143],a[220:223],a[60:63],v[140:143]
v_exp_f32 v119, v119
m16 v[148:151],a[220:223],a[76:79],v[148:151]
v_exp_f32 v120, v120
m16 v[196:199],v[220:223],v[172:175],v[196:199]
v_exp_f32 v121, v121
m16 v[200:203],v[220:223],v[176:179],v[200:203]
s_waitcnt vmcnt(12) lgkmcnt(0)
s_barrier
m16 v[16:19],a[224:227],v[172:175],v[16:19]
v_exp_f32 v122, v122
m16 v[48:51],a[224:227],v[176:179],v[48:51]
r128 a[192:195],v1,33792
v_add_u32 v210, 0x60000, v210
m16 v[20:23],a[228:231],v[172:175],v[20:23]
r128 a[196:199],v1,34304
cvt v160,v112,v113
m16 v[52:55],a[228:231],v[176:179],v[52:55]
r128 a[200:203],v1,33856
cvt v161,v114,v115
m16 v[24:27],a[232:235],v[172:175],v[24:27]
v_exp_f32 v123, v123
m16 v[56:59],a[232:235],v[176:179],v[56:59]
r128 a[204:207],v1,34368
s_add_u32 m0, s70, 67584
m16 v[28:31],a[236:239],v[172:175],v[28:31]
r128 a[208:211],v1,33920
cvt v162,v116,v117
m16 v[60:63],a[236:239],v[176:179],v[60:63]
v_exp_f32 v124, v124
r128 a[212:215],v1,34432
m16 v[32:35],a[240:243],v[172:175],v[32:35]
r128 a[216:219],v1,33984
cvt v163,v118,v119
m16 v[64:67],a[240:243],v[176:179],v[64:67]
v_exp_f32 v125, v125
r128 a[220:223],v1,34496
m16 v[36:39],a[244:247],v[172:175],v[36:39]
v_exp_f32 v126, v126
m16 v[68:71],a[244:247],v[176:179],v[68:71]
buffer_load_dwordx4 v210, s[56:59], 0 offen offset:0 lds
cvt v164,v120,v121
m16 v[40:43],a[248:251],v[172:175],v[40:43]
v_exp_f32 v127, v127
m16 v[72:75],a[248:251],v[176:179],v[72:75]
cvt v165,v122,v123
cvt v166,v124,v125
m16 v[44:47],a[252:255],v[172:175],v[44:47]
cvt v167,v126,v127
m16 v[76:79],a[252:255],v[176:179],v[76:79]
s_waitcnt lgkmcnt(0)
m16 v[112:115],a[192:195],a[48:51],v[184:187]
v_exp_f32 v136, v136
rtr a[224:225],v2,0
m16 v[120:123],a[192:195],a[64:67],v[188:191]
rtr a[226:227],v2,512
buffer_load_dwordx4 v210, s[56:59], s44 offen offset:1024 lds
buffer_load_dword v254, v9, s[52:55], 0 offen sc1
m16 v[116:119],a[196:199],a[48:51],v[184:187]
v_exp_f32 v137, v137
rtr a[228:229],v2,32
m16 v[124:127],a[196:199],a[64:67],v[188:191]
rtr a[230:231],v2,544
v_exp_f32 v138, v138
m16 v[112:115],a[200:203],a[52:55],v[112:115]
rtr a[232:233],v2,64
rtr a[234:235],v2,576
buffer_load_dwordx4 v210, s[56:59], s45 offen offset:2048 lds
m16 v[120:123],a[200:203],a[68:71],v[120:123]
rtr a[236:237],v2,96
v_exp_f32 v139, v139
m16 v[116:119],a[204:207],a[52:55],v[116:119]
rtr a[238:239],v2,608
rtr a[240:241],v2,128
rtr a[242:243],v2,640
m16 v[124:127],a[204:207],a[68:71],v[124:127]
v_exp_f32 v140, v140
rtr a[244:245],v2,160
m16 v[112:115],a[208:211],a[56:59],v[112:115]
buffer_load_dwordx4 v210, s[56:59], s46 offen offset:3072 lds
rtr a[246:247],v2,672
cvt v172,v136,v137
m16 v[120:123],a[208:211],a[72:75],v[120:123]
v_exp_f32 v141, v141
m16 v[116:119],a[212:215],a[56:59],v[116:119]
rtr a[248:249],v2,192
rtr a[250:251],v2,704
m16 v[124:127],a[212:215],a[72:75],v[124:127]
rtr a[252:253],v2,224
v_add_u32 v210, 0x20000, v210
m16 v[112:115],a[216:219],a[60:63],v[112:115]
v_exp_f32 v142, v142
m16 v[120:123],a[216:219],a[76:79],v[120:123]
rtr a[254:255],v2,736
cvt v173,v138,v139
m16 v[116:119],a[220:223],a[60:63],v[116:119]
v_exp_f32 v143, v143
m16 v[124:127],a[220:223],a[76:79],v[124:127]
s_add_u32 m0, s70, 50688
r128 a[192:195],v1,42240
m16 v[196:199],v[220:223],v[160:163],v[196:199]
v_exp_f32 v144, v144
m16 v[200:203],v[220:223],v[164:167],v[200:203]
r128 a[196:199],v1,42752
s_waitcnt lgkmcnt(10)
m16 v[16:19],a[224:227],v[160:163],v[16:19]
v_exp_f32 v145, v145
m16 v[48:51],a[224:227],v[164:167],v[48:51]
buffer_load_dwordx4 v210, s[56:59], 0 offen offset:0 lds
r128 a[200:203],v1,42304
m16 v[20:23],a[228:231],v[160:163],v[20:23]
r128 a[204:207],v1,42816
cvt v174,v140,v141
m16 v[52:55],a[228:231],v[164:167],v[52:55]
v_exp_f32 v146, v146
m16 v[24:27],a[232:235],v[160:163],v[24:27]
r128 a[208:211],v1,42368
buffer_load_dwordx4 v210, s[56:59], s44 offen offset:1024 lds
m16 v[56:59],a[232:235],v[164:167],v[56:59]
v_exp_f32 v147, v147
m16 v[28:31],a[236:239],v[160:163],v[28:31]
r128 a[212:215],v1,42880
buffer_load_dwordx4 v210, s[56:59], s45 offen offset:2048 lds
m16 v[60:63],a[236:239],v[164:167],v[60:63]
v_exp_f32 v148, v148
r128 a[216:219],v1,42432
s_waitcnt lgkmcnt(7)
m16 v[32:35],a[240:243],v[160:163],v[32:35]
v_exp_f32 v149, v149
m16 v[64:67],a[240:243],v[164:167],v[64:67]
r128 a[220:223],v1,42944
cvt v175,v142,v143
m16 v[36:39],a[244:247],v[160:163],v[36:39]
v_exp_f32 v150, v150
m16 v[68:71],a[244:247],v[164:167],v[68:71]
buffer_load_dwordx4 v210, s[56:59], s46 offen offset:3072 lds
cvt v176,v144,v145
m16 v[40:43],a[248:251],v[160:163],v[40:43]
v_exp_f32 v151, v151
m16 v[72:75],a[248:251],v[164:167],v[72:75]
cvt v177,v146,v147
cvt v178,v148,v149
m16 v[44:47],a[252:255],v[160:163],v[44:47]
cvt v179,v150,v151
m16 v[76:79],a[252:255],v[164:167],v[76:79]
s_waitcnt lgkmcnt(0)
m16 v[136:139],a[192:195],a[48:51],v[184:187]
v_exp_f32 v112, v112
rtr a[224:225],v2,8448
m16 v[144:147],a[192:195],a[64:67],v[188:191]
rtr a[226:227],v2,8960
v_exp_f32 v113, v113
m16 v[140:143],a[196:199],a[48:51],v[184:187]
rtr a[228:229],v2,8480
rtr a[230:231],v2,8992
cvt v160,v112,v113
m16 v[148:151],a[196:199],a[64:67],v[188:191]
v_exp_f32 v114, v114
rtr a[232:233],v2,8512
m16 v[136:139],a[200:203],a[52:55],v[136:139]
rtr a[234:235],v2,9024
rtr a[236:237],v2,8544
m16 v[144:147],a[200:203],a[68:71],v[144:147]
v_exp_f32 v115, v115
rtr a[238:239],v2,9056
m16 v[140:143],a[204:207],a[52:55],v[140:143]
rtr a[240:241],v2,8576
rtr a[242:243],v2,9088
cvt v161,v114,v115
m16 v[148:151],a[204:207],a[68:71],v[148:151]
v_exp_f32 v116, v116
rtr a[244:245],v2,8608
m16 v[136:139],a[208:211],a[56:59],v[136:139]
rtr a[246:247],v2,9120
v_exp_f32 v117, v117
m16 v[144:147],a[208:211],a[72:75],v[144:147]
rtr a[248:249],v2,8640
rtr a[250:251],v2,9152
cvt v162,v116,v117
m16 v[140:143],a[212:215],a[56:59],v[140:143]
rtr a[252:253],v2,8672
v_exp_f32 v118, v118
m16 v[148:151],a[212:215],a[72:75],v[148:151]
rtr a[254:255],v2,9184
v_exp_f32 v119, v119
m16 v[136:139],a[216:219],a[60:63],v[136:139]
v_exp_f32 v120, v120
cvt v163,v118,v119
m16 v[144:147],a[216:219],a[76:79],v[144:147]
v_exp_f32 v121, v121
m16 v[140:143],a[220:223],a[60:63],v[140:143]
v_exp_f32 v122, v122
cvt v164,v120,v121
m16 v[148:151],a[220:223],a[76:79],v[148:151]
v_exp_f32 v123, v123
m16 v[196:199],v[220:223],v[172:175],v[196:199]
v_exp_f32 v124, v124
cvt v165,v122,v123
m16 v[200:203],v[220:223],v[176:179],v[200:203]
s_waitcnt vmcnt(17) lgkmcnt(0)
s_barrier
m16 v[16:19],a[224:227],v[172:175],v[16:19]
v_exp_f32 v125, v125
m16 v[48:51],a[224:227],v[176:179],v[48:51]
s_waitcnt vmcnt(6)
v_cmp_ne_u32 vcc, 0x01010101, v254
s_mov_b32 s28, 0
s_nop 0
s_cmp_eq_u64 vcc, 0
s_cbranch_scc1 Lb_p0_ok
s_mov_b32 s29, 20000
v_mov_b32 v254, 163824
ds_read_b32 v254, v254
s_waitcnt lgkmcnt(0)
v_readfirstlane_b32 s28, v254
s_nop 1
s_and_b32 s28, s28, s42
s_cmp_eq_u32 s28, 0
s_cbranch_scc1 Lb_p0
v_or_b32 v7, 0x40000000, v7
s_branch Lb_p0_ok
Lb_p0:
s_sleep 2
buffer_load_dword v254, v9, s[52:55], 0 offen sc1
s_waitcnt vmcnt(0)
s_sub_u32 s29, s29, 1
s_cmp_eq_u32 s29, 0
s_cbranch_scc1 Lb_p0_ok
v_cmp_ne_u32 vcc, 0x01010101, v254
s_mov_b32 s28, 0
s_nop 0
s_cmp_eq_u64 vcc, 0
s_cbranch_scc0 Lb_p0
Lb_p0_ok:
rtr a[192:193],v2,33792
rtr a[194:195],v2,34304
m16 v[20:23],a[228:231],v[172:175],v[20:23]
v_mov_b32 v211, v7
buffer_load_dwordx4 a[96:99], v211, s[24:27], 0 offen offset:0 sc1
rtr a[196:197],v2,33824
cvt v166,v124,v125
m16 v[52:55],a[228:231],v[176:179],v[52:55]
rtr a[198:199],v2,34336
m16 v[24:27],a[232:235],v[172:175],v[24:27]
buffer_load_dwordx4 a[100:103], v211, s[24:27], 0 offen offset:1024 sc1
rtr a[200:201],v2,33856
rtr a[202:203],v2,34368
m16 v[56:59],a[232:235],v[176:179],v[56:59]
buffer_load_dwordx4 a[104:107], v211, s[24:27], s47 offen offset:0 sc1
rtr a[204:205],v2,33888
m16 v[28:31],a[236:239],v[172:175],v[28:31]
rtr a[206:207],v2,34400
m16 v[60:63],a[236:239],v[176:179],v[60:63]
buffer_load_dwordx4 a[108:111], v211, s[24:27], s47 offen offset:1024 sc1
rtr a[208:209],v2,33920
rtr a[210:211],v2,34432
m16 v[32:35],a[240:243],v[172:175],v[32:35]
v_add_u32 v211, 0x5800, v211
buffer_load_dwordx4 a[112:115], v211, s[24:27], 0 offen offset:0 sc1
rtr a[212:213],v2,33952
m16 v[64:67],a[240:243],v[176:179],v[64:67]
v_exp_f32 v126, v126
m16 v[36:39],a[244:247],v[172:175],v[36:39]
rtr a[214:215],v2,34464
buffer_load_dwordx4 a[116:119], v211, s[24:27], 0 offen offset:1024 sc1
m16 v[68:71],a[244:247],v[176:179],v[68:71]
rtr a[216:217],v2,33984
rtr a[218:219],v2,34496
m16 v[40:43],a[248:251],v[172:175],v[40:43]
buffer_load_dwordx4 a[120:123], v211, s[24:27], s47 offen offset:0 sc1
rtr a[220:221],v2,34016
m16 v[72:75],a[248:251],v[176:179],v[72:75]
v_exp_f32 v127, v127
m16 v[44:47],a[252:255],v[172:175],v[44:47]
rtr a[222:223],v2,34528
buffer_load_dwordx4 a[124:127], v211, s[24:27], s47 offen offset:1024 sc1
m16 v[76:79],a[252:255],v[176:179],v[76:79]
cvt v167,v126,v127
m16 v[196:199],v[220:223],v[160:163],v[196:199]
v_exp_f32 v136, v136
rtr a[224:225],v2,42240
m16 v[200:203],v[220:223],v[164:167],v[200:203]
v_exp_f32 v137, v137
rtr a[226:227],v2,42752
v_add_u32 v210, 0x60000, v210
v_add_u32 v211, 0x10800, v211
buffer_load_dwordx4 a[128:131], v211, s[24:27], 0 offen offset:0 sc1
s_waitcnt lgkmcnt(10)
m16 v[16:19],a[192:195],v[160:163],v[16:19]
v_exp_f32 v138, v138
rtr a[228:229],v2,42272
m16 v[48:51],a[192:195],v[164:167],v[48:51]
v_exp_f32 v139, v139
rtr a[230:231],v2,42784
s_add_u32 m0, s70, 101376
buffer_load_dwordx4 a[132:135], v211, s[24:27], 0 offen offset:1024 sc1
m16 v[20:23],a[196:199],v[160:163],v[20:23]
v_exp_f32 v140, v140
rtr a[232:233],v2,42304
rtr a[234:235],v2,42816
m16 v[52:55],a[196:199],v[164:167],v[52:55]
v_exp_f32 v141, v141
rtr a[236:237],v2,42336
buffer_load_dwordx4 a[136:139], v211, s[24:27], s47 offen offset:0 sc1
m16 v[24:27],a[200:203],v[160:163],v[24:27]
v_exp_f32 v142, v142
rtr a[238:239],v2,42848
buffer_load_dwordx4 v210, s[56:59], 0 offen offset:0 lds
m16 v[56:59],a[200:203],v[164:167],v[56:59]
v_exp_f32 v143, v143
rtr a[240:241],v2,42368
buffer_load_dwordx4 a[140:143], v211, s[24:27], s47 offen offset:1024 sc1
m16 v[28:31],a[204:207],v[160:163],v[28:31]
rtr a[242:243],v2,42880
v_exp_f32 v144, v144
m16 v[60:63],a[204:207],v[164:167],v[60:63]
rtr a[244:245],v2,42400
buffer_load_dwordx4 v210, s[56:59], s44 offen offset:1024 lds
v_add_u32 v211, 0x5800, v211
buffer_load_dwordx4 a[144:147], v211, s[24:27], 0 offen offset:0 sc1
s_waitcnt lgkmcnt(11)
m16 v[32:35],a[208:211],v[160:163],v[32:35]
v_exp_f32 v145, v145
rtr a[246:247],v2,42912
rtr a[248:249],v2,42432
m16 v[64:67],a[208:211],v[164:167],v[64:67]
v_exp_f32 v146, v146
rtr a[250:251],v2,42944
buffer_load_dwordx4 a[148:151], v211, s[24:27], 0 offen offset:1024 sc1
m16 v[36:39],a[212:215],v[160:163],v[36:39]
v_exp_f32 v147, v147
rtr a[252:253],v2,42464
buffer_load_dwordx4 v210, s[56:59], s45 offen offset:2048 lds
m16 v[68:71],a[212:215],v[164:167],v[68:71]
v_exp_f32 v148, v148
rtr a[254:255],v2,42976
buffer_load_dwordx4 a[152:155], v211, s[24:27], s47 offen offset:0 sc1
m16 v[40:43],a[216:219],v[160:163],v[40:43]
v_exp_f32 v149, v149
buffer_load_dwordx4 v210, s[56:59], s46 offen offset:3072 lds
m16 v[72:75],a[216:219],v[164:167],v[72:75]
v_exp_f32 v150, v150
buffer_load_dwordx4 a[156:159], v211, s[24:27], s47 offen offset:1024 sc1
m16 v[44:47],a[220:223],v[160:163],v[44:47]
v_exp_f32 v151, v151
cvt v172,v136,v137
m16 v[76:79],a[220:223],v[164:167],v[76:79]
cvt v173,v138,v139
cvt v174,v140,v141
cvt v175,v142,v143
cvt v176,v144,v145
cvt v177,v146,v147
cvt v178,v148,v149
cvt v179,v150,v151
m16 v[196:199],v[220:223],v[172:175],v[196:199]
rtr a[192:193],v12,0
rtr a[194:195],v12,1024
m16 v[200:203],v[220:223],v[176:179],v[200:203]
rtr a[196:197],v12,8
rtr a[198:199],v12,1032
s_waitcnt lgkmcnt(12)
m16 v[16:19],a[224:227],v[172:175],v[16:19]
rtr a[200:201],v12,256
rtr a[202:203],v12,1280
m16 v[48:51],a[224:227],v[176:179],v[48:51]
rtr a[204:205],v12,264
rtr a[206:207],v12,1288
m16 v[20:23],a[228:231],v[172:175],v[20:23]
rtr a[208:209],v12,512
rtr a[210:211],v12,1536
m16 v[52:55],a[228:231],v[176:179],v[52:55]
rtr a[212:213],v12,520
rtr a[214:215],v12,1544
m16 v[24:27],a[232:235],v[172:175],v[24:27]
rtr a[216:217],v12,768
rtr a[218:219],v12,1792
m16 v[56:59],a[232:235],v[176:179],v[56:59]
rtr a[220:221],v12,776
rtr a[222:223],v12,1800
m16 v[28:31],a[236:239],v[172:175],v[28:31]
rtr a[160:161],v12,4096
v_rcp_f32 v230, v196
m16 v[60:63],a[236:239],v[176:179],v[60:63]
rtr a[162:163],v12,5120
rtr a[164:165],v12,4104
s_waitcnt lgkmcnt(15)
m16 v[32:35],a[240:243],v[172:175],v[32:35]
rtr a[166:167],v12,5128
rtr a[168:169],v12,4352
m16 v[64:67],a[240:243],v[176:179],v[64:67]
rtr a[170:171],v12,5376
rtr a[172:173],v12,4360
m16 v[36:39],a[244:247],v[172:175],v[36:39]
rtr a[174:175],v12,5384
rtr a[176:177],v12,4608
m16 v[68:71],a[244:247],v[176:179],v[68:71]
rtr a[178:179],v12,5632
rtr a[180:181],v12,4616
m16 v[40:43],a[248:251],v[172:175],v[40:43]
rtr a[182:183],v12,5640
rtr a[184:185],v12,4864
m16 v[72:75],a[248:251],v[176:179],v[72:75]
v_rcp_f32 v232, v200
rtr a[186:187],v12,5888
m16 v[44:47],a[252:255],v[172:175],v[44:47]
rtr a[188:189],v12,4872
v_add_f32 v236, v196, v200
v_mov_b32 v231, v230
v_mov_b32 v233, v232
v_mov_b32 v237, 0x53800000
v_cmp_nle_f32 vcc, v236, v237
v_mov_b32 v236, 163824
s_nop 0
v_cndmask_b32 v237, 0, 1, vcc
ds_or_b32 v236, v237
m16 v[76:79],a[252:255],v[176:179],v[76:79]
rtr a[190:191],v12,5896
s_waitcnt vmcnt(16)
s_waitcnt lgkmcnt(0)
s_barrier
ds_read_b32 v237, v236
s_waitcnt lgkmcnt(0)
v_readfirstlane_b32 s28, v237
s_nop 1
s_and_b32 s28, s28, s42
s_cmp_eq_u32 s28, 0
s_cbranch_scc1 Lb_phc
s_mov_b32 s42, 0
v_and_b32 v7, 0x3fffffff, v7
s_mov_b32 s29, 0
Lb_mx0:
s_waitcnt vmcnt(0) lgkmcnt(0)
s_barrier
s_add_u32 m0, s100, 0
s_nop 0
buffer_load_dwordx4 v14, s[16:19], s29 offen offset:0 lds
s_add_u32 m0, s100, 800
s_nop 0
buffer_load_dwordx4 v14, s[16:19], s29 offen offset:256 lds
s_waitcnt vmcnt(0) lgkmcnt(0)
s_barrier
r128 a[192:195],v3,0
r128 a[196:199],v3,512
r128 a[200:203],v3,64
r128 a[204:207],v3,576
r128 a[208:211],v3,128
r128 a[212:215],v3,640
r128 a[216:219],v3,192
r128 a[220:223],v3,704
s_waitcnt vmcnt(0) lgkmcnt(0)
m16 v[112:115],a[192:195],a[0:3],0
m16 v[120:123],a[192:195],a[16:19],0
m16 v[116:119],a[196:199],a[0:3],0
m16 v[124:127],a[196:199],a[16:19],0
m16 v[112:115],a[200:203],a[4:7],v[112:115]
m16 v[120:123],a[200:203],a[20:23],v[120:123]
m16 v[116:119],a[204:207],a[4:7],v[116:119]
m16 v[124:127],a[204:207],a[20:23],v[124:127]
m16 v[112:115],a[208:211],a[8:11],v[112:115]
m16 v[120:123],a[208:211],a[24:27],v[120:123]
m16 v[116:119],a[212:215],a[8:11],v[116:119]
m16 v[124:127],a[212:215],a[24:27],v[124:127]
m16 v[112:115],a[216:219],a[12:15],v[112:115]
m16 v[120:123],a[216:219],a[28:31],v[120:123]
m16 v[116:119],a[220:223],a[12:15],v[116:119]
m16 v[124:127],a[220:223],a[28:31],v[124:127]
s_nop 4
v_max3_f32 v224, v224, v112, v113
v_max3_f32 v224, v224, v114, v115
v_max3_f32 v224, v224, v116, v117
v_max3_f32 v224, v224, v118, v119
v_max3_f32 v225, v225, v120, v121
v_max3_f32 v225, v225, v122, v123
v_max3_f32 v225, v225, v124, v125
v_max3_f32 v225, v225, v126, v127
s_add_u32 s29, s29, 8192
s_cmp_lt_u32 s29, 131072
s_cbranch_scc1 Lb_mx0
s_mov_b32 s29, 131072
Lb_mx1:
s_waitcnt vmcnt(0) lgkmcnt(0)
s_barrier
s_add_u32 m0, s100, 0
s_nop 0
buffer_load_dwordx4 v14, s[16:19], s29 offen offset:0 lds
s_add_u32 m0, s100, 800
s_nop 0
buffer_load_dwordx4 v14, s[16:19], s29 offen offset:256 lds
s_waitcnt vmcnt(0) lgkmcnt(0)
s_barrier
r128 a[192:195],v3,0
r128 a[196:199],v3,512
r128 a[200:203],v3,64
r128 a[204:207],v3,576
r128 a[208:211],v3,128
r128 a[212:215],v3,640
r128 a[216:219],v3,192
r128 a[220:223],v3,704
s_waitcnt vmcnt(0) lgkmcnt(0)
m16 v[112:115],a[192:195],a[48:51],0
m16 v[120:123],a[192:195],a[64:67],0
m16 v[116:119],a[196:199],a[48:51],0
m16 v[124:127],a[196:199],a[64:67],0
m16 v[112:115],a[200:203],a[52:55],v[112:115]
m16 v[120:123],a[200:203],a[68:71],v[120:123]
m16 v[116:119],a[204:207],a[52:55],v[116:119]
m16 v[124:127],a[204:207],a[68:71],v[124:127]
m16 v[112:115],a[208:211],a[56:59],v[112:115]
m16 v[120:123],a[208:211],a[72:75],v[120:123]
m16 v[116:119],a[212:215],a[56:59],v[116:119]
m16 v[124:127],a[212:215],a[72:75],v[124:127]
m16 v[112:115],a[216:219],a[60:63],v[112:115]
m16 v[120:123],a[216:219],a[76:79],v[120:123]
m16 v[116:119],a[220:223],a[60:63],v[116:119]
m16 v[124:127],a[220:223],a[76:79],v[124:127]
s_nop 4
v_max3_f32 v227, v227, v112, v113
v_max3_f32 v227, v227, v114, v115
v_max3_f32 v227, v227, v116, v117
v_max3_f32 v227, v227, v118, v119
v_max3_f32 v228, v228, v120, v121
v_max3_f32 v228, v228, v122, v123
v_max3_f32 v228, v228, v124, v125
v_max3_f32 v228, v228, v126, v127
s_add_u32 s29, s29, 8192
s_cmp_lt_u32 s29, 262144
s_cbranch_scc1 Lb_mx1
s_barrier
s_add_u32 m0, s100, 0
s_mov_b32 s28, 0
buffer_load_dwordx4 v14, s[16:19], s28 offen offset:0 nt lds
s_add_u32 m0, s100, 800
s_mov_b32 s28, 0
buffer_load_dwordx4 v14, s[16:19], s28 offen offset:256 nt lds
s_add_u32 m0, s100, 8448
s_mov_b32 s28, 8192
buffer_load_dwordx4 v14, s[16:19], s28 offen offset:0 nt lds
s_add_u32 m0, s100, 9248
s_mov_b32 s28, 8192
buffer_load_dwordx4 v14, s[16:19], s28 offen offset:256 nt lds
s_add_u32 m0, s100, 16896
s_mov_b32 s28, 0
buffer_load_dwordx4 v14, s[20:23], s28 offen offset:0 nt lds
s_add_u32 m0, s100, 17696
s_mov_b32 s28, 0
buffer_load_dwordx4 v14, s[20:23], s28 offen offset:256 nt lds
s_add_u32 m0, s100, 25344
s_mov_b32 s28, 8192
buffer_load_dwordx4 v14, s[20:23], s28 offen offset:0 nt lds
s_add_u32 m0, s100, 26144
s_mov_b32 s28, 8192
buffer_load_dwordx4 v14, s[20:23], s28 offen offset:256 nt lds
s_add_u32 m0, s100, 33792
s_mov_b32 s28, 16384
buffer_load_dwordx4 v14, s[16:19], s28 offen offset:0 nt lds
s_add_u32 m0, s100, 34592
s_mov_b32 s28, 16384
buffer_load_dwordx4 v14, s[16:19], s28 offen offset:256 nt lds
s_add_u32 m0, s100, 42240
s_mov_b32 s28, 24576
buffer_load_dwordx4 v14, s[16:19], s28 offen offset:0 nt lds
s_add_u32 m0, s100, 43040
s_mov_b32 s28, 24576
buffer_load_dwordx4 v14, s[16:19], s28 offen offset:256 nt lds
s_add_u32 m0, s100, 50688
s_mov_b32 s28, 16384
buffer_load_dwordx4 v14, s[20:23], s28 offen offset:0 nt lds
s_add_u32 m0, s100, 51488
s_mov_b32 s28, 16384
buffer_load_dwordx4 v14, s[20:23], s28 offen offset:256 nt lds
s_add_u32 m0, s100, 59136
s_mov_b32 s28, 24576
buffer_load_dwordx4 v14, s[20:23], s28 offen offset:0 nt lds
s_add_u32 m0, s100, 59936
s_mov_b32 s28, 24576
buffer_load_dwordx4 v14, s[20:23], s28 offen offset:256 nt lds
s_add_u32 m0, s100, 67584
s_mov_b32 s28, 32768
buffer_load_dwordx4 v14, s[16:19], s28 offen offset:0 nt lds
s_add_u32 m0, s100, 68384
s_mov_b32 s28, 32768
buffer_load_dwordx4 v14, s[16:19], s28 offen offset:256 nt lds
s_add_u32 m0, s100, 76032
s_mov_b32 s28, 40960
buffer_load_dwordx4 v14, s[16:19], s28 offen offset:0 nt lds
s_add_u32 m0, s100, 76832
s_mov_b32 s28, 40960
buffer_load_dwordx4 v14, s[16:19], s28 offen offset:256 nt lds
s_add_u32 m0, s100, 84480
s_mov_b32 s28, 32768
buffer_load_dwordx4 v14, s[20:23], s28 offen offset:0 nt lds
s_add_u32 m0, s100, 85280
s_mov_b32 s28, 32768
buffer_load_dwordx4 v14, s[20:23], s28 offen offset:256 nt lds
s_add_u32 m0, s100, 92928
s_mov_b32 s28, 40960
buffer_load_dwordx4 v14, s[20:23], s28 offen offset:0 nt lds
s_add_u32 m0, s100, 93728
s_mov_b32 s28, 40960
buffer_load_dwordx4 v14, s[20:23], s28 offen offset:256 nt lds
s_add_u32 m0, s100, 101376
s_mov_b32 s28, 49152
buffer_load_dwordx4 v14, s[16:19], s28 offen offset:0 nt lds
s_add_u32 m0, s100, 102176
s_mov_b32 s28, 49152
buffer_load_dwordx4 v14, s[16:19], s28 offen offset:256 nt lds
s_add_u32 m0, s100, 109824
s_mov_b32 s28, 57344
buffer_load_dwordx4 v14, s[16:19], s28 offen offset:0 nt lds
s_add_u32 m0, s100, 110624
s_mov_b32 s28, 57344
buffer_load_dwordx4 v14, s[16:19], s28 offen offset:256 nt lds
s_add_u32 m0, s100, 118272
s_mov_b32 s28, 49152
buffer_load_dwordx4 v14, s[20:23], s28 offen offset:0 nt lds
s_add_u32 m0, s100, 119072
s_mov_b32 s28, 49152
buffer_load_dwordx4 v14, s[20:23], s28 offen offset:256 nt lds
s_add_u32 m0, s100, 126720
s_mov_b32 s28, 57344
buffer_load_dwordx4 v14, s[20:23], s28 offen offset:0 nt lds
s_add_u32 m0, s100, 127520
s_mov_b32 s28, 57344
buffer_load_dwordx4 v14, s[20:23], s28 offen offset:256 nt lds
s_mov_b32 s28, 81920
buffer_load_dwordx4 a[96:99], v14, s[16:19], s28 offen offset:0 nt
s_mov_b32 s28, 81920
buffer_load_dwordx4 a[100:103], v14, s[16:19], s28 offen offset:256 nt
s_mov_b32 s28, 90112
buffer_load_dwordx4 a[104:107], v14, s[16:19], s28 offen offset:0 nt
s_mov_b32 s28, 90112
buffer_load_dwordx4 a[108:111], v14, s[16:19], s28 offen offset:256 nt
s_mov_b32 s28, 114688
buffer_load_dwordx4 a[112:115], v14, s[16:19], s28 offen offset:0 nt
s_mov_b32 s28, 114688
buffer_load_dwordx4 a[116:119], v14, s[16:19], s28 offen offset:256 nt
s_mov_b32 s28, 122880
buffer_load_dwordx4 a[120:123], v14, s[16:19], s28 offen offset:0 nt
s_mov_b32 s28, 122880
buffer_load_dwordx4 a[124:127], v14, s[16:19], s28 offen offset:256 nt
s_mov_b32 s28, 131072
buffer_load_dwordx4 a[128:131], v14, s[20:23], s28 offen offset:0 nt
s_mov_b32 s28, 131072
buffer_load_dwordx4 a[132:135], v14, s[20:23], s28 offen offset:256 nt
s_mov_b32 s28, 139264
buffer_load_dwordx4 a[136:139], v14, s[20:23], s28 offen offset:0 nt
s_mov_b32 s28, 139264
buffer_load_dwordx4 a[140:143], v14, s[20:23], s28 offen offset:256 nt
s_mov_b32 s28, 163840
buffer_load_dwordx4 a[144:147], v14, s[16:19], s28 offen offset:0 nt
s_mov_b32 s28, 163840
buffer_load_dwordx4 a[148:151], v14, s[16:19], s28 offen offset:256 nt
s_mov_b32 s28, 172032
buffer_load_dwordx4 a[152:155], v14, s[16:19], s28 offen offset:0 nt
s_mov_b32 s28, 172032
buffer_load_dwordx4 a[156:159], v14, s[16:19], s28 offen offset:256 nt
s_mov_b32 s28, 180224
buffer_load_dwordx4 a[160:163], v14, s[20:23], s28 offen offset:0 nt
s_mov_b32 s28, 180224
buffer_load_dwordx4 a[164:167], v14, s[20:23], s28 offen offset:256 nt
s_mov_b32 s28, 188416
buffer_load_dwordx4 a[168:171], v14, s[20:23], s28 offen offset:0 nt
s_mov_b32 s28, 188416
buffer_load_dwordx4 a[172:175], v14, s[20:23], s28 offen offset:256 nt
s_mov_b32 s28, 212992
buffer_load_dwordx4 a[176:179], v14, s[16:19], s28 offen offset:0 nt
s_mov_b32 s28, 212992
buffer_load_dwordx4 a[180:183], v14, s[16:19], s28 offen offset:256 nt
s_mov_b32 s28, 221184
buffer_load_dwordx4 a[184:187], v14, s[16:19], s28 offen offset:0 nt
s_mov_b32 s28, 221184
buffer_load_dwordx4 a[188:191], v14, s[16:19], s28 offen offset:256 nt
s_waitcnt vmcnt(0) lgkmcnt(0)
s_barrier
r128 a[192:195],v3,0
r128 a[196:199],v3,512
r128 a[200:203],v3,64
r128 a[204:207],v3,576
r128 a[208:211],v3,128
r128 a[212:215],v3,640
r128 a[216:219],v3,192
r128 a[220:223],v3,704
s_waitcnt vmcnt(0) lgkmcnt(0)
m16 v[112:115],a[192:195],a[0:3],0
m16 v[120:123],a[192:195],a[16:19],0
m16 v[116:119],a[196:199],a[0:3],0
m16 v[124:127],a[196:199],a[16:19],0
m16 v[112:115],a[200:203],a[4:7],v[112:115]
m16 v[120:123],a[200:203],a[20:23],v[120:123]
m16 v[116:119],a[204:207],a[4:7],v[116:119]
m16 v[124:127],a[204:207],a[20:23],v[124:127]
m16 v[112:115],a[208:211],a[8:11],v[112:115]
m16 v[120:123],a[208:211],a[24:27],v[120:123]
m16 v[116:119],a[212:215],a[8:11],v[116:119]
m16 v[124:127],a[212:215],a[24:27],v[124:127]
m16 v[112:115],a[216:219],a[12:15],v[112:115]
m16 v[120:123],a[216:219],a[28:31],v[120:123]
m16 v[116:119],a[220:223],a[12:15],v[116:119]
m16 v[124:127],a[220:223],a[28:31],v[124:127]
r128 a[192:195],v3,8448
r128 a[196:199],v3,8960
r128 a[200:203],v3,8512
r128 a[204:207],v3,9024
r128 a[208:211],v3,8576
r128 a[212:215],v3,9088
r128 a[216:219],v3,8640
r128 a[220:223],v3,9152
s_nop 7
s_branch Lb_attn
Lb_phc:
s_waitcnt lgkmcnt(0)
m16 v[112:115],a[192:195],a[96:99],0
rtr a[224:225],v10,0
rtr a[226:227],v10,1024
v_add_u32 v210, 0x20000, v210
m16 v[144:147],a[192:195],a[100:103],0
v_mul_f32 v16, v16, v230
rtr a[228:229],v10,8
v_add_u32 v211, 0x10800, v211
buffer_load_dwordx4 a[32:35], v211, s[24:27], 0 offen offset:0 sc1
m16 v[116:119],a[196:199],a[96:99],0
v_mul_f32 v17, v17, v230
rtr a[230:231],v10,1032
v_mul_f32 v18, v18, v230
m16 v[148:151],a[196:199],a[100:103],0
rtr a[232:233],v10,256
v_mul_f32 v19, v19, v230
v_mul_f32 v20, v20, v230
m16 v[120:123],a[200:203],a[96:99],0
rtr a[234:235],v10,1280
rtr a[236:237],v10,264
v_mul_f32 v21, v21, v230
m16 v[152:155],a[200:203],a[100:103],0
rtr a[238:239],v10,1288
s_add_u32 m0, s70, 84480
v_mul_f32 v22, v22, v230
m16 v[124:127],a[204:207],a[96:99],0
rtr a[240:241],v10,512
buffer_load_dwordx4 a[36:39], v211, s[24:27], 0 offen offset:1024 sc1
v_mul_f32 v23, v23, v230
m16 v[156:159],a[204:207],a[100:103],0
rtr a[242:243],v10,1536
s_mov_b32 s29, 45056
cvt v238,v16,v17
m16 v[128:131],a[208:211],a[96:99],0
rtr a[244:245],v10,520
rtr a[246:247],v10,1544
m16 v[160:163],a[208:211],a[100:103],0
rtr a[248:249],v10,768
cvt v239,v18,v19
m16 v[132:135],a[212:215],a[96:99],0
rtr a[250:251],v10,1792
buffer_load_dwordx4 v210, s[56:59], 0 offen offset:0 lds
m16 v[164:167],a[212:215],a[100:103],0
rtr a[252:253],v10,776
cvt v240,v20,v21
m16 v[136:139],a[216:219],a[96:99],0
rtr a[254:255],v10,1800
buffer_load_dwordx4 a[40:43], v211, s[24:27], s47 offen offset:0 sc1
m16 v[168:171],a[216:219],a[100:103],0
rtr a[0:1],v10,4096
rtr a[2:3],v10,5120
m16 v[140:143],a[220:223],a[96:99],0
cvt v241,v22,v23
rtr a[4:5],v10,4104
m16 v[172:175],a[220:223],a[100:103],0
rtr a[6:7],v10,5128
buffer_load_dwordx4 v210, s[56:59], s44 offen offset:1024 lds
m16 v[112:115],a[160:163],a[104:107],v[112:115]
buffer_store_dwordx4 v[238:241], v5, s[24:27], s29 offen offset:0 sc1
rtr a[8:9],v10,4352
m16 v[144:147],a[160:163],a[108:111],v[144:147]
v_mul_f32 v48, v48, v232
rtr a[10:11],v10,5376
m16 v[116:119],a[164:167],a[104:107],v[116:119]
rtr a[12:13],v10,4360
v_mul_f32 v49, v49, v232
m16 v[148:151],a[164:167],a[108:111],v[148:151]
rtr a[14:15],v10,5384
buffer_load_dwordx4 a[44:47], v211, s[24:27], s47 offen offset:1024 sc1
v_mul_f32 v50, v50, v232
m16 v[120:123],a[168:171],a[104:107],v[120:123]
rtr a[16:17],v10,4608
v_mul_f32 v51, v51, v232
m16 v[152:155],a[168:171],a[108:111],v[152:155]
rtr a[18:19],v10,5632
buffer_load_dwordx4 v210, s[56:59], s45 offen offset:2048 lds
v_mul_f32 v52, v52, v232
m16 v[124:127],a[172:175],a[104:107],v[124:127]
rtr a[20:21],v10,4616
rtr a[22:23],v10,5640
v_mul_f32 v53, v53, v232
m16 v[156:159],a[172:175],a[108:111],v[156:159]
rtr a[24:25],v10,4864
rtr a[26:27],v10,5888
m16 v[128:131],a[176:179],a[104:107],v[128:131]
v_mul_f32 v54, v54, v232
rtr a[28:29],v10,4872
m16 v[160:163],a[176:179],a[108:111],v[160:163]
v_add_u32 v211, 0x5800, v211
buffer_load_dwordx4 a[48:51], v211, s[24:27], 0 offen offset:0 sc1
v_mul_f32 v55, v55, v232
m16 v[132:135],a[180:183],a[104:107],v[132:135]
rtr a[30:31],v10,5896
buffer_load_dwordx4 v210, s[56:59], s46 offen offset:3072 lds
cvt v242,v48,v49
m16 v[164:167],a[180:183],a[108:111],v[164:167]
cvt v243,v50,v51
cvt v244,v52,v53
m16 v[136:139],a[184:187],a[104:107],v[136:139]
cvt v245,v54,v55
buffer_store_dwordx4 v[242:245], v5, s[24:27], s29 offen offset:1024 sc1
m16 v[168:171],a[184:187],a[108:111],v[168:171]
m16 v[140:143],a[188:191],a[104:107],v[140:143]
m16 v[172:175],a[188:191],a[108:111],v[172:175]
s_waitcnt vmcnt(23) lgkmcnt(0)
m16 v[112:115],a[224:227],a[112:115],v[112:115]
rtr a[192:193],v10,33792
rtr a[194:195],v10,34816
v_add_u32 v210, 0x60000, v210
m16 v[144:147],a[224:227],a[116:119],v[144:147]
v_mul_f32 v24, v24, v230
rtr a[196:197],v10,33800
buffer_load_dwordx4 a[52:55], v211, s[24:27], 0 offen offset:1024 sc1
m16 v[116:119],a[228:231],a[112:115],v[116:119]
v_mul_f32 v25, v25, v230
rtr a[198:199],v10,34824
v_mul_f32 v26, v26, v230
m16 v[148:151],a[228:231],a[116:119],v[148:151]
rtr a[200:201],v10,34048
v_mul_f32 v27, v27, v230
v_mul_f32 v28, v28, v230
m16 v[120:123],a[232:235],a[112:115],v[120:123]
rtr a[202:203],v10,35072
rtr a[204:205],v10,34056
v_mul_f32 v29, v29, v230
m16 v[152:155],a[232:235],a[116:119],v[152:155]
rtr a[206:207],v10,35080
s_add_u32 m0, s70, 118272
v_mul_f32 v30, v30, v230
m16 v[124:127],a[236:239],a[112:115],v[124:127]
rtr a[208:209],v10,34304
buffer_load_dwordx4 a[56:59], v211, s[24:27], s47 offen offset:0 sc1
v_mul_f32 v31, v31, v230
m16 v[156:159],a[236:239],a[116:119],v[156:159]
rtr a[210:211],v10,35328
s_mov_b32 s29, 56320
cvt v246,v24,v25
m16 v[128:131],a[240:243],a[112:115],v[128:131]
rtr a[212:213],v10,34312
rtr a[214:215],v10,35336
m16 v[160:163],a[240:243],a[116:119],v[160:163]
rtr a[216:217],v10,34560
cvt v247,v26,v27
m16 v[132:135],a[244:247],a[112:115],v[132:135]
rtr a[218:219],v10,35584
buffer_load_dwordx4 v210, s[56:59], 0 offen offset:0 lds
m16 v[164:167],a[244:247],a[116:119],v[164:167]
rtr a[220:221],v10,34568
cvt v248,v28,v29
m16 v[136:139],a[248:251],a[112:115],v[136:139]
rtr a[222:223],v10,35592
buffer_load_dwordx4 a[60:63], v211, s[24:27], s47 offen offset:1024 sc1
m16 v[168:171],a[248:251],a[116:119],v[168:171]
rtr a[160:161],v10,37888
rtr a[162:163],v10,38912
m16 v[140:143],a[252:255],a[112:115],v[140:143]
cvt v249,v30,v31
rtr a[164:165],v10,37896
m16 v[172:175],a[252:255],a[116:119],v[172:175]
rtr a[166:167],v10,38920
buffer_load_dwordx4 v210, s[56:59], s44 offen offset:1024 lds
m16 v[112:115],a[0:3],a[120:123],v[112:115]
buffer_store_dwordx4 v[246:249], v5, s[24:27], s29 offen offset:0 sc1
rtr a[168:169],v10,38144
m16 v[144:147],a[0:3],a[124:127],v[144:147]
v_mul_f32 v56, v56, v232
rtr a[170:171],v10,39168
m16 v[116:119],a[4:7],a[120:123],v[116:119]
rtr a[172:173],v10,38152
v_mul_f32 v57, v57, v232
m16 v[148:151],a[4:7],a[124:127],v[148:151]
rtr a[174:175],v10,39176
v_add_u32 v211, 0x10800, v211
buffer_load_dwordx4 a[64:67], v211, s[24:27], 0 offen offset:0 sc1
v_mul_f32 v58, v58, v232
m16 v[120:123],a[8:11],a[120:123],v[120:123]
rtr a[176:177],v10,38400
v_mul_f32 v59, v59, v232
m16 v[152:155],a[8:11],a[124:127],v[152:155]
rtr a[178:179],v10,39424
buffer_load_dwordx4 v210, s[56:59], s45 offen offset:2048 lds
v_mul_f32 v60, v60, v232
m16 v[124:127],a[12:15],a[120:123],v[124:127]
rtr a[180:181],v10,38408
rtr a[182:183],v10,39432
v_mul_f32 v61, v61, v232
m16 v[156:159],a[12:15],a[124:127],v[156:159]
rtr a[184:185],v10,38656
rtr a[186:187],v10,39680
m16 v[128:131],a[16:19],a[120:123],v[128:131]
v_mul_f32 v62, v62, v232
rtr a[188:189],v10,38664
m16 v[160:163],a[16:19],a[124:127],v[160:163]
buffer_load_dwordx4 a[68:71], v211, s[24:27], 0 offen offset:1024 sc1
v_mul_f32 v63, v63, v232
m16 v[132:135],a[20:23],a[120:123],v[132:135]
rtr a[190:191],v10,39688
buffer_load_dwordx4 v210, s[56:59], s46 offen offset:3072 lds
cvt v250,v56,v57
m16 v[164:167],a[20:23],a[124:127],v[164:167]
cvt v251,v58,v59
cvt v252,v60,v61
m16 v[136:139],a[24:27],a[120:123],v[136:139]
cvt v253,v62,v63
buffer_store_dwordx4 v[250:253], v5, s[24:27], s29 offen offset:1024 sc1
m16 v[168:171],a[24:27],a[124:127],v[168:171]
m16 v[140:143],a[28:31],a[120:123],v[140:143]
m16 v[172:175],a[28:31],a[124:127],v[172:175]
s_waitcnt vmcnt(29) lgkmcnt(0)
s_barrier
m16 v[112:115],a[192:195],a[128:131],v[112:115]
rtr a[224:225],v10,16896
rtr a[226:227],v10,17920
v_add_u32 v210, 0x20000, v210
m16 v[144:147],a[192:195],a[132:135],v[144:147]
v_mul_f32 v32, v32, v230
rtr a[228:229],v10,16904
buffer_load_dwordx4 a[72:75], v211, s[24:27], s47 offen offset:0 sc1
m16 v[116:119],a[196:199],a[128:131],v[116:119]
v_mul_f32 v33, v33, v230
rtr a[230:231],v10,17928
v_mul_f32 v34, v34, v230
m16 v[148:151],a[196:199],a[132:135],v[148:151]
rtr a[232:233],v10,17152
v_mul_f32 v35, v35, v230
v_mul_f32 v36, v36, v230
m16 v[120:123],a[200:203],a[128:131],v[120:123]
rtr a[234:235],v10,18176
rtr a[236:237],v10,17160
v_mul_f32 v37, v37, v230
m16 v[152:155],a[200:203],a[132:135],v[152:155]
rtr a[238:239],v10,18184
s_add_u32 m0, s70, 147424
v_mul_f32 v38, v38, v230
m16 v[124:127],a[204:207],a[128:131],v[124:127]
rtr a[240:241],v10,17408
buffer_load_dwordx4 a[76:79], v211, s[24:27], s47 offen offset:1024 sc1
v_mul_f32 v39, v39, v230
m16 v[156:159],a[204:207],a[132:135],v[156:159]
rtr a[242:243],v10,18432
s_mov_b32 s29, 67584
cvt v238,v32,v33
m16 v[128:131],a[208:211],a[128:131],v[128:131]
rtr a[244:245],v10,17416
rtr a[246:247],v10,18440
m16 v[160:163],a[208:211],a[132:135],v[160:163]
rtr a[248:249],v10,17664
cvt v239,v34,v35
m16 v[132:135],a[212:215],a[128:131],v[132:135]
rtr a[250:251],v10,18688
buffer_load_dwordx4 v210, s[56:59], 0 offen offset:0 lds
m16 v[164:167],a[212:215],a[132:135],v[164:167]
rtr a[252:253],v10,17672
cvt v240,v36,v37
m16 v[136:139],a[216:219],a[128:131],v[136:139]
rtr a[254:255],v10,18696
v_add_u32 v211, 0x5800, v211
buffer_load_dwordx4 a[80:83], v211, s[24:27], 0 offen offset:0 sc1
m16 v[168:171],a[216:219],a[132:135],v[168:171]
rtr a[0:1],v10,20992
rtr a[2:3],v10,22016
m16 v[140:143],a[220:223],a[128:131],v[140:143]
cvt v241,v38,v39
rtr a[4:5],v10,21000
m16 v[172:175],a[220:223],a[132:135],v[172:175]
rtr a[6:7],v10,22024
buffer_load_dwordx4 v210, s[56:59], s44 offen offset:1024 lds
m16 v[112:115],a[160:163],a[136:139],v[112:115]
buffer_store_dwordx4 v[238:241], v5, s[24:27], s29 offen offset:0 sc1
rtr a[8:9],v10,21248
m16 v[144:147],a[160:163],a[140:143],v[144:147]
v_mul_f32 v64, v64, v232
rtr a[10:11],v10,22272
m16 v[116:119],a[164:167],a[136:139],v[116:119]
rtr a[12:13],v10,21256
v_mul_f32 v65, v65, v232
m16 v[148:151],a[164:167],a[140:143],v[148:151]
rtr a[14:15],v10,22280
buffer_load_dwordx4 a[84:87], v211, s[24:27], 0 offen offset:1024 sc1
v_mul_f32 v66, v66, v232
m16 v[120:123],a[168:171],a[136:139],v[120:123]
rtr a[16:17],v10,21504
v_mul_f32 v67, v67, v232
m16 v[152:155],a[168:171],a[140:143],v[152:155]
rtr a[18:19],v10,22528
buffer_load_dwordx4 v210, s[56:59], s45 offen offset:2048 lds
v_mul_f32 v68, v68, v232
m16 v[124:127],a[172:175],a[136:139],v[124:127]
rtr a[20:21],v10,21512
rtr a[22:23],v10,22536
v_mul_f32 v69, v69, v232
m16 v[156:159],a[172:175],a[140:143],v[156:159]
rtr a[24:25],v10,21760
rtr a[26:27],v10,22784
m16 v[128:131],a[176:179],a[136:139],v[128:131]
v_mul_f32 v70, v70, v232
rtr a[28:29],v10,21768
m16 v[160:163],a[176:179],a[140:143],v[160:163]
buffer_load_dwordx4 a[88:91], v211, s[24:27], s47 offen offset:0 sc1
v_mul_f32 v71, v71, v232
m16 v[132:135],a[180:183],a[136:139],v[132:135]
rtr a[30:31],v10,22792
buffer_load_dwordx4 v210, s[56:59], s46 offen offset:3072 lds
cvt v242,v64,v65
m16 v[164:167],a[180:183],a[140:143],v[164:167]
cvt v243,v66,v67
cvt v244,v68,v69
m16 v[136:139],a[184:187],a[136:139],v[136:139]
cvt v245,v70,v71
buffer_store_dwordx4 v[242:245], v5, s[24:27], s29 offen offset:1024 sc1
m16 v[168:171],a[184:187],a[140:143],v[168:171]
m16 v[140:143],a[188:191],a[136:139],v[140:143]
m16 v[172:175],a[188:191],a[140:143],v[172:175]
s_waitcnt vmcnt(33) lgkmcnt(0)
m16 v[112:115],a[224:227],a[144:147],v[112:115]
rtr a[192:193],v11,0
rtr a[194:195],v11,1024
v_add_u32 v210, 0x60000, v210
m16 v[144:147],a[224:227],a[148:151],v[144:147]
v_mul_f32 v40, v40, v230
rtr a[196:197],v11,8
buffer_load_dwordx4 a[92:95], v211, s[24:27], s47 offen offset:1024 sc1
m16 v[116:119],a[228:231],a[144:147],v[116:119]
v_mul_f32 v41, v41, v230
rtr a[198:199],v11,1032
v_mul_f32 v42, v42, v230
m16 v[148:151],a[228:231],a[148:151],v[148:151]
rtr a[200:201],v11,256
v_mul_f32 v43, v43, v230
v_mul_f32 v44, v44, v230
m16 v[120:123],a[232:235],a[144:147],v[120:123]
rtr a[202:203],v11,1280
rtr a[204:205],v11,264
v_mul_f32 v45, v45, v230
m16 v[152:155],a[232:235],a[148:151],v[152:155]
rtr a[206:207],v11,1288
s_add_u32 m0, s70, 0
v_mul_f32 v46, v46, v230
m16 v[124:127],a[236:239],a[144:147],v[124:127]
rtr a[208:209],v11,512
v_mul_f32 v47, v47, v230
m16 v[156:159],a[236:239],a[148:151],v[156:159]
rtr a[210:211],v11,1536
s_mov_b32 s29, 78848
cvt v246,v40,v41
m16 v[128:131],a[240:243],a[144:147],v[128:131]
rtr a[212:213],v11,520
rtr a[214:215],v11,1544
m16 v[160:163],a[240:243],a[148:151],v[160:163]
rtr a[216:217],v11,768
cvt v247,v42,v43
m16 v[132:135],a[244:247],a[144:147],v[132:135]
rtr a[218:219],v11,1792
buffer_load_dwordx4 v210, s[56:59], 0 offen offset:0 lds
m16 v[164:167],a[244:247],a[148:151],v[164:167]
rtr a[220:221],v11,776
cvt v248,v44,v45
m16 v[136:139],a[248:251],a[144:147],v[136:139]
rtr a[222:223],v11,1800
m16 v[168:171],a[248:251],a[148:151],v[168:171]
rtr a[160:161],v11,4096
rtr a[162:163],v11,5120
m16 v[140:143],a[252:255],a[144:147],v[140:143]
cvt v249,v46,v47
rtr a[164:165],v11,4104
m16 v[172:175],a[252:255],a[148:151],v[172:175]
rtr a[166:167],v11,5128
buffer_load_dwordx4 v210, s[56:59], s44 offen offset:1024 lds
m16 v[112:115],a[0:3],a[152:155],v[112:115]
buffer_store_dwordx4 v[246:249], v5, s[24:27], s29 offen offset:0 sc1
rtr a[168:169],v11,4352
m16 v[144:147],a[0:3],a[156:159],v[144:147]
v_mul_f32 v72, v72, v232
rtr a[170:171],v11,5376
m16 v[116:119],a[4:7],a[152:155],v[116:119]
rtr a[172:173],v11,4360
v_mul_f32 v73, v73, v232
m16 v[148:151],a[4:7],a[156:159],v[148:151]
rtr a[174:175],v11,5384
v_mul_f32 v74, v74, v232
m16 v[120:123],a[8:11],a[152:155],v[120:123]
rtr a[176:177],v11,4608
v_mul_f32 v75, v75, v232
m16 v[152:155],a[8:11],a[156:159],v[152:155]
rtr a[178:179],v11,5632
buffer_load_dwordx4 v210, s[56:59], s45 offen offset:2048 lds
v_mul_f32 v76, v76, v232
m16 v[124:127],a[12:15],a[152:155],v[124:127]
rtr a[180:181],v11,4616
rtr a[182:183],v11,5640
v_mul_f32 v77, v77, v232
m16 v[156:159],a[12:15],a[156:159],v[156:159]
rtr a[184:185],v11,4864
rtr a[186:187],v11,5888
m16 v[128:131],a[16:19],a[152:155],v[128:131]
v_mul_f32 v78, v78, v232
rtr a[188:189],v11,4872
m16 v[160:163],a[16:19],a[156:159],v[160:163]
v_mul_f32 v79, v79, v232
m16 v[132:135],a[20:23],a[152:155],v[132:135]
rtr a[190:191],v11,5896
buffer_load_dwordx4 v210, s[56:59], s46 offen offset:3072 lds
cvt v250,v72,v73
m16 v[164:167],a[20:23],a[156:159],v[164:167]
cvt v251,v74,v75
cvt v252,v76,v77
m16 v[136:139],a[24:27],a[152:155],v[136:139]
cvt v253,v78,v79
buffer_store_dwordx4 v[250:253], v5, s[24:27], s29 offen offset:1024 sc1
m16 v[168:171],a[24:27],a[156:159],v[168:171]
m16 v[140:143],a[28:31],a[152:155],v[140:143]
m16 v[172:175],a[28:31],a[156:159],v[172:175]
s_waitcnt vmcnt(33) lgkmcnt(0)
s_barrier
m16 v[112:115],a[192:195],a[32:35],v[112:115]
rtr a[224:225],v10,50688
rtr a[226:227],v10,51712
m16 v[144:147],a[192:195],a[36:39],v[144:147]
v_add_u32 v210, 0x20000, v210
rtr a[228:229],v10,50696
m16 v[116:119],a[196:199],a[32:35],v[116:119]
v_add_u32 v211, 0x10800, v211
buffer_load_dwordx4 v[16:19], v211, s[24:27], 0 offen offset:0 sc1
rtr a[230:231],v10,51720
m16 v[148:151],a[196:199],a[36:39],v[148:151]
rtr a[232:233],v10,50944
m16 v[120:123],a[200:203],a[32:35],v[120:123]
rtr a[234:235],v10,51968
rtr a[236:237],v10,50952
m16 v[152:155],a[200:203],a[36:39],v[152:155]
rtr a[238:239],v10,51976
s_add_u32 m0, s70, 33792
m16 v[124:127],a[204:207],a[32:35],v[124:127]
rtr a[240:241],v10,51200
buffer_load_dwordx4 v[20:23], v211, s[24:27], 0 offen offset:1024 sc1
m16 v[156:159],a[204:207],a[36:39],v[156:159]
rtr a[242:243],v10,52224
m16 v[128:131],a[208:211],a[32:35],v[128:131]
rtr a[244:245],v10,51208
rtr a[246:247],v10,52232
m16 v[160:163],a[208:211],a[36:39],v[160:163]
rtr a[248:249],v10,51456
m16 v[132:135],a[212:215],a[32:35],v[132:135]
rtr a[250:251],v10,52480
buffer_load_dwordx4 v210, s[56:59], 0 offen offset:0 lds
m16 v[164:167],a[212:215],a[36:39],v[164:167]
rtr a[252:253],v10,51464
m16 v[136:139],a[216:219],a[32:35],v[136:139]
rtr a[254:255],v10,52488
buffer_load_dwordx4 v[24:27], v211, s[24:27], s47 offen offset:0 sc1
m16 v[168:171],a[216:219],a[36:39],v[168:171]
rtr a[0:1],v10,54784
rtr a[2:3],v10,55808
m16 v[140:143],a[220:223],a[32:35],v[140:143]
rtr a[4:5],v10,54792
m16 v[172:175],a[220:223],a[36:39],v[172:175]
rtr a[6:7],v10,55816
buffer_load_dwordx4 v210, s[56:59], s44 offen offset:1024 lds
m16 v[112:115],a[160:163],a[40:43],v[112:115]
rtr a[8:9],v10,55040
m16 v[144:147],a[160:163],a[44:47],v[144:147]
rtr a[10:11],v10,56064
rtr a[12:13],v10,55048
m16 v[116:119],a[164:167],a[40:43],v[116:119]
rtr a[14:15],v10,56072
buffer_load_dwordx4 v[28:31], v211, s[24:27], s47 offen offset:1024 sc1
m16 v[148:151],a[164:167],a[44:47],v[148:151]
rtr a[16:17],v10,55296
m16 v[120:123],a[168:171],a[40:43],v[120:123]
rtr a[18:19],v10,56320
buffer_load_dwordx4 v210, s[56:59], s45 offen offset:2048 lds
m16 v[152:155],a[168:171],a[44:47],v[152:155]
rtr a[20:21],v10,55304
rtr a[22:23],v10,56328
m16 v[124:127],a[172:175],a[40:43],v[124:127]
rtr a[24:25],v10,55552
m16 v[156:159],a[172:175],a[44:47],v[156:159]
rtr a[26:27],v10,56576
m16 v[128:131],a[176:179],a[40:43],v[128:131]
rtr a[28:29],v10,55560
v_add_u32 v211, 0x5800, v211
buffer_load_dwordx4 v[32:35], v211, s[24:27], 0 offen offset:0 sc1
m16 v[160:163],a[176:179],a[44:47],v[160:163]
rtr a[30:31],v10,56584
buffer_load_dwordx4 v210, s[56:59], s46 offen offset:3072 lds
m16 v[132:135],a[180:183],a[40:43],v[132:135]
m16 v[164:167],a[180:183],a[44:47],v[164:167]
m16 v[136:139],a[184:187],a[40:43],v[136:139]
m16 v[168:171],a[184:187],a[44:47],v[168:171]
m16 v[140:143],a[188:191],a[40:43],v[140:143]
m16 v[172:175],a[188:191],a[44:47],v[172:175]
s_waitcnt vmcnt(34) lgkmcnt(0)
m16 v[112:115],a[224:227],a[48:51],v[112:115]
rtr a[192:193],v11,33792
rtr a[194:195],v11,34816
m16 v[144:147],a[224:227],a[52:55],v[144:147]
v_add_u32 v210, 0x60000, v210
rtr a[196:197],v11,33800
m16 v[116:119],a[228:231],a[48:51],v[116:119]
buffer_load_dwordx4 v[36:39], v211, s[24:27], 0 offen offset:1024 sc1
rtr a[198:199],v11,34824
m16 v[148:151],a[228:231],a[52:55],v[148:151]
rtr a[200:201],v11,34048
m16 v[120:123],a[232:235],a[48:51],v[120:123]
rtr a[202:203],v11,35072
rtr a[204:205],v11,34056
m16 v[152:155],a[232:235],a[52:55],v[152:155]
rtr a[206:207],v11,35080
s_add_u32 m0, s70, 16896
m16 v[124:127],a[236:239],a[48:51],v[124:127]
rtr a[208:209],v11,34304
buffer_load_dwordx4 v[40:43], v211, s[24:27], s47 offen offset:0 sc1
m16 v[156:159],a[236:239],a[52:55],v[156:159]
rtr a[210:211],v11,35328
m16 v[128:131],a[240:243],a[48:51],v[128:131]
rtr a[212:213],v11,34312
rtr a[214:215],v11,35336
m16 v[160:163],a[240:243],a[52:55],v[160:163]
rtr a[216:217],v11,34560
m16 v[132:135],a[244:247],a[48:51],v[132:135]
rtr a[218:219],v11,35584
buffer_load_dwordx4 v210, s[56:59], 0 offen offset:0 lds
m16 v[164:167],a[244:247],a[52:55],v[164:167]
rtr a[220:221],v11,34568
m16 v[136:139],a[248:251],a[48:51],v[136:139]
rtr a[222:223],v11,35592
buffer_load_dwordx4 v[44:47], v211, s[24:27], s47 offen offset:1024 sc1
m16 v[168:171],a[248:251],a[52:55],v[168:171]
rtr a[160:161],v11,37888
rtr a[162:163],v11,38912
m16 v[140:143],a[252:255],a[48:51],v[140:143]
rtr a[164:165],v11,37896
m16 v[172:175],a[252:255],a[52:55],v[172:175]
rtr a[166:167],v11,38920
buffer_load_dwordx4 v210, s[56:59], s44 offen offset:1024 lds
m16 v[112:115],a[0:3],a[56:59],v[112:115]
rtr a[168:169],v11,38144
m16 v[144:147],a[0:3],a[60:63],v[144:147]
rtr a[170:171],v11,39168
rtr a[172:173],v11,38152
m16 v[116:119],a[4:7],a[56:59],v[116:119]
rtr a[174:175],v11,39176
v_add_u32 v211, 0x10800, v211
buffer_load_dwordx4 v[48:51], v211, s[24:27], 0 offen offset:0 sc1
m16 v[148:151],a[4:7],a[60:63],v[148:151]
rtr a[176:177],v11,38400
m16 v[120:123],a[8:11],a[56:59],v[120:123]
rtr a[178:179],v11,39424
buffer_load_dwordx4 v210, s[56:59], s45 offen offset:2048 lds
m16 v[152:155],a[8:11],a[60:63],v[152:155]
rtr a[180:181],v11,38408
rtr a[182:183],v11,39432
m16 v[124:127],a[12:15],a[56:59],v[124:127]
rtr a[184:185],v11,38656
m16 v[156:159],a[12:15],a[60:63],v[156:159]
rtr a[186:187],v11,39680
m16 v[128:131],a[16:19],a[56:59],v[128:131]
rtr a[188:189],v11,38664
buffer_load_dwordx4 v[52:55], v211, s[24:27], 0 offen offset:1024 sc1
m16 v[160:163],a[16:19],a[60:63],v[160:163]
rtr a[190:191],v11,39688
buffer_load_dwordx4 v210, s[56:59], s46 offen offset:3072 lds
m16 v[132:135],a[20:23],a[56:59],v[132:135]
m16 v[164:167],a[20:23],a[60:63],v[164:167]
m16 v[136:139],a[24:27],a[56:59],v[136:139]
m16 v[168:171],a[24:27],a[60:63],v[168:171]
m16 v[140:143],a[28:31],a[56:59],v[140:143]
m16 v[172:175],a[28:31],a[60:63],v[172:175]
s_waitcnt vmcnt(34) lgkmcnt(0)
s_barrier
m16 v[112:115],a[192:195],a[64:67],v[112:115]
rtr a[224:225],v11,16896
rtr a[226:227],v11,17920
m16 v[144:147],a[192:195],a[68:71],v[144:147]
v_add_u32 v210, 0x20000, v210
rtr a[228:229],v11,16904
m16 v[116:119],a[196:199],a[64:67],v[116:119]
buffer_load_dwordx4 v[56:59], v211, s[24:27], s47 offen offset:0 sc1
rtr a[230:231],v11,17928
m16 v[148:151],a[196:199],a[68:71],v[148:151]
rtr a[232:233],v11,17152
m16 v[120:123],a[200:203],a[64:67],v[120:123]
rtr a[234:235],v11,18176
rtr a[236:237],v11,17160
m16 v[152:155],a[200:203],a[68:71],v[152:155]
rtr a[238:239],v11,18184
s_add_u32 m0, s70, 67584
m16 v[124:127],a[204:207],a[64:67],v[124:127]
rtr a[240:241],v11,17408
buffer_load_dwordx4 v[60:63], v211, s[24:27], s47 offen offset:1024 sc1
m16 v[156:159],a[204:207],a[68:71],v[156:159]
rtr a[242:243],v11,18432
m16 v[128:131],a[208:211],a[64:67],v[128:131]
rtr a[244:245],v11,17416
rtr a[246:247],v11,18440
m16 v[160:163],a[208:211],a[68:71],v[160:163]
rtr a[248:249],v11,17664
m16 v[132:135],a[212:215],a[64:67],v[132:135]
rtr a[250:251],v11,18688
buffer_load_dwordx4 v210, s[56:59], 0 offen offset:0 lds
m16 v[164:167],a[212:215],a[68:71],v[164:167]
rtr a[252:253],v11,17672
m16 v[136:139],a[216:219],a[64:67],v[136:139]
rtr a[254:255],v11,18696
v_add_u32 v211, 0x5800, v211
buffer_load_dwordx4 v[64:67], v211, s[24:27], 0 offen offset:0 sc1
m16 v[168:171],a[216:219],a[68:71],v[168:171]
rtr a[0:1],v11,20992
rtr a[2:3],v11,22016
m16 v[140:143],a[220:223],a[64:67],v[140:143]
rtr a[4:5],v11,21000
m16 v[172:175],a[220:223],a[68:71],v[172:175]
rtr a[6:7],v11,22024
buffer_load_dwordx4 v210, s[56:59], s44 offen offset:1024 lds
m16 v[112:115],a[160:163],a[72:75],v[112:115]
rtr a[8:9],v11,21248
m16 v[144:147],a[160:163],a[76:79],v[144:147]
rtr a[10:11],v11,22272
rtr a[12:13],v11,21256
m16 v[116:119],a[164:167],a[72:75],v[116:119]
rtr a[14:15],v11,22280
buffer_load_dwordx4 v[68:71], v211, s[24:27], 0 offen offset:1024 sc1
m16 v[148:151],a[164:167],a[76:79],v[148:151]
rtr a[16:17],v11,21504
m16 v[120:123],a[168:171],a[72:75],v[120:123]
rtr a[18:19],v11,22528
buffer_load_dwordx4 v210, s[56:59], s45 offen offset:2048 lds
m16 v[152:155],a[168:171],a[76:79],v[152:155]
rtr a[20:21],v11,21512
rtr a[22:23],v11,22536
m16 v[124:127],a[172:175],a[72:75],v[124:127]
rtr a[24:25],v11,21760
m16 v[156:159],a[172:175],a[76:79],v[156:159]
rtr a[26:27],v11,22784
m16 v[128:131],a[176:179],a[72:75],v[128:131]
rtr a[28:29],v11,21768
buffer_load_dwordx4 v[72:75], v211, s[24:27], s47 offen offset:0 sc1
m16 v[160:163],a[176:179],a[76:79],v[160:163]
rtr a[30:31],v11,22792
buffer_load_dwordx4 v210, s[56:59], s46 offen offset:3072 lds
m16 v[132:135],a[180:183],a[72:75],v[132:135]
m16 v[164:167],a[180:183],a[76:79],v[164:167]
m16 v[136:139],a[184:187],a[72:75],v[136:139]
m16 v[168:171],a[184:187],a[76:79],v[168:171]
m16 v[140:143],a[188:191],a[72:75],v[140:143]
m16 v[172:175],a[188:191],a[76:79],v[172:175]
s_waitcnt vmcnt(33) lgkmcnt(0)
m16 v[112:115],a[224:227],a[80:83],v[112:115]
rtr a[192:193],v11,50688
rtr a[194:195],v11,51712
m16 v[144:147],a[224:227],a[84:87],v[144:147]
v_add_u32 v210, 0x60000, v210
rtr a[196:197],v11,50696
m16 v[116:119],a[228:231],a[80:83],v[116:119]
buffer_load_dwordx4 v[76:79], v211, s[24:27], s47 offen offset:1024 sc1
rtr a[198:199],v11,51720
m16 v[148:151],a[228:231],a[84:87],v[148:151]
rtr a[200:201],v11,50944
m16 v[120:123],a[232:235],a[80:83],v[120:123]
rtr a[202:203],v11,51968
rtr a[204:205],v11,50952
m16 v[152:155],a[232:235],a[84:87],v[152:155]
rtr a[206:207],v11,51976
s_add_u32 m0, s70, 50688
m16 v[124:127],a[236:239],a[80:83],v[124:127]
rtr a[208:209],v11,51200
v_add_u32 v211, 0x10800, v211
buffer_load_dwordx4 v[80:83], v211, s[24:27], 0 offen offset:0 sc1
m16 v[156:159],a[236:239],a[84:87],v[156:159]
rtr a[210:211],v11,52224
m16 v[128:131],a[240:243],a[80:83],v[128:131]
rtr a[212:213],v11,51208
rtr a[214:215],v11,52232
m16 v[160:163],a[240:243],a[84:87],v[160:163]
rtr a[216:217],v11,51456
m16 v[132:135],a[244:247],a[80:83],v[132:135]
rtr a[218:219],v11,52480
buffer_load_dwordx4 v210, s[56:59], 0 offen offset:0 lds
m16 v[164:167],a[244:247],a[84:87],v[164:167]
rtr a[220:221],v11,51464
m16 v[136:139],a[248:251],a[80:83],v[136:139]
rtr a[222:223],v11,52488
buffer_load_dwordx4 v[84:87], v211, s[24:27], 0 offen offset:1024 sc1
m16 v[168:171],a[248:251],a[84:87],v[168:171]
rtr a[160:161],v11,54784
rtr a[162:163],v11,55808
m16 v[140:143],a[252:255],a[80:83],v[140:143]
rtr a[164:165],v11,54792
m16 v[172:175],a[252:255],a[84:87],v[172:175]
rtr a[166:167],v11,55816
buffer_load_dwordx4 v210, s[56:59], s44 offen offset:1024 lds
m16 v[112:115],a[0:3],a[88:91],v[112:115]
rtr a[168:169],v11,55040
m16 v[144:147],a[0:3],a[92:95],v[144:147]
rtr a[170:171],v11,56064
rtr a[172:173],v11,55048
m16 v[116:119],a[4:7],a[88:91],v[116:119]
rtr a[174:175],v11,56072
buffer_load_dwordx4 v[88:91], v211, s[24:27], s47 offen offset:0 sc1
m16 v[148:151],a[4:7],a[92:95],v[148:151]
rtr a[176:177],v11,55296
m16 v[120:123],a[8:11],a[88:91],v[120:123]
rtr a[178:179],v11,56320
buffer_load_dwordx4 v210, s[56:59], s45 offen offset:2048 lds
m16 v[152:155],a[8:11],a[92:95],v[152:155]
rtr a[180:181],v11,55304
rtr a[182:183],v11,56328
m16 v[124:127],a[12:15],a[88:91],v[124:127]
rtr a[184:185],v11,55552
m16 v[156:159],a[12:15],a[92:95],v[156:159]
rtr a[186:187],v11,56576
m16 v[128:131],a[16:19],a[88:91],v[128:131]
rtr a[188:189],v11,55560
buffer_load_dwordx4 v[92:95], v211, s[24:27], s47 offen offset:1024 sc1
m16 v[160:163],a[16:19],a[92:95],v[160:163]
rtr a[190:191],v11,56584
buffer_load_dwordx4 v210, s[56:59], s46 offen offset:3072 lds
m16 v[132:135],a[20:23],a[88:91],v[132:135]
m16 v[164:167],a[20:23],a[92:95],v[164:167]
m16 v[136:139],a[24:27],a[88:91],v[136:139]
m16 v[168:171],a[24:27],a[92:95],v[168:171]
m16 v[140:143],a[28:31],a[88:91],v[140:143]
m16 v[172:175],a[28:31],a[92:95],v[172:175]
s_waitcnt vmcnt(30) lgkmcnt(0)
s_barrier
m16 v[112:115],a[192:195],v[16:19],v[112:115]
rtr a[224:225],v12,0
rtr a[226:227],v12,1024
m16 v[144:147],a[192:195],v[20:23],v[144:147]
v_add_u32 v210, 0x20000, v210
rtr a[228:229],v12,8
m16 v[116:119],a[196:199],v[16:19],v[116:119]
v_add_u32 v211, 0x5800, v211
buffer_load_dwordx4 v[96:99], v211, s[24:27], 0 offen offset:0 sc1
rtr a[230:231],v12,1032
m16 v[148:151],a[196:199],v[20:23],v[148:151]
rtr a[232:233],v12,256
m16 v[120:123],a[200:203],v[16:19],v[120:123]
rtr a[234:235],v12,1280
rtr a[236:237],v12,264
m16 v[152:155],a[200:203],v[20:23],v[152:155]
rtr a[238:239],v12,1288
s_add_u32 m0, s70, 101376
m16 v[124:127],a[204:207],v[16:19],v[124:127]
rtr a[240:241],v12,512
buffer_load_dwordx4 v[100:103], v211, s[24:27], 0 offen offset:1024 sc1
m16 v[156:159],a[204:207],v[20:23],v[156:159]
rtr a[242:243],v12,1536
m16 v[128:131],a[208:211],v[16:19],v[128:131]
rtr a[244:245],v12,520
rtr a[246:247],v12,1544
m16 v[160:163],a[208:211],v[20:23],v[160:163]
rtr a[248:249],v12,768
m16 v[132:135],a[212:215],v[16:19],v[132:135]
rtr a[250:251],v12,1792
buffer_load_dwordx4 v210, s[56:59], 0 offen offset:0 lds
m16 v[164:167],a[212:215],v[20:23],v[164:167]
rtr a[252:253],v12,776
m16 v[136:139],a[216:219],v[16:19],v[136:139]
rtr a[254:255],v12,1800
buffer_load_dwordx4 v[104:107], v211, s[24:27], s47 offen offset:0 sc1
m16 v[168:171],a[216:219],v[20:23],v[168:171]
rtr a[0:1],v12,4096
rtr a[2:3],v12,5120
m16 v[140:143],a[220:223],v[16:19],v[140:143]
rtr a[4:5],v12,4104
m16 v[172:175],a[220:223],v[20:23],v[172:175]
rtr a[6:7],v12,5128
buffer_load_dwordx4 v210, s[56:59], s44 offen offset:1024 lds
m16 v[112:115],a[160:163],v[24:27],v[112:115]
rtr a[8:9],v12,4352
m16 v[144:147],a[160:163],v[28:31],v[144:147]
rtr a[10:11],v12,5376
rtr a[12:13],v12,4360
m16 v[116:119],a[164:167],v[24:27],v[116:119]
rtr a[14:15],v12,5384
buffer_load_dwordx4 v[108:111], v211, s[24:27], s47 offen offset:1024 sc1
m16 v[148:151],a[164:167],v[28:31],v[148:151]
rtr a[16:17],v12,4608
m16 v[120:123],a[168:171],v[24:27],v[120:123]
rtr a[18:19],v12,5632
buffer_load_dwordx4 v210, s[56:59], s45 offen offset:2048 lds
m16 v[152:155],a[168:171],v[28:31],v[152:155]
rtr a[20:21],v12,4616
rtr a[22:23],v12,5640
m16 v[124:127],a[172:175],v[24:27],v[124:127]
rtr a[24:25],v12,4864
m16 v[156:159],a[172:175],v[28:31],v[156:159]
rtr a[26:27],v12,5888
m16 v[128:131],a[176:179],v[24:27],v[128:131]
rtr a[28:29],v12,4872
v_add_u32 v211, 0x10800, v211
buffer_load_dwordx4 a[96:99], v211, s[24:27], 0 offen offset:0 sc1
m16 v[160:163],a[176:179],v[28:31],v[160:163]
rtr a[30:31],v12,5896
buffer_load_dwordx4 v210, s[56:59], s46 offen offset:3072 lds
m16 v[132:135],a[180:183],v[24:27],v[132:135]
m16 v[164:167],a[180:183],v[28:31],v[164:167]
m16 v[136:139],a[184:187],v[24:27],v[136:139]
m16 v[168:171],a[184:187],v[28:31],v[168:171]
m16 v[140:143],a[188:191],v[24:27],v[140:143]
m16 v[172:175],a[188:191],v[28:31],v[172:175]
s_waitcnt vmcnt(32) lgkmcnt(0)
m16 v[112:115],a[224:227],v[32:35],v[112:115]
rtr a[192:193],v10,0
rtr a[194:195],v10,1024
m16 v[144:147],a[224:227],v[36:39],v[144:147]
v_add_u32 v210, 0xffca0000, v210
rtr a[196:197],v10,8
m16 v[116:119],a[228:231],v[32:35],v[116:119]
buffer_load_dwordx4 a[100:103], v211, s[24:27], 0 offen offset:1024 sc1
rtr a[198:199],v10,1032
m16 v[148:151],a[228:231],v[36:39],v[148:151]
rtr a[200:201],v10,256
m16 v[120:123],a[232:235],v[32:35],v[120:123]
rtr a[202:203],v10,1280
rtr a[204:205],v10,264
m16 v[152:155],a[232:235],v[36:39],v[152:155]
rtr a[206:207],v10,1288
s_add_u32 m0, s70, 84480
m16 v[124:127],a[236:239],v[32:35],v[124:127]
rtr a[208:209],v10,512
buffer_load_dwordx4 a[104:107], v211, s[24:27], s47 offen offset:0 sc1
m16 v[156:159],a[236:239],v[36:39],v[156:159]
rtr a[210:211],v10,1536
m16 v[128:131],a[240:243],v[32:35],v[128:131]
rtr a[212:213],v10,520
rtr a[214:215],v10,1544
m16 v[160:163],a[240:243],v[36:39],v[160:163]
rtr a[216:217],v10,768
m16 v[132:135],a[244:247],v[32:35],v[132:135]
rtr a[218:219],v10,1792
buffer_load_dwordx4 v210, s[56:59], 0 offen offset:0 lds
m16 v[164:167],a[244:247],v[36:39],v[164:167]
rtr a[220:221],v10,776
m16 v[136:139],a[248:251],v[32:35],v[136:139]
rtr a[222:223],v10,1800
buffer_load_dwordx4 a[108:111], v211, s[24:27], s47 offen offset:1024 sc1
m16 v[168:171],a[248:251],v[36:39],v[168:171]
rtr a[160:161],v10,4096
rtr a[162:163],v10,5120
m16 v[140:143],a[252:255],v[32:35],v[140:143]
rtr a[164:165],v10,4104
m16 v[172:175],a[252:255],v[36:39],v[172:175]
rtr a[166:167],v10,5128
buffer_load_dwordx4 v210, s[56:59], s44 offen offset:1024 lds
m16 v[112:115],a[0:3],v[40:43],v[112:115]
rtr a[168:169],v10,4352
m16 v[144:147],a[0:3],v[44:47],v[144:147]
rtr a[170:171],v10,5376
rtr a[172:173],v10,4360
m16 v[116:119],a[4:7],v[40:43],v[116:119]
rtr a[174:175],v10,5384
v_add_u32 v211, 0x5800, v211
buffer_load_dwordx4 a[112:115], v211, s[24:27], 0 offen offset:0 sc1
m16 v[148:151],a[4:7],v[44:47],v[148:151]
rtr a[176:177],v10,4608
m16 v[120:123],a[8:11],v[40:43],v[120:123]
rtr a[178:179],v10,5632
buffer_load_dwordx4 v210, s[56:59], s45 offen offset:2048 lds
m16 v[152:155],a[8:11],v[44:47],v[152:155]
rtr a[180:181],v10,4616
rtr a[182:183],v10,5640
m16 v[124:127],a[12:15],v[40:43],v[124:127]
rtr a[184:185],v10,4864
m16 v[156:159],a[12:15],v[44:47],v[156:159]
rtr a[186:187],v10,5888
m16 v[128:131],a[16:19],v[40:43],v[128:131]
rtr a[188:189],v10,4872
buffer_load_dwordx4 a[116:119], v211, s[24:27], 0 offen offset:1024 sc1
m16 v[160:163],a[16:19],v[44:47],v[160:163]
rtr a[190:191],v10,5896
buffer_load_dwordx4 v210, s[56:59], s46 offen offset:3072 lds
m16 v[132:135],a[20:23],v[40:43],v[132:135]
m16 v[164:167],a[20:23],v[44:47],v[164:167]
m16 v[136:139],a[24:27],v[40:43],v[136:139]
m16 v[168:171],a[24:27],v[44:47],v[168:171]
m16 v[140:143],a[28:31],v[40:43],v[140:143]
m16 v[172:175],a[28:31],v[44:47],v[172:175]
s_waitcnt vmcnt(34) lgkmcnt(0)
s_barrier
m16 v[112:115],a[192:195],v[48:51],v[112:115]
rtr a[224:225],v10,33792
rtr a[226:227],v10,34816
m16 v[144:147],a[192:195],v[52:55],v[144:147]
v_add_u32 v210, 0x20000, v210
rtr a[228:229],v10,33800
m16 v[116:119],a[196:199],v[48:51],v[116:119]
buffer_load_dwordx4 a[120:123], v211, s[24:27], s47 offen offset:0 sc1
rtr a[230:231],v10,34824
m16 v[148:151],a[196:199],v[52:55],v[148:151]
rtr a[232:233],v10,34048
m16 v[120:123],a[200:203],v[48:51],v[120:123]
rtr a[234:235],v10,35072
rtr a[236:237],v10,34056
m16 v[152:155],a[200:203],v[52:55],v[152:155]
s_add_u32 m0, s70, 118272
rtr a[238:239],v10,35080
m16 v[124:127],a[204:207],v[48:51],v[124:127]
rtr a[240:241],v10,34304
buffer_load_dwordx4 a[124:127], v211, s[24:27], s47 offen offset:1024 sc1
m16 v[156:159],a[204:207],v[52:55],v[156:159]
rtr a[242:243],v10,35328
m16 v[128:131],a[208:211],v[48:51],v[128:131]
rtr a[244:245],v10,34312
rtr a[246:247],v10,35336
m16 v[160:163],a[208:211],v[52:55],v[160:163]
buffer_load_dwordx4 v210, s[56:59], 0 offen offset:0 lds
rtr a[248:249],v10,34560
m16 v[132:135],a[212:215],v[48:51],v[132:135]
rtr a[250:251],v10,35584
m16 v[164:167],a[212:215],v[52:55],v[164:167]
rtr a[252:253],v10,34568
m16 v[136:139],a[216:219],v[48:51],v[136:139]
rtr a[254:255],v10,35592
buffer_load_dwordx4 v210, s[56:59], s44 offen offset:1024 lds
m16 v[168:171],a[216:219],v[52:55],v[168:171]
rtr a[0:1],v10,37888
m16 v[140:143],a[220:223],v[48:51],v[140:143]
rtr a[2:3],v10,38912
rtr a[4:5],v10,37896
m16 v[172:175],a[220:223],v[52:55],v[172:175]
rtr a[6:7],v10,38920
m16 v[112:115],a[160:163],v[56:59],v[112:115]
rtr a[8:9],v10,38144
m16 v[144:147],a[160:163],v[60:63],v[144:147]
rtr a[10:11],v10,39168
rtr a[12:13],v10,38152
m16 v[116:119],a[164:167],v[56:59],v[116:119]
buffer_load_dwordx4 v210, s[56:59], s45 offen offset:2048 lds
rtr a[14:15],v10,39176
m16 v[148:151],a[164:167],v[60:63],v[148:151]
rtr a[16:17],v10,38400
m16 v[120:123],a[168:171],v[56:59],v[120:123]
rtr a[18:19],v10,39424
m16 v[152:155],a[168:171],v[60:63],v[152:155]
rtr a[20:21],v10,38408
rtr a[22:23],v10,39432
m16 v[124:127],a[172:175],v[56:59],v[124:127]
buffer_load_dwordx4 v210, s[56:59], s46 offen offset:3072 lds
rtr a[24:25],v10,38656
m16 v[156:159],a[172:175],v[60:63],v[156:159]
rtr a[26:27],v10,39680
m16 v[128:131],a[176:179],v[56:59],v[128:131]
rtr a[28:29],v10,38664
m16 v[160:163],a[176:179],v[60:63],v[160:163]
rtr a[30:31],v10,39688
buffer_load_dword v254, v13, s[24:27], 0 offen sc1
m16 v[132:135],a[180:183],v[56:59],v[132:135]
m16 v[164:167],a[180:183],v[60:63],v[164:167]
m16 v[136:139],a[184:187],v[56:59],v[136:139]
m16 v[168:171],a[184:187],v[60:63],v[168:171]
m16 v[140:143],a[188:191],v[56:59],v[140:143]
m16 v[172:175],a[188:191],v[60:63],v[172:175]
s_waitcnt vmcnt(33) lgkmcnt(0)
m16 v[112:115],a[224:227],v[64:67],v[112:115]
rtr a[192:193],v10,16896
rtr a[194:195],v10,17920
m16 v[144:147],a[224:227],v[68:71],v[144:147]
v_add_u32 v210, 0x60000, v210
rtr a[196:197],v10,16904
m16 v[116:119],a[228:231],v[64:67],v[116:119]
rtr a[198:199],v10,17928
m16 v[148:151],a[228:231],v[68:71],v[148:151]
rtr a[200:201],v10,17152
m16 v[120:123],a[232:235],v[64:67],v[120:123]
rtr a[202:203],v10,18176
rtr a[204:205],v10,17160
m16 v[152:155],a[232:235],v[68:71],v[152:155]
rtr a[206:207],v10,18184
s_add_u32 m0, s70, 147424
m16 v[124:127],a[236:239],v[64:67],v[124:127]
rtr a[208:209],v10,17408
m16 v[156:159],a[236:239],v[68:71],v[156:159]
rtr a[210:211],v10,18432
m16 v[128:131],a[240:243],v[64:67],v[128:131]
rtr a[212:213],v10,17416
rtr a[214:215],v10,18440
m16 v[160:163],a[240:243],v[68:71],v[160:163]
rtr a[216:217],v10,17664
m16 v[132:135],a[244:247],v[64:67],v[132:135]
rtr a[218:219],v10,18688
buffer_load_dwordx4 v210, s[56:59], 0 offen offset:0 lds
m16 v[164:167],a[244:247],v[68:71],v[164:167]
rtr a[220:221],v10,17672
m16 v[136:139],a[248:251],v[64:67],v[136:139]
rtr a[222:223],v10,18696
m16 v[168:171],a[248:251],v[68:71],v[168:171]
rtr a[160:161],v10,20992
rtr a[162:163],v10,22016
m16 v[140:143],a[252:255],v[64:67],v[140:143]
rtr a[164:165],v10,21000
m16 v[172:175],a[252:255],v[68:71],v[172:175]
rtr a[166:167],v10,22024
buffer_load_dwordx4 v210, s[56:59], s44 offen offset:1024 lds
m16 v[112:115],a[0:3],v[72:75],v[112:115]
rtr a[168:169],v10,21248
m16 v[144:147],a[0:3],v[76:79],v[144:147]
rtr a[170:171],v10,22272
rtr a[172:173],v10,21256
m16 v[116:119],a[4:7],v[72:75],v[116:119]
rtr a[174:175],v10,22280
m16 v[148:151],a[4:7],v[76:79],v[148:151]
rtr a[176:177],v10,21504
m16 v[120:123],a[8:11],v[72:75],v[120:123]
rtr a[178:179],v10,22528
buffer_load_dwordx4 v210, s[56:59], s45 offen offset:2048 lds
m16 v[152:155],a[8:11],v[76:79],v[152:155]
rtr a[180:181],v10,21512
rtr a[182:183],v10,22536
m16 v[124:127],a[12:15],v[72:75],v[124:127]
rtr a[184:185],v10,21760
m16 v[156:159],a[12:15],v[76:79],v[156:159]
rtr a[186:187],v10,22784
m16 v[128:131],a[16:19],v[72:75],v[128:131]
rtr a[188:189],v10,21768
m16 v[160:163],a[16:19],v[76:79],v[160:163]
rtr a[190:191],v10,22792
buffer_load_dwordx4 v210, s[56:59], s46 offen offset:3072 lds
m16 v[132:135],a[20:23],v[72:75],v[132:135]
m16 v[164:167],a[20:23],v[76:79],v[164:167]
m16 v[136:139],a[24:27],v[72:75],v[136:139]
m16 v[168:171],a[24:27],v[76:79],v[168:171]
m16 v[140:143],a[28:31],v[72:75],v[140:143]
m16 v[172:175],a[28:31],v[76:79],v[172:175]
s_waitcnt vmcnt(29) lgkmcnt(0)
s_barrier
s_waitcnt vmcnt(4)
v_cmp_ne_u32 vcc, 1, v254
s_mov_b32 s28, 0
s_nop 0
s_cmp_eq_u64 vcc, 0
s_cbranch_scc1 Lb_p1_ok
s_mov_b32 s29, 20000
Lb_p1:
s_sleep 2
buffer_load_dword v254, v13, s[24:27], 0 offen sc1
s_waitcnt vmcnt(0)
s_sub_u32 s29, s29, 1
s_cmp_eq_u32 s29, 0
s_cbranch_scc1 Lb_p1_ok
v_cmp_ne_u32 vcc, 1, v254
s_mov_b32 s28, 0
s_nop 0
s_cmp_eq_u64 vcc, 0
s_cbranch_scc0 Lb_p1
Lb_p1_ok:
m16 v[112:115],a[192:195],v[80:83],v[112:115]
rtr a[224:225],v11,0
rtr a[226:227],v11,1024
m16 v[144:147],a[192:195],v[84:87],v[144:147]
v_add_u32 v210, 0x20000, v210
rtr a[228:229],v11,8
m16 v[116:119],a[196:199],v[80:83],v[116:119]
v_add_u32 v211, 0xfff6b800, v211
buffer_load_dwordx4 a[128:131], v211, s[24:27], 0 offen offset:0 sc1
rtr a[230:231],v11,1032
m16 v[148:151],a[196:199],v[84:87],v[148:151]
rtr a[232:233],v11,256
m16 v[120:123],a[200:203],v[80:83],v[120:123]
rtr a[234:235],v11,1280
rtr a[236:237],v11,264
m16 v[152:155],a[200:203],v[84:87],v[152:155]
rtr a[238:239],v11,1288
s_add_u32 m0, s70, 0
m16 v[124:127],a[204:207],v[80:83],v[124:127]
rtr a[240:241],v11,512
buffer_load_dwordx4 a[132:135], v211, s[24:27], 0 offen offset:1024 sc1
m16 v[156:159],a[204:207],v[84:87],v[156:159]
rtr a[242:243],v11,1536
m16 v[128:131],a[208:211],v[80:83],v[128:131]
rtr a[244:245],v11,520
rtr a[246:247],v11,1544
m16 v[160:163],a[208:211],v[84:87],v[160:163]
rtr a[248:249],v11,768
m16 v[132:135],a[212:215],v[80:83],v[132:135]
rtr a[250:251],v11,1792
buffer_load_dwordx4 v210, s[56:59], 0 offen offset:0 lds
m16 v[164:167],a[212:215],v[84:87],v[164:167]
rtr a[252:253],v11,776
m16 v[136:139],a[216:219],v[80:83],v[136:139]
rtr a[254:255],v11,1800
buffer_load_dwordx4 a[136:139], v211, s[24:27], s47 offen offset:0 sc1
m16 v[168:171],a[216:219],v[84:87],v[168:171]
rtr a[0:1],v11,4096
rtr a[2:3],v11,5120
m16 v[140:143],a[220:223],v[80:83],v[140:143]
rtr a[4:5],v11,4104
m16 v[172:175],a[220:223],v[84:87],v[172:175]
rtr a[6:7],v11,5128
buffer_load_dwordx4 v210, s[56:59], s44 offen offset:1024 lds
m16 v[112:115],a[160:163],v[88:91],v[112:115]
rtr a[8:9],v11,4352
m16 v[144:147],a[160:163],v[92:95],v[144:147]
rtr a[10:11],v11,5376
rtr a[12:13],v11,4360
m16 v[116:119],a[164:167],v[88:91],v[116:119]
rtr a[14:15],v11,5384
buffer_load_dwordx4 a[140:143], v211, s[24:27], s47 offen offset:1024 sc1
m16 v[148:151],a[164:167],v[92:95],v[148:151]
rtr a[16:17],v11,4608
m16 v[120:123],a[168:171],v[88:91],v[120:123]
rtr a[18:19],v11,5632
buffer_load_dwordx4 v210, s[56:59], s45 offen offset:2048 lds
m16 v[152:155],a[168:171],v[92:95],v[152:155]
rtr a[20:21],v11,4616
rtr a[22:23],v11,5640
m16 v[124:127],a[172:175],v[88:91],v[124:127]
rtr a[24:25],v11,4864
m16 v[156:159],a[172:175],v[92:95],v[156:159]
rtr a[26:27],v11,5888
m16 v[128:131],a[176:179],v[88:91],v[128:131]
rtr a[28:29],v11,4872
v_add_u32 v211, 0x5800, v211
buffer_load_dwordx4 a[144:147], v211, s[24:27], 0 offen offset:0 sc1
m16 v[160:163],a[176:179],v[92:95],v[160:163]
rtr a[30:31],v11,5896
buffer_load_dwordx4 v210, s[56:59], s46 offen offset:3072 lds
m16 v[132:135],a[180:183],v[88:91],v[132:135]
m16 v[164:167],a[180:183],v[92:95],v[164:167]
m16 v[136:139],a[184:187],v[88:91],v[136:139]
m16 v[168:171],a[184:187],v[92:95],v[168:171]
m16 v[140:143],a[188:191],v[88:91],v[140:143]
m16 v[172:175],a[188:191],v[92:95],v[172:175]
s_waitcnt lgkmcnt(0)
m16 v[112:115],a[224:227],v[96:99],v[112:115]
rtr a[192:193],v10,50688
rtr a[194:195],v10,51712
m16 v[144:147],a[224:227],v[100:103],v[144:147]
v_add_u32 v210, 0x60000, v210
rtr a[196:197],v10,50696
m16 v[116:119],a[228:231],v[96:99],v[116:119]
buffer_load_dwordx4 a[148:151], v211, s[24:27], 0 offen offset:1024 sc1
rtr a[198:199],v10,51720
m16 v[148:151],a[228:231],v[100:103],v[148:151]
rtr a[200:201],v10,50944
m16 v[120:123],a[232:235],v[96:99],v[120:123]
rtr a[202:203],v10,51968
rtr a[204:205],v10,50952
m16 v[152:155],a[232:235],v[100:103],v[152:155]
rtr a[206:207],v10,51976
s_add_u32 m0, s70, 33792
m16 v[124:127],a[236:239],v[96:99],v[124:127]
rtr a[208:209],v10,51200
buffer_load_dwordx4 a[152:155], v211, s[24:27], s47 offen offset:0 sc1
m16 v[156:159],a[236:239],v[100:103],v[156:159]
rtr a[210:211],v10,52224
m16 v[128:131],a[240:243],v[96:99],v[128:131]
rtr a[212:213],v10,51208
rtr a[214:215],v10,52232
m16 v[160:163],a[240:243],v[100:103],v[160:163]
rtr a[216:217],v10,51456
m16 v[132:135],a[244:247],v[96:99],v[132:135]
rtr a[218:219],v10,52480
buffer_load_dwordx4 v210, s[56:59], 0 offen offset:0 lds
m16 v[164:167],a[244:247],v[100:103],v[164:167]
rtr a[220:221],v10,51464
m16 v[136:139],a[248:251],v[96:99],v[136:139]
rtr a[222:223],v10,52488
buffer_load_dwordx4 a[156:159], v211, s[24:27], s47 offen offset:1024 sc1
m16 v[168:171],a[248:251],v[100:103],v[168:171]
rtr a[160:161],v10,54784
rtr a[162:163],v10,55808
m16 v[140:143],a[252:255],v[96:99],v[140:143]
rtr a[164:165],v10,54792
m16 v[172:175],a[252:255],v[100:103],v[172:175]
rtr a[166:167],v10,55816
buffer_load_dwordx4 v210, s[56:59], s44 offen offset:1024 lds
m16 v[112:115],a[0:3],v[104:107],v[112:115]
rtr a[168:169],v10,55040
m16 v[144:147],a[0:3],v[108:111],v[144:147]
rtr a[170:171],v10,56064
rtr a[172:173],v10,55048
m16 v[116:119],a[4:7],v[104:107],v[116:119]
rtr a[174:175],v10,56072
v_add_u32 v211, 0x10800, v211
buffer_load_dwordx4 a[32:35], v211, s[24:27], 0 offen offset:0 sc1
m16 v[148:151],a[4:7],v[108:111],v[148:151]
rtr a[176:177],v10,55296
m16 v[120:123],a[8:11],v[104:107],v[120:123]
rtr a[178:179],v10,56320
buffer_load_dwordx4 v210, s[56:59], s45 offen offset:2048 lds
m16 v[152:155],a[8:11],v[108:111],v[152:155]
rtr a[180:181],v10,55304
rtr a[182:183],v10,56328
m16 v[124:127],a[12:15],v[104:107],v[124:127]
rtr a[184:185],v10,55552
m16 v[156:159],a[12:15],v[108:111],v[156:159]
rtr a[186:187],v10,56576
m16 v[128:131],a[16:19],v[104:107],v[128:131]
rtr a[188:189],v10,55560
buffer_load_dwordx4 a[36:39], v211, s[24:27], 0 offen offset:1024 sc1
m16 v[160:163],a[16:19],v[108:111],v[160:163]
rtr a[190:191],v10,56584
buffer_load_dwordx4 v210, s[56:59], s46 offen offset:3072 lds
m16 v[132:135],a[20:23],v[104:107],v[132:135]
m16 v[164:167],a[20:23],v[108:111],v[164:167]
m16 v[136:139],a[24:27],v[104:107],v[136:139]
m16 v[168:171],a[24:27],v[108:111],v[168:171]
m16 v[140:143],a[28:31],v[104:107],v[140:143]
m16 v[172:175],a[28:31],v[108:111],v[172:175]
s_waitcnt lgkmcnt(0)
s_barrier
m16 v[112:115],a[192:195],a[96:99],v[112:115]
rtr a[224:225],v11,33792
rtr a[226:227],v11,34816
m16 v[144:147],a[192:195],a[100:103],v[144:147]
v_add_u32 v210, 0x20000, v210
rtr a[228:229],v11,33800
m16 v[116:119],a[196:199],a[96:99],v[116:119]
buffer_load_dwordx4 a[40:43], v211, s[24:27], s47 offen offset:0 sc1
rtr a[230:231],v11,34824
m16 v[148:151],a[196:199],a[100:103],v[148:151]
rtr a[232:233],v11,34048
m16 v[120:123],a[200:203],a[96:99],v[120:123]
rtr a[234:235],v11,35072
rtr a[236:237],v11,34056
m16 v[152:155],a[200:203],a[100:103],v[152:155]
rtr a[238:239],v11,35080
s_add_u32 m0, s70, 16896
m16 v[124:127],a[204:207],a[96:99],v[124:127]
rtr a[240:241],v11,34304
buffer_load_dwordx4 a[44:47], v211, s[24:27], s47 offen offset:1024 sc1
m16 v[156:159],a[204:207],a[100:103],v[156:159]
rtr a[242:243],v11,35328
m16 v[128:131],a[208:211],a[96:99],v[128:131]
rtr a[244:245],v11,34312
rtr a[246:247],v11,35336
m16 v[160:163],a[208:211],a[100:103],v[160:163]
rtr a[248:249],v11,34560
m16 v[132:135],a[212:215],a[96:99],v[132:135]
rtr a[250:251],v11,35584
buffer_load_dwordx4 v210, s[56:59], 0 offen offset:0 lds
m16 v[164:167],a[212:215],a[100:103],v[164:167]
rtr a[252:253],v11,34568
m16 v[136:139],a[216:219],a[96:99],v[136:139]
rtr a[254:255],v11,35592
v_add_u32 v211, 0x5800, v211
buffer_load_dwordx4 a[48:51], v211, s[24:27], 0 offen offset:0 sc1
m16 v[168:171],a[216:219],a[100:103],v[168:171]
rtr a[0:1],v11,37888
rtr a[2:3],v11,38912
m16 v[140:143],a[220:223],a[96:99],v[140:143]
rtr a[4:5],v11,37896
m16 v[172:175],a[220:223],a[100:103],v[172:175]
rtr a[6:7],v11,38920
buffer_load_dwordx4 v210, s[56:59], s44 offen offset:1024 lds
m16 v[112:115],a[160:163],a[104:107],v[112:115]
rtr a[8:9],v11,38144
m16 v[144:147],a[160:163],a[108:111],v[144:147]
rtr a[10:11],v11,39168
rtr a[12:13],v11,38152
m16 v[116:119],a[164:167],a[104:107],v[116:119]
rtr a[14:15],v11,39176
buffer_load_dwordx4 a[52:55], v211, s[24:27], 0 offen offset:1024 sc1
m16 v[148:151],a[164:167],a[108:111],v[148:151]
rtr a[16:17],v11,38400
m16 v[120:123],a[168:171],a[104:107],v[120:123]
rtr a[18:19],v11,39424
buffer_load_dwordx4 v210, s[56:59], s45 offen offset:2048 lds
m16 v[152:155],a[168:171],a[108:111],v[152:155]
rtr a[20:21],v11,38408
rtr a[22:23],v11,39432
m16 v[124:127],a[172:175],a[104:107],v[124:127]
rtr a[24:25],v11,38656
m16 v[156:159],a[172:175],a[108:111],v[156:159]
rtr a[26:27],v11,39680
m16 v[128:131],a[176:179],a[104:107],v[128:131]
rtr a[28:29],v11,38664
buffer_load_dwordx4 a[56:59], v211, s[24:27], s47 offen offset:0 sc1
m16 v[160:163],a[176:179],a[108:111],v[160:163]
rtr a[30:31],v11,39688
buffer_load_dwordx4 v210, s[56:59], s46 offen offset:3072 lds
m16 v[132:135],a[180:183],a[104:107],v[132:135]
m16 v[164:167],a[180:183],a[108:111],v[164:167]
m16 v[136:139],a[184:187],a[104:107],v[136:139]
m16 v[168:171],a[184:187],a[108:111],v[168:171]
m16 v[140:143],a[188:191],a[104:107],v[140:143]
m16 v[172:175],a[188:191],a[108:111],v[172:175]
s_waitcnt lgkmcnt(0)
m16 v[112:115],a[224:227],a[112:115],v[112:115]
rtr a[192:193],v11,16896
rtr a[194:195],v11,17920
m16 v[144:147],a[224:227],a[116:119],v[144:147]
v_add_u32 v210, 0x60000, v210
rtr a[196:197],v11,16904
m16 v[116:119],a[228:231],a[112:115],v[116:119]
buffer_load_dwordx4 a[60:63], v211, s[24:27], s47 offen offset:1024 sc1
rtr a[198:199],v11,17928
m16 v[148:151],a[228:231],a[116:119],v[148:151]
rtr a[200:201],v11,17152
m16 v[120:123],a[232:235],a[112:115],v[120:123]
rtr a[202:203],v11,18176
rtr a[204:205],v11,17160
m16 v[152:155],a[232:235],a[116:119],v[152:155]
rtr a[206:207],v11,18184
s_add_u32 m0, s70, 67584
m16 v[124:127],a[236:239],a[112:115],v[124:127]
rtr a[208:209],v11,17408
v_add_u32 v211, 0x10800, v211
buffer_load_dwordx4 a[64:67], v211, s[24:27], 0 offen offset:0 sc1
m16 v[156:159],a[236:239],a[116:119],v[156:159]
rtr a[210:211],v11,18432
m16 v[128:131],a[240:243],a[112:115],v[128:131]
rtr a[212:213],v11,17416
rtr a[214:215],v11,18440
m16 v[160:163],a[240:243],a[116:119],v[160:163]
rtr a[216:217],v11,17664
m16 v[132:135],a[244:247],a[112:115],v[132:135]
rtr a[218:219],v11,18688
buffer_load_dwordx4 v210, s[56:59], 0 offen offset:0 lds
m16 v[164:167],a[244:247],a[116:119],v[164:167]
rtr a[220:221],v11,17672
m16 v[136:139],a[248:251],a[112:115],v[136:139]
rtr a[222:223],v11,18696
buffer_load_dwordx4 a[68:71], v211, s[24:27], 0 offen offset:1024 sc1
m16 v[168:171],a[248:251],a[116:119],v[168:171]
rtr a[160:161],v11,20992
rtr a[162:163],v11,22016
m16 v[140:143],a[252:255],a[112:115],v[140:143]
rtr a[164:165],v11,21000
m16 v[172:175],a[252:255],a[116:119],v[172:175]
rtr a[166:167],v11,22024
buffer_load_dwordx4 v210, s[56:59], s44 offen offset:1024 lds
m16 v[112:115],a[0:3],a[120:123],v[112:115]
rtr a[168:169],v11,21248
m16 v[144:147],a[0:3],a[124:127],v[144:147]
rtr a[170:171],v11,22272
rtr a[172:173],v11,21256
m16 v[116:119],a[4:7],a[120:123],v[116:119]
rtr a[174:175],v11,22280
buffer_load_dwordx4 a[72:75], v211, s[24:27], s47 offen offset:0 sc1
m16 v[148:151],a[4:7],a[124:127],v[148:151]
rtr a[176:177],v11,21504
m16 v[120:123],a[8:11],a[120:123],v[120:123]
rtr a[178:179],v11,22528
buffer_load_dwordx4 v210, s[56:59], s45 offen offset:2048 lds
m16 v[152:155],a[8:11],a[124:127],v[152:155]
rtr a[180:181],v11,21512
rtr a[182:183],v11,22536
m16 v[124:127],a[12:15],a[120:123],v[124:127]
rtr a[184:185],v11,21760
m16 v[156:159],a[12:15],a[124:127],v[156:159]
rtr a[186:187],v11,22784
m16 v[128:131],a[16:19],a[120:123],v[128:131]
rtr a[188:189],v11,21768
buffer_load_dwordx4 a[76:79], v211, s[24:27], s47 offen offset:1024 sc1
m16 v[160:163],a[16:19],a[124:127],v[160:163]
rtr a[190:191],v11,22792
buffer_load_dwordx4 v210, s[56:59], s46 offen offset:3072 lds
m16 v[132:135],a[20:23],a[120:123],v[132:135]
m16 v[164:167],a[20:23],a[124:127],v[164:167]
m16 v[136:139],a[24:27],a[120:123],v[136:139]
m16 v[168:171],a[24:27],a[124:127],v[168:171]
m16 v[140:143],a[28:31],a[120:123],v[140:143]
m16 v[172:175],a[28:31],a[124:127],v[172:175]
s_waitcnt vmcnt(30) lgkmcnt(0)
s_barrier
m16 v[112:115],a[192:195],a[128:131],v[112:115]
rtr a[224:225],v11,50688
rtr a[226:227],v11,51712
m16 v[144:147],a[192:195],a[132:135],v[144:147]
v_add_u32 v210, 0x20000, v210
rtr a[228:229],v11,50696
m16 v[116:119],a[196:199],a[128:131],v[116:119]
v_add_u32 v211, 0x5800, v211
buffer_load_dwordx4 a[80:83], v211, s[24:27], 0 offen offset:0 sc1
rtr a[230:231],v11,51720
m16 v[148:151],a[196:199],a[132:135],v[148:151]
rtr a[232:233],v11,50944
m16 v[120:123],a[200:203],a[128:131],v[120:123]
rtr a[234:235],v11,51968
rtr a[236:237],v11,50952
m16 v[152:155],a[200:203],a[132:135],v[152:155]
rtr a[238:239],v11,51976
s_add_u32 m0, s70, 50688
m16 v[124:127],a[204:207],a[128:131],v[124:127]
rtr a[240:241],v11,51200
buffer_load_dwordx4 a[84:87], v211, s[24:27], 0 offen offset:1024 sc1
m16 v[156:159],a[204:207],a[132:135],v[156:159]
rtr a[242:243],v11,52224
m16 v[128:131],a[208:211],a[128:131],v[128:131]
rtr a[244:245],v11,51208
rtr a[246:247],v11,52232
m16 v[160:163],a[208:211],a[132:135],v[160:163]
rtr a[248:249],v11,51456
m16 v[132:135],a[212:215],a[128:131],v[132:135]
rtr a[250:251],v11,52480
buffer_load_dwordx4 v210, s[56:59], 0 offen offset:0 lds
m16 v[164:167],a[212:215],a[132:135],v[164:167]
rtr a[252:253],v11,51464
m16 v[136:139],a[216:219],a[128:131],v[136:139]
rtr a[254:255],v11,52488
buffer_load_dwordx4 a[88:91], v211, s[24:27], s47 offen offset:0 sc1
m16 v[168:171],a[216:219],a[132:135],v[168:171]
rtr a[0:1],v11,54784
rtr a[2:3],v11,55808
m16 v[140:143],a[220:223],a[128:131],v[140:143]
rtr a[4:5],v11,54792
m16 v[172:175],a[220:223],a[132:135],v[172:175]
rtr a[6:7],v11,55816
buffer_load_dwordx4 v210, s[56:59], s44 offen offset:1024 lds
m16 v[112:115],a[160:163],a[136:139],v[112:115]
rtr a[8:9],v11,55040
m16 v[144:147],a[160:163],a[140:143],v[144:147]
rtr a[10:11],v11,56064
rtr a[12:13],v11,55048
m16 v[116:119],a[164:167],a[136:139],v[116:119]
rtr a[14:15],v11,56072
buffer_load_dwordx4 a[92:95], v211, s[24:27], s47 offen offset:1024 sc1
m16 v[148:151],a[164:167],a[140:143],v[148:151]
rtr a[16:17],v11,55296
m16 v[120:123],a[168:171],a[136:139],v[120:123]
rtr a[18:19],v11,56320
buffer_load_dwordx4 v210, s[56:59], s45 offen offset:2048 lds
m16 v[152:155],a[168:171],a[140:143],v[152:155]
rtr a[20:21],v11,55304
rtr a[22:23],v11,56328
m16 v[124:127],a[172:175],a[136:139],v[124:127]
rtr a[24:25],v11,55552
m16 v[156:159],a[172:175],a[140:143],v[156:159]
rtr a[26:27],v11,56576
m16 v[128:131],a[176:179],a[136:139],v[128:131]
rtr a[28:29],v11,55560
v_add_u32 v211, 0x10800, v211
buffer_load_dwordx4 v[16:19], v211, s[24:27], 0 offen offset:0 sc1
m16 v[160:163],a[176:179],a[140:143],v[160:163]
rtr a[30:31],v11,56584
buffer_load_dwordx4 v210, s[56:59], s46 offen offset:3072 lds
m16 v[132:135],a[180:183],a[136:139],v[132:135]
m16 v[164:167],a[180:183],a[140:143],v[164:167]
m16 v[136:139],a[184:187],a[136:139],v[136:139]
m16 v[168:171],a[184:187],a[140:143],v[168:171]
m16 v[140:143],a[188:191],a[136:139],v[140:143]
m16 v[172:175],a[188:191],a[140:143],v[172:175]
s_waitcnt vmcnt(32) lgkmcnt(0)
m16 v[112:115],a[224:227],a[144:147],v[112:115]
rtr a[192:193],v12,0
rtr a[194:195],v12,1024
m16 v[144:147],a[224:227],a[148:151],v[144:147]
v_add_u32 v210, 0x60000, v210
rtr a[196:197],v12,8
m16 v[116:119],a[228:231],a[144:147],v[116:119]
buffer_load_dwordx4 v[20:23], v211, s[24:27], 0 offen offset:1024 sc1
rtr a[198:199],v12,1032
m16 v[148:151],a[228:231],a[148:151],v[148:151]
rtr a[200:201],v12,256
m16 v[120:123],a[232:235],a[144:147],v[120:123]
rtr a[202:203],v12,1280
rtr a[204:205],v12,264
m16 v[152:155],a[232:235],a[148:151],v[152:155]
rtr a[206:207],v12,1288
s_add_u32 m0, s70, 101376
m16 v[124:127],a[236:239],a[144:147],v[124:127]
rtr a[208:209],v12,512
buffer_load_dwordx4 v[24:27], v211, s[24:27], s47 offen offset:0 sc1
m16 v[156:159],a[236:239],a[148:151],v[156:159]
rtr a[210:211],v12,1536
m16 v[128:131],a[240:243],a[144:147],v[128:131]
rtr a[212:213],v12,520
rtr a[214:215],v12,1544
m16 v[160:163],a[240:243],a[148:151],v[160:163]
rtr a[216:217],v12,768
m16 v[132:135],a[244:247],a[144:147],v[132:135]
rtr a[218:219],v12,1792
buffer_load_dwordx4 v210, s[56:59], 0 offen offset:0 lds
m16 v[164:167],a[244:247],a[148:151],v[164:167]
rtr a[220:221],v12,776
m16 v[136:139],a[248:251],a[144:147],v[136:139]
rtr a[222:223],v12,1800
buffer_load_dwordx4 v[28:31], v211, s[24:27], s47 offen offset:1024 sc1
m16 v[168:171],a[248:251],a[148:151],v[168:171]
rtr a[160:161],v12,4096
rtr a[162:163],v12,5120
m16 v[140:143],a[252:255],a[144:147],v[140:143]
rtr a[164:165],v12,4104
m16 v[172:175],a[252:255],a[148:151],v[172:175]
rtr a[166:167],v12,5128
buffer_load_dwordx4 v210, s[56:59], s44 offen offset:1024 lds
m16 v[112:115],a[0:3],a[152:155],v[112:115]
rtr a[168:169],v12,4352
m16 v[144:147],a[0:3],a[156:159],v[144:147]
rtr a[170:171],v12,5376
rtr a[172:173],v12,4360
m16 v[116:119],a[4:7],a[152:155],v[116:119]
rtr a[174:175],v12,5384
v_add_u32 v211, 0x5800, v211
buffer_load_dwordx4 v[32:35], v211, s[24:27], 0 offen offset:0 sc1
m16 v[148:151],a[4:7],a[156:159],v[148:151]
rtr a[176:177],v12,4608
m16 v[120:123],a[8:11],a[152:155],v[120:123]
rtr a[178:179],v12,5632
buffer_load_dwordx4 v210, s[56:59], s45 offen offset:2048 lds
m16 v[152:155],a[8:11],a[156:159],v[152:155]
rtr a[180:181],v12,4616
rtr a[182:183],v12,5640
m16 v[124:127],a[12:15],a[152:155],v[124:127]
rtr a[184:185],v12,4864
m16 v[156:159],a[12:15],a[156:159],v[156:159]
rtr a[186:187],v12,5888
m16 v[128:131],a[16:19],a[152:155],v[128:131]
rtr a[188:189],v12,4872
buffer_load_dwordx4 v[36:39], v211, s[24:27], 0 offen offset:1024 sc1
m16 v[160:163],a[16:19],a[156:159],v[160:163]
rtr a[190:191],v12,5896
buffer_load_dwordx4 v210, s[56:59], s46 offen offset:3072 lds
m16 v[132:135],a[20:23],a[152:155],v[132:135]
m16 v[164:167],a[20:23],a[156:159],v[164:167]
m16 v[136:139],a[24:27],a[152:155],v[136:139]
m16 v[168:171],a[24:27],a[156:159],v[168:171]
m16 v[140:143],a[28:31],a[152:155],v[140:143]
m16 v[172:175],a[28:31],a[156:159],v[172:175]
s_waitcnt vmcnt(34) lgkmcnt(0)
s_barrier
m16 v[112:115],a[192:195],a[32:35],v[112:115]
rtr a[224:225],v10,0
rtr a[226:227],v10,1024
m16 v[144:147],a[192:195],a[36:39],v[144:147]
v_add_u32 v210, 0x20000, v210
rtr a[228:229],v10,8
m16 v[116:119],a[196:199],a[32:35],v[116:119]
buffer_load_dwordx4 v[40:43], v211, s[24:27], s47 offen offset:0 sc1
rtr a[230:231],v10,1032
m16 v[148:151],a[196:199],a[36:39],v[148:151]
rtr a[232:233],v10,256
m16 v[120:123],a[200:203],a[32:35],v[120:123]
rtr a[234:235],v10,1280
rtr a[236:237],v10,264
m16 v[152:155],a[200:203],a[36:39],v[152:155]
rtr a[238:239],v10,1288
s_add_u32 m0, s70, 84480
m16 v[124:127],a[204:207],a[32:35],v[124:127]
rtr a[240:241],v10,512
buffer_load_dwordx4 v[44:47], v211, s[24:27], s47 offen offset:1024 sc1
m16 v[156:159],a[204:207],a[36:39],v[156:159]
rtr a[242:243],v10,1536
m16 v[128:131],a[208:211],a[32:35],v[128:131]
rtr a[244:245],v10,520
rtr a[246:247],v10,1544
m16 v[160:163],a[208:211],a[36:39],v[160:163]
rtr a[248:249],v10,768
m16 v[132:135],a[212:215],a[32:35],v[132:135]
rtr a[250:251],v10,1792
buffer_load_dwordx4 v210, s[56:59], 0 offen offset:0 lds
m16 v[164:167],a[212:215],a[36:39],v[164:167]
rtr a[252:253],v10,776
m16 v[136:139],a[216:219],a[32:35],v[136:139]
rtr a[254:255],v10,1800
v_add_u32 v211, 0x10800, v211
buffer_load_dwordx4 v[48:51], v211, s[24:27], 0 offen offset:0 sc1
m16 v[168:171],a[216:219],a[36:39],v[168:171]
rtr a[0:1],v10,4096
rtr a[2:3],v10,5120
m16 v[140:143],a[220:223],a[32:35],v[140:143]
rtr a[4:5],v10,4104
m16 v[172:175],a[220:223],a[36:39],v[172:175]
rtr a[6:7],v10,5128
buffer_load_dwordx4 v210, s[56:59], s44 offen offset:1024 lds
m16 v[112:115],a[160:163],a[40:43],v[112:115]
rtr a[8:9],v10,4352
m16 v[144:147],a[160:163],a[44:47],v[144:147]
rtr a[10:11],v10,5376
rtr a[12:13],v10,4360
m16 v[116:119],a[164:167],a[40:43],v[116:119]
rtr a[14:15],v10,5384
buffer_load_dwordx4 v[52:55], v211, s[24:27], 0 offen offset:1024 sc1
m16 v[148:151],a[164:167],a[44:47],v[148:151]
rtr a[16:17],v10,4608
m16 v[120:123],a[168:171],a[40:43],v[120:123]
rtr a[18:19],v10,5632
buffer_load_dwordx4 v210, s[56:59], s45 offen offset:2048 lds
m16 v[152:155],a[168:171],a[44:47],v[152:155]
rtr a[20:21],v10,4616
rtr a[22:23],v10,5640
m16 v[124:127],a[172:175],a[40:43],v[124:127]
rtr a[24:25],v10,4864
m16 v[156:159],a[172:175],a[44:47],v[156:159]
rtr a[26:27],v10,5888
m16 v[128:131],a[176:179],a[40:43],v[128:131]
rtr a[28:29],v10,4872
buffer_load_dwordx4 v[56:59], v211, s[24:27], s47 offen offset:0 sc1
m16 v[160:163],a[176:179],a[44:47],v[160:163]
rtr a[30:31],v10,5896
buffer_load_dwordx4 v210, s[56:59], s46 offen offset:3072 lds
m16 v[132:135],a[180:183],a[40:43],v[132:135]
m16 v[164:167],a[180:183],a[44:47],v[164:167]
m16 v[136:139],a[184:187],a[40:43],v[136:139]
m16 v[168:171],a[184:187],a[44:47],v[168:171]
m16 v[140:143],a[188:191],a[40:43],v[140:143]
m16 v[172:175],a[188:191],a[44:47],v[172:175]
s_waitcnt vmcnt(35) lgkmcnt(0)
m16 v[112:115],a[224:227],a[48:51],v[112:115]
rtr a[192:193],v10,33792
rtr a[194:195],v10,34816
m16 v[144:147],a[224:227],a[52:55],v[144:147]
v_add_u32 v210, 2883584, v8
rtr a[196:197],v10,33800
m16 v[116:119],a[228:231],a[48:51],v[116:119]
buffer_load_dwordx4 v[60:63], v211, s[24:27], s47 offen offset:1024 sc1
rtr a[198:199],v10,34824
m16 v[148:151],a[228:231],a[52:55],v[148:151]
rtr a[200:201],v10,34048
m16 v[120:123],a[232:235],a[48:51],v[120:123]
rtr a[202:203],v10,35072
rtr a[204:205],v10,34056
m16 v[152:155],a[232:235],a[52:55],v[152:155]
rtr a[206:207],v10,35080
s_add_u32 m0, s70, 118272
m16 v[124:127],a[236:239],a[48:51],v[124:127]
rtr a[208:209],v10,34304
v_add_u32 v211, 0x5800, v211
buffer_load_dwordx4 v[64:67], v211, s[24:27], 0 offen offset:0 sc1
m16 v[156:159],a[236:239],a[52:55],v[156:159]
rtr a[210:211],v10,35328
m16 v[128:131],a[240:243],a[48:51],v[128:131]
rtr a[212:213],v10,34312
rtr a[214:215],v10,35336
m16 v[160:163],a[240:243],a[52:55],v[160:163]
rtr a[216:217],v10,34560
m16 v[132:135],a[244:247],a[48:51],v[132:135]
rtr a[218:219],v10,35584
buffer_load_dwordx4 v210, s[56:59], 0 offen offset:0 lds
m16 v[164:167],a[244:247],a[52:55],v[164:167]
rtr a[220:221],v10,34568
m16 v[136:139],a[248:251],a[48:51],v[136:139]
rtr a[222:223],v10,35592
buffer_load_dwordx4 v[68:71], v211, s[24:27], 0 offen offset:1024 sc1
m16 v[168:171],a[248:251],a[52:55],v[168:171]
rtr a[160:161],v10,37888
rtr a[162:163],v10,38912
m16 v[140:143],a[252:255],a[48:51],v[140:143]
rtr a[164:165],v10,37896
m16 v[172:175],a[252:255],a[52:55],v[172:175]
rtr a[166:167],v10,38920
buffer_load_dwordx4 v210, s[56:59], s44 offen offset:1024 lds
m16 v[112:115],a[0:3],a[56:59],v[112:115]
rtr a[168:169],v10,38144
m16 v[144:147],a[0:3],a[60:63],v[144:147]
rtr a[170:171],v10,39168
rtr a[172:173],v10,38152
m16 v[116:119],a[4:7],a[56:59],v[116:119]
rtr a[174:175],v10,39176
buffer_load_dwordx4 v[72:75], v211, s[24:27], s47 offen offset:0 sc1
m16 v[148:151],a[4:7],a[60:63],v[148:151]
rtr a[176:177],v10,38400
m16 v[120:123],a[8:11],a[56:59],v[120:123]
rtr a[178:179],v10,39424
buffer_load_dwordx4 v210, s[56:59], s45 offen offset:2048 lds
m16 v[152:155],a[8:11],a[60:63],v[152:155]
rtr a[180:181],v10,38408
rtr a[182:183],v10,39432
m16 v[124:127],a[12:15],a[56:59],v[124:127]
rtr a[184:185],v10,38656
m16 v[156:159],a[12:15],a[60:63],v[156:159]
rtr a[186:187],v10,39680
m16 v[128:131],a[16:19],a[56:59],v[128:131]
rtr a[188:189],v10,38664
buffer_load_dwordx4 v[76:79], v211, s[24:27], s47 offen offset:1024 sc1
m16 v[160:163],a[16:19],a[60:63],v[160:163]
rtr a[190:191],v10,39688
buffer_load_dwordx4 v210, s[56:59], s46 offen offset:3072 lds
m16 v[132:135],a[20:23],a[56:59],v[132:135]
m16 v[164:167],a[20:23],a[60:63],v[164:167]
m16 v[136:139],a[24:27],a[56:59],v[136:139]
m16 v[168:171],a[24:27],a[60:63],v[168:171]
m16 v[140:143],a[28:31],a[56:59],v[140:143]
m16 v[172:175],a[28:31],a[60:63],v[172:175]
s_waitcnt vmcnt(36) lgkmcnt(0)
s_barrier
m16 v[112:115],a[192:195],a[64:67],v[112:115]
rtr a[224:225],v10,16896
rtr a[226:227],v10,17920
v_add_u32 v210, 0x80000, v210
m16 v[144:147],a[192:195],a[68:71],v[144:147]
rtr a[228:229],v10,16904
v_add_u32 v211, 495616, v7
buffer_load_dwordx4 v[80:83], v211, s[24:27], 0 offen offset:0 sc1
v_lshlrev_b32 v1, 4, v0
m16 v[116:119],a[196:199],a[64:67],v[116:119]
rtr a[230:231],v10,17928
s_mul_i32 s28, s36, 6144
v_add_u32 v1, s28, v1
m16 v[148:151],a[196:199],a[68:71],v[148:151]
rtr a[232:233],v10,17152
s_xor_b32 s29, s3, 1
s_mul_i32 s29, s29, 22528
m16 v[120:123],a[200:203],a[64:67],v[120:123]
rtr a[234:235],v10,18176
rtr a[236:237],v10,17160
v_add_u32 v2, s29, v1
m16 v[152:155],a[200:203],a[68:71],v[152:155]
rtr a[238:239],v10,18184
s_add_u32 m0, s70, 147424
s_mul_i32 s29, s3, 22528
m16 v[124:127],a[204:207],a[64:67],v[124:127]
rtr a[240:241],v10,17408
buffer_load_dwordx4 v[84:87], v211, s[24:27], 0 offen offset:1024 sc1
v_add_u32 v1, s29, v1
m16 v[156:159],a[204:207],a[68:71],v[156:159]
rtr a[242:243],v10,18432
v_and_b32 v14, 15, v0
v_mul_u32_u24 v14, 144, v14
m16 v[128:131],a[208:211],a[64:67],v[128:131]
rtr a[244:245],v10,17416
rtr a[246:247],v10,18440
v_lshrrev_b32 v4, 4, v0
m16 v[160:163],a[208:211],a[68:71],v[160:163]
rtr a[248:249],v10,17664
v_lshl_add_u32 v14, v4, 4, v14
s_add_u32 s29, s28, 118272
m16 v[132:135],a[212:215],a[64:67],v[132:135]
rtr a[250:251],v10,18688
buffer_load_dwordx4 v210, s[56:59], 0 offen offset:0 lds
s_lshl_b32 s60, s36, 10
m16 v[164:167],a[212:215],a[68:71],v[164:167]
rtr a[252:253],v10,17672
s_add_u32 s29, s29, s60
v_add_u32 v14, s29, v14
m16 v[136:139],a[216:219],a[64:67],v[136:139]
rtr a[254:255],v10,18696
buffer_load_dwordx4 v[88:91], v211, s[24:27], s47 offen offset:0 sc1
v_lshrrev_b32 v4, 3, v0
m16 v[168:171],a[216:219],a[68:71],v[168:171]
rtr a[0:1],v10,20992
rtr a[2:3],v10,22016
v_and_b32 v3, 7, v0
m16 v[140:143],a[220:223],a[64:67],v[140:143]
rtr a[4:5],v10,21000
v_lshlrev_b32 v3, 4, v3
v_mul_u32_u24 v15, 144, v4
m16 v[172:175],a[220:223],a[68:71],v[172:175]
rtr a[6:7],v10,22024
buffer_load_dwordx4 v210, s[56:59], s44 offen offset:1024 lds
v_add3_u32 v15, v15, v3, s29
m16 v[112:115],a[160:163],a[72:75],v[112:115]
rtr a[8:9],v10,21248
v_lshl_add_u32 v3, v4, 12, v3
s_mov_b32 s66, 32768
m16 v[144:147],a[160:163],a[76:79],v[144:147]
rtr a[10:11],v10,22272
rtr a[12:13],v10,21256
s_mov_b32 s67, 98304
m16 v[116:119],a[164:167],a[72:75],v[116:119]
rtr a[14:15],v10,22280
buffer_load_dwordx4 v[92:95], v211, s[24:27], s47 offen offset:1024 sc1
s_mov_b32 s68, 163840
m16 v[148:151],a[164:167],a[76:79],v[148:151]
rtr a[16:17],v10,21504
s_mul_i32 s28, s37, 720896
s_lshl_b32 s29, s31, 11
m16 v[120:123],a[168:171],a[72:75],v[120:123]
rtr a[18:19],v10,22528
buffer_load_dwordx4 v210, s[56:59], s45 offen offset:2048 lds
s_add_u32 s28, s28, s29
m16 v[152:155],a[168:171],a[76:79],v[152:155]
rtr a[20:21],v10,21512
rtr a[22:23],v10,22536
s_lshl_b32 s29, s38, 8
m16 v[124:127],a[172:175],a[72:75],v[124:127]
rtr a[24:25],v10,21760
s_add_u32 s28, s28, s29
s_lshl_b32 s29, s3, 7
m16 v[156:159],a[172:175],a[76:79],v[156:159]
rtr a[26:27],v10,22784
s_add_u32 s28, s28, s29
s_mul_i32 s29, s36, 196608
m16 v[128:131],a[176:179],a[72:75],v[128:131]
rtr a[28:29],v10,21768
buffer_load_dwordx4 v[96:99], v211, s[24:27], s4 offen offset:0 sc1
s_add_u32 s28, s28, s29
m16 v[160:163],a[176:179],a[76:79],v[160:163]
rtr a[30:31],v10,22792
buffer_load_dwordx4 v210, s[56:59], s46 offen offset:3072 lds
v_add_u32 v3, s28, v3
m16 v[132:135],a[180:183],a[72:75],v[132:135]
s_mul_i32 s61, s38, 45056
s_add_u32 s61, s61, 1572864
v_add_u32 v1, s61, v1
m16 v[164:167],a[180:183],a[76:79],v[164:167]
v_add_u32 v2, s61, v2
s_mov_b32 s60, 1966080
s_lshl_b32 s61, s38, 1
m16 v[136:139],a[184:187],a[72:75],v[136:139]
s_add_u32 s61, s61, s3
s_lshl_b32 s61, s61, 2
s_add_u32 s61, s61, s36
m16 v[168:171],a[184:187],a[76:79],v[168:171]
s_lshl_b32 s61, s61, 7
s_add_u32 s60, s60, s61
v_mov_b32 v9, s60
m16 v[140:143],a[188:191],a[72:75],v[140:143]
s_xor_b32 s60, s60, 512
v_mov_b32 v4, s60
v_mov_b32 v5, 1
m16 v[172:175],a[188:191],a[76:79],v[172:175]
s_mov_b32 s62, 2048
s_mov_b32 s63, 4096
s_mov_b32 s64, 65536
s_mov_b32 s65, 131072
s_waitcnt vmcnt(39) lgkmcnt(0)
m16 v[112:115],a[224:227],a[80:83],v[112:115]
rtr a[192:193],v11,0
rtr a[194:195],v11,1024
m16 v[144:147],a[224:227],a[84:87],v[144:147]
v_add_u32 v210, 0x80000, v210
rtr a[196:197],v11,8
m16 v[116:119],a[228:231],a[80:83],v[116:119]
buffer_load_dwordx4 v[100:103], v211, s[24:27], s4 offen offset:1024 sc1
rtr a[198:199],v11,1032
m16 v[148:151],a[228:231],a[84:87],v[148:151]
rtr a[200:201],v11,256
m16 v[120:123],a[232:235],a[80:83],v[120:123]
rtr a[202:203],v11,1280
rtr a[204:205],v11,264
m16 v[152:155],a[232:235],a[84:87],v[152:155]
rtr a[206:207],v11,1288
s_add_u32 m0, s70, 0
m16 v[124:127],a[236:239],a[80:83],v[124:127]
rtr a[208:209],v11,512
buffer_load_dwordx4 v[104:107], v211, s[24:27], s5 offen offset:0 sc1
m16 v[156:159],a[236:239],a[84:87],v[156:159]
rtr a[210:211],v11,1536
m16 v[128:131],a[240:243],a[80:83],v[128:131]
rtr a[212:213],v11,520
rtr a[214:215],v11,1544
m16 v[160:163],a[240:243],a[84:87],v[160:163]
rtr a[216:217],v11,768
m16 v[132:135],a[244:247],a[80:83],v[132:135]
rtr a[218:219],v11,1792
buffer_load_dwordx4 v210, s[56:59], 0 offen offset:0 lds
m16 v[164:167],a[244:247],a[84:87],v[164:167]
rtr a[220:221],v11,776
m16 v[136:139],a[248:251],a[80:83],v[136:139]
rtr a[222:223],v11,1800
buffer_load_dwordx4 v[108:111], v211, s[24:27], s5 offen offset:1024 sc1
m16 v[168:171],a[248:251],a[84:87],v[168:171]
rtr a[160:161],v11,4096
rtr a[162:163],v11,5120
m16 v[140:143],a[252:255],a[80:83],v[140:143]
rtr a[164:165],v11,4104
m16 v[172:175],a[252:255],a[84:87],v[172:175]
rtr a[166:167],v11,5128
buffer_load_dwordx4 v210, s[56:59], s44 offen offset:1024 lds
m16 v[112:115],a[0:3],a[88:91],v[112:115]
rtr a[168:169],v11,4352
m16 v[144:147],a[0:3],a[92:95],v[144:147]
rtr a[170:171],v11,5376
rtr a[172:173],v11,4360
m16 v[116:119],a[4:7],a[88:91],v[116:119]
rtr a[174:175],v11,5384
v_add_u32 v211, 0x16000, v211
buffer_load_dwordx4 a[96:99], v211, s[24:27], 0 offen offset:0 sc1
m16 v[148:151],a[4:7],a[92:95],v[148:151]
rtr a[176:177],v11,4608
m16 v[120:123],a[8:11],a[88:91],v[120:123]
rtr a[178:179],v11,5632
buffer_load_dwordx4 v210, s[56:59], s45 offen offset:2048 lds
m16 v[152:155],a[8:11],a[92:95],v[152:155]
rtr a[180:181],v11,4616
rtr a[182:183],v11,5640
m16 v[124:127],a[12:15],a[88:91],v[124:127]
rtr a[184:185],v11,4864
m16 v[156:159],a[12:15],a[92:95],v[156:159]
rtr a[186:187],v11,5888
m16 v[128:131],a[16:19],a[88:91],v[128:131]
rtr a[188:189],v11,4872
buffer_load_dwordx4 a[100:103], v211, s[24:27], 0 offen offset:1024 sc1
m16 v[160:163],a[16:19],a[92:95],v[160:163]
rtr a[190:191],v11,5896
buffer_load_dwordx4 v210, s[56:59], s46 offen offset:3072 lds
m16 v[132:135],a[20:23],a[88:91],v[132:135]
m16 v[164:167],a[20:23],a[92:95],v[164:167]
m16 v[136:139],a[24:27],a[88:91],v[136:139]
m16 v[168:171],a[24:27],a[92:95],v[168:171]
m16 v[140:143],a[28:31],a[88:91],v[140:143]
m16 v[172:175],a[28:31],a[92:95],v[172:175]
s_waitcnt vmcnt(36) lgkmcnt(0)
s_barrier
m16 v[112:115],a[192:195],v[16:19],v[112:115]
rtr a[224:225],v10,50688
rtr a[226:227],v10,51712
m16 v[144:147],a[192:195],v[20:23],v[144:147]
v_add_u32 v210, s6, v210
rtr a[228:229],v10,50696
m16 v[116:119],a[196:199],v[16:19],v[116:119]
buffer_load_dwordx4 a[104:107], v211, s[24:27], s47 offen offset:0 sc1
rtr a[230:231],v10,51720
m16 v[148:151],a[196:199],v[20:23],v[148:151]
rtr a[232:233],v10,50944
m16 v[120:123],a[200:203],v[16:19],v[120:123]
rtr a[234:235],v10,51968
rtr a[236:237],v10,50952
m16 v[152:155],a[200:203],v[20:23],v[152:155]
rtr a[238:239],v10,51976
s_add_u32 m0, s70, 33792
m16 v[124:127],a[204:207],v[16:19],v[124:127]
buffer_load_dwordx4 a[108:111], v211, s[24:27], s47 offen offset:1024 sc1
rtr a[240:241],v10,51200
m16 v[156:159],a[204:207],v[20:23],v[156:159]
rtr a[242:243],v10,52224
m16 v[128:131],a[208:211],v[16:19],v[128:131]
rtr a[244:245],v10,51208
rtr a[246:247],v10,52232
m16 v[160:163],a[208:211],v[20:23],v[160:163]
rtr a[248:249],v10,51456
m16 v[132:135],a[212:215],v[16:19],v[132:135]
rtr a[250:251],v10,52480
buffer_load_dwordx4 v210, s[56:59], 0 offen offset:0 lds
m16 v[164:167],a[212:215],v[20:23],v[164:167]
buffer_load_dwordx4 a[112:115], v211, s[24:27], s4 offen offset:0 sc1
rtr a[252:253],v10,51464
m16 v[136:139],a[216:219],v[16:19],v[136:139]
rtr a[254:255],v10,52488
m16 v[168:171],a[216:219],v[20:23],v[168:171]
rtr a[0:1],v10,54784
rtr a[2:3],v10,55808
m16 v[140:143],a[220:223],v[16:19],v[140:143]
rtr a[4:5],v10,54792
m16 v[172:175],a[220:223],v[20:23],v[172:175]
rtr a[6:7],v10,55816
buffer_load_dwordx4 v210, s[56:59], s44 offen offset:1024 lds
m16 v[112:115],a[160:163],v[24:27],v[112:115]
buffer_load_dwordx4 a[116:119], v211, s[24:27], s4 offen offset:1024 sc1
rtr a[8:9],v10,55040
m16 v[144:147],a[160:163],v[28:31],v[144:147]
rtr a[10:11],v10,56064
rtr a[12:13],v10,55048
m16 v[116:119],a[164:167],v[24:27],v[116:119]
rtr a[14:15],v10,56072
m16 v[148:151],a[164:167],v[28:31],v[148:151]
rtr a[16:17],v10,55296
m16 v[120:123],a[168:171],v[24:27],v[120:123]
rtr a[18:19],v10,56320
buffer_load_dwordx4 v210, s[56:59], s45 offen offset:2048 lds
m16 v[152:155],a[168:171],v[28:31],v[152:155]
buffer_load_dwordx4 a[120:123], v211, s[24:27], s5 offen offset:0 sc1
rtr a[20:21],v10,55304
m16 v[124:127],a[172:175],v[24:27],v[124:127]
rtr a[22:23],v10,56328
rtr a[24:25],v10,55552
m16 v[156:159],a[172:175],v[28:31],v[156:159]
rtr a[26:27],v10,56576
m16 v[128:131],a[176:179],v[24:27],v[128:131]
rtr a[28:29],v10,55560
m16 v[160:163],a[176:179],v[28:31],v[160:163]
rtr a[30:31],v10,56584
buffer_load_dwordx4 v210, s[56:59], s46 offen offset:3072 lds
m16 v[132:135],a[180:183],v[24:27],v[132:135]
buffer_load_dwordx4 a[124:127], v211, s[24:27], s5 offen offset:1024 sc1
m16 v[164:167],a[180:183],v[28:31],v[164:167]
m16 v[136:139],a[184:187],v[24:27],v[136:139]
m16 v[168:171],a[184:187],v[28:31],v[168:171]
m16 v[140:143],a[188:191],v[24:27],v[140:143]
m16 v[172:175],a[188:191],v[28:31],v[172:175]
s_waitcnt vmcnt(44) lgkmcnt(0)
m16 v[112:115],a[224:227],v[32:35],v[112:115]
rtr a[192:193],v11,33792
rtr a[194:195],v11,34816
m16 v[144:147],a[224:227],v[36:39],v[144:147]
v_add_u32 v210, 0x80000, v210
rtr a[196:197],v11,33800
m16 v[116:119],a[228:231],v[32:35],v[116:119]
v_add_u32 v211, 0x16000, v211
buffer_load_dwordx4 a[128:131], v211, s[24:27], 0 offen offset:0 sc1
rtr a[198:199],v11,34824
m16 v[148:151],a[228:231],v[36:39],v[148:151]
rtr a[200:201],v11,34048
m16 v[120:123],a[232:235],v[32:35],v[120:123]
rtr a[202:203],v11,35072
rtr a[204:205],v11,34056
m16 v[152:155],a[232:235],v[36:39],v[152:155]
rtr a[206:207],v11,35080
s_add_u32 m0, s70, 16896
m16 v[124:127],a[236:239],v[32:35],v[124:127]
buffer_load_dwordx4 a[132:135], v211, s[24:27], 0 offen offset:1024 sc1
rtr a[208:209],v11,34304
m16 v[156:159],a[236:239],v[36:39],v[156:159]
rtr a[210:211],v11,35328
m16 v[128:131],a[240:243],v[32:35],v[128:131]
rtr a[212:213],v11,34312
rtr a[214:215],v11,35336
m16 v[160:163],a[240:243],v[36:39],v[160:163]
rtr a[216:217],v11,34560
m16 v[132:135],a[244:247],v[32:35],v[132:135]
rtr a[218:219],v11,35584
buffer_load_dwordx4 v210, s[56:59], 0 offen offset:0 lds
m16 v[164:167],a[244:247],v[36:39],v[164:167]
buffer_load_dwordx4 a[136:139], v211, s[24:27], s47 offen offset:0 sc1
rtr a[220:221],v11,34568
m16 v[136:139],a[248:251],v[32:35],v[136:139]
rtr a[222:223],v11,35592
m16 v[168:171],a[248:251],v[36:39],v[168:171]
rtr a[160:161],v11,37888
rtr a[162:163],v11,38912
m16 v[140:143],a[252:255],v[32:35],v[140:143]
rtr a[164:165],v11,37896
m16 v[172:175],a[252:255],v[36:39],v[172:175]
rtr a[166:167],v11,38920
buffer_load_dwordx4 v210, s[56:59], s44 offen offset:1024 lds
m16 v[112:115],a[0:3],v[40:43],v[112:115]
buffer_load_dwordx4 a[140:143], v211, s[24:27], s47 offen offset:1024 sc1
rtr a[168:169],v11,38144
m16 v[144:147],a[0:3],v[44:47],v[144:147]
rtr a[170:171],v11,39168
rtr a[172:173],v11,38152
m16 v[116:119],a[4:7],v[40:43],v[116:119]
rtr a[174:175],v11,39176
m16 v[148:151],a[4:7],v[44:47],v[148:151]
rtr a[176:177],v11,38400
m16 v[120:123],a[8:11],v[40:43],v[120:123]
rtr a[178:179],v11,39424
buffer_load_dwordx4 v210, s[56:59], s45 offen offset:2048 lds
m16 v[152:155],a[8:11],v[44:47],v[152:155]
buffer_load_dwordx4 a[144:147], v211, s[24:27], s4 offen offset:0 sc1
rtr a[180:181],v11,38408
m16 v[124:127],a[12:15],v[40:43],v[124:127]
rtr a[182:183],v11,39432
rtr a[184:185],v11,38656
m16 v[156:159],a[12:15],v[44:47],v[156:159]
rtr a[186:187],v11,39680
m16 v[128:131],a[16:19],v[40:43],v[128:131]
rtr a[188:189],v11,38664
m16 v[160:163],a[16:19],v[44:47],v[160:163]
rtr a[190:191],v11,39688
buffer_load_dwordx4 v210, s[56:59], s46 offen offset:3072 lds
m16 v[132:135],a[20:23],v[40:43],v[132:135]
buffer_load_dwordx4 a[148:151], v211, s[24:27], s4 offen offset:1024 sc1
m16 v[164:167],a[20:23],v[44:47],v[164:167]
m16 v[136:139],a[24:27],v[40:43],v[136:139]
m16 v[168:171],a[24:27],v[44:47],v[168:171]
m16 v[140:143],a[28:31],v[40:43],v[140:143]
m16 v[172:175],a[28:31],v[44:47],v[172:175]
s_waitcnt vmcnt(38) lgkmcnt(0)
s_barrier
m16 v[112:115],a[192:195],v[48:51],v[112:115]
rtr a[224:225],v11,16896
rtr a[226:227],v11,17920
m16 v[144:147],a[192:195],v[52:55],v[144:147]
v_add_u32 v210, 0x80000, v210
rtr a[228:229],v11,16904
m16 v[116:119],a[196:199],v[48:51],v[116:119]
buffer_load_dwordx4 a[152:155], v211, s[24:27], s5 offen offset:0 sc1
rtr a[230:231],v11,17928
m16 v[148:151],a[196:199],v[52:55],v[148:151]
rtr a[232:233],v11,17152
m16 v[120:123],a[200:203],v[48:51],v[120:123]
rtr a[234:235],v11,18176
rtr a[236:237],v11,17160
m16 v[152:155],a[200:203],v[52:55],v[152:155]
rtr a[238:239],v11,18184
s_add_u32 m0, s70, 67584
m16 v[124:127],a[204:207],v[48:51],v[124:127]
buffer_load_dwordx4 a[156:159], v211, s[24:27], s5 offen offset:1024 sc1
rtr a[240:241],v11,17408
m16 v[156:159],a[204:207],v[52:55],v[156:159]
rtr a[242:243],v11,18432
m16 v[128:131],a[208:211],v[48:51],v[128:131]
rtr a[244:245],v11,17416
rtr a[246:247],v11,18440
m16 v[160:163],a[208:211],v[52:55],v[160:163]
rtr a[248:249],v11,17664
m16 v[132:135],a[212:215],v[48:51],v[132:135]
rtr a[250:251],v11,18688
buffer_load_dwordx4 v210, s[56:59], 0 offen offset:0 lds
m16 v[164:167],a[212:215],v[52:55],v[164:167]
v_add_u32 v211, s7, v211
buffer_load_dwordx4 a[32:35], v211, s[24:27], 0 offen offset:0 sc1
rtr a[252:253],v11,17672
m16 v[136:139],a[216:219],v[48:51],v[136:139]
rtr a[254:255],v11,18696
m16 v[168:171],a[216:219],v[52:55],v[168:171]
rtr a[0:1],v11,20992
rtr a[2:3],v11,22016
m16 v[140:143],a[220:223],v[48:51],v[140:143]
rtr a[4:5],v11,21000
m16 v[172:175],a[220:223],v[52:55],v[172:175]
rtr a[6:7],v11,22024
buffer_load_dwordx4 v210, s[56:59], s44 offen offset:1024 lds
m16 v[112:115],a[160:163],v[56:59],v[112:115]
buffer_load_dwordx4 a[36:39], v211, s[24:27], 0 offen offset:1024 sc1
rtr a[8:9],v11,21248
m16 v[144:147],a[160:163],v[60:63],v[144:147]
rtr a[10:11],v11,22272
rtr a[12:13],v11,21256
m16 v[116:119],a[164:167],v[56:59],v[116:119]
rtr a[14:15],v11,22280
m16 v[148:151],a[164:167],v[60:63],v[148:151]
rtr a[16:17],v11,21504
m16 v[120:123],a[168:171],v[56:59],v[120:123]
rtr a[18:19],v11,22528
buffer_load_dwordx4 v210, s[56:59], s45 offen offset:2048 lds
m16 v[152:155],a[168:171],v[60:63],v[152:155]
buffer_load_dwordx4 a[40:43], v211, s[24:27], s47 offen offset:0 sc1
rtr a[20:21],v11,21512
m16 v[124:127],a[172:175],v[56:59],v[124:127]
rtr a[22:23],v11,22536
rtr a[24:25],v11,21760
m16 v[156:159],a[172:175],v[60:63],v[156:159]
rtr a[26:27],v11,22784
m16 v[128:131],a[176:179],v[56:59],v[128:131]
rtr a[28:29],v11,21768
m16 v[160:163],a[176:179],v[60:63],v[160:163]
rtr a[30:31],v11,22792
buffer_load_dwordx4 v210, s[56:59], s46 offen offset:3072 lds
m16 v[132:135],a[180:183],v[56:59],v[132:135]
buffer_load_dwordx4 a[44:47], v211, s[24:27], s47 offen offset:1024 sc1
m16 v[164:167],a[180:183],v[60:63],v[164:167]
m16 v[136:139],a[184:187],v[56:59],v[136:139]
m16 v[168:171],a[184:187],v[60:63],v[168:171]
m16 v[140:143],a[188:191],v[56:59],v[140:143]
m16 v[172:175],a[188:191],v[60:63],v[172:175]
s_waitcnt lgkmcnt(0)
m16 v[112:115],a[224:227],v[64:67],v[112:115]
rtr a[192:193],v11,50688
rtr a[194:195],v11,51712
m16 v[144:147],a[224:227],v[68:71],v[144:147]
rtr a[196:197],v11,50696
buffer_load_dwordx4 a[48:51], v211, s[24:27], s4 offen offset:0 sc1
m16 v[116:119],a[228:231],v[64:67],v[116:119]
rtr a[198:199],v11,51720
m16 v[148:151],a[228:231],v[68:71],v[148:151]
rtr a[200:201],v11,50944
m16 v[120:123],a[232:235],v[64:67],v[120:123]
rtr a[202:203],v11,51968
rtr a[204:205],v11,50952
m16 v[152:155],a[232:235],v[68:71],v[152:155]
rtr a[206:207],v11,51976
buffer_load_dwordx4 a[52:55], v211, s[24:27], s4 offen offset:1024 sc1
m16 v[124:127],a[236:239],v[64:67],v[124:127]
rtr a[208:209],v11,51200
m16 v[156:159],a[236:239],v[68:71],v[156:159]
rtr a[210:211],v11,52224
m16 v[128:131],a[240:243],v[64:67],v[128:131]
rtr a[212:213],v11,51208
rtr a[214:215],v11,52232
m16 v[160:163],a[240:243],v[68:71],v[160:163]
rtr a[216:217],v11,51456
m16 v[132:135],a[244:247],v[64:67],v[132:135]
rtr a[218:219],v11,52480
buffer_load_dwordx4 a[56:59], v211, s[24:27], s5 offen offset:0 sc1
m16 v[164:167],a[244:247],v[68:71],v[164:167]
rtr a[220:221],v11,51464
m16 v[136:139],a[248:251],v[64:67],v[136:139]
rtr a[222:223],v11,52488
m16 v[168:171],a[248:251],v[68:71],v[168:171]
rtr a[160:161],v11,54784
rtr a[162:163],v11,55808
m16 v[140:143],a[252:255],v[64:67],v[140:143]
rtr a[164:165],v11,54792
m16 v[172:175],a[252:255],v[68:71],v[172:175]
rtr a[166:167],v11,55816
buffer_load_dwordx4 a[60:63], v211, s[24:27], s5 offen offset:1024 sc1
m16 v[112:115],a[0:3],v[72:75],v[112:115]
rtr a[168:169],v11,55040
m16 v[144:147],a[0:3],v[76:79],v[144:147]
rtr a[170:171],v11,56064
rtr a[172:173],v11,55048
m16 v[116:119],a[4:7],v[72:75],v[116:119]
rtr a[174:175],v11,56072
m16 v[148:151],a[4:7],v[76:79],v[148:151]
rtr a[176:177],v11,55296
m16 v[120:123],a[8:11],v[72:75],v[120:123]
rtr a[178:179],v11,56320
v_add_u32 v211, 0x16000, v211
buffer_load_dwordx4 a[64:67], v211, s[24:27], 0 offen offset:0 sc1
m16 v[152:155],a[8:11],v[76:79],v[152:155]
rtr a[180:181],v11,55304
rtr a[182:183],v11,56328
m16 v[124:127],a[12:15],v[72:75],v[124:127]
rtr a[184:185],v11,55552
m16 v[156:159],a[12:15],v[76:79],v[156:159]
rtr a[186:187],v11,56576
m16 v[128:131],a[16:19],v[72:75],v[128:131]
rtr a[188:189],v11,55560
m16 v[160:163],a[16:19],v[76:79],v[160:163]
rtr a[190:191],v11,56584
buffer_load_dwordx4 a[68:71], v211, s[24:27], 0 offen offset:1024 sc1
m16 v[132:135],a[20:23],v[72:75],v[132:135]
m16 v[164:167],a[20:23],v[76:79],v[164:167]
m16 v[136:139],a[24:27],v[72:75],v[136:139]
m16 v[168:171],a[24:27],v[76:79],v[168:171]
m16 v[140:143],a[28:31],v[72:75],v[140:143]
m16 v[172:175],a[28:31],v[76:79],v[172:175]
s_waitcnt vmcnt(36) lgkmcnt(0)
s_barrier
m16 v[112:115],a[192:195],v[80:83],v[112:115]
rtr a[224:225],v12,0
rtr a[226:227],v12,1024
m16 v[144:147],a[192:195],v[84:87],v[144:147]
rtr a[228:229],v12,8
buffer_load_dwordx4 a[72:75], v211, s[24:27], s47 offen offset:0 sc1
m16 v[116:119],a[196:199],v[80:83],v[116:119]
rtr a[230:231],v12,1032
m16 v[148:151],a[196:199],v[84:87],v[148:151]
rtr a[232:233],v12,256
m16 v[120:123],a[200:203],v[80:83],v[120:123]
rtr a[234:235],v12,1280
rtr a[236:237],v12,264
m16 v[152:155],a[200:203],v[84:87],v[152:155]
cvt v128,v128,v129
cvt v129,v130,v131
m16 v[124:127],a[204:207],v[80:83],v[124:127]
rtr a[238:239],v12,1288
buffer_load_dwordx4 a[76:79], v211, s[24:27], s47 offen offset:1024 sc1
cvt v130,v132,v133
m16 v[156:159],a[204:207],v[84:87],v[156:159]
rtr a[240:241],v12,512
cvt v131,v134,v135
buffer_store_dwordx4 v[128:131], v1, s[24:27], 0 offen offset:0 sc1
m16 v[112:115],a[208:211],v[88:91],v[112:115]
rtr a[242:243],v12,1536
cvt v132,v136,v137
m16 v[144:147],a[208:211],v[92:95],v[144:147]
rtr a[244:245],v12,520
rtr a[246:247],v12,1544
cvt v133,v138,v139
cvt v134,v140,v141
m16 v[116:119],a[212:215],v[88:91],v[116:119]
rtr a[248:249],v12,768
cvt v135,v142,v143
m16 v[148:151],a[212:215],v[92:95],v[148:151]
rtr a[250:251],v12,1792
buffer_load_dwordx4 a[80:83], v211, s[24:27], s4 offen offset:0 sc1
buffer_store_dwordx4 v[132:135], v1, s[24:27], 0 offen offset:1024 sc1
m16 v[120:123],a[216:219],v[88:91],v[120:123]
rtr a[252:253],v12,776
cvt v160,v160,v161
cvt v161,v162,v163
m16 v[152:155],a[216:219],v[92:95],v[152:155]
rtr a[254:255],v12,1800
cvt v162,v164,v165
m16 v[124:127],a[220:223],v[88:91],v[124:127]
rtr a[0:1],v12,4096
rtr a[2:3],v12,5120
cvt v163,v166,v167
buffer_store_dwordx4 v[160:163], v1, s[24:27], s62 offen offset:0 sc1
m16 v[156:159],a[220:223],v[92:95],v[156:159]
rtr a[4:5],v12,4104
cvt v164,v168,v169
m16 v[112:115],a[160:163],v[96:99],v[112:115]
rtr a[6:7],v12,5128
buffer_load_dwordx4 a[84:87], v211, s[24:27], s4 offen offset:1024 sc1
cvt v165,v170,v171
cvt v166,v172,v173
m16 v[144:147],a[160:163],v[100:103],v[144:147]
rtr a[8:9],v12,4352
cvt v167,v174,v175
m16 v[116:119],a[164:167],v[96:99],v[116:119]
rtr a[10:11],v12,5376
rtr a[12:13],v12,4360
buffer_store_dwordx4 v[164:167], v1, s[24:27], s62 offen offset:1024 sc1
m16 v[148:151],a[164:167],v[100:103],v[148:151]
rtr a[14:15],v12,5384
rtr a[16:17],v12,4608
m16 v[120:123],a[168:171],v[96:99],v[120:123]
rtr a[18:19],v12,5632
buffer_load_dwordx4 a[88:91], v211, s[24:27], s5 offen offset:0 sc1
m16 v[152:155],a[168:171],v[100:103],v[152:155]
rtr a[20:21],v12,4616
rtr a[22:23],v12,5640
m16 v[124:127],a[172:175],v[96:99],v[124:127]
rtr a[24:25],v12,4864
m16 v[156:159],a[172:175],v[100:103],v[156:159]
rtr a[26:27],v12,5888
m16 v[112:115],a[176:179],v[104:107],v[112:115]
rtr a[28:29],v12,4872
m16 v[144:147],a[176:179],v[108:111],v[144:147]
rtr a[30:31],v12,5896
buffer_load_dwordx4 a[92:95], v211, s[24:27], s5 offen offset:1024 sc1
m16 v[116:119],a[180:183],v[104:107],v[116:119]
m16 v[148:151],a[180:183],v[108:111],v[148:151]
m16 v[120:123],a[184:187],v[104:107],v[120:123]
m16 v[152:155],a[184:187],v[108:111],v[152:155]
m16 v[124:127],a[188:191],v[104:107],v[124:127]
m16 v[156:159],a[188:191],v[108:111],v[156:159]
s_waitcnt vmcnt(36) lgkmcnt(0)
m16 v[112:115],a[224:227],a[96:99],v[112:115]
rtr a[192:193],v10,0
rtr a[194:195],v10,1024
m16 v[144:147],a[224:227],a[100:103],v[144:147]
rtr a[196:197],v10,8
v_add_u32 v211, 0x16000, v211
buffer_load_dwordx4 v[16:19], v211, s[24:27], 0 offen offset:0 sc1
m16 v[116:119],a[228:231],a[96:99],v[116:119]
rtr a[198:199],v10,1032
m16 v[148:151],a[228:231],a[100:103],v[148:151]
rtr a[200:201],v10,256
m16 v[120:123],a[232:235],a[96:99],v[120:123]
rtr a[202:203],v10,1280
rtr a[204:205],v10,264
m16 v[152:155],a[232:235],a[100:103],v[152:155]
rtr a[206:207],v10,1288
buffer_load_dwordx4 v[20:23], v211, s[24:27], 0 offen offset:1024 sc1
m16 v[124:127],a[236:239],a[96:99],v[124:127]
rtr a[208:209],v10,512
m16 v[156:159],a[236:239],a[100:103],v[156:159]
rtr a[210:211],v10,1536
m16 v[112:115],a[240:243],a[104:107],v[112:115]
rtr a[212:213],v10,520
rtr a[214:215],v10,1544
m16 v[144:147],a[240:243],a[108:111],v[144:147]
rtr a[216:217],v10,768
m16 v[116:119],a[244:247],a[104:107],v[116:119]
rtr a[218:219],v10,1792
buffer_load_dwordx4 v[24:27], v211, s[24:27], s47 offen offset:0 sc1
m16 v[148:151],a[244:247],a[108:111],v[148:151]
rtr a[220:221],v10,776
m16 v[120:123],a[248:251],a[104:107],v[120:123]
rtr a[222:223],v10,1800
m16 v[152:155],a[248:251],a[108:111],v[152:155]
rtr a[160:161],v10,4096
rtr a[162:163],v10,5120
m16 v[124:127],a[252:255],a[104:107],v[124:127]
rtr a[164:165],v10,4104
m16 v[156:159],a[252:255],a[108:111],v[156:159]
rtr a[166:167],v10,5128
buffer_load_dwordx4 v[28:31], v211, s[24:27], s47 offen offset:1024 sc1
m16 v[112:115],a[0:3],a[112:115],v[112:115]
rtr a[168:169],v10,4352
m16 v[144:147],a[0:3],a[116:119],v[144:147]
rtr a[170:171],v10,5376
rtr a[172:173],v10,4360
m16 v[116:119],a[4:7],a[112:115],v[116:119]
rtr a[174:175],v10,5384
m16 v[148:151],a[4:7],a[116:119],v[148:151]
rtr a[176:177],v10,4608
m16 v[120:123],a[8:11],a[112:115],v[120:123]
rtr a[178:179],v10,5632
buffer_load_dwordx4 v[32:35], v211, s[24:27], s4 offen offset:0 sc1
m16 v[152:155],a[8:11],a[116:119],v[152:155]
rtr a[180:181],v10,4616
rtr a[182:183],v10,5640
m16 v[124:127],a[12:15],a[112:115],v[124:127]
rtr a[184:185],v10,4864
m16 v[156:159],a[12:15],a[116:119],v[156:159]
rtr a[186:187],v10,5888
m16 v[112:115],a[16:19],a[120:123],v[112:115]
rtr a[188:189],v10,4872
m16 v[144:147],a[16:19],a[124:127],v[144:147]
rtr a[190:191],v10,5896
buffer_load_dwordx4 v[36:39], v211, s[24:27], s4 offen offset:1024 sc1
m16 v[116:119],a[20:23],a[120:123],v[116:119]
m16 v[148:151],a[20:23],a[124:127],v[148:151]
m16 v[120:123],a[24:27],a[120:123],v[120:123]
m16 v[152:155],a[24:27],a[124:127],v[152:155]
m16 v[124:127],a[28:31],a[120:123],v[124:127]
m16 v[156:159],a[28:31],a[124:127],v[156:159]
s_waitcnt vmcnt(30) lgkmcnt(0)
s_barrier
m16 v[112:115],a[192:195],a[128:131],v[112:115]
rtr a[224:225],v10,33792
rtr a[226:227],v10,34816
m16 v[144:147],a[192:195],a[132:135],v[144:147]
rtr a[228:229],v10,33800
buffer_load_dwordx4 v[40:43], v211, s[24:27], s5 offen offset:0 sc1
m16 v[116:119],a[196:199],a[128:131],v[116:119]
rtr a[230:231],v10,34824
m16 v[148:151],a[196:199],a[132:135],v[148:151]
rtr a[232:233],v10,34048
m16 v[120:123],a[200:203],a[128:131],v[120:123]
rtr a[234:235],v10,35072
rtr a[236:237],v10,34056
m16 v[152:155],a[200:203],a[132:135],v[152:155]
rtr a[238:239],v10,35080
buffer_load_dwordx4 v[44:47], v211, s[24:27], s5 offen offset:1024 sc1
m16 v[124:127],a[204:207],a[128:131],v[124:127]
rtr a[240:241],v10,34304
m16 v[156:159],a[204:207],a[132:135],v[156:159]
rtr a[242:243],v10,35328
m16 v[112:115],a[208:211],a[136:139],v[112:115]
s_waitcnt vmcnt(10)
s_mov_b64 exec, 1
buffer_store_dword v5, v4, s[24:27], 0 offen sc1
s_mov_b64 exec, -1
s_nop 3
rtr a[244:245],v10,34312
m16 v[144:147],a[208:211],a[140:143],v[144:147]
rtr a[246:247],v10,35336
rtr a[248:249],v10,34560
m16 v[116:119],a[212:215],a[136:139],v[116:119]
rtr a[250:251],v10,35584
m16 v[148:151],a[212:215],a[140:143],v[148:151]
rtr a[252:253],v10,34568
m16 v[120:123],a[216:219],a[136:139],v[120:123]
rtr a[254:255],v10,35592
m16 v[152:155],a[216:219],a[140:143],v[152:155]
rtr a[0:1],v10,37888
rtr a[2:3],v10,38912
m16 v[124:127],a[220:223],a[136:139],v[124:127]
rtr a[4:5],v10,37896
m16 v[156:159],a[220:223],a[140:143],v[156:159]
rtr a[6:7],v10,38920
m16 v[112:115],a[160:163],a[144:147],v[112:115]
rtr a[8:9],v10,38144
m16 v[144:147],a[160:163],a[148:151],v[144:147]
rtr a[10:11],v10,39168
rtr a[12:13],v10,38152
m16 v[116:119],a[164:167],a[144:147],v[116:119]
rtr a[14:15],v10,39176
m16 v[148:151],a[164:167],a[148:151],v[148:151]
rtr a[16:17],v10,38400
m16 v[120:123],a[168:171],a[144:147],v[120:123]
rtr a[18:19],v10,39424
m16 v[152:155],a[168:171],a[148:151],v[152:155]
rtr a[20:21],v10,38408
rtr a[22:23],v10,39432
m16 v[124:127],a[172:175],a[144:147],v[124:127]
rtr a[24:25],v10,38656
m16 v[156:159],a[172:175],a[148:151],v[156:159]
rtr a[26:27],v10,39680
m16 v[112:115],a[176:179],a[152:155],v[112:115]
rtr a[28:29],v10,38664
m16 v[144:147],a[176:179],a[156:159],v[144:147]
rtr a[30:31],v10,39688
m16 v[116:119],a[180:183],a[152:155],v[116:119]
m16 v[148:151],a[180:183],a[156:159],v[148:151]
m16 v[120:123],a[184:187],a[152:155],v[120:123]
m16 v[152:155],a[184:187],a[156:159],v[152:155]
m16 v[124:127],a[188:191],a[152:155],v[124:127]
m16 v[156:159],a[188:191],a[156:159],v[156:159]
s_waitcnt lgkmcnt(0)
m16 v[112:115],a[224:227],a[32:35],v[112:115]
rtr a[192:193],v10,16896
rtr a[194:195],v10,17920
m16 v[144:147],a[224:227],a[36:39],v[144:147]
rtr a[196:197],v10,16904
m16 v[116:119],a[228:231],a[32:35],v[116:119]
rtr a[198:199],v10,17928
m16 v[148:151],a[228:231],a[36:39],v[148:151]
rtr a[200:201],v10,17152
m16 v[120:123],a[232:235],a[32:35],v[120:123]
rtr a[202:203],v10,18176
rtr a[204:205],v10,17160
m16 v[152:155],a[232:235],a[36:39],v[152:155]
rtr a[206:207],v10,18184
m16 v[124:127],a[236:239],a[32:35],v[124:127]
rtr a[208:209],v10,17408
m16 v[156:159],a[236:239],a[36:39],v[156:159]
rtr a[210:211],v10,18432
m16 v[112:115],a[240:243],a[40:43],v[112:115]
rtr a[212:213],v10,17416
rtr a[214:215],v10,18440
m16 v[144:147],a[240:243],a[44:47],v[144:147]
rtr a[216:217],v10,17664
m16 v[116:119],a[244:247],a[40:43],v[116:119]
rtr a[218:219],v10,18688
m16 v[148:151],a[244:247],a[44:47],v[148:151]
rtr a[220:221],v10,17672
m16 v[120:123],a[248:251],a[40:43],v[120:123]
buffer_load_dword v254, v9, s[24:27], 0 offen sc1
rtr a[222:223],v10,18696
m16 v[152:155],a[248:251],a[44:47],v[152:155]
rtr a[160:161],v10,20992
rtr a[162:163],v10,22016
m16 v[124:127],a[252:255],a[40:43],v[124:127]
rtr a[164:165],v10,21000
m16 v[156:159],a[252:255],a[44:47],v[156:159]
rtr a[166:167],v10,22024
m16 v[112:115],a[0:3],a[48:51],v[112:115]
rtr a[168:169],v10,21248
m16 v[144:147],a[0:3],a[52:55],v[144:147]
rtr a[170:171],v10,22272
rtr a[172:173],v10,21256
m16 v[116:119],a[4:7],a[48:51],v[116:119]
rtr a[174:175],v10,22280
m16 v[148:151],a[4:7],a[52:55],v[148:151]
rtr a[176:177],v10,21504
m16 v[120:123],a[8:11],a[48:51],v[120:123]
rtr a[178:179],v10,22528
m16 v[152:155],a[8:11],a[52:55],v[152:155]
rtr a[180:181],v10,21512
rtr a[182:183],v10,22536
m16 v[124:127],a[12:15],a[48:51],v[124:127]
rtr a[184:185],v10,21760
m16 v[156:159],a[12:15],a[52:55],v[156:159]
rtr a[186:187],v10,22784
m16 v[112:115],a[16:19],a[56:59],v[112:115]
rtr a[188:189],v10,21768
m16 v[144:147],a[16:19],a[60:63],v[144:147]
rtr a[190:191],v10,22792
m16 v[116:119],a[20:23],a[56:59],v[116:119]
m16 v[148:151],a[20:23],a[60:63],v[148:151]
m16 v[120:123],a[24:27],a[56:59],v[120:123]
m16 v[152:155],a[24:27],a[60:63],v[152:155]
m16 v[124:127],a[28:31],a[56:59],v[124:127]
m16 v[156:159],a[28:31],a[60:63],v[156:159]
s_waitcnt vmcnt(10) lgkmcnt(0)
s_barrier
m16 v[112:115],a[192:195],a[64:67],v[112:115]
rtr a[224:225],v11,0
rtr a[226:227],v11,1024
m16 v[144:147],a[192:195],a[68:71],v[144:147]
rtr a[228:229],v11,8
m16 v[116:119],a[196:199],a[64:67],v[116:119]
rtr a[230:231],v11,1032
m16 v[148:151],a[196:199],a[68:71],v[148:151]
rtr a[232:233],v11,256
m16 v[120:123],a[200:203],a[64:67],v[120:123]
rtr a[234:235],v11,1280
rtr a[236:237],v11,264
m16 v[152:155],a[200:203],a[68:71],v[152:155]
rtr a[238:239],v11,1288
m16 v[124:127],a[204:207],a[64:67],v[124:127]
rtr a[240:241],v11,512
s_waitcnt vmcnt(0)
v_cmp_ne_u32 vcc, 1, v254
s_mov_b32 s28, 0
s_nop 0
s_cmp_eq_u64 vcc, 0
s_cbranch_scc1 Lb_p2_ok
s_mov_b32 s29, 20000
Lb_p2:
s_sleep 2
buffer_load_dword v254, v9, s[24:27], 0 offen sc1
s_waitcnt vmcnt(0)
s_sub_u32 s29, s29, 1
s_cmp_eq_u32 s29, 0
s_cbranch_scc1 Lb_p2_ok
v_cmp_ne_u32 vcc, 1, v254
s_mov_b32 s28, 0
s_nop 0
s_cmp_eq_u64 vcc, 0
s_cbranch_scc0 Lb_p2
Lb_p2_ok:
m16 v[156:159],a[204:207],a[68:71],v[156:159]
rtr a[242:243],v11,1536
buffer_load_dwordx4 v[136:139], v2, s[24:27], 0 offen offset:0 sc1
m16 v[112:115],a[208:211],a[72:75],v[112:115]
rtr a[244:245],v11,520
rtr a[246:247],v11,1544
m16 v[144:147],a[208:211],a[76:79],v[144:147]
buffer_load_dwordx4 v[140:143], v2, s[24:27], 0 offen offset:1024 sc1
rtr a[248:249],v11,768
m16 v[116:119],a[212:215],a[72:75],v[116:119]
rtr a[250:251],v11,1792
m16 v[148:151],a[212:215],a[76:79],v[148:151]
buffer_load_dwordx4 v[168:171], v2, s[24:27], s62 offen offset:0 sc1
rtr a[252:253],v11,776
m16 v[120:123],a[216:219],a[72:75],v[120:123]
buffer_load_dwordx4 v[172:175], v2, s[24:27], s62 offen offset:1024 sc1
rtr a[254:255],v11,1800
m16 v[152:155],a[216:219],a[76:79],v[152:155]
rtr a[0:1],v11,4096
rtr a[2:3],v11,5120
m16 v[124:127],a[220:223],a[72:75],v[124:127]
rtr a[4:5],v11,4104
m16 v[156:159],a[220:223],a[76:79],v[156:159]
rtr a[6:7],v11,5128
m16 v[112:115],a[160:163],a[80:83],v[112:115]
rtr a[8:9],v11,4352
m16 v[144:147],a[160:163],a[84:87],v[144:147]
rtr a[10:11],v11,5376
rtr a[12:13],v11,4360
m16 v[116:119],a[164:167],a[80:83],v[116:119]
rtr a[14:15],v11,5384
m16 v[148:151],a[164:167],a[84:87],v[148:151]
rtr a[16:17],v11,4608
m16 v[120:123],a[168:171],a[80:83],v[120:123]
rtr a[18:19],v11,5632
m16 v[152:155],a[168:171],a[84:87],v[152:155]
rtr a[20:21],v11,4616
rtr a[22:23],v11,5640
m16 v[124:127],a[172:175],a[80:83],v[124:127]
rtr a[24:25],v11,4864
m16 v[156:159],a[172:175],a[84:87],v[156:159]
rtr a[26:27],v11,5888
m16 v[112:115],a[176:179],a[88:91],v[112:115]
rtr a[28:29],v11,4872
m16 v[144:147],a[176:179],a[92:95],v[144:147]
rtr a[30:31],v11,5896
m16 v[116:119],a[180:183],a[88:91],v[116:119]
m16 v[148:151],a[180:183],a[92:95],v[148:151]
m16 v[120:123],a[184:187],a[88:91],v[120:123]
m16 v[152:155],a[184:187],a[92:95],v[152:155]
m16 v[124:127],a[188:191],a[88:91],v[124:127]
m16 v[156:159],a[188:191],a[92:95],v[156:159]
s_waitcnt lgkmcnt(0)
m16 v[112:115],a[224:227],v[16:19],v[112:115]
m16 v[116:119],a[228:231],v[16:19],v[116:119]
s_waitcnt vmcnt(2)
v_lshlrev_b32 v128, 16, v136
m16 v[120:123],a[232:235],v[16:19],v[120:123]
v_and_b32 v129, 0xffff0000, v136
v_lshlrev_b32 v130, 16, v137
v_and_b32 v131, 0xffff0000, v137
m16 v[124:127],a[236:239],v[16:19],v[124:127]
v_lshlrev_b32 v132, 16, v138
v_and_b32 v133, 0xffff0000, v138
v_lshlrev_b32 v134, 16, v139
m16 v[112:115],a[240:243],v[24:27],v[112:115]
v_and_b32 v135, 0xffff0000, v139
v_lshlrev_b32 v136, 16, v140
v_and_b32 v137, 0xffff0000, v140
m16 v[116:119],a[244:247],v[24:27],v[116:119]
v_lshlrev_b32 v138, 16, v141
v_and_b32 v139, 0xffff0000, v141
m16 v[120:123],a[248:251],v[24:27],v[120:123]
v_lshlrev_b32 v140, 16, v142
v_and_b32 v141, 0xffff0000, v142
v_lshlrev_b32 v142, 16, v143
m16 v[124:127],a[252:255],v[24:27],v[124:127]
v_and_b32 v143, 0xffff0000, v143
s_waitcnt vmcnt(0)
v_lshlrev_b32 v160, 16, v168
m16 v[112:115],a[0:3],v[32:35],v[112:115]
v_and_b32 v161, 0xffff0000, v168
v_lshlrev_b32 v162, 16, v169
v_and_b32 v163, 0xffff0000, v169
m16 v[116:119],a[4:7],v[32:35],v[116:119]
v_lshlrev_b32 v164, 16, v170
v_and_b32 v165, 0xffff0000, v170
m16 v[120:123],a[8:11],v[32:35],v[120:123]
v_lshlrev_b32 v166, 16, v171
m16 v[124:127],a[12:15],v[32:35],v[124:127]
v_and_b32 v167, 0xffff0000, v171
v_lshlrev_b32 v168, 16, v172
m16 v[112:115],a[16:19],v[40:43],v[112:115]
v_and_b32 v169, 0xffff0000, v172
v_lshlrev_b32 v170, 16, v173
m16 v[116:119],a[20:23],v[40:43],v[116:119]
v_and_b32 v171, 0xffff0000, v173
v_lshlrev_b32 v172, 16, v174
m16 v[120:123],a[24:27],v[40:43],v[120:123]
v_and_b32 v173, 0xffff0000, v174
v_lshlrev_b32 v174, 16, v175
m16 v[124:127],a[28:31],v[40:43],v[124:127]
v_and_b32 v175, 0xffff0000, v175
m16 v[144:147],a[224:227],v[20:23],v[144:147]
m16 v[148:151],a[228:231],v[20:23],v[148:151]
m16 v[152:155],a[232:235],v[20:23],v[152:155]
m16 v[156:159],a[236:239],v[20:23],v[156:159]
v_add_f32 v112, v112, v128
v_add_f32 v113, v113, v129
v_add_f32 v114, v114, v130
m16 v[144:147],a[240:243],v[28:31],v[144:147]
v_add_f32 v115, v115, v131
v_add_f32 v116, v116, v132
m16 v[148:151],a[244:247],v[28:31],v[148:151]
v_add_f32 v117, v117, v133
v_add_f32 v118, v118, v134
v_add_f32 v119, v119, v135
m16 v[152:155],a[248:251],v[28:31],v[152:155]
v_add_f32 v120, v120, v136
v_add_f32 v121, v121, v137
v_add_f32 v122, v122, v138
m16 v[156:159],a[252:255],v[28:31],v[156:159]
v_add_f32 v123, v123, v139
v_add_f32 v124, v124, v140
v_add_f32 v125, v125, v141
m16 v[144:147],a[0:3],v[36:39],v[144:147]
v_add_f32 v126, v126, v142
v_add_f32 v127, v127, v143
cvt v208,v112,v113
m16 v[148:151],a[4:7],v[36:39],v[148:151]
cvt v209,v114,v115
m16 v[152:155],a[8:11],v[36:39],v[152:155]
cvt v210,v116,v117
cvt v211,v118,v119
m16 v[156:159],a[12:15],v[36:39],v[156:159]
cvt v212,v120,v121
cvt v213,v122,v123
m16 v[144:147],a[16:19],v[44:47],v[144:147]
cvt v214,v124,v125
cvt v215,v126,v127
m16 v[148:151],a[20:23],v[44:47],v[148:151]
ds_write_b128 v14, v[208:211] offset:0
ds_write_b128 v14, v[212:215] offset:64
m16 v[152:155],a[24:27],v[44:47],v[152:155]
r128 v[128:131],v15,0
r128 v[132:135],v15,1152
m16 v[156:159],a[28:31],v[44:47],v[156:159]
s_waitcnt lgkmcnt(0)
buffer_store_dwordx4 v[128:131], v3, s[48:51], 0 offen
buffer_store_dwordx4 v[132:135], v3, s[48:51], s66 offen
v_pk_add_f32 v[144:145], v[144:145], v[160:161]
v_pk_add_f32 v[146:147], v[146:147], v[162:163]
v_pk_add_f32 v[148:149], v[148:149], v[164:165]
v_pk_add_f32 v[150:151], v[150:151], v[166:167]
v_pk_add_f32 v[152:153], v[152:153], v[168:169]
v_pk_add_f32 v[154:155], v[154:155], v[170:171]
v_pk_add_f32 v[156:157], v[156:157], v[172:173]
v_pk_add_f32 v[158:159], v[158:159], v[174:175]
cvt v216,v144,v145
cvt v217,v146,v147
cvt v218,v148,v149
cvt v219,v150,v151
cvt v220,v152,v153
cvt v221,v154,v155
cvt v222,v156,v157
cvt v223,v158,v159
ds_write_b128 v14, v[216:219] offset:2304
ds_write_b128 v14, v[220:223] offset:2368
r128 v[160:163],v15,2304
r128 v[164:167],v15,3456
s_waitcnt lgkmcnt(0)
buffer_store_dwordx4 v[160:163], v3, s[48:51], s64 offen
buffer_store_dwordx4 v[164:167], v3, s[48:51], s67 offen
s_endpgm
.text
.globl concat_heads__mha_block_cached__gqa_block_cached__near_ridge_kernel
.p2align 8
.type concat_heads__mha_block_cached__gqa_block_cached__near_ridge_kernel,@function
concat_heads__mha_block_cached__gqa_block_cached__near_ridge_kernel:
s_cmp_ge_u32 s2, 256
s_cbranch_scc1 concat_heads__mha_block_cached__gqa_block_cached__near_ridge_kernel_end
s_and_b32 s3, s2, 7
s_lshr_b32 s30, s2, 3
s_lshr_b32 s31, s3, 2
s_mul_i32 s33, s31, 40
s_load_dwordx8 s[40:47], s[0:1], s33
s_add_u32 s33, s33, 32
s_load_dwordx2 s[4:5], s[0:1], s33
s_load_dwordx4 s[48:51], s[0:1], 80
s_load_dwordx2 s[34:35], s[0:1], 96
v_lshrrev_b32 v16, 6, v0
v_and_b32 v0, 63, v0
s_and_b32 s32, s30, 7
s_and_b32 s33, s3, 3
s_lshl_b32 s33, s33, 2
s_lshr_b32 s28, s30, 3
v_readfirstlane_b32 s36, v16
s_add_u32 s33, s33, s28
s_getpc_b64 s[96:97]
concat_heads__mha_block_cached__gqa_block_cached__near_ridge_kernel_pc:
s_lshl_b32 s28, s30, 2
s_add_u32 s28, s28, s36
s_lshl_b32 s28, s28, 7
v_lshlrev_b32 v20, 14, v0
v_add_u32 v20, s28, v20
s_mov_b32 s98, concat_heads__mha_block_cached__gqa_block_cached__near_ridge_kernel_codeend-concat_heads__mha_block_cached__gqa_block_cached__near_ridge_kernel_codebeg-128
s_sub_u32 s96, s96, concat_heads__mha_block_cached__gqa_block_cached__near_ridge_kernel_pc-concat_heads__mha_block_cached__gqa_block_cached__near_ridge_kernel_codebeg
s_subb_u32 s97, s97, 0
v_cmp_gt_u32 s[28:29], s98, v20
v_mov_b32 v19, s97
v_add_co_u32 v18, vcc, s96, v20
s_nop 1
v_addc_co_u32 v19, vcc, 0, v19, vcc
s_mov_b64 exec, s[28:29]
global_load_dword v255, v[18:19], off
s_mov_b64 exec, -1
s_mov_b32 s60, 0
s_mov_b32 s61, 31744
s_mov_b32 s62, 129024
s_mov_b32 s63, 160768
s_mov_b32 s64, 0
s_mov_b32 s65, 30720
s_mov_b32 s66, 65536
v_lshrrev_b32 v16, 4, v0
v_and_b32 v21, 7, v0
v_xor_b32 v17, v21, v16
v_lshlrev_b32 v17, 4, v17
v_lshrrev_b32 v22, 3, v0
v_lshl_add_u32 v17, v22, 11, v17
s_mul_i32 s28, s36, 98304
v_add_u32 v245, s28, v17
v_xor_b32 v17, 64, v17
s_add_u32 s28, s28, 15360
v_add_u32 v251, s28, v17
v_bfe_u32 v19, v0, 2, 2
v_and_b32 v20, 3, v0
v_and_b32 v22, 3, v22
v_lshlrev_b32 v18, 13, v22
v_lshrrev_b32 v23, 5, v0
v_lshl_add_u32 v18, v23, 7, v18
v_bfe_u32 v23, v0, 4, 1
v_lshlrev_b32 v23, 2, v23
v_xor_b32 v23, v23, v21
v_lshl_add_u32 v18, v23, 4, v18
s_and_b32 s28, s36, 1
s_lshr_b32 s29, s36, 1
s_lshl_b32 s6, s28, 16
s_lshl_b32 s7, s29, 8
s_add_u32 s6, s6, s7
v_add_u32 v244, s6, v18
s_mul_i32 s68, s28, 8200
s_lshl_b32 s7, s29, 12
s_add_u32 s68, s68, s7
s_add_u32 s68, s68, 114640
s_mul_i32 s69, s36, 6144
s_add_u32 s69, s69, 69584
s_mul_i32 s28, s32, 360448
s_lshl_b32 s29, s33, 9
s_waitcnt lgkmcnt(0)
s_add_u32 s8, s40, s28
s_addc_u32 s9, s41, 0
s_mov_b32 s10, 360448
s_mov_b32 s11, 0x00020000
s_add_u32 s12, s46, s29
s_addc_u32 s13, s47, 0
s_sub_u32 s14, 8388608, s29
s_mov_b32 s15, 0x00020000
s_add_u32 m0, s68, 16400
s_nop 0
buffer_load_dwordx4 v244, s[12:15], s60 offen offset:0 lds
buffer_load_dwordx4 v244, s[12:15], s61 offen offset:1024 lds
buffer_load_dwordx4 v244, s[12:15], s62 offen offset:2048 lds
buffer_load_dwordx4 v244, s[12:15], s63 offen offset:3072 lds
v_add_u32 v244, 262144, v244
s_add_u32 m0, s69, 4096
s_cmp_eq_u32 s36, 3
s_cbranch_scc1 concat_heads__mha_block_cached__gqa_block_cached__near_ridge_kernel_sk0
buffer_load_dwordx4 v245, s[8:11], s66 offen offset:0 lds
buffer_load_dwordx4 v251, s[8:11], s66 offen offset:1024 lds
concat_heads__mha_block_cached__gqa_block_cached__near_ridge_kernel_sk0:
s_add_u32 m0, s69, 0
s_nop 0
buffer_load_dwordx4 v245, s[8:11], s64 offen offset:0 lds
buffer_load_dwordx4 v251, s[8:11], s64 offen offset:1024 lds
buffer_load_dwordx4 v245, s[8:11], s65 offen offset:2048 lds
buffer_load_dwordx4 v251, s[8:11], s65 offen offset:3072 lds
v_add_u32 v245, 128, v245
v_add_u32 v251, 128, v251
s_add_u32 m0, s68, 32800
s_nop 0
buffer_load_dwordx4 v244, s[12:15], s60 offen offset:0 lds
buffer_load_dwordx4 v244, s[12:15], s61 offen offset:1024 lds
buffer_load_dwordx4 v244, s[12:15], s62 offen offset:2048 lds
buffer_load_dwordx4 v244, s[12:15], s63 offen offset:3072 lds
v_add_u32 v244, 262144, v244
s_add_u32 m0, s69, 26624
s_cmp_eq_u32 s36, 3
s_cbranch_scc1 concat_heads__mha_block_cached__gqa_block_cached__near_ridge_kernel_sk1
buffer_load_dwordx4 v245, s[8:11], s66 offen offset:0 lds
buffer_load_dwordx4 v251, s[8:11], s66 offen offset:1024 lds
concat_heads__mha_block_cached__gqa_block_cached__near_ridge_kernel_sk1:
s_add_u32 m0, s69, 22528
s_nop 0
buffer_load_dwordx4 v245, s[8:11], s64 offen offset:0 lds
buffer_load_dwordx4 v251, s[8:11], s64 offen offset:1024 lds
buffer_load_dwordx4 v245, s[8:11], s65 offen offset:2048 lds
buffer_load_dwordx4 v251, s[8:11], s65 offen offset:3072 lds
v_add_u32 v245, 128, v245
v_add_u32 v251, 128, v251
s_add_u32 m0, s68, 0
s_nop 0
buffer_load_dwordx4 v244, s[12:15], s60 offen offset:0 lds
buffer_load_dwordx4 v244, s[12:15], s61 offen offset:1024 lds
buffer_load_dwordx4 v244, s[12:15], s62 offen offset:2048 lds
buffer_load_dwordx4 v244, s[12:15], s63 offen offset:3072 lds
v_add_u32 v244, 262144, v244
v_and_b32 v21, 15, v0
v_lshrrev_b32 v22, 1, v21
v_xor_b32 v22, v22, v16
v_lshlrev_b32 v22, 4, v22
v_lshl_add_u32 v22, v21, 7, v22
v_add_u32 v246, s69, v22
v_xor_b32 v22, 64, v22
v_add_u32 v247, s69, v22
v_lshlrev_b32 v22, 7, v19
v_lshrrev_b32 v23, 1, v19
v_lshl_add_u32 v22, v23, 6, v22
v_lshl_add_u32 v22, v20, 4, v22
v_lshrrev_b32 v23, 1, v16
v_lshl_add_u32 v22, v23, 11, v22
v_and_b32 v23, 1, v16
v_mul_u32_u24 v23, 8200, v23
v_add_u32 v23, 114640, v23
v_add_u32 v248, v23, v22
v_xor_b32 v22, 64, v22
v_add_u32 v249, v23, v22
v_lshlrev_b32 v14, 11, v16
v_lshl_add_u32 v14, v21, 4, v14
s_cmp_eq_u32 s36, 3
s_cbranch_scc1 concat_heads__mha_block_cached__gqa_block_cached__near_ridge_kernel_v1
s_waitcnt vmcnt(14)
s_barrier
r128 a[64:67],v246,0
r128 a[68:71],v246,2048
r128 a[72:75],v246,4096
r128 a[76:79],v247,0
r128 a[80:83],v247,2048
r128 a[84:87],v247,4096
rtr a[0:1],v248,16400
rtr a[2:3],v248,17424
rtr a[4:5],v248,16408
rtr a[6:7],v248,17432
rtr a[8:9],v249,16400
rtr a[10:11],v249,17424
rtr a[12:13],v249,16408
rtr a[14:15],v249,17432
rtr a[16:17],v248,16912
rtr a[18:19],v248,17936
rtr a[20:21],v248,16920
rtr a[22:23],v248,17944
rtr a[24:25],v249,16912
rtr a[26:27],v249,17936
rtr a[28:29],v249,16920
rtr a[30:31],v249,17944
rtr a[32:33],v248,20496
rtr a[34:35],v248,21520
rtr a[36:37],v248,20504
rtr a[38:39],v248,21528
rtr a[40:41],v249,20496
rtr a[42:43],v249,21520
rtr a[44:45],v249,20504
rtr a[46:47],v249,21528
rtr a[48:49],v248,21008
rtr a[50:51],v248,22032
rtr a[52:53],v248,21016
rtr a[54:55],v248,22040
rtr a[56:57],v249,21008
rtr a[58:59],v249,22032
rtr a[60:61],v249,21016
rtr a[62:63],v249,22040
s_waitcnt vmcnt(10) lgkmcnt(0)
s_barrier
m16 v[112:115],a[0:3],a[64:67],0
rtr a[192:193],v248,32800
s_add_u32 m0, s68, 16400
m16 v[144:147],a[0:3],a[68:71],0
s_lshl_b32 s96, s36, 9
rtr a[194:195],v248,33824
m16 v[176:179],a[0:3],a[72:75],0
v_add_u32 v14, s96, v14
rtr a[196:197],v248,32808
m16 v[116:119],a[4:7],a[64:67],0
buffer_load_dwordx4 v244, s[12:15], s60 offen offset:0 lds
rtr a[198:199],v248,33832
m16 v[148:151],a[4:7],a[68:71],0
s_mul_i32 s100, s36, 2112
m16 v[180:183],a[4:7],a[72:75],0
rtr a[200:201],v249,32800
buffer_load_dwordx4 v244, s[12:15], s61 offen offset:1024 lds
m16 v[120:123],a[8:11],a[64:67],0
s_lshl_b32 s96, s32, 5
rtr a[202:203],v249,33824
m16 v[152:155],a[8:11],a[68:71],0
rtr a[204:205],v249,32808
s_lshl_b32 s97, s33, 1
m16 v[184:187],a[8:11],a[72:75],0
buffer_load_dwordx4 v244, s[12:15], s62 offen offset:2048 lds
m16 v[124:127],a[12:15],a[64:67],0
rtr a[206:207],v249,33832
s_add_u32 s96, s96, s97
m16 v[156:159],a[12:15],a[68:71],0
rtr a[208:209],v248,33312
m16 v[188:191],a[12:15],a[72:75],0
rtr a[210:211],v248,34336
buffer_load_dwordx4 v244, s[12:15], s63 offen offset:3072 lds
m16 v[128:131],a[16:19],a[64:67],0
s_lshl_b32 s96, s96, 17
m16 v[160:163],a[16:19],a[68:71],0
rtr a[212:213],v248,33320
s_add_u32 s16, s42, s96
s_addc_u32 s17, s43, 0
m16 v[192:195],a[16:19],a[72:75],0
rtr a[214:215],v248,34344
v_add_u32 v244, 262144, v244
m16 v[132:135],a[20:23],a[64:67],0
rtr a[216:217],v249,33312
s_mov_b32 s18, 0x40000
m16 v[164:167],a[20:23],a[68:71],0
m16 v[196:199],a[20:23],a[72:75],0
rtr a[218:219],v249,34336
s_add_u32 m0, s69, 0
m16 v[136:139],a[24:27],a[64:67],0
s_mov_b32 s19, 0x00020000
rtr a[220:221],v249,33320
m16 v[168:171],a[24:27],a[68:71],0
rtr a[222:223],v249,34344
s_add_u32 s20, s44, s96
s_addc_u32 s21, s45, 0
m16 v[200:203],a[24:27],a[72:75],0
buffer_load_dwordx4 v245, s[8:11], s64 offen offset:0 lds
m16 v[140:143],a[28:31],a[64:67],0
rtr a[224:225],v248,36896
s_mov_b32 s22, 0x40000
m16 v[172:175],a[28:31],a[68:71],0
rtr a[226:227],v248,37920
m16 v[204:207],a[28:31],a[72:75],0
rtr a[228:229],v248,36904
buffer_load_dwordx4 v251, s[8:11], s64 offen offset:1024 lds
m16 v[16:19],a[32:35],a[64:67],0
s_mov_b32 s23, 0x00020000
rtr a[230:231],v248,37928
m16 v[48:51],a[32:35],a[68:71],0
s_lshl_b32 s96, s31, 3
buffer_load_dwordx4 v245, s[8:11], s65 offen offset:2048 lds
m16 v[80:83],a[32:35],a[72:75],0
rtr a[232:233],v249,36896
s_add_u32 s96, s96, s32
m16 v[20:23],a[36:39],a[64:67],0
rtr a[234:235],v249,37920
m16 v[52:55],a[36:39],a[68:71],0
rtr a[236:237],v249,36904
buffer_load_dwordx4 v251, s[8:11], s65 offen offset:3072 lds
m16 v[84:87],a[36:39],a[72:75],0
s_lshl_b32 s39, s96, 4
m16 v[24:27],a[40:43],a[64:67],0
rtr a[238:239],v249,37928
s_add_u32 s39, s39, s33
m16 v[56:59],a[40:43],a[68:71],0
rtr a[240:241],v248,37408
s_add_u32 m0, s69, 4096
m16 v[88:91],a[40:43],a[72:75],0
rtr a[242:243],v248,38432
s_mul_i32 s96, s96, 2130944
m16 v[28:31],a[44:47],a[64:67],0
m16 v[60:63],a[44:47],a[68:71],0
rtr a[244:245],v248,37416
buffer_load_dwordx4 v245, s[8:11], s66 offen offset:0 lds
m16 v[92:95],a[44:47],a[72:75],0
s_add_u32 s24, s34, s96
s_addc_u32 s25, s35, 0
rtr a[246:247],v248,38440
m16 v[32:35],a[48:51],a[64:67],0
rtr a[248:249],v249,37408
s_mov_b32 s26, 0x200000
m16 v[64:67],a[48:51],a[68:71],0
buffer_load_dwordx4 v251, s[8:11], s66 offen offset:1024 lds
m16 v[96:99],a[48:51],a[72:75],0
rtr a[250:251],v249,38432
s_mov_b32 s27, 0x00020000
m16 v[36:39],a[52:55],a[64:67],0
rtr a[252:253],v249,37416
m16 v[68:71],a[52:55],a[68:71],0
rtr a[254:255],v249,38440
v_add_u32 v245, 128, v245
m16 v[100:103],a[52:55],a[72:75],0
s_mov_b32 s56, s4
m16 v[40:43],a[56:59],a[64:67],0
s_mov_b32 s57, s5
m16 v[72:75],a[56:59],a[68:71],0
v_add_u32 v251, 128, v251
m16 v[104:107],a[56:59],a[72:75],0
s_mov_b32 s58, 8388608
m16 v[44:47],a[60:63],a[64:67],0
m16 v[76:79],a[60:63],a[68:71],0
m16 v[108:111],a[60:63],a[72:75],0
s_waitcnt vmcnt(10) lgkmcnt(0)
s_barrier
m16 v[112:115],a[192:195],a[76:79],v[112:115]
r128 a[88:91],v246,22528
s_add_u32 m0, s68, 32800
m16 v[144:147],a[192:195],a[80:83],v[144:147]
s_mov_b32 s59, 0x00020000
r128 a[92:95],v246,24576
m16 v[176:179],a[192:195],a[84:87],v[176:179]
s_mov_b32 s40, 0x3e0293ee
r128 v[240:243],v246,26624
m16 v[116:119],a[196:199],a[76:79],v[116:119]
r128 a[64:67],v247,22528
buffer_load_dwordx4 v244, s[12:15], s60 offen offset:0 lds
m16 v[148:151],a[196:199],a[80:83],v[148:151]
s_mov_b32 s41, 0x3e0293ee
r128 a[68:71],v247,24576
m16 v[180:183],a[196:199],a[84:87],v[180:183]
r128 a[72:75],v247,26624
s_mov_b32 s42, 1
m16 v[120:123],a[200:203],a[76:79],v[120:123]
rtr a[0:1],v248,0
m16 v[152:155],a[200:203],a[80:83],v[152:155]
rtr a[2:3],v248,1024
buffer_load_dwordx4 v244, s[12:15], s61 offen offset:1024 lds
m16 v[184:187],a[200:203],a[84:87],v[184:187]
s_mov_b32 s43, 0
rtr a[4:5],v248,8
m16 v[124:127],a[204:207],a[76:79],v[124:127]
rtr a[6:7],v248,1032
s_mov_b32 s37, s32
m16 v[156:159],a[204:207],a[80:83],v[156:159]
m16 v[188:191],a[204:207],a[84:87],v[188:191]
rtr a[8:9],v249,0
buffer_load_dwordx4 v244, s[12:15], s62 offen offset:2048 lds
m16 v[128:131],a[208:211],a[76:79],v[128:131]
s_and_b32 s38, s3, 1
rtr a[10:11],v249,1024
m16 v[160:163],a[208:211],a[80:83],v[160:163]
rtr a[12:13],v249,8
s_lshl_b32 s38, s38, 2
m16 v[192:195],a[208:211],a[84:87],v[192:195]
rtr a[14:15],v249,1032
m16 v[132:135],a[212:215],a[76:79],v[132:135]
rtr a[16:17],v248,512
buffer_load_dwordx4 v244, s[12:15], s63 offen offset:3072 lds
m16 v[164:167],a[212:215],a[80:83],v[164:167]
s_lshr_b32 s96, s30, 3
rtr a[18:19],v248,1536
m16 v[196:199],a[212:215],a[84:87],v[196:199]
rtr a[20:21],v248,520
s_add_u32 s38, s38, s96
m16 v[136:139],a[216:219],a[76:79],v[136:139]
rtr a[22:23],v248,1544
m16 v[168:171],a[216:219],a[80:83],v[168:171]
rtr a[24:25],v249,512
v_add_u32 v244, 262144, v244
m16 v[200:203],a[216:219],a[84:87],v[200:203]
s_bfe_u32 s67, s3, 0x10001
m16 v[140:143],a[220:223],a[76:79],v[140:143]
rtr a[26:27],v249,1536
s_mov_b32 s44, 31744
m16 v[172:175],a[220:223],a[80:83],v[172:175]
rtr a[28:29],v249,520
m16 v[204:207],a[220:223],a[84:87],v[204:207]
rtr a[30:31],v249,1544
s_add_u32 m0, s100, 0
m16 v[16:19],a[224:227],a[76:79],v[16:19]
s_mov_b32 s45, 14336
rtr a[32:33],v248,4096
m16 v[48:51],a[224:227],a[80:83],v[48:51]
s_mov_b32 s46, 46080
rtr a[34:35],v248,5120
m16 v[80:83],a[224:227],a[84:87],v[80:83]
rtr a[36:37],v248,4104
s_mov_b32 s28, 0
m16 v[20:23],a[228:231],a[76:79],v[20:23]
s_mov_b32 s47, 11264
rtr a[38:39],v248,5128
m16 v[52:55],a[228:231],a[80:83],v[52:55]
rtr a[40:41],v249,4096
s_mov_b32 s4, 22528
m16 v[84:87],a[228:231],a[84:87],v[84:87]
rtr a[42:43],v249,5120
m16 v[24:27],a[232:235],a[76:79],v[24:27]
rtr a[44:45],v249,4104
buffer_load_dwordx4 v14, s[16:19], s28 offen offset:0 nt lds
m16 v[56:59],a[232:235],a[80:83],v[56:59]
s_mov_b32 s5, 33792
m16 v[88:91],a[232:235],a[84:87],v[88:91]
rtr a[46:47],v249,5128
s_sub_u32 s70, s68, 114640
m16 v[28:31],a[236:239],a[76:79],v[28:31]
rtr a[48:49],v248,4608
m16 v[60:63],a[236:239],a[80:83],v[60:63]
rtr a[50:51],v248,5632
s_add_u32 m0, s100, 800
m16 v[92:95],a[236:239],a[84:87],v[92:95]
s_cmp_eq_u32 s67, 0
s_cselect_b32 s6, 48, 4294967216
rtr a[52:53],v248,4616
m16 v[32:35],a[240:243],a[76:79],v[32:35]
rtr a[54:55],v248,5640
s_mul_i32 s7, s6, 11264
m16 v[64:67],a[240:243],a[80:83],v[64:67]
rtr a[56:57],v249,4608
m16 v[96:99],a[240:243],a[84:87],v[96:99]
rtr a[58:59],v249,5632
s_mov_b32 s28, 0
m16 v[36:39],a[244:247],a[76:79],v[36:39]
s_lshl_b32 s6, s6, 16
rtr a[60:61],v249,4616
m16 v[68:71],a[244:247],a[80:83],v[68:71]
rtr a[62:63],v249,5640
s_mov_b32 s3, s67
m16 v[100:103],a[244:247],a[84:87],v[100:103]
m16 v[40:43],a[248:251],a[76:79],v[40:43]
buffer_load_dwordx4 v14, s[16:19], s28 offen offset:256 nt lds
s_and_b32 s96, s2, 3
m16 v[72:75],a[248:251],a[80:83],v[72:75]
m16 v[104:107],a[248:251],a[84:87],v[104:107]
s_lshl_b32 s96, s96, 5
m16 v[44:47],a[252:255],a[76:79],v[44:47]
m16 v[76:79],a[252:255],a[80:83],v[76:79]
m16 v[108:111],a[252:255],a[84:87],v[108:111]
s_waitcnt vmcnt(12) lgkmcnt(0)
s_barrier
m16 v[112:115],a[0:3],a[88:91],v[112:115]
rtr a[192:193],v248,16400
s_add_u32 m0, s68, 0
m16 v[144:147],a[0:3],a[92:95],v[144:147]
s_add_u32 s96, s96, s30
rtr a[194:195],v248,17424
m16 v[176:179],a[0:3],v[240:243],v[176:179]
s_lshl_b32 s96, s96, 2
rtr a[196:197],v248,16408
m16 v[116:119],a[4:7],a[88:91],v[116:119]
buffer_load_dwordx4 v244, s[12:15], s60 offen offset:0 lds
rtr a[198:199],v248,17432
m16 v[148:151],a[4:7],a[92:95],v[148:151]
s_add_u32 s96, s96, s36
buffer_load_dwordx4 v244, s[12:15], s61 offen offset:1024 lds
m16 v[180:183],a[4:7],v[240:243],v[180:183]
rtr a[200:201],v249,16400
s_lshl_b32 s96, s96, 14
m16 v[120:123],a[8:11],a[88:91],v[120:123]
rtr a[202:203],v249,17424
buffer_load_dwordx4 v244, s[12:15], s62 offen offset:2048 lds
m16 v[152:155],a[8:11],a[92:95],v[152:155]
rtr a[204:205],v249,16408
v_lshlrev_b32 v250, 7, v0
m16 v[184:187],a[8:11],v[240:243],v[184:187]
buffer_load_dwordx4 v244, s[12:15], s63 offen offset:3072 lds
m16 v[124:127],a[12:15],a[88:91],v[124:127]
rtr a[206:207],v249,17432
v_add_u32 v250, s96, v250
m16 v[156:159],a[12:15],a[92:95],v[156:159]
rtr a[208:209],v248,16912
v_add_u32 v244, 262144, v244
m16 v[188:191],a[12:15],v[240:243],v[188:191]
rtr a[210:211],v248,17936
v_mov_b32 v208, 0x80000000
m16 v[128:131],a[16:19],a[88:91],v[128:131]
s_add_u32 m0, s69, 22528
m16 v[160:163],a[16:19],a[92:95],v[160:163]
rtr a[212:213],v248,16920
v_cmp_gt_u32 vcc, 5, v0
m16 v[192:195],a[16:19],v[240:243],v[192:195]
rtr a[214:215],v248,17944
buffer_load_dwordx4 v245, s[8:11], s64 offen offset:0 lds
m16 v[132:135],a[20:23],a[88:91],v[132:135]
rtr a[216:217],v249,16912
s_lshl_b32 s97, s33, 2
m16 v[164:167],a[20:23],a[92:95],v[164:167]
buffer_load_dwordx4 v251, s[8:11], s64 offen offset:1024 lds
m16 v[196:199],a[20:23],v[240:243],v[196:199]
rtr a[218:219],v249,17936
s_add_u32 s96, s97, 1974272
m16 v[136:139],a[24:27],a[88:91],v[136:139]
rtr a[220:221],v249,16920
buffer_load_dwordx4 v245, s[8:11], s65 offen offset:2048 lds
m16 v[168:171],a[24:27],a[92:95],v[168:171]
rtr a[222:223],v249,17944
v_cndmask_b32 v250, v208, v250, vcc
m16 v[200:203],a[24:27],v[240:243],v[200:203]
buffer_load_dwordx4 v251, s[8:11], s65 offen offset:3072 lds
m16 v[140:143],a[28:31],a[88:91],v[140:143]
rtr a[224:225],v248,20496
s_add_u32 s97, s97, s36
m16 v[172:175],a[28:31],a[92:95],v[172:175]
rtr a[226:227],v248,21520
m16 v[204:207],a[28:31],v[240:243],v[204:207]
rtr a[228:229],v248,20504
s_add_u32 m0, s69, 26624
m16 v[16:19],a[32:35],a[88:91],v[16:19]
s_lshl_b32 s97, s97, 7
rtr a[230:231],v248,21528
m16 v[48:51],a[32:35],a[92:95],v[48:51]
s_add_u32 s97, s97, 1966080
buffer_load_dwordx4 v245, s[8:11], s66 offen offset:0 lds
m16 v[80:83],a[32:35],v[240:243],v[80:83]
rtr a[232:233],v249,20496
v_mov_b32 v214, s97
m16 v[20:23],a[36:39],a[88:91],v[20:23]
rtr a[234:235],v249,21520
buffer_load_dwordx4 v251, s[8:11], s66 offen offset:1024 lds
m16 v[52:55],a[36:39],a[92:95],v[52:55]
rtr a[236:237],v249,20504
v_mov_b32 v213, s96
m16 v[84:87],a[36:39],v[240:243],v[84:87]
v_add_u32 v245, 128, v245
m16 v[24:27],a[40:43],a[88:91],v[24:27]
rtr a[238:239],v249,21528
v_cmp_eq_u32 vcc, 0, v0
m16 v[56:59],a[40:43],a[92:95],v[56:59]
rtr a[240:241],v248,21008
v_add_u32 v251, 128, v251
m16 v[88:91],a[40:43],v[240:243],v[88:91]
rtr a[242:243],v248,22032
v_mov_b32 v215, 0
m16 v[28:31],a[44:47],a[88:91],v[28:31]
s_add_u32 m0, s100, 8448
m16 v[60:63],a[44:47],a[92:95],v[60:63]
rtr a[244:245],v248,21016
s_mov_b32 s52, s50
m16 v[92:95],a[44:47],v[240:243],v[92:95]
rtr a[246:247],v248,22040
s_mov_b32 s28, 8192
m16 v[32:35],a[48:51],a[88:91],v[32:35]
rtr a[248:249],v249,21008
s_mov_b32 s53, s51
m16 v[64:67],a[48:51],a[92:95],v[64:67]
buffer_load_dwordx4 v14, s[16:19], s28 offen offset:0 nt lds
m16 v[96:99],a[48:51],v[240:243],v[96:99]
rtr a[250:251],v249,22032
v_cndmask_b32 v214, v213, v214, vcc
m16 v[36:39],a[52:55],a[88:91],v[36:39]
rtr a[252:253],v249,21016
s_add_u32 m0, s100, 9248
m16 v[68:71],a[52:55],a[92:95],v[68:71]
rtr a[254:255],v249,22040
s_mov_b32 s54, 256
m16 v[100:103],a[52:55],v[240:243],v[100:103]
s_mov_b32 s28, 8192
m16 v[40:43],a[56:59],a[88:91],v[40:43]
s_mov_b32 s55, 0x00020000
m16 v[72:75],a[56:59],a[92:95],v[72:75]
buffer_load_dwordx4 v14, s[16:19], s28 offen offset:256 nt lds
m16 v[104:107],a[56:59],v[240:243],v[104:107]
s_mov_b64 exec, 3
buffer_store_dword v215, v214, s[24:27], 0 offen sc1
s_mov_b64 exec, -1
s_nop 3
m16 v[44:47],a[60:63],a[88:91],v[44:47]
m16 v[76:79],a[60:63],a[92:95],v[76:79]
m16 v[108:111],a[60:63],v[240:243],v[108:111]
s_waitcnt vmcnt(15) lgkmcnt(0)
s_barrier
m16 v[112:115],a[192:195],a[64:67],v[112:115]
r128 a[76:79],v246,0
s_add_u32 m0, s68, 16400
m16 v[144:147],a[192:195],a[68:71],v[144:147]
s_mov_b32 s50, 5767168
r128 a[80:83],v246,2048
m16 v[176:179],a[192:195],a[72:75],v[176:179]
s_mov_b32 s51, 0x00020000
r128 a[84:87],v246,4096
m16 v[116:119],a[196:199],a[64:67],v[116:119]
r128 a[88:91],v247,0
s_lshl_b32 s71, s33, 2
m16 v[148:151],a[196:199],a[68:71],v[148:151]
r128 a[92:95],v247,2048
m16 v[180:183],a[196:199],a[72:75],v[180:183]
r128 v[240:243],v247,4096
buffer_load_dwordx4 v244, s[12:15], s60 offen offset:0 lds
m16 v[120:123],a[200:203],a[64:67],v[120:123]
s_add_u32 s71, s71, 1974272
rtr a[0:1],v248,32800
m16 v[152:155],a[200:203],a[68:71],v[152:155]
rtr a[2:3],v248,33824
v_lshlrev_b32 v15, 4, v0
m16 v[184:187],a[200:203],a[72:75],v[184:187]
rtr a[4:5],v248,32808
m16 v[124:127],a[204:207],a[64:67],v[124:127]
rtr a[6:7],v248,33832
v_add_u32 v15, s100, v15
m16 v[156:159],a[204:207],a[68:71],v[156:159]
buffer_load_dwordx4 v244, s[12:15], s61 offen offset:1024 lds
m16 v[188:191],a[204:207],a[72:75],v[188:191]
rtr a[8:9],v249,32800
v_add_u32 v253, 67584, v15
m16 v[128:131],a[208:211],a[64:67],v[128:131]
rtr a[10:11],v249,33824
m16 v[160:163],a[208:211],a[68:71],v[160:163]
rtr a[12:13],v249,32808
v_and_b32 v208, 7, v0
m16 v[192:195],a[208:211],a[72:75],v[192:195]
rtr a[14:15],v249,33832
m16 v[132:135],a[212:215],a[64:67],v[132:135]
rtr a[16:17],v248,33312
buffer_load_dwordx4 v244, s[12:15], s62 offen offset:2048 lds
m16 v[164:167],a[212:215],a[68:71],v[164:167]
v_mul_u32_u24 v208, 1056, v208
rtr a[18:19],v248,34336
m16 v[196:199],a[212:215],a[72:75],v[196:199]
rtr a[20:21],v248,33320
v_bfe_u32 v209, v0, 3, 1
m16 v[136:139],a[216:219],a[64:67],v[136:139]
rtr a[22:23],v248,34344
m16 v[168:171],a[216:219],a[68:71],v[168:171]
rtr a[24:25],v249,33312
v_lshl_add_u32 v208, v209, 8, v208
m16 v[200:203],a[216:219],a[72:75],v[200:203]
buffer_load_dwordx4 v244, s[12:15], s63 offen offset:3072 lds
m16 v[140:143],a[220:223],a[64:67],v[140:143]
rtr a[26:27],v249,34336
v_lshrrev_b32 v209, 4, v0
m16 v[172:175],a[220:223],a[68:71],v[172:175]
rtr a[28:29],v249,33320
m16 v[204:207],a[220:223],a[72:75],v[204:207]
rtr a[30:31],v249,34344
v_lshl_add_u32 v3, v209, 4, v208
m16 v[16:19],a[224:227],a[64:67],v[16:19]
rtr a[32:33],v248,36896
v_add_u32 v1, 67584, v3
m16 v[48:51],a[224:227],a[68:71],v[48:51]
rtr a[34:35],v248,37920
v_add_u32 v244, 262144, v244
m16 v[80:83],a[224:227],a[72:75],v[80:83]
rtr a[36:37],v248,36904
v_bfe_u32 v208, v0, 2, 3
m16 v[20:23],a[228:231],a[64:67],v[20:23]
rtr a[38:39],v248,37928
m16 v[52:55],a[228:231],a[68:71],v[52:55]
rtr a[40:41],v249,36896
v_mul_u32_u24 v208, 1056, v208
m16 v[84:87],a[228:231],a[72:75],v[84:87]
rtr a[42:43],v249,37920
m16 v[24:27],a[232:235],a[64:67],v[24:27]
rtr a[44:45],v249,36904
s_add_u32 m0, s100, 16896
m16 v[56:59],a[232:235],a[68:71],v[56:59]
v_lshrrev_b32 v209, 5, v0
m16 v[88:91],a[232:235],a[72:75],v[88:91]
rtr a[46:47],v249,37928
v_lshl_add_u32 v208, v209, 8, v208
m16 v[28:31],a[236:239],a[64:67],v[28:31]
rtr a[48:49],v248,37408
m16 v[60:63],a[236:239],a[68:71],v[60:63]
rtr a[50:51],v248,38432
v_and_b32 v210, 3, v0
m16 v[92:95],a[236:239],a[72:75],v[92:95]
rtr a[52:53],v248,37416
s_mov_b32 s28, 0
m16 v[32:35],a[240:243],a[64:67],v[32:35]
rtr a[54:55],v248,38440
v_lshl_add_u32 v208, v210, 3, v208
m16 v[64:67],a[240:243],a[68:71],v[64:67]
rtr a[56:57],v249,37408
m16 v[96:99],a[240:243],a[72:75],v[96:99]
rtr a[58:59],v249,38432
v_add_u32 v4, 16896, v208
m16 v[36:39],a[244:247],a[64:67],v[36:39]
rtr a[60:61],v249,37416
m16 v[68:71],a[244:247],a[68:71],v[68:71]
rtr a[62:63],v249,38440
buffer_load_dwordx4 v14, s[20:23], s28 offen offset:0 nt lds
m16 v[100:103],a[244:247],a[72:75],v[100:103]
v_add_u32 v2, 67584, v4
m16 v[40:43],a[248:251],a[64:67],v[40:43]
s_mul_i32 s96, s33, 90112
m16 v[72:75],a[248:251],a[68:71],v[72:75]
m16 v[104:107],a[248:251],a[72:75],v[104:107]
s_mul_i32 s97, s36, 3072
m16 v[44:47],a[252:255],a[64:67],v[44:47]
m16 v[76:79],a[252:255],a[68:71],v[76:79]
m16 v[108:111],a[252:255],a[72:75],v[108:111]
s_waitcnt vmcnt(14) lgkmcnt(0)
s_barrier
m16 v[112:115],a[0:3],a[76:79],v[112:115]
rtr a[192:193],v248,0
s_add_u32 m0, s68, 32800
m16 v[144:147],a[0:3],a[80:83],v[144:147]
s_add_u32 s96, s96, s97
rtr a[194:195],v248,1024
m16 v[176:179],a[0:3],a[84:87],v[176:179]
v_lshlrev_b32 v5, 4, v0
rtr a[196:197],v248,8
m16 v[116:119],a[4:7],a[76:79],v[116:119]
buffer_load_dwordx4 v244, s[12:15], s60 offen offset:0 lds
rtr a[198:199],v248,1032
m16 v[148:151],a[4:7],a[80:83],v[148:151]
v_add_u32 v5, s96, v5
buffer_load_dwordx4 v244, s[12:15], s61 offen offset:1024 lds
m16 v[180:183],a[4:7],a[84:87],v[180:183]
rtr a[200:201],v249,0
v_bfe_u32 v211, v0, 2, 2
m16 v[120:123],a[8:11],a[76:79],v[120:123]
rtr a[202:203],v249,1024
buffer_load_dwordx4 v244, s[12:15], s62 offen offset:2048 lds
m16 v[152:155],a[8:11],a[80:83],v[152:155]
rtr a[204:205],v249,8
v_bfe_u32 v212, v0, 4, 1
m16 v[184:187],a[8:11],a[84:87],v[184:187]
buffer_load_dwordx4 v244, s[12:15], s63 offen offset:3072 lds
m16 v[124:127],a[12:15],a[76:79],v[124:127]
rtr a[206:207],v249,1032
v_mul_u32_u24 v208, 8200, v212
m16 v[156:159],a[12:15],a[80:83],v[156:159]
rtr a[208:209],v248,512
v_add_u32 v244, 262144, v244
m16 v[188:191],a[12:15],a[84:87],v[188:191]
rtr a[210:211],v248,1536
v_lshl_add_u32 v208, v209, 11, v208
m16 v[128:131],a[16:19],a[76:79],v[128:131]
s_add_u32 m0, s69, 0
m16 v[160:163],a[16:19],a[80:83],v[160:163]
rtr a[212:213],v248,520
v_lshl_add_u32 v208, v211, 6, v208
m16 v[192:195],a[16:19],a[84:87],v[192:195]
rtr a[214:215],v248,1544
buffer_load_dwordx4 v245, s[8:11], s64 offen offset:0 lds
m16 v[132:135],a[20:23],a[76:79],v[132:135]
rtr a[216:217],v249,512
v_lshl_add_u32 v208, v210, 4, v208
m16 v[164:167],a[20:23],a[80:83],v[164:167]
buffer_load_dwordx4 v251, s[8:11], s64 offen offset:1024 lds
m16 v[196:199],a[20:23],a[84:87],v[196:199]
rtr a[218:219],v249,1536
v_mov_b32 v10, v208
m16 v[136:139],a[24:27],a[76:79],v[136:139]
rtr a[220:221],v249,520
buffer_load_dwordx4 v245, s[8:11], s65 offen offset:2048 lds
m16 v[168:171],a[24:27],a[80:83],v[168:171]
rtr a[222:223],v249,1544
v_add_u32 v11, 67584, v208
m16 v[200:203],a[24:27],a[84:87],v[200:203]
buffer_load_dwordx4 v251, s[8:11], s65 offen offset:3072 lds
m16 v[140:143],a[28:31],a[76:79],v[140:143]
rtr a[224:225],v248,4096
v_add_u32 v12, 147424, v208
m16 v[172:175],a[28:31],a[80:83],v[172:175]
rtr a[226:227],v248,5120
m16 v[204:207],a[28:31],a[84:87],v[204:207]
rtr a[228:229],v248,4104
s_add_u32 m0, s69, 4096
m16 v[16:19],a[32:35],a[76:79],v[16:19]
s_lshl_b32 s96, s31, 3
rtr a[230:231],v248,5128
m16 v[48:51],a[32:35],a[80:83],v[48:51]
s_add_u32 s96, s96, s37
buffer_load_dwordx4 v245, s[8:11], s66 offen offset:0 lds
m16 v[80:83],a[32:35],a[84:87],v[80:83]
rtr a[232:233],v249,4096
s_lshl_b32 s97, s96, 4
m16 v[20:23],a[36:39],a[76:79],v[20:23]
rtr a[234:235],v249,5120
buffer_load_dwordx4 v251, s[8:11], s66 offen offset:1024 lds
m16 v[52:55],a[36:39],a[80:83],v[52:55]
rtr a[236:237],v249,4104
v_lshl_add_u32 v9, v210, 2, s97
m16 v[84:87],a[36:39],a[84:87],v[84:87]
v_add_u32 v245, 128, v245
m16 v[24:27],a[40:43],a[76:79],v[24:27]
rtr a[238:239],v249,5128
s_mov_b32 s97, 1974272
m16 v[56:59],a[40:43],a[80:83],v[56:59]
rtr a[240:241],v248,4608
v_add_u32 v251, 128, v251
m16 v[88:91],a[40:43],a[84:87],v[88:91]
rtr a[242:243],v248,5632
v_and_b32 v13, 15, v0
m16 v[28:31],a[44:47],a[76:79],v[28:31]
s_add_u32 m0, s100, 17696
m16 v[60:63],a[44:47],a[80:83],v[60:63]
rtr a[244:245],v248,4616
v_lshl_add_u32 v13, v13, 2, s97
m16 v[92:95],a[44:47],a[84:87],v[92:95]
rtr a[246:247],v248,5640
s_mov_b32 s28, 0
m16 v[32:35],a[48:51],a[76:79],v[32:35]
rtr a[248:249],v249,4608
v_bfe_u32 v211, v0, 2, 2
m16 v[64:67],a[48:51],a[80:83],v[64:67]
buffer_load_dwordx4 v14, s[20:23], s28 offen offset:256 nt lds
m16 v[96:99],a[48:51],a[84:87],v[96:99]
rtr a[250:251],v249,5632
v_and_b32 v210, 3, v0
m16 v[36:39],a[52:55],a[76:79],v[36:39]
rtr a[252:253],v249,4616
s_add_u32 m0, s100, 25344
m16 v[68:71],a[52:55],a[80:83],v[68:71]
rtr a[254:255],v249,5640
v_lshlrev_b32 v208, 11, v211
m16 v[100:103],a[52:55],a[84:87],v[100:103]
s_mov_b32 s28, 8192
m16 v[40:43],a[56:59],a[76:79],v[40:43]
v_lshl_add_u32 v208, v210, 4, v208
m16 v[72:75],a[56:59],a[80:83],v[72:75]
buffer_load_dwordx4 v14, s[20:23], s28 offen offset:0 nt lds
m16 v[104:107],a[56:59],a[84:87],v[104:107]
s_and_b32 s96, s36, 1
m16 v[44:47],a[60:63],a[76:79],v[44:47]
m16 v[76:79],a[60:63],a[80:83],v[76:79]
m16 v[108:111],a[60:63],a[84:87],v[108:111]
s_waitcnt vmcnt(13) lgkmcnt(0)
s_barrier
m16 v[112:115],a[192:195],a[88:91],v[112:115]
r128 a[64:67],v246,22528
s_add_u32 m0, s68, 0
m16 v[144:147],a[192:195],a[92:95],v[144:147]
s_lshl_b32 s96, s96, 13
r128 a[68:71],v246,24576
m16 v[176:179],a[192:195],v[240:243],v[176:179]
s_lshl_b32 s97, s38, 8
r128 a[72:75],v246,26624
m16 v[116:119],a[196:199],a[88:91],v[116:119]
r128 a[76:79],v247,22528
s_add_u32 s96, s96, s97
m16 v[148:151],a[196:199],a[92:95],v[148:151]
r128 a[80:83],v247,24576
m16 v[180:183],a[196:199],v[240:243],v[180:183]
r128 a[84:87],v247,26624
buffer_load_dwordx4 v244, s[12:15], s60 offen offset:0 lds
m16 v[120:123],a[200:203],a[88:91],v[120:123]
s_lshl_b32 s97, s3, 22
rtr a[0:1],v248,16400
m16 v[152:155],a[200:203],a[92:95],v[152:155]
rtr a[2:3],v248,17424
s_add_u32 s96, s96, s97
m16 v[184:187],a[200:203],v[240:243],v[184:187]
rtr a[4:5],v248,16408
m16 v[124:127],a[204:207],a[88:91],v[124:127]
rtr a[6:7],v248,17432
v_add_u32 v208, s96, v208
m16 v[156:159],a[204:207],a[92:95],v[156:159]
buffer_load_dwordx4 v244, s[12:15], s61 offen offset:1024 lds
m16 v[188:191],a[204:207],v[240:243],v[188:191]
rtr a[8:9],v249,16400
v_lshrrev_b32 v209, 4, v0
m16 v[128:131],a[208:211],a[88:91],v[128:131]
rtr a[10:11],v249,17424
m16 v[160:163],a[208:211],a[92:95],v[160:163]
rtr a[12:13],v249,16408
s_lshl_b32 s97, s3, 1
m16 v[192:195],a[208:211],v[240:243],v[192:195]
rtr a[14:15],v249,17432
m16 v[132:135],a[212:215],a[88:91],v[132:135]
rtr a[16:17],v248,16912
buffer_load_dwordx4 v244, s[12:15], s62 offen offset:2048 lds
m16 v[164:167],a[212:215],a[92:95],v[164:167]
v_xor_b32 v212, s97, v209
rtr a[18:19],v248,17936
m16 v[196:199],a[212:215],v[240:243],v[196:199]
rtr a[20:21],v248,16920
v_lshl_add_u32 v6, v212, 6, v208
m16 v[136:139],a[216:219],a[88:91],v[136:139]
rtr a[22:23],v248,17944
m16 v[168:171],a[216:219],a[92:95],v[168:171]
rtr a[24:25],v249,16912
s_lshr_b32 s96, s36, 1
m16 v[200:203],a[216:219],v[240:243],v[200:203]
buffer_load_dwordx4 v244, s[12:15], s63 offen offset:3072 lds
m16 v[140:143],a[220:223],a[88:91],v[140:143]
rtr a[26:27],v249,17936
s_lshl_b32 s97, s96, 16
m16 v[172:175],a[220:223],a[92:95],v[172:175]
rtr a[28:29],v249,16920
m16 v[204:207],a[220:223],v[240:243],v[204:207]
rtr a[30:31],v249,17944
v_add_u32 v6, s97, v6
m16 v[16:19],a[224:227],a[88:91],v[16:19]
rtr a[32:33],v248,20496
v_and_b32 v212, 1, v209
m16 v[48:51],a[224:227],a[92:95],v[48:51]
rtr a[34:35],v248,21520
v_add_u32 v244, 262144, v244
m16 v[80:83],a[224:227],v[240:243],v[80:83]
rtr a[36:37],v248,20504
v_lshl_add_u32 v8, v212, 6, v208
m16 v[20:23],a[228:231],a[88:91],v[20:23]
rtr a[38:39],v248,21528
m16 v[52:55],a[228:231],a[92:95],v[52:55]
rtr a[40:41],v249,20496
v_lshrrev_b32 v212, 1, v209
m16 v[84:87],a[228:231],v[240:243],v[84:87]
rtr a[42:43],v249,21520
m16 v[24:27],a[232:235],a[88:91],v[24:27]
rtr a[44:45],v249,20504
s_add_u32 m0, s100, 26144
m16 v[56:59],a[232:235],a[92:95],v[56:59]
v_lshl_add_u32 v8, v212, 16, v8
m16 v[88:91],a[232:235],v[240:243],v[88:91]
rtr a[46:47],v249,21528
s_lshl_b32 s97, s96, 17
m16 v[28:31],a[236:239],a[88:91],v[28:31]
rtr a[48:49],v248,21008
m16 v[60:63],a[236:239],a[92:95],v[60:63]
rtr a[50:51],v248,22032
s_lshl_b32 s96, s3, 7
m16 v[92:95],a[236:239],v[240:243],v[92:95]
rtr a[52:53],v248,21016
s_mov_b32 s28, 8192
m16 v[32:35],a[240:243],a[88:91],v[32:35]
rtr a[54:55],v248,22040
s_add_u32 s97, s97, s96
m16 v[64:67],a[240:243],a[92:95],v[64:67]
rtr a[56:57],v249,21008
m16 v[96:99],a[240:243],v[240:243],v[96:99]
rtr a[58:59],v249,22032
v_add_u32 v8, s97, v8
m16 v[36:39],a[244:247],a[88:91],v[36:39]
rtr a[60:61],v249,21016
m16 v[68:71],a[244:247],a[92:95],v[68:71]
rtr a[62:63],v249,22040
buffer_load_dwordx4 v14, s[20:23], s28 offen offset:256 nt lds
m16 v[100:103],a[244:247],v[240:243],v[100:103]
s_mul_i32 s96, s36, 3072
m16 v[40:43],a[248:251],a[88:91],v[40:43]
s_mul_i32 s97, s3, 720896
m16 v[72:75],a[248:251],a[92:95],v[72:75]
m16 v[104:107],a[248:251],v[240:243],v[104:107]
s_add_u32 s96, s96, s97
m16 v[44:47],a[252:255],a[88:91],v[44:47]
m16 v[76:79],a[252:255],a[92:95],v[76:79]
m16 v[108:111],a[252:255],v[240:243],v[108:111]
s_waitcnt vmcnt(13) lgkmcnt(0)
s_barrier
m16 v[112:115],a[0:3],a[64:67],v[112:115]
rtr a[192:193],v248,32800
s_add_u32 m0, s68, 16400
m16 v[144:147],a[0:3],a[68:71],v[144:147]
v_lshlrev_b32 v7, 4, v0
rtr a[194:195],v248,33824
m16 v[176:179],a[0:3],a[72:75],v[176:179]
rtr a[196:197],v248,32808
buffer_load_dwordx4 v244, s[12:15], s60 offen offset:0 lds
m16 v[116:119],a[4:7],a[64:67],v[116:119]
rtr a[198:199],v248,33832
m16 v[148:151],a[4:7],a[68:71],v[148:151]
buffer_load_dwordx4 v244, s[12:15], s61 offen offset:1024 lds
m16 v[180:183],a[4:7],a[72:75],v[180:183]
rtr a[200:201],v249,32800
m16 v[120:123],a[8:11],a[64:67],v[120:123]
rtr a[202:203],v249,33824
buffer_load_dwordx4 v244, s[12:15], s62 offen offset:2048 lds
m16 v[152:155],a[8:11],a[68:71],v[152:155]
rtr a[204:205],v249,32808
m16 v[184:187],a[8:11],a[72:75],v[184:187]
buffer_load_dwordx4 v244, s[12:15], s63 offen offset:3072 lds
m16 v[124:127],a[12:15],a[64:67],v[124:127]
rtr a[206:207],v249,33832
m16 v[156:159],a[12:15],a[68:71],v[156:159]
rtr a[208:209],v248,33312
v_add_u32 v244, 262144, v244
m16 v[188:191],a[12:15],a[72:75],v[188:191]
rtr a[210:211],v248,34336
m16 v[128:131],a[16:19],a[64:67],v[128:131]
s_add_u32 m0, s69, 22528
m16 v[160:163],a[16:19],a[68:71],v[160:163]
rtr a[212:213],v248,33320
m16 v[192:195],a[16:19],a[72:75],v[192:195]
rtr a[214:215],v248,34344
buffer_load_dwordx4 v245, s[8:11], s64 offen offset:0 lds
m16 v[132:135],a[20:23],a[64:67],v[132:135]
rtr a[216:217],v249,33312
m16 v[164:167],a[20:23],a[68:71],v[164:167]
buffer_load_dwordx4 v251, s[8:11], s64 offen offset:1024 lds
m16 v[196:199],a[20:23],a[72:75],v[196:199]
rtr a[218:219],v249,34336
m16 v[136:139],a[24:27],a[64:67],v[136:139]
rtr a[220:221],v249,33320
buffer_load_dwordx4 v245, s[8:11], s65 offen offset:2048 lds
m16 v[168:171],a[24:27],a[68:71],v[168:171]
rtr a[222:223],v249,34344
m16 v[200:203],a[24:27],a[72:75],v[200:203]
buffer_load_dwordx4 v251, s[8:11], s65 offen offset:3072 lds
m16 v[140:143],a[28:31],a[64:67],v[140:143]
rtr a[224:225],v248,36896
m16 v[172:175],a[28:31],a[68:71],v[172:175]
rtr a[226:227],v248,37920
m16 v[204:207],a[28:31],a[72:75],v[204:207]
rtr a[228:229],v248,36904
s_add_u32 m0, s69, 26624
m16 v[16:19],a[32:35],a[64:67],v[16:19]
v_add_u32 v7, s96, v7
rtr a[230:231],v248,37928
m16 v[48:51],a[32:35],a[68:71],v[48:51]
buffer_load_dwordx4 v245, s[8:11], s66 offen offset:0 lds
m16 v[80:83],a[32:35],a[72:75],v[80:83]
rtr a[232:233],v249,36896
m16 v[20:23],a[36:39],a[64:67],v[20:23]
rtr a[234:235],v249,37920
buffer_load_dwordx4 v251, s[8:11], s66 offen offset:1024 lds
m16 v[52:55],a[36:39],a[68:71],v[52:55]
rtr a[236:237],v249,36904
m16 v[84:87],a[36:39],a[72:75],v[84:87]
v_add_u32 v245, 128, v245
m16 v[24:27],a[40:43],a[64:67],v[24:27]
rtr a[238:239],v249,37928
m16 v[56:59],a[40:43],a[68:71],v[56:59]
rtr a[240:241],v248,37408
v_add_u32 v251, 128, v251
m16 v[88:91],a[40:43],a[72:75],v[88:91]
rtr a[242:243],v248,38432
m16 v[28:31],a[44:47],a[64:67],v[28:31]
s_add_u32 m0, s100, 33792
m16 v[60:63],a[44:47],a[68:71],v[60:63]
rtr a[244:245],v248,37416
m16 v[92:95],a[44:47],a[72:75],v[92:95]
rtr a[246:247],v248,38440
s_mov_b32 s28, 16384
m16 v[32:35],a[48:51],a[64:67],v[32:35]
rtr a[248:249],v249,37408
m16 v[64:67],a[48:51],a[68:71],v[64:67]
buffer_load_dwordx4 v14, s[16:19], s28 offen offset:0 nt lds
m16 v[96:99],a[48:51],a[72:75],v[96:99]
rtr a[250:251],v249,38432
m16 v[36:39],a[52:55],a[64:67],v[36:39]
rtr a[252:253],v249,37416
s_add_u32 m0, s100, 34592
m16 v[68:71],a[52:55],a[68:71],v[68:71]
rtr a[254:255],v249,38440
m16 v[100:103],a[52:55],a[72:75],v[100:103]
s_mov_b32 s28, 16384
m16 v[40:43],a[56:59],a[64:67],v[40:43]
m16 v[72:75],a[56:59],a[68:71],v[72:75]
buffer_load_dwordx4 v14, s[16:19], s28 offen offset:256 nt lds
m16 v[104:107],a[56:59],a[72:75],v[104:107]
m16 v[44:47],a[60:63],a[64:67],v[44:47]
m16 v[76:79],a[60:63],a[68:71],v[76:79]
m16 v[108:111],a[60:63],a[72:75],v[108:111]
s_waitcnt vmcnt(13) lgkmcnt(0)
s_barrier
m16 v[112:115],a[192:195],a[76:79],v[112:115]
r128 a[88:91],v246,0
s_add_u32 m0, s68, 32800
m16 v[144:147],a[192:195],a[80:83],v[144:147]
r128 a[92:95],v246,2048
m16 v[176:179],a[192:195],a[84:87],v[176:179]
r128 v[240:243],v246,4096
m16 v[116:119],a[196:199],a[76:79],v[116:119]
r128 a[64:67],v247,0
m16 v[148:151],a[196:199],a[80:83],v[148:151]
r128 a[68:71],v247,2048
m16 v[180:183],a[196:199],a[84:87],v[180:183]
r128 a[72:75],v247,4096
buffer_load_dwordx4 v244, s[12:15], s60 offen offset:0 lds
m16 v[120:123],a[200:203],a[76:79],v[120:123]
rtr a[0:1],v248,0
m16 v[152:155],a[200:203],a[80:83],v[152:155]
rtr a[2:3],v248,1024
m16 v[184:187],a[200:203],a[84:87],v[184:187]
rtr a[4:5],v248,8
m16 v[124:127],a[204:207],a[76:79],v[124:127]
rtr a[6:7],v248,1032
m16 v[156:159],a[204:207],a[80:83],v[156:159]
buffer_load_dwordx4 v244, s[12:15], s61 offen offset:1024 lds
m16 v[188:191],a[204:207],a[84:87],v[188:191]
rtr a[8:9],v249,0
m16 v[128:131],a[208:211],a[76:79],v[128:131]
rtr a[10:11],v249,1024
m16 v[160:163],a[208:211],a[80:83],v[160:163]
rtr a[12:13],v249,8
m16 v[192:195],a[208:211],a[84:87],v[192:195]
rtr a[14:15],v249,1032
m16 v[132:135],a[212:215],a[76:79],v[132:135]
rtr a[16:17],v248,512
buffer_load_dwordx4 v244, s[12:15], s62 offen offset:2048 lds
m16 v[164:167],a[212:215],a[80:83],v[164:167]
rtr a[18:19],v248,1536
m16 v[196:199],a[212:215],a[84:87],v[196:199]
rtr a[20:21],v248,520
m16 v[136:139],a[216:219],a[76:79],v[136:139]
rtr a[22:23],v248,1544
m16 v[168:171],a[216:219],a[80:83],v[168:171]
rtr a[24:25],v249,512
m16 v[200:203],a[216:219],a[84:87],v[200:203]
buffer_load_dwordx4 v244, s[12:15], s63 offen offset:3072 lds
m16 v[140:143],a[220:223],a[76:79],v[140:143]
rtr a[26:27],v249,1536
m16 v[172:175],a[220:223],a[80:83],v[172:175]
rtr a[28:29],v249,520
m16 v[204:207],a[220:223],a[84:87],v[204:207]
rtr a[30:31],v249,1544
m16 v[16:19],a[224:227],a[76:79],v[16:19]
rtr a[32:33],v248,4096
m16 v[48:51],a[224:227],a[80:83],v[48:51]
rtr a[34:35],v248,5120
v_add_u32 v244, 262144, v244
m16 v[80:83],a[224:227],a[84:87],v[80:83]
rtr a[36:37],v248,4104
m16 v[20:23],a[228:231],a[76:79],v[20:23]
rtr a[38:39],v248,5128
m16 v[52:55],a[228:231],a[80:83],v[52:55]
rtr a[40:41],v249,4096
m16 v[84:87],a[228:231],a[84:87],v[84:87]
rtr a[42:43],v249,5120
m16 v[24:27],a[232:235],a[76:79],v[24:27]
rtr a[44:45],v249,4104
s_add_u32 m0, s100, 42240
m16 v[56:59],a[232:235],a[80:83],v[56:59]
m16 v[88:91],a[232:235],a[84:87],v[88:91]
rtr a[46:47],v249,5128
m16 v[28:31],a[236:239],a[76:79],v[28:31]
rtr a[48:49],v248,4608
m16 v[60:63],a[236:239],a[80:83],v[60:63]
rtr a[50:51],v248,5632
m16 v[92:95],a[236:239],a[84:87],v[92:95]
rtr a[52:53],v248,4616
s_mov_b32 s28, 24576
m16 v[32:35],a[240:243],a[76:79],v[32:35]
rtr a[54:55],v248,5640
m16 v[64:67],a[240:243],a[80:83],v[64:67]
rtr a[56:57],v249,4608
m16 v[96:99],a[240:243],a[84:87],v[96:99]
rtr a[58:59],v249,5632
m16 v[36:39],a[244:247],a[76:79],v[36:39]
rtr a[60:61],v249,4616
m16 v[68:71],a[244:247],a[80:83],v[68:71]
rtr a[62:63],v249,5640
buffer_load_dwordx4 v14, s[16:19], s28 offen offset:0 nt lds
m16 v[100:103],a[244:247],a[84:87],v[100:103]
m16 v[40:43],a[248:251],a[76:79],v[40:43]
m16 v[72:75],a[248:251],a[80:83],v[72:75]
m16 v[104:107],a[248:251],a[84:87],v[104:107]
m16 v[44:47],a[252:255],a[76:79],v[44:47]
m16 v[76:79],a[252:255],a[80:83],v[76:79]
m16 v[108:111],a[252:255],a[84:87],v[108:111]
s_waitcnt vmcnt(13) lgkmcnt(0)
s_barrier
m16 v[112:115],a[0:3],a[88:91],v[112:115]
rtr a[192:193],v248,16400
s_add_u32 m0, s68, 0
m16 v[144:147],a[0:3],a[92:95],v[144:147]
rtr a[194:195],v248,17424
m16 v[176:179],a[0:3],v[240:243],v[176:179]
rtr a[196:197],v248,16408
buffer_load_dwordx4 v244, s[12:15], s60 offen offset:0 lds
m16 v[116:119],a[4:7],a[88:91],v[116:119]
rtr a[198:199],v248,17432
m16 v[148:151],a[4:7],a[92:95],v[148:151]
buffer_load_dwordx4 v244, s[12:15], s61 offen offset:1024 lds
m16 v[180:183],a[4:7],v[240:243],v[180:183]
rtr a[200:201],v249,16400
m16 v[120:123],a[8:11],a[88:91],v[120:123]
rtr a[202:203],v249,17424
buffer_load_dwordx4 v244, s[12:15], s62 offen offset:2048 lds
m16 v[152:155],a[8:11],a[92:95],v[152:155]
rtr a[204:205],v249,16408
m16 v[184:187],a[8:11],v[240:243],v[184:187]
buffer_load_dwordx4 v244, s[12:15], s63 offen offset:3072 lds
m16 v[124:127],a[12:15],a[88:91],v[124:127]
rtr a[206:207],v249,17432
m16 v[156:159],a[12:15],a[92:95],v[156:159]
rtr a[208:209],v248,16912
v_add_u32 v244, 262144, v244
m16 v[188:191],a[12:15],v[240:243],v[188:191]
rtr a[210:211],v248,17936
m16 v[128:131],a[16:19],a[88:91],v[128:131]
s_add_u32 m0, s69, 0
m16 v[160:163],a[16:19],a[92:95],v[160:163]
rtr a[212:213],v248,16920
m16 v[192:195],a[16:19],v[240:243],v[192:195]
rtr a[214:215],v248,17944
buffer_load_dwordx4 v245, s[8:11], s64 offen offset:0 lds
m16 v[132:135],a[20:23],a[88:91],v[132:135]
rtr a[216:217],v249,16912
m16 v[164:167],a[20:23],a[92:95],v[164:167]
buffer_load_dwordx4 v251, s[8:11], s64 offen offset:1024 lds
m16 v[196:199],a[20:23],v[240:243],v[196:199]
rtr a[218:219],v249,17936
m16 v[136:139],a[24:27],a[88:91],v[136:139]
rtr a[220:221],v249,16920
buffer_load_dwordx4 v245, s[8:11], s65 offen offset:2048 lds
m16 v[168:171],a[24:27],a[92:95],v[168:171]
rtr a[222:223],v249,17944
m16 v[200:203],a[24:27],v[240:243],v[200:203]
buffer_load_dwordx4 v251, s[8:11], s65 offen offset:3072 lds
m16 v[140:143],a[28:31],a[88:91],v[140:143]
rtr a[224:225],v248,20496
m16 v[172:175],a[28:31],a[92:95],v[172:175]
rtr a[226:227],v248,21520
m16 v[204:207],a[28:31],v[240:243],v[204:207]
rtr a[228:229],v248,20504
s_add_u32 m0, s69, 4096
m16 v[16:19],a[32:35],a[88:91],v[16:19]
rtr a[230:231],v248,21528
m16 v[48:51],a[32:35],a[92:95],v[48:51]
buffer_load_dwordx4 v245, s[8:11], s66 offen offset:0 lds
m16 v[80:83],a[32:35],v[240:243],v[80:83]
rtr a[232:233],v249,20496
m16 v[20:23],a[36:39],a[88:91],v[20:23]
rtr a[234:235],v249,21520
buffer_load_dwordx4 v251, s[8:11], s66 offen offset:1024 lds
m16 v[52:55],a[36:39],a[92:95],v[52:55]
rtr a[236:237],v249,20504
m16 v[84:87],a[36:39],v[240:243],v[84:87]
v_add_u32 v245, 128, v245
m16 v[24:27],a[40:43],a[88:91],v[24:27]
rtr a[238:239],v249,21528
m16 v[56:59],a[40:43],a[92:95],v[56:59]
rtr a[240:241],v248,21008
v_add_u32 v251, 128, v251
m16 v[88:91],a[40:43],v[240:243],v[88:91]
rtr a[242:243],v248,22032
m16 v[28:31],a[44:47],a[88:91],v[28:31]
s_add_u32 m0, s100, 43040
m16 v[60:63],a[44:47],a[92:95],v[60:63]
rtr a[244:245],v248,21016
m16 v[92:95],a[44:47],v[240:243],v[92:95]
rtr a[246:247],v248,22040
s_mov_b32 s28, 24576
m16 v[32:35],a[48:51],a[88:91],v[32:35]
rtr a[248:249],v249,21008
m16 v[64:67],a[48:51],a[92:95],v[64:67]
buffer_load_dwordx4 v14, s[16:19], s28 offen offset:256 nt lds
m16 v[96:99],a[48:51],v[240:243],v[96:99]
rtr a[250:251],v249,22032
m16 v[36:39],a[52:55],a[88:91],v[36:39]
rtr a[252:253],v249,21016
s_add_u32 m0, s100, 50688
m16 v[68:71],a[52:55],a[92:95],v[68:71]
rtr a[254:255],v249,22040
m16 v[100:103],a[52:55],v[240:243],v[100:103]
s_mov_b32 s28, 16384
m16 v[40:43],a[56:59],a[88:91],v[40:43]
m16 v[72:75],a[56:59],a[92:95],v[72:75]
buffer_load_dwordx4 v14, s[20:23], s28 offen offset:0 nt lds
m16 v[104:107],a[56:59],v[240:243],v[104:107]
m16 v[44:47],a[60:63],a[88:91],v[44:47]
m16 v[76:79],a[60:63],a[92:95],v[76:79]
m16 v[108:111],a[60:63],v[240:243],v[108:111]
s_waitcnt vmcnt(13) lgkmcnt(0)
s_barrier
m16 v[112:115],a[192:195],a[64:67],v[112:115]
r128 a[76:79],v246,22528
s_add_u32 m0, s68, 16400
m16 v[144:147],a[192:195],a[68:71],v[144:147]
r128 a[80:83],v246,24576
m16 v[176:179],a[192:195],a[72:75],v[176:179]
r128 a[84:87],v246,26624
m16 v[116:119],a[196:199],a[64:67],v[116:119]
r128 a[88:91],v247,22528
m16 v[148:151],a[196:199],a[68:71],v[148:151]
r128 a[92:95],v247,24576
m16 v[180:183],a[196:199],a[72:75],v[180:183]
r128 v[240:243],v247,26624
buffer_load_dwordx4 v244, s[12:15], s60 offen offset:0 lds
m16 v[120:123],a[200:203],a[64:67],v[120:123]
rtr a[0:1],v248,32800
m16 v[152:155],a[200:203],a[68:71],v[152:155]
rtr a[2:3],v248,33824
m16 v[184:187],a[200:203],a[72:75],v[184:187]
rtr a[4:5],v248,32808
m16 v[124:127],a[204:207],a[64:67],v[124:127]
rtr a[6:7],v248,33832
m16 v[156:159],a[204:207],a[68:71],v[156:159]
buffer_load_dwordx4 v244, s[12:15], s61 offen offset:1024 lds
m16 v[188:191],a[204:207],a[72:75],v[188:191]
rtr a[8:9],v249,32800
m16 v[128:131],a[208:211],a[64:67],v[128:131]
rtr a[10:11],v249,33824
m16 v[160:163],a[208:211],a[68:71],v[160:163]
rtr a[12:13],v249,32808
m16 v[192:195],a[208:211],a[72:75],v[192:195]
rtr a[14:15],v249,33832
m16 v[132:135],a[212:215],a[64:67],v[132:135]
rtr a[16:17],v248,33312
buffer_load_dwordx4 v244, s[12:15], s62 offen offset:2048 lds
m16 v[164:167],a[212:215],a[68:71],v[164:167]
rtr a[18:19],v248,34336
m16 v[196:199],a[212:215],a[72:75],v[196:199]
rtr a[20:21],v248,33320
m16 v[136:139],a[216:219],a[64:67],v[136:139]
rtr a[22:23],v248,34344
m16 v[168:171],a[216:219],a[68:71],v[168:171]
rtr a[24:25],v249,33312
m16 v[200:203],a[216:219],a[72:75],v[200:203]
buffer_load_dwordx4 v244, s[12:15], s63 offen offset:3072 lds
m16 v[140:143],a[220:223],a[64:67],v[140:143]
rtr a[26:27],v249,34336
m16 v[172:175],a[220:223],a[68:71],v[172:175]
rtr a[28:29],v249,33320
m16 v[204:207],a[220:223],a[72:75],v[204:207]
rtr a[30:31],v249,34344
m16 v[16:19],a[224:227],a[64:67],v[16:19]
rtr a[32:33],v248,36896
m16 v[48:51],a[224:227],a[68:71],v[48:51]
rtr a[34:35],v248,37920
v_add_u32 v244, 262144, v244
m16 v[80:83],a[224:227],a[72:75],v[80:83]
rtr a[36:37],v248,36904
m16 v[20:23],a[228:231],a[64:67],v[20:23]
rtr a[38:39],v248,37928
m16 v[52:55],a[228:231],a[68:71],v[52:55]
rtr a[40:41],v249,36896
m16 v[84:87],a[228:231],a[72:75],v[84:87]
rtr a[42:43],v249,37920
m16 v[24:27],a[232:235],a[64:67],v[24:27]
rtr a[44:45],v249,36904
s_add_u32 m0, s100, 51488
m16 v[56:59],a[232:235],a[68:71],v[56:59]
m16 v[88:91],a[232:235],a[72:75],v[88:91]
rtr a[46:47],v249,37928
m16 v[28:31],a[236:239],a[64:67],v[28:31]
rtr a[48:49],v248,37408
m16 v[60:63],a[236:239],a[68:71],v[60:63]
rtr a[50:51],v248,38432
m16 v[92:95],a[236:239],a[72:75],v[92:95]
rtr a[52:53],v248,37416
s_mov_b32 s28, 16384
m16 v[32:35],a[240:243],a[64:67],v[32:35]
rtr a[54:55],v248,38440
m16 v[64:67],a[240:243],a[68:71],v[64:67]
rtr a[56:57],v249,37408
m16 v[96:99],a[240:243],a[72:75],v[96:99]
rtr a[58:59],v249,38432
m16 v[36:39],a[244:247],a[64:67],v[36:39]
rtr a[60:61],v249,37416
m16 v[68:71],a[244:247],a[68:71],v[68:71]
rtr a[62:63],v249,38440
buffer_load_dwordx4 v14, s[20:23], s28 offen offset:256 nt lds
m16 v[100:103],a[244:247],a[72:75],v[100:103]
m16 v[40:43],a[248:251],a[64:67],v[40:43]
m16 v[72:75],a[248:251],a[68:71],v[72:75]
m16 v[104:107],a[248:251],a[72:75],v[104:107]
m16 v[44:47],a[252:255],a[64:67],v[44:47]
m16 v[76:79],a[252:255],a[68:71],v[76:79]
m16 v[108:111],a[252:255],a[72:75],v[108:111]
s_waitcnt vmcnt(13) lgkmcnt(0)
s_barrier
m16 v[112:115],a[0:3],a[76:79],v[112:115]
rtr a[192:193],v248,0
s_add_u32 m0, s68, 32800
m16 v[144:147],a[0:3],a[80:83],v[144:147]
rtr a[194:195],v248,1024
buffer_load_dwordx4 v244, s[12:15], s60 offen offset:0 lds
m16 v[176:179],a[0:3],a[84:87],v[176:179]
rtr a[196:197],v248,8
m16 v[116:119],a[4:7],a[76:79],v[116:119]
rtr a[198:199],v248,1032
buffer_load_dwordx4 v244, s[12:15], s61 offen offset:1024 lds
m16 v[148:151],a[4:7],a[80:83],v[148:151]
m16 v[180:183],a[4:7],a[84:87],v[180:183]
rtr a[200:201],v249,0
buffer_load_dwordx4 v244, s[12:15], s62 offen offset:2048 lds
m16 v[120:123],a[8:11],a[76:79],v[120:123]
rtr a[202:203],v249,1024
m16 v[152:155],a[8:11],a[80:83],v[152:155]
rtr a[204:205],v249,8
buffer_load_dwordx4 v244, s[12:15], s63 offen offset:3072 lds
m16 v[184:187],a[8:11],a[84:87],v[184:187]
m16 v[124:127],a[12:15],a[76:79],v[124:127]
rtr a[206:207],v249,1032
v_add_u32 v244, 262144, v244
m16 v[156:159],a[12:15],a[80:83],v[156:159]
rtr a[208:209],v248,512
m16 v[188:191],a[12:15],a[84:87],v[188:191]
rtr a[210:211],v248,1536
s_add_u32 m0, s69, 22528
m16 v[128:131],a[16:19],a[76:79],v[128:131]
m16 v[160:163],a[16:19],a[80:83],v[160:163]
rtr a[212:213],v248,520
buffer_load_dwordx4 v245, s[8:11], s64 offen offset:0 lds
m16 v[192:195],a[16:19],a[84:87],v[192:195]
rtr a[214:215],v248,1544
m16 v[132:135],a[20:23],a[76:79],v[132:135]
rtr a[216:217],v249,512
buffer_load_dwordx4 v251, s[8:11], s64 offen offset:1024 lds
m16 v[164:167],a[20:23],a[80:83],v[164:167]
m16 v[196:199],a[20:23],a[84:87],v[196:199]
rtr a[218:219],v249,1536
buffer_load_dwordx4 v245, s[8:11], s65 offen offset:2048 lds
m16 v[136:139],a[24:27],a[76:79],v[136:139]
rtr a[220:221],v249,520
m16 v[168:171],a[24:27],a[80:83],v[168:171]
rtr a[222:223],v249,1544
buffer_load_dwordx4 v251, s[8:11], s65 offen offset:3072 lds
m16 v[200:203],a[24:27],a[84:87],v[200:203]
m16 v[140:143],a[28:31],a[76:79],v[140:143]
rtr a[224:225],v248,4096
s_add_u32 m0, s69, 26624
m16 v[172:175],a[28:31],a[80:83],v[172:175]
rtr a[226:227],v248,5120
m16 v[204:207],a[28:31],a[84:87],v[204:207]
rtr a[228:229],v248,4104
buffer_load_dwordx4 v245, s[8:11], s66 offen offset:0 lds
m16 v[16:19],a[32:35],a[76:79],v[16:19]
rtr a[230:231],v248,5128
buffer_load_dwordx4 v251, s[8:11], s66 offen offset:1024 lds
m16 v[48:51],a[32:35],a[80:83],v[48:51]
m16 v[80:83],a[32:35],a[84:87],v[80:83]
rtr a[232:233],v249,4096
v_add_u32 v245, 128, v245
m16 v[20:23],a[36:39],a[76:79],v[20:23]
rtr a[234:235],v249,5120
m16 v[52:55],a[36:39],a[80:83],v[52:55]
rtr a[236:237],v249,4104
v_add_u32 v251, 128, v251
m16 v[84:87],a[36:39],a[84:87],v[84:87]
m16 v[24:27],a[40:43],a[76:79],v[24:27]
rtr a[238:239],v249,5128
s_add_u32 m0, s100, 59136
m16 v[56:59],a[40:43],a[80:83],v[56:59]
rtr a[240:241],v248,4608
m16 v[88:91],a[40:43],a[84:87],v[88:91]
rtr a[242:243],v248,5632
s_mov_b32 s28, 24576
m16 v[28:31],a[44:47],a[76:79],v[28:31]
m16 v[60:63],a[44:47],a[80:83],v[60:63]
rtr a[244:245],v248,4616
buffer_load_dwordx4 v14, s[20:23], s28 offen offset:0 nt lds
m16 v[92:95],a[44:47],a[84:87],v[92:95]
rtr a[246:247],v248,5640
m16 v[32:35],a[48:51],a[76:79],v[32:35]
rtr a[248:249],v249,4608
s_add_u32 m0, s100, 59936
m16 v[64:67],a[48:51],a[80:83],v[64:67]
m16 v[96:99],a[48:51],a[84:87],v[96:99]
rtr a[250:251],v249,5632
s_mov_b32 s28, 24576
m16 v[36:39],a[52:55],a[76:79],v[36:39]
rtr a[252:253],v249,4616
m16 v[68:71],a[52:55],a[80:83],v[68:71]
rtr a[254:255],v249,5640
buffer_load_dwordx4 v14, s[20:23], s28 offen offset:256 nt lds
m16 v[100:103],a[52:55],a[84:87],v[100:103]
m16 v[40:43],a[56:59],a[76:79],v[40:43]
buffer_load_dword v255, v250, s[56:59], 0 offen
m16 v[72:75],a[56:59],a[80:83],v[72:75]
m16 v[104:107],a[56:59],a[84:87],v[104:107]
v_add_u32 v250, 640, v250
m16 v[44:47],a[60:63],a[76:79],v[44:47]
m16 v[76:79],a[60:63],a[80:83],v[76:79]
m16 v[108:111],a[60:63],a[84:87],v[108:111]
s_waitcnt vmcnt(14) lgkmcnt(0)
s_barrier
m16 v[112:115],a[192:195],a[88:91],v[112:115]
r128 a[64:67],v246,0
s_add_u32 m0, s68, 0
m16 v[144:147],a[192:195],a[92:95],v[144:147]
r128 a[68:71],v246,2048
m16 v[176:179],a[192:195],v[240:243],v[176:179]
r128 a[72:75],v246,4096
m16 v[116:119],a[196:199],a[88:91],v[116:119]
r128 a[76:79],v247,0
buffer_load_dwordx4 v244, s[12:15], s60 offen offset:0 lds
m16 v[148:151],a[196:199],a[92:95],v[148:151]
r128 a[80:83],v247,2048
m16 v[180:183],a[196:199],v[240:243],v[180:183]
r128 a[84:87],v247,4096
m16 v[120:123],a[200:203],a[88:91],v[120:123]
rtr a[0:1],v248,16400
m16 v[152:155],a[200:203],a[92:95],v[152:155]
rtr a[2:3],v248,17424
buffer_load_dwordx4 v244, s[12:15], s61 offen offset:1024 lds
m16 v[184:187],a[200:203],v[240:243],v[184:187]
rtr a[4:5],v248,16408
m16 v[124:127],a[204:207],a[88:91],v[124:127]
rtr a[6:7],v248,17432
m16 v[156:159],a[204:207],a[92:95],v[156:159]
m16 v[188:191],a[204:207],v[240:243],v[188:191]
rtr a[8:9],v249,16400
buffer_load_dwordx4 v244, s[12:15], s62 offen offset:2048 lds
m16 v[128:131],a[208:211],a[88:91],v[128:131]
rtr a[10:11],v249,17424
m16 v[160:163],a[208:211],a[92:95],v[160:163]
rtr a[12:13],v249,16408
m16 v[192:195],a[208:211],v[240:243],v[192:195]
rtr a[14:15],v249,17432
m16 v[132:135],a[212:215],a[88:91],v[132:135]
rtr a[16:17],v248,16912
buffer_load_dwordx4 v244, s[12:15], s63 offen offset:3072 lds
m16 v[164:167],a[212:215],a[92:95],v[164:167]
rtr a[18:19],v248,17936
m16 v[196:199],a[212:215],v[240:243],v[196:199]
rtr a[20:21],v248,16920
m16 v[136:139],a[216:219],a[88:91],v[136:139]
rtr a[22:23],v248,17944
m16 v[168:171],a[216:219],a[92:95],v[168:171]
rtr a[24:25],v249,16912
v_add_u32 v244, 262144, v244
m16 v[200:203],a[216:219],v[240:243],v[200:203]
m16 v[140:143],a[220:223],a[88:91],v[140:143]
rtr a[26:27],v249,17936
m16 v[172:175],a[220:223],a[92:95],v[172:175]
rtr a[28:29],v249,16920
m16 v[204:207],a[220:223],v[240:243],v[204:207]
rtr a[30:31],v249,17944
s_mov_b32 s28, 32768
m16 v[16:19],a[224:227],a[88:91],v[16:19]
rtr a[32:33],v248,20496
m16 v[48:51],a[224:227],a[92:95],v[48:51]
rtr a[34:35],v248,21520
m16 v[80:83],a[224:227],v[240:243],v[80:83]
rtr a[36:37],v248,20504
buffer_load_dwordx4 v[208:211], v14, s[16:19], s28 offen offset:0 nt
m16 v[20:23],a[228:231],a[88:91],v[20:23]
rtr a[38:39],v248,21528
m16 v[52:55],a[228:231],a[92:95],v[52:55]
rtr a[40:41],v249,20496
m16 v[84:87],a[228:231],v[240:243],v[84:87]
rtr a[42:43],v249,21520
m16 v[24:27],a[232:235],a[88:91],v[24:27]
rtr a[44:45],v249,20504
s_mov_b32 s28, 32768
m16 v[56:59],a[232:235],a[92:95],v[56:59]
m16 v[88:91],a[232:235],v[240:243],v[88:91]
rtr a[46:47],v249,21528
m16 v[28:31],a[236:239],a[88:91],v[28:31]
rtr a[48:49],v248,21008
m16 v[60:63],a[236:239],a[92:95],v[60:63]
rtr a[50:51],v248,22032
buffer_load_dwordx4 v[212:215], v14, s[16:19], s28 offen offset:256 nt
m16 v[92:95],a[236:239],v[240:243],v[92:95]
rtr a[52:53],v248,21016
m16 v[32:35],a[240:243],a[88:91],v[32:35]
rtr a[54:55],v248,22040
m16 v[64:67],a[240:243],a[92:95],v[64:67]
rtr a[56:57],v249,21008
m16 v[96:99],a[240:243],v[240:243],v[96:99]
rtr a[58:59],v249,22032
buffer_load_dword v255, v250, s[56:59], 0 offen
m16 v[36:39],a[244:247],a[88:91],v[36:39]
rtr a[60:61],v249,21016
m16 v[68:71],a[244:247],a[92:95],v[68:71]
rtr a[62:63],v249,22040
m16 v[100:103],a[244:247],v[240:243],v[100:103]
m16 v[40:43],a[248:251],a[88:91],v[40:43]
v_add_u32 v250, 640, v250
m16 v[72:75],a[248:251],a[92:95],v[72:75]
m16 v[104:107],a[248:251],v[240:243],v[104:107]
m16 v[44:47],a[252:255],a[88:91],v[44:47]
m16 v[76:79],a[252:255],a[92:95],v[76:79]
m16 v[108:111],a[252:255],v[240:243],v[108:111]
s_waitcnt vmcnt(16) lgkmcnt(0)
s_barrier
m16 v[112:115],a[0:3],a[64:67],v[112:115]
rtr a[192:193],v248,32800
s_add_u32 m0, s68, 16400
m16 v[144:147],a[0:3],a[68:71],v[144:147]
rtr a[194:195],v248,33824
m16 v[176:179],a[0:3],a[72:75],v[176:179]
rtr a[196:197],v248,32808
buffer_load_dwordx4 v244, s[12:15], s60 offen offset:0 lds
m16 v[116:119],a[4:7],a[64:67],v[116:119]
rtr a[198:199],v248,33832
m16 v[148:151],a[4:7],a[68:71],v[148:151]
buffer_load_dwordx4 v244, s[12:15], s61 offen offset:1024 lds
m16 v[180:183],a[4:7],a[72:75],v[180:183]
rtr a[200:201],v249,32800
m16 v[120:123],a[8:11],a[64:67],v[120:123]
rtr a[202:203],v249,33824
buffer_load_dwordx4 v244, s[12:15], s62 offen offset:2048 lds
m16 v[152:155],a[8:11],a[68:71],v[152:155]
rtr a[204:205],v249,32808
m16 v[184:187],a[8:11],a[72:75],v[184:187]
m16 v[124:127],a[12:15],a[64:67],v[124:127]
rtr a[206:207],v249,33832
buffer_load_dwordx4 v244, s[12:15], s63 offen offset:3072 lds
m16 v[156:159],a[12:15],a[68:71],v[156:159]
rtr a[208:209],v248,33312
m16 v[188:191],a[12:15],a[72:75],v[188:191]
rtr a[210:211],v248,34336
v_add_u32 v244, 262144, v244
m16 v[128:131],a[16:19],a[64:67],v[128:131]
m16 v[160:163],a[16:19],a[68:71],v[160:163]
rtr a[212:213],v248,33320
s_add_u32 m0, s69, 0
m16 v[192:195],a[16:19],a[72:75],v[192:195]
rtr a[214:215],v248,34344
m16 v[132:135],a[20:23],a[64:67],v[132:135]
rtr a[216:217],v249,33312
m16 v[164:167],a[20:23],a[68:71],v[164:167]
buffer_load_dwordx4 v245, s[8:11], s64 offen offset:0 lds
m16 v[196:199],a[20:23],a[72:75],v[196:199]
rtr a[218:219],v249,34336
m16 v[136:139],a[24:27],a[64:67],v[136:139]
rtr a[220:221],v249,33320
buffer_load_dwordx4 v251, s[8:11], s64 offen offset:1024 lds
m16 v[168:171],a[24:27],a[68:71],v[168:171]
rtr a[222:223],v249,34344
m16 v[200:203],a[24:27],a[72:75],v[200:203]
buffer_load_dwordx4 v245, s[8:11], s65 offen offset:2048 lds
m16 v[140:143],a[28:31],a[64:67],v[140:143]
rtr a[224:225],v248,36896
m16 v[172:175],a[28:31],a[68:71],v[172:175]
rtr a[226:227],v248,37920
m16 v[204:207],a[28:31],a[72:75],v[204:207]
rtr a[228:229],v248,36904
buffer_load_dwordx4 v251, s[8:11], s65 offen offset:3072 lds
m16 v[16:19],a[32:35],a[64:67],v[16:19]
rtr a[230:231],v248,37928
m16 v[48:51],a[32:35],a[68:71],v[48:51]
s_add_u32 m0, s69, 4096
m16 v[80:83],a[32:35],a[72:75],v[80:83]
rtr a[232:233],v249,36896
m16 v[20:23],a[36:39],a[64:67],v[20:23]
rtr a[234:235],v249,37920
buffer_load_dwordx4 v245, s[8:11], s66 offen offset:0 lds
m16 v[52:55],a[36:39],a[68:71],v[52:55]
rtr a[236:237],v249,36904
m16 v[84:87],a[36:39],a[72:75],v[84:87]
buffer_load_dwordx4 v251, s[8:11], s66 offen offset:1024 lds
m16 v[24:27],a[40:43],a[64:67],v[24:27]
rtr a[238:239],v249,37928
m16 v[56:59],a[40:43],a[68:71],v[56:59]
rtr a[240:241],v248,37408
m16 v[88:91],a[40:43],a[72:75],v[88:91]
rtr a[242:243],v248,38432
v_add_u32 v245, 128, v245
m16 v[28:31],a[44:47],a[64:67],v[28:31]
m16 v[60:63],a[44:47],a[68:71],v[60:63]
rtr a[244:245],v248,37416
v_add_u32 v251, 128, v251
m16 v[92:95],a[44:47],a[72:75],v[92:95]
rtr a[246:247],v248,38440
m16 v[32:35],a[48:51],a[64:67],v[32:35]
rtr a[248:249],v249,37408
s_mov_b32 s28, 40960
m16 v[64:67],a[48:51],a[68:71],v[64:67]
m16 v[96:99],a[48:51],a[72:75],v[96:99]
rtr a[250:251],v249,38432
m16 v[36:39],a[52:55],a[64:67],v[36:39]
rtr a[252:253],v249,37416
buffer_load_dwordx4 v[216:219], v14, s[16:19], s28 offen offset:0 nt
m16 v[68:71],a[52:55],a[68:71],v[68:71]
rtr a[254:255],v249,38440
m16 v[100:103],a[52:55],a[72:75],v[100:103]
buffer_load_dword v255, v250, s[56:59], 0 offen
m16 v[40:43],a[56:59],a[64:67],v[40:43]
m16 v[72:75],a[56:59],a[68:71],v[72:75]
v_add_u32 v250, 640, v250
m16 v[104:107],a[56:59],a[72:75],v[104:107]
m16 v[44:47],a[60:63],a[64:67],v[44:47]
m16 v[76:79],a[60:63],a[68:71],v[76:79]
m16 v[108:111],a[60:63],a[72:75],v[108:111]
s_waitcnt vmcnt(15) lgkmcnt(0)
s_barrier
m16 v[112:115],a[192:195],a[76:79],v[112:115]
r128 a[88:91],v246,22528
s_add_u32 m0, s68, 32800
m16 v[144:147],a[192:195],a[80:83],v[144:147]
r128 a[92:95],v246,24576
m16 v[176:179],a[192:195],a[84:87],v[176:179]
r128 v[240:243],v246,26624
m16 v[116:119],a[196:199],a[76:79],v[116:119]
r128 a[64:67],v247,22528
buffer_load_dwordx4 v244, s[12:15], s60 offen offset:0 lds
m16 v[148:151],a[196:199],a[80:83],v[148:151]
r128 a[68:71],v247,24576
m16 v[180:183],a[196:199],a[84:87],v[180:183]
r128 a[72:75],v247,26624
m16 v[120:123],a[200:203],a[76:79],v[120:123]
rtr a[0:1],v248,0
m16 v[152:155],a[200:203],a[80:83],v[152:155]
rtr a[2:3],v248,1024
buffer_load_dwordx4 v244, s[12:15], s61 offen offset:1024 lds
m16 v[184:187],a[200:203],a[84:87],v[184:187]
rtr a[4:5],v248,8
m16 v[124:127],a[204:207],a[76:79],v[124:127]
rtr a[6:7],v248,1032
m16 v[156:159],a[204:207],a[80:83],v[156:159]
m16 v[188:191],a[204:207],a[84:87],v[188:191]
rtr a[8:9],v249,0
buffer_load_dwordx4 v244, s[12:15], s62 offen offset:2048 lds
m16 v[128:131],a[208:211],a[76:79],v[128:131]
rtr a[10:11],v249,1024
m16 v[160:163],a[208:211],a[80:83],v[160:163]
rtr a[12:13],v249,8
m16 v[192:195],a[208:211],a[84:87],v[192:195]
rtr a[14:15],v249,1032
m16 v[132:135],a[212:215],a[76:79],v[132:135]
rtr a[16:17],v248,512
buffer_load_dwordx4 v244, s[12:15], s63 offen offset:3072 lds
m16 v[164:167],a[212:215],a[80:83],v[164:167]
rtr a[18:19],v248,1536
m16 v[196:199],a[212:215],a[84:87],v[196:199]
rtr a[20:21],v248,520
m16 v[136:139],a[216:219],a[76:79],v[136:139]
rtr a[22:23],v248,1544
m16 v[168:171],a[216:219],a[80:83],v[168:171]
rtr a[24:25],v249,512
v_add_u32 v244, 262144, v244
m16 v[200:203],a[216:219],a[84:87],v[200:203]
m16 v[140:143],a[220:223],a[76:79],v[140:143]
rtr a[26:27],v249,1536
m16 v[172:175],a[220:223],a[80:83],v[172:175]
rtr a[28:29],v249,520
m16 v[204:207],a[220:223],a[84:87],v[204:207]
rtr a[30:31],v249,1544
s_mov_b32 s28, 40960
m16 v[16:19],a[224:227],a[76:79],v[16:19]
rtr a[32:33],v248,4096
m16 v[48:51],a[224:227],a[80:83],v[48:51]
rtr a[34:35],v248,5120
m16 v[80:83],a[224:227],a[84:87],v[80:83]
rtr a[36:37],v248,4104
buffer_load_dwordx4 v[220:223], v14, s[16:19], s28 offen offset:256 nt
m16 v[20:23],a[228:231],a[76:79],v[20:23]
rtr a[38:39],v248,5128
m16 v[52:55],a[228:231],a[80:83],v[52:55]
rtr a[40:41],v249,4096
m16 v[84:87],a[228:231],a[84:87],v[84:87]
rtr a[42:43],v249,5120
m16 v[24:27],a[232:235],a[76:79],v[24:27]
rtr a[44:45],v249,4104
s_mov_b32 s28, 32768
m16 v[56:59],a[232:235],a[80:83],v[56:59]
m16 v[88:91],a[232:235],a[84:87],v[88:91]
rtr a[46:47],v249,5128
m16 v[28:31],a[236:239],a[76:79],v[28:31]
rtr a[48:49],v248,4608
m16 v[60:63],a[236:239],a[80:83],v[60:63]
rtr a[50:51],v248,5632
buffer_load_dwordx4 v[224:227], v14, s[20:23], s28 offen offset:0 nt
m16 v[92:95],a[236:239],a[84:87],v[92:95]
rtr a[52:53],v248,4616
m16 v[32:35],a[240:243],a[76:79],v[32:35]
rtr a[54:55],v248,5640
m16 v[64:67],a[240:243],a[80:83],v[64:67]
rtr a[56:57],v249,4608
m16 v[96:99],a[240:243],a[84:87],v[96:99]
rtr a[58:59],v249,5632
buffer_load_dword v255, v250, s[56:59], 0 offen
m16 v[36:39],a[244:247],a[76:79],v[36:39]
rtr a[60:61],v249,4616
m16 v[68:71],a[244:247],a[80:83],v[68:71]
rtr a[62:63],v249,5640
m16 v[100:103],a[244:247],a[84:87],v[100:103]
m16 v[40:43],a[248:251],a[76:79],v[40:43]
v_add_u32 v250, 640, v250
m16 v[72:75],a[248:251],a[80:83],v[72:75]
m16 v[104:107],a[248:251],a[84:87],v[104:107]
m16 v[44:47],a[252:255],a[76:79],v[44:47]
m16 v[76:79],a[252:255],a[80:83],v[76:79]
m16 v[108:111],a[252:255],a[84:87],v[108:111]
s_waitcnt vmcnt(15) lgkmcnt(0)
s_barrier
m16 v[112:115],a[0:3],a[88:91],v[112:115]
rtr a[192:193],v248,16400
s_add_u32 m0, s68, 0
m16 v[144:147],a[0:3],a[92:95],v[144:147]
rtr a[194:195],v248,17424
m16 v[176:179],a[0:3],v[240:243],v[176:179]
rtr a[196:197],v248,16408
buffer_load_dwordx4 v244, s[12:15], s60 offen offset:0 lds
m16 v[116:119],a[4:7],a[88:91],v[116:119]
rtr a[198:199],v248,17432
m16 v[148:151],a[4:7],a[92:95],v[148:151]
buffer_load_dwordx4 v244, s[12:15], s61 offen offset:1024 lds
m16 v[180:183],a[4:7],v[240:243],v[180:183]
rtr a[200:201],v249,16400
m16 v[120:123],a[8:11],a[88:91],v[120:123]
rtr a[202:203],v249,17424
buffer_load_dwordx4 v244, s[12:15], s62 offen offset:2048 lds
m16 v[152:155],a[8:11],a[92:95],v[152:155]
rtr a[204:205],v249,16408
m16 v[184:187],a[8:11],v[240:243],v[184:187]
m16 v[124:127],a[12:15],a[88:91],v[124:127]
rtr a[206:207],v249,17432
buffer_load_dwordx4 v244, s[12:15], s63 offen offset:3072 lds
m16 v[156:159],a[12:15],a[92:95],v[156:159]
rtr a[208:209],v248,16912
m16 v[188:191],a[12:15],v[240:243],v[188:191]
rtr a[210:211],v248,17936
v_add_u32 v244, 262144, v244
m16 v[128:131],a[16:19],a[88:91],v[128:131]
m16 v[160:163],a[16:19],a[92:95],v[160:163]
rtr a[212:213],v248,16920
s_add_u32 m0, s69, 22528
m16 v[192:195],a[16:19],v[240:243],v[192:195]
rtr a[214:215],v248,17944
m16 v[132:135],a[20:23],a[88:91],v[132:135]
rtr a[216:217],v249,16912
m16 v[164:167],a[20:23],a[92:95],v[164:167]
buffer_load_dwordx4 v245, s[8:11], s64 offen offset:0 lds
m16 v[196:199],a[20:23],v[240:243],v[196:199]
rtr a[218:219],v249,17936
m16 v[136:139],a[24:27],a[88:91],v[136:139]
rtr a[220:221],v249,16920
buffer_load_dwordx4 v251, s[8:11], s64 offen offset:1024 lds
m16 v[168:171],a[24:27],a[92:95],v[168:171]
rtr a[222:223],v249,17944
m16 v[200:203],a[24:27],v[240:243],v[200:203]
buffer_load_dwordx4 v245, s[8:11], s65 offen offset:2048 lds
m16 v[140:143],a[28:31],a[88:91],v[140:143]
rtr a[224:225],v248,20496
m16 v[172:175],a[28:31],a[92:95],v[172:175]
rtr a[226:227],v248,21520
m16 v[204:207],a[28:31],v[240:243],v[204:207]
rtr a[228:229],v248,20504
buffer_load_dwordx4 v251, s[8:11], s65 offen offset:3072 lds
m16 v[16:19],a[32:35],a[88:91],v[16:19]
rtr a[230:231],v248,21528
m16 v[48:51],a[32:35],a[92:95],v[48:51]
s_add_u32 m0, s69, 26624
m16 v[80:83],a[32:35],v[240:243],v[80:83]
rtr a[232:233],v249,20496
m16 v[20:23],a[36:39],a[88:91],v[20:23]
rtr a[234:235],v249,21520
buffer_load_dwordx4 v245, s[8:11], s66 offen offset:0 lds
m16 v[52:55],a[36:39],a[92:95],v[52:55]
rtr a[236:237],v249,20504
m16 v[84:87],a[36:39],v[240:243],v[84:87]
buffer_load_dwordx4 v251, s[8:11], s66 offen offset:1024 lds
m16 v[24:27],a[40:43],a[88:91],v[24:27]
rtr a[238:239],v249,21528
m16 v[56:59],a[40:43],a[92:95],v[56:59]
rtr a[240:241],v248,21008
m16 v[88:91],a[40:43],v[240:243],v[88:91]
rtr a[242:243],v248,22032
v_add_u32 v245, 128, v245
m16 v[28:31],a[44:47],a[88:91],v[28:31]
m16 v[60:63],a[44:47],a[92:95],v[60:63]
rtr a[244:245],v248,21016
v_add_u32 v251, 128, v251
m16 v[92:95],a[44:47],v[240:243],v[92:95]
rtr a[246:247],v248,22040
m16 v[32:35],a[48:51],a[88:91],v[32:35]
rtr a[248:249],v249,21008
s_mov_b32 s28, 32768
m16 v[64:67],a[48:51],a[92:95],v[64:67]
m16 v[96:99],a[48:51],v[240:243],v[96:99]
rtr a[250:251],v249,22032
m16 v[36:39],a[52:55],a[88:91],v[36:39]
rtr a[252:253],v249,21016
buffer_load_dwordx4 v[228:231], v14, s[20:23], s28 offen offset:256 nt
m16 v[68:71],a[52:55],a[92:95],v[68:71]
rtr a[254:255],v249,22040
m16 v[100:103],a[52:55],v[240:243],v[100:103]
buffer_load_dword v255, v250, s[56:59], 0 offen
m16 v[40:43],a[56:59],a[88:91],v[40:43]
m16 v[72:75],a[56:59],a[92:95],v[72:75]
v_add_u32 v250, 640, v250
m16 v[104:107],a[56:59],v[240:243],v[104:107]
m16 v[44:47],a[60:63],a[88:91],v[44:47]
m16 v[76:79],a[60:63],a[92:95],v[76:79]
m16 v[108:111],a[60:63],v[240:243],v[108:111]
s_waitcnt vmcnt(15) lgkmcnt(0)
s_barrier
m16 v[112:115],a[192:195],a[64:67],v[112:115]
r128 a[76:79],v246,0
s_add_u32 m0, s68, 16400
m16 v[144:147],a[192:195],a[68:71],v[144:147]
r128 a[80:83],v246,2048
m16 v[176:179],a[192:195],a[72:75],v[176:179]
r128 a[84:87],v246,4096
m16 v[116:119],a[196:199],a[64:67],v[116:119]
r128 a[88:91],v247,0
buffer_load_dwordx4 v244, s[12:15], s60 offen offset:0 lds
m16 v[148:151],a[196:199],a[68:71],v[148:151]
r128 a[92:95],v247,2048
m16 v[180:183],a[196:199],a[72:75],v[180:183]
r128 v[240:243],v247,4096
m16 v[120:123],a[200:203],a[64:67],v[120:123]
rtr a[0:1],v248,32800
m16 v[152:155],a[200:203],a[68:71],v[152:155]
rtr a[2:3],v248,33824
buffer_load_dwordx4 v244, s[12:15], s61 offen offset:1024 lds
m16 v[184:187],a[200:203],a[72:75],v[184:187]
rtr a[4:5],v248,32808
m16 v[124:127],a[204:207],a[64:67],v[124:127]
rtr a[6:7],v248,33832
m16 v[156:159],a[204:207],a[68:71],v[156:159]
m16 v[188:191],a[204:207],a[72:75],v[188:191]
rtr a[8:9],v249,32800
buffer_load_dwordx4 v244, s[12:15], s62 offen offset:2048 lds
m16 v[128:131],a[208:211],a[64:67],v[128:131]
rtr a[10:11],v249,33824
m16 v[160:163],a[208:211],a[68:71],v[160:163]
rtr a[12:13],v249,32808
m16 v[192:195],a[208:211],a[72:75],v[192:195]
rtr a[14:15],v249,33832
m16 v[132:135],a[212:215],a[64:67],v[132:135]
rtr a[16:17],v248,33312
buffer_load_dwordx4 v244, s[12:15], s63 offen offset:3072 lds
m16 v[164:167],a[212:215],a[68:71],v[164:167]
rtr a[18:19],v248,34336
m16 v[196:199],a[212:215],a[72:75],v[196:199]
rtr a[20:21],v248,33320
m16 v[136:139],a[216:219],a[64:67],v[136:139]
rtr a[22:23],v248,34344
m16 v[168:171],a[216:219],a[68:71],v[168:171]
rtr a[24:25],v249,33312
v_add_u32 v244, 262144, v244
m16 v[200:203],a[216:219],a[72:75],v[200:203]
m16 v[140:143],a[220:223],a[64:67],v[140:143]
rtr a[26:27],v249,34336
m16 v[172:175],a[220:223],a[68:71],v[172:175]
rtr a[28:29],v249,33320
m16 v[204:207],a[220:223],a[72:75],v[204:207]
rtr a[30:31],v249,34344
s_mov_b32 s28, 40960
m16 v[16:19],a[224:227],a[64:67],v[16:19]
rtr a[32:33],v248,36896
m16 v[48:51],a[224:227],a[68:71],v[48:51]
rtr a[34:35],v248,37920
m16 v[80:83],a[224:227],a[72:75],v[80:83]
rtr a[36:37],v248,36904
buffer_load_dwordx4 v[232:235], v14, s[20:23], s28 offen offset:0 nt
m16 v[20:23],a[228:231],a[64:67],v[20:23]
rtr a[38:39],v248,37928
m16 v[52:55],a[228:231],a[68:71],v[52:55]
rtr a[40:41],v249,36896
m16 v[84:87],a[228:231],a[72:75],v[84:87]
rtr a[42:43],v249,37920
m16 v[24:27],a[232:235],a[64:67],v[24:27]
rtr a[44:45],v249,36904
s_mov_b32 s28, 40960
m16 v[56:59],a[232:235],a[68:71],v[56:59]
m16 v[88:91],a[232:235],a[72:75],v[88:91]
rtr a[46:47],v249,37928
m16 v[28:31],a[236:239],a[64:67],v[28:31]
rtr a[48:49],v248,37408
m16 v[60:63],a[236:239],a[68:71],v[60:63]
rtr a[50:51],v248,38432
buffer_load_dwordx4 v[236:239], v14, s[20:23], s28 offen offset:256 nt
m16 v[92:95],a[236:239],a[72:75],v[92:95]
rtr a[52:53],v248,37416
m16 v[32:35],a[240:243],a[64:67],v[32:35]
rtr a[54:55],v248,38440
m16 v[64:67],a[240:243],a[68:71],v[64:67]
rtr a[56:57],v249,37408
m16 v[96:99],a[240:243],a[72:75],v[96:99]
rtr a[58:59],v249,38432
buffer_load_dword v255, v250, s[56:59], 0 offen
m16 v[36:39],a[244:247],a[64:67],v[36:39]
rtr a[60:61],v249,37416
m16 v[68:71],a[244:247],a[68:71],v[68:71]
rtr a[62:63],v249,38440
m16 v[100:103],a[244:247],a[72:75],v[100:103]
m16 v[40:43],a[248:251],a[64:67],v[40:43]
v_add_u32 v250, 640, v250
m16 v[72:75],a[248:251],a[68:71],v[72:75]
m16 v[104:107],a[248:251],a[72:75],v[104:107]
m16 v[44:47],a[252:255],a[64:67],v[44:47]
m16 v[76:79],a[252:255],a[68:71],v[76:79]
m16 v[108:111],a[252:255],a[72:75],v[108:111]
s_waitcnt vmcnt(15) lgkmcnt(0)
s_barrier
m16 v[112:115],a[0:3],a[76:79],v[112:115]
rtr a[192:193],v248,0
s_add_u32 m0, s68, 32800
m16 v[144:147],a[0:3],a[80:83],v[144:147]
rtr a[194:195],v248,1024
m16 v[176:179],a[0:3],a[84:87],v[176:179]
rtr a[196:197],v248,8
buffer_load_dwordx4 v244, s[12:15], s60 offen offset:0 lds
m16 v[116:119],a[4:7],a[76:79],v[116:119]
rtr a[198:199],v248,1032
m16 v[148:151],a[4:7],a[80:83],v[148:151]
buffer_load_dwordx4 v244, s[12:15], s61 offen offset:1024 lds
m16 v[180:183],a[4:7],a[84:87],v[180:183]
rtr a[200:201],v249,0
m16 v[120:123],a[8:11],a[76:79],v[120:123]
rtr a[202:203],v249,1024
buffer_load_dwordx4 v244, s[12:15], s62 offen offset:2048 lds
m16 v[152:155],a[8:11],a[80:83],v[152:155]
rtr a[204:205],v249,8
m16 v[184:187],a[8:11],a[84:87],v[184:187]
m16 v[124:127],a[12:15],a[76:79],v[124:127]
rtr a[206:207],v249,1032
buffer_load_dwordx4 v244, s[12:15], s63 offen offset:3072 lds
m16 v[156:159],a[12:15],a[80:83],v[156:159]
rtr a[208:209],v248,512
m16 v[188:191],a[12:15],a[84:87],v[188:191]
rtr a[210:211],v248,1536
v_add_u32 v244, 262144, v244
m16 v[128:131],a[16:19],a[76:79],v[128:131]
m16 v[160:163],a[16:19],a[80:83],v[160:163]
rtr a[212:213],v248,520
s_add_u32 m0, s69, 0
m16 v[192:195],a[16:19],a[84:87],v[192:195]
rtr a[214:215],v248,1544
m16 v[132:135],a[20:23],a[76:79],v[132:135]
rtr a[216:217],v249,512
m16 v[164:167],a[20:23],a[80:83],v[164:167]
buffer_load_dwordx4 v245, s[8:11], s64 offen offset:0 lds
m16 v[196:199],a[20:23],a[84:87],v[196:199]
rtr a[218:219],v249,1536
m16 v[136:139],a[24:27],a[76:79],v[136:139]
rtr a[220:221],v249,520
buffer_load_dwordx4 v251, s[8:11], s64 offen offset:1024 lds
m16 v[168:171],a[24:27],a[80:83],v[168:171]
rtr a[222:223],v249,1544
m16 v[200:203],a[24:27],a[84:87],v[200:203]
buffer_load_dwordx4 v245, s[8:11], s65 offen offset:2048 lds
m16 v[140:143],a[28:31],a[76:79],v[140:143]
rtr a[224:225],v248,4096
m16 v[172:175],a[28:31],a[80:83],v[172:175]
rtr a[226:227],v248,5120
m16 v[204:207],a[28:31],a[84:87],v[204:207]
rtr a[228:229],v248,4104
buffer_load_dwordx4 v251, s[8:11], s65 offen offset:3072 lds
m16 v[16:19],a[32:35],a[76:79],v[16:19]
rtr a[230:231],v248,5128
m16 v[48:51],a[32:35],a[80:83],v[48:51]
s_add_u32 m0, s69, 4096
m16 v[80:83],a[32:35],a[84:87],v[80:83]
rtr a[232:233],v249,4096
m16 v[20:23],a[36:39],a[76:79],v[20:23]
rtr a[234:235],v249,5120
buffer_load_dwordx4 v245, s[8:11], s66 offen offset:0 lds
m16 v[52:55],a[36:39],a[80:83],v[52:55]
rtr a[236:237],v249,4104
m16 v[84:87],a[36:39],a[84:87],v[84:87]
buffer_load_dwordx4 v251, s[8:11], s66 offen offset:1024 lds
m16 v[24:27],a[40:43],a[76:79],v[24:27]
rtr a[238:239],v249,5128
m16 v[56:59],a[40:43],a[80:83],v[56:59]
rtr a[240:241],v248,4608
m16 v[88:91],a[40:43],a[84:87],v[88:91]
rtr a[242:243],v248,5632
v_add_u32 v245, 128, v245
m16 v[28:31],a[44:47],a[76:79],v[28:31]
m16 v[60:63],a[44:47],a[80:83],v[60:63]
rtr a[244:245],v248,4616
v_add_u32 v251, 128, v251
m16 v[92:95],a[44:47],a[84:87],v[92:95]
rtr a[246:247],v248,5640
m16 v[32:35],a[48:51],a[76:79],v[32:35]
rtr a[248:249],v249,4608
s_mov_b32 s28, 81920
m16 v[64:67],a[48:51],a[80:83],v[64:67]
m16 v[96:99],a[48:51],a[84:87],v[96:99]
rtr a[250:251],v249,5632
m16 v[36:39],a[52:55],a[76:79],v[36:39]
rtr a[252:253],v249,4616
buffer_load_dwordx4 a[96:99], v14, s[16:19], s28 offen offset:0 nt
m16 v[68:71],a[52:55],a[80:83],v[68:71]
rtr a[254:255],v249,5640
m16 v[100:103],a[52:55],a[84:87],v[100:103]
buffer_load_dword v255, v250, s[56:59], 0 offen
m16 v[40:43],a[56:59],a[76:79],v[40:43]
m16 v[72:75],a[56:59],a[80:83],v[72:75]
v_add_u32 v250, 640, v250
m16 v[104:107],a[56:59],a[84:87],v[104:107]
m16 v[44:47],a[60:63],a[76:79],v[44:47]
m16 v[76:79],a[60:63],a[80:83],v[76:79]
m16 v[108:111],a[60:63],a[84:87],v[108:111]
s_waitcnt vmcnt(15) lgkmcnt(0)
s_barrier
m16 v[112:115],a[192:195],a[88:91],v[112:115]
r128 a[64:67],v246,22528
s_add_u32 m0, s68, 0
m16 v[144:147],a[192:195],a[92:95],v[144:147]
r128 a[68:71],v246,24576
m16 v[176:179],a[192:195],v[240:243],v[176:179]
r128 a[72:75],v246,26624
m16 v[116:119],a[196:199],a[88:91],v[116:119]
r128 a[76:79],v247,22528
buffer_load_dwordx4 v244, s[12:15], s60 offen offset:0 lds
m16 v[148:151],a[196:199],a[92:95],v[148:151]
r128 a[80:83],v247,24576
m16 v[180:183],a[196:199],v[240:243],v[180:183]
r128 a[84:87],v247,26624
m16 v[120:123],a[200:203],a[88:91],v[120:123]
rtr a[0:1],v248,16400
m16 v[152:155],a[200:203],a[92:95],v[152:155]
rtr a[2:3],v248,17424
buffer_load_dwordx4 v244, s[12:15], s61 offen offset:1024 lds
m16 v[184:187],a[200:203],v[240:243],v[184:187]
rtr a[4:5],v248,16408
m16 v[124:127],a[204:207],a[88:91],v[124:127]
rtr a[6:7],v248,17432
m16 v[156:159],a[204:207],a[92:95],v[156:159]
m16 v[188:191],a[204:207],v[240:243],v[188:191]
rtr a[8:9],v249,16400
buffer_load_dwordx4 v244, s[12:15], s62 offen offset:2048 lds
m16 v[128:131],a[208:211],a[88:91],v[128:131]
rtr a[10:11],v249,17424
m16 v[160:163],a[208:211],a[92:95],v[160:163]
rtr a[12:13],v249,16408
m16 v[192:195],a[208:211],v[240:243],v[192:195]
rtr a[14:15],v249,17432
m16 v[132:135],a[212:215],a[88:91],v[132:135]
rtr a[16:17],v248,16912
buffer_load_dwordx4 v244, s[12:15], s63 offen offset:3072 lds
m16 v[164:167],a[212:215],a[92:95],v[164:167]
rtr a[18:19],v248,17936
m16 v[196:199],a[212:215],v[240:243],v[196:199]
rtr a[20:21],v248,16920
m16 v[136:139],a[216:219],a[88:91],v[136:139]
rtr a[22:23],v248,17944
m16 v[168:171],a[216:219],a[92:95],v[168:171]
rtr a[24:25],v249,16912
v_add_u32 v244, 262144, v244
m16 v[200:203],a[216:219],v[240:243],v[200:203]
m16 v[140:143],a[220:223],a[88:91],v[140:143]
rtr a[26:27],v249,17936
m16 v[172:175],a[220:223],a[92:95],v[172:175]
rtr a[28:29],v249,16920
m16 v[204:207],a[220:223],v[240:243],v[204:207]
rtr a[30:31],v249,17944
s_mov_b32 s28, 81920
m16 v[16:19],a[224:227],a[88:91],v[16:19]
rtr a[32:33],v248,20496
m16 v[48:51],a[224:227],a[92:95],v[48:51]
rtr a[34:35],v248,21520
m16 v[80:83],a[224:227],v[240:243],v[80:83]
rtr a[36:37],v248,20504
buffer_load_dwordx4 a[100:103], v14, s[16:19], s28 offen offset:256 nt
m16 v[20:23],a[228:231],a[88:91],v[20:23]
rtr a[38:39],v248,21528
m16 v[52:55],a[228:231],a[92:95],v[52:55]
rtr a[40:41],v249,20496
m16 v[84:87],a[228:231],v[240:243],v[84:87]
rtr a[42:43],v249,21520
m16 v[24:27],a[232:235],a[88:91],v[24:27]
rtr a[44:45],v249,20504
s_mov_b32 s28, 90112
m16 v[56:59],a[232:235],a[92:95],v[56:59]
m16 v[88:91],a[232:235],v[240:243],v[88:91]
rtr a[46:47],v249,21528
m16 v[28:31],a[236:239],a[88:91],v[28:31]
rtr a[48:49],v248,21008
m16 v[60:63],a[236:239],a[92:95],v[60:63]
rtr a[50:51],v248,22032
buffer_load_dwordx4 a[104:107], v14, s[16:19], s28 offen offset:0 nt
m16 v[92:95],a[236:239],v[240:243],v[92:95]
rtr a[52:53],v248,21016
m16 v[32:35],a[240:243],a[88:91],v[32:35]
rtr a[54:55],v248,22040
m16 v[64:67],a[240:243],a[92:95],v[64:67]
rtr a[56:57],v249,21008
m16 v[96:99],a[240:243],v[240:243],v[96:99]
rtr a[58:59],v249,22032
buffer_load_dword v255, v250, s[56:59], 0 offen
m16 v[36:39],a[244:247],a[88:91],v[36:39]
rtr a[60:61],v249,21016
m16 v[68:71],a[244:247],a[92:95],v[68:71]
rtr a[62:63],v249,22040
m16 v[100:103],a[244:247],v[240:243],v[100:103]
m16 v[40:43],a[248:251],a[88:91],v[40:43]
v_add_u32 v250, 640, v250
m16 v[72:75],a[248:251],a[92:95],v[72:75]
m16 v[104:107],a[248:251],v[240:243],v[104:107]
m16 v[44:47],a[252:255],a[88:91],v[44:47]
m16 v[76:79],a[252:255],a[92:95],v[76:79]
m16 v[108:111],a[252:255],v[240:243],v[108:111]
s_waitcnt vmcnt(15) lgkmcnt(0)
s_barrier
m16 v[112:115],a[0:3],a[64:67],v[112:115]
rtr a[192:193],v248,32800
s_add_u32 m0, s68, 16400
m16 v[144:147],a[0:3],a[68:71],v[144:147]
rtr a[194:195],v248,33824
m16 v[176:179],a[0:3],a[72:75],v[176:179]
rtr a[196:197],v248,32808
buffer_load_dwordx4 v244, s[12:15], s60 offen offset:0 lds
m16 v[116:119],a[4:7],a[64:67],v[116:119]
rtr a[198:199],v248,33832
m16 v[148:151],a[4:7],a[68:71],v[148:151]
buffer_load_dwordx4 v244, s[12:15], s61 offen offset:1024 lds
m16 v[180:183],a[4:7],a[72:75],v[180:183]
rtr a[200:201],v249,32800
m16 v[120:123],a[8:11],a[64:67],v[120:123]
rtr a[202:203],v249,33824
buffer_load_dwordx4 v244, s[12:15], s62 offen offset:2048 lds
m16 v[152:155],a[8:11],a[68:71],v[152:155]
rtr a[204:205],v249,32808
m16 v[184:187],a[8:11],a[72:75],v[184:187]
m16 v[124:127],a[12:15],a[64:67],v[124:127]
rtr a[206:207],v249,33832
buffer_load_dwordx4 v244, s[12:15], s63 offen offset:3072 lds
m16 v[156:159],a[12:15],a[68:71],v[156:159]
rtr a[208:209],v248,33312
m16 v[188:191],a[12:15],a[72:75],v[188:191]
rtr a[210:211],v248,34336
v_add_u32 v244, 262144, v244
m16 v[128:131],a[16:19],a[64:67],v[128:131]
m16 v[160:163],a[16:19],a[68:71],v[160:163]
rtr a[212:213],v248,33320
s_add_u32 m0, s69, 22528
m16 v[192:195],a[16:19],a[72:75],v[192:195]
rtr a[214:215],v248,34344
m16 v[132:135],a[20:23],a[64:67],v[132:135]
rtr a[216:217],v249,33312
m16 v[164:167],a[20:23],a[68:71],v[164:167]
buffer_load_dwordx4 v245, s[8:11], s64 offen offset:0 lds
m16 v[196:199],a[20:23],a[72:75],v[196:199]
rtr a[218:219],v249,34336
m16 v[136:139],a[24:27],a[64:67],v[136:139]
rtr a[220:221],v249,33320
buffer_load_dwordx4 v251, s[8:11], s64 offen offset:1024 lds
m16 v[168:171],a[24:27],a[68:71],v[168:171]
rtr a[222:223],v249,34344
m16 v[200:203],a[24:27],a[72:75],v[200:203]
buffer_load_dwordx4 v245, s[8:11], s65 offen offset:2048 lds
m16 v[140:143],a[28:31],a[64:67],v[140:143]
rtr a[224:225],v248,36896
m16 v[172:175],a[28:31],a[68:71],v[172:175]
rtr a[226:227],v248,37920
m16 v[204:207],a[28:31],a[72:75],v[204:207]
rtr a[228:229],v248,36904
buffer_load_dwordx4 v251, s[8:11], s65 offen offset:3072 lds
m16 v[16:19],a[32:35],a[64:67],v[16:19]
rtr a[230:231],v248,37928
m16 v[48:51],a[32:35],a[68:71],v[48:51]
s_add_u32 m0, s69, 26624
m16 v[80:83],a[32:35],a[72:75],v[80:83]
rtr a[232:233],v249,36896
m16 v[20:23],a[36:39],a[64:67],v[20:23]
rtr a[234:235],v249,37920
buffer_load_dwordx4 v245, s[8:11], s66 offen offset:0 lds
m16 v[52:55],a[36:39],a[68:71],v[52:55]
rtr a[236:237],v249,36904
m16 v[84:87],a[36:39],a[72:75],v[84:87]
buffer_load_dwordx4 v251, s[8:11], s66 offen offset:1024 lds
m16 v[24:27],a[40:43],a[64:67],v[24:27]
rtr a[238:239],v249,37928
m16 v[56:59],a[40:43],a[68:71],v[56:59]
rtr a[240:241],v248,37408
m16 v[88:91],a[40:43],a[72:75],v[88:91]
rtr a[242:243],v248,38432
v_add_u32 v245, 128, v245
m16 v[28:31],a[44:47],a[64:67],v[28:31]
m16 v[60:63],a[44:47],a[68:71],v[60:63]
rtr a[244:245],v248,37416
v_add_u32 v251, 128, v251
m16 v[92:95],a[44:47],a[72:75],v[92:95]
rtr a[246:247],v248,38440
m16 v[32:35],a[48:51],a[64:67],v[32:35]
rtr a[248:249],v249,37408
s_mov_b32 s28, 90112
m16 v[64:67],a[48:51],a[68:71],v[64:67]
m16 v[96:99],a[48:51],a[72:75],v[96:99]
rtr a[250:251],v249,38432
m16 v[36:39],a[52:55],a[64:67],v[36:39]
rtr a[252:253],v249,37416
buffer_load_dwordx4 a[108:111], v14, s[16:19], s28 offen offset:256 nt
m16 v[68:71],a[52:55],a[68:71],v[68:71]
rtr a[254:255],v249,38440
m16 v[100:103],a[52:55],a[72:75],v[100:103]
buffer_load_dword v255, v250, s[56:59], 0 offen
m16 v[40:43],a[56:59],a[64:67],v[40:43]
m16 v[72:75],a[56:59],a[68:71],v[72:75]
v_add_u32 v250, 640, v250
m16 v[104:107],a[56:59],a[72:75],v[104:107]
m16 v[44:47],a[60:63],a[64:67],v[44:47]
m16 v[76:79],a[60:63],a[68:71],v[76:79]
m16 v[108:111],a[60:63],a[72:75],v[108:111]
s_waitcnt vmcnt(15) lgkmcnt(0)
s_barrier
m16 v[112:115],a[192:195],a[76:79],v[112:115]
r128 a[88:91],v246,0
s_add_u32 m0, s68, 32800
m16 v[144:147],a[192:195],a[80:83],v[144:147]
r128 a[92:95],v246,2048
m16 v[176:179],a[192:195],a[84:87],v[176:179]
r128 v[240:243],v246,4096
m16 v[116:119],a[196:199],a[76:79],v[116:119]
r128 a[64:67],v247,0
buffer_load_dwordx4 v244, s[12:15], s60 offen offset:0 lds
m16 v[148:151],a[196:199],a[80:83],v[148:151]
r128 a[68:71],v247,2048
m16 v[180:183],a[196:199],a[84:87],v[180:183]
r128 a[72:75],v247,4096
m16 v[120:123],a[200:203],a[76:79],v[120:123]
rtr a[0:1],v248,0
m16 v[152:155],a[200:203],a[80:83],v[152:155]
rtr a[2:3],v248,1024
buffer_load_dwordx4 v244, s[12:15], s61 offen offset:1024 lds
m16 v[184:187],a[200:203],a[84:87],v[184:187]
rtr a[4:5],v248,8
m16 v[124:127],a[204:207],a[76:79],v[124:127]
rtr a[6:7],v248,1032
m16 v[156:159],a[204:207],a[80:83],v[156:159]
m16 v[188:191],a[204:207],a[84:87],v[188:191]
rtr a[8:9],v249,0
buffer_load_dwordx4 v244, s[12:15], s62 offen offset:2048 lds
m16 v[128:131],a[208:211],a[76:79],v[128:131]
rtr a[10:11],v249,1024
m16 v[160:163],a[208:211],a[80:83],v[160:163]
rtr a[12:13],v249,8
m16 v[192:195],a[208:211],a[84:87],v[192:195]
rtr a[14:15],v249,1032
m16 v[132:135],a[212:215],a[76:79],v[132:135]
rtr a[16:17],v248,512
buffer_load_dwordx4 v244, s[12:15], s63 offen offset:3072 lds
m16 v[164:167],a[212:215],a[80:83],v[164:167]
rtr a[18:19],v248,1536
m16 v[196:199],a[212:215],a[84:87],v[196:199]
rtr a[20:21],v248,520
m16 v[136:139],a[216:219],a[76:79],v[136:139]
rtr a[22:23],v248,1544
m16 v[168:171],a[216:219],a[80:83],v[168:171]
rtr a[24:25],v249,512
v_add_u32 v244, 262144, v244
m16 v[200:203],a[216:219],a[84:87],v[200:203]
m16 v[140:143],a[220:223],a[76:79],v[140:143]
rtr a[26:27],v249,1536
m16 v[172:175],a[220:223],a[80:83],v[172:175]
rtr a[28:29],v249,520
m16 v[204:207],a[220:223],a[84:87],v[204:207]
rtr a[30:31],v249,1544
s_mov_b32 s28, 114688
m16 v[16:19],a[224:227],a[76:79],v[16:19]
rtr a[32:33],v248,4096
m16 v[48:51],a[224:227],a[80:83],v[48:51]
rtr a[34:35],v248,5120
m16 v[80:83],a[224:227],a[84:87],v[80:83]
rtr a[36:37],v248,4104
buffer_load_dwordx4 a[112:115], v14, s[16:19], s28 offen offset:0 nt
m16 v[20:23],a[228:231],a[76:79],v[20:23]
rtr a[38:39],v248,5128
m16 v[52:55],a[228:231],a[80:83],v[52:55]
rtr a[40:41],v249,4096
m16 v[84:87],a[228:231],a[84:87],v[84:87]
rtr a[42:43],v249,5120
m16 v[24:27],a[232:235],a[76:79],v[24:27]
rtr a[44:45],v249,4104
s_mov_b32 s28, 114688
m16 v[56:59],a[232:235],a[80:83],v[56:59]
m16 v[88:91],a[232:235],a[84:87],v[88:91]
rtr a[46:47],v249,5128
m16 v[28:31],a[236:239],a[76:79],v[28:31]
rtr a[48:49],v248,4608
m16 v[60:63],a[236:239],a[80:83],v[60:63]
rtr a[50:51],v248,5632
buffer_load_dwordx4 a[116:119], v14, s[16:19], s28 offen offset:256 nt
m16 v[92:95],a[236:239],a[84:87],v[92:95]
rtr a[52:53],v248,4616
m16 v[32:35],a[240:243],a[76:79],v[32:35]
rtr a[54:55],v248,5640
m16 v[64:67],a[240:243],a[80:83],v[64:67]
rtr a[56:57],v249,4608
m16 v[96:99],a[240:243],a[84:87],v[96:99]
rtr a[58:59],v249,5632
buffer_load_dword v255, v250, s[56:59], 0 offen
m16 v[36:39],a[244:247],a[76:79],v[36:39]
rtr a[60:61],v249,4616
m16 v[68:71],a[244:247],a[80:83],v[68:71]
rtr a[62:63],v249,5640
m16 v[100:103],a[244:247],a[84:87],v[100:103]
m16 v[40:43],a[248:251],a[76:79],v[40:43]
v_add_u32 v250, 640, v250
m16 v[72:75],a[248:251],a[80:83],v[72:75]
m16 v[104:107],a[248:251],a[84:87],v[104:107]
m16 v[44:47],a[252:255],a[76:79],v[44:47]
m16 v[76:79],a[252:255],a[80:83],v[76:79]
m16 v[108:111],a[252:255],a[84:87],v[108:111]
s_waitcnt vmcnt(15) lgkmcnt(0)
s_barrier
m16 v[112:115],a[0:3],a[88:91],v[112:115]
rtr a[192:193],v248,16400
s_add_u32 m0, s68, 0
m16 v[144:147],a[0:3],a[92:95],v[144:147]
rtr a[194:195],v248,17424
m16 v[176:179],a[0:3],v[240:243],v[176:179]
rtr a[196:197],v248,16408
buffer_load_dwordx4 v244, s[12:15], s60 offen offset:0 lds
m16 v[116:119],a[4:7],a[88:91],v[116:119]
rtr a[198:199],v248,17432
m16 v[148:151],a[4:7],a[92:95],v[148:151]
buffer_load_dwordx4 v244, s[12:15], s61 offen offset:1024 lds
m16 v[180:183],a[4:7],v[240:243],v[180:183]
rtr a[200:201],v249,16400
m16 v[120:123],a[8:11],a[88:91],v[120:123]
rtr a[202:203],v249,17424
buffer_load_dwordx4 v244, s[12:15], s62 offen offset:2048 lds
m16 v[152:155],a[8:11],a[92:95],v[152:155]
rtr a[204:205],v249,16408
m16 v[184:187],a[8:11],v[240:243],v[184:187]
m16 v[124:127],a[12:15],a[88:91],v[124:127]
rtr a[206:207],v249,17432
buffer_load_dwordx4 v244, s[12:15], s63 offen offset:3072 lds
m16 v[156:159],a[12:15],a[92:95],v[156:159]
rtr a[208:209],v248,16912
m16 v[188:191],a[12:15],v[240:243],v[188:191]
rtr a[210:211],v248,17936
v_add_u32 v244, 262144, v244
m16 v[128:131],a[16:19],a[88:91],v[128:131]
m16 v[160:163],a[16:19],a[92:95],v[160:163]
rtr a[212:213],v248,16920
s_add_u32 m0, s69, 0
m16 v[192:195],a[16:19],v[240:243],v[192:195]
rtr a[214:215],v248,17944
m16 v[132:135],a[20:23],a[88:91],v[132:135]
rtr a[216:217],v249,16912
m16 v[164:167],a[20:23],a[92:95],v[164:167]
buffer_load_dwordx4 v245, s[8:11], s64 offen offset:0 lds
m16 v[196:199],a[20:23],v[240:243],v[196:199]
rtr a[218:219],v249,17936
m16 v[136:139],a[24:27],a[88:91],v[136:139]
rtr a[220:221],v249,16920
buffer_load_dwordx4 v251, s[8:11], s64 offen offset:1024 lds
m16 v[168:171],a[24:27],a[92:95],v[168:171]
rtr a[222:223],v249,17944
m16 v[200:203],a[24:27],v[240:243],v[200:203]
buffer_load_dwordx4 v245, s[8:11], s65 offen offset:2048 lds
m16 v[140:143],a[28:31],a[88:91],v[140:143]
rtr a[224:225],v248,20496
m16 v[172:175],a[28:31],a[92:95],v[172:175]
rtr a[226:227],v248,21520
m16 v[204:207],a[28:31],v[240:243],v[204:207]
rtr a[228:229],v248,20504
buffer_load_dwordx4 v251, s[8:11], s65 offen offset:3072 lds
m16 v[16:19],a[32:35],a[88:91],v[16:19]
rtr a[230:231],v248,21528
m16 v[48:51],a[32:35],a[92:95],v[48:51]
s_add_u32 m0, s69, 4096
m16 v[80:83],a[32:35],v[240:243],v[80:83]
rtr a[232:233],v249,20496
m16 v[20:23],a[36:39],a[88:91],v[20:23]
rtr a[234:235],v249,21520
buffer_load_dwordx4 v245, s[8:11], s66 offen offset:0 lds
m16 v[52:55],a[36:39],a[92:95],v[52:55]
rtr a[236:237],v249,20504
m16 v[84:87],a[36:39],v[240:243],v[84:87]
buffer_load_dwordx4 v251, s[8:11], s66 offen offset:1024 lds
m16 v[24:27],a[40:43],a[88:91],v[24:27]
rtr a[238:239],v249,21528
m16 v[56:59],a[40:43],a[92:95],v[56:59]
rtr a[240:241],v248,21008
m16 v[88:91],a[40:43],v[240:243],v[88:91]
rtr a[242:243],v248,22032
v_add_u32 v245, 128, v245
m16 v[28:31],a[44:47],a[88:91],v[28:31]
m16 v[60:63],a[44:47],a[92:95],v[60:63]
rtr a[244:245],v248,21016
v_add_u32 v251, 128, v251
m16 v[92:95],a[44:47],v[240:243],v[92:95]
rtr a[246:247],v248,22040
m16 v[32:35],a[48:51],a[88:91],v[32:35]
rtr a[248:249],v249,21008
s_mov_b32 s28, 122880
m16 v[64:67],a[48:51],a[92:95],v[64:67]
m16 v[96:99],a[48:51],v[240:243],v[96:99]
rtr a[250:251],v249,22032
m16 v[36:39],a[52:55],a[88:91],v[36:39]
rtr a[252:253],v249,21016
buffer_load_dwordx4 a[120:123], v14, s[16:19], s28 offen offset:0 nt
m16 v[68:71],a[52:55],a[92:95],v[68:71]
rtr a[254:255],v249,22040
m16 v[100:103],a[52:55],v[240:243],v[100:103]
buffer_load_dword v255, v250, s[56:59], 0 offen
m16 v[40:43],a[56:59],a[88:91],v[40:43]
m16 v[72:75],a[56:59],a[92:95],v[72:75]
v_add_u32 v250, 640, v250
m16 v[104:107],a[56:59],v[240:243],v[104:107]
m16 v[44:47],a[60:63],a[88:91],v[44:47]
m16 v[76:79],a[60:63],a[92:95],v[76:79]
m16 v[108:111],a[60:63],v[240:243],v[108:111]
s_waitcnt vmcnt(15) lgkmcnt(0)
s_barrier
m16 v[112:115],a[192:195],a[64:67],v[112:115]
r128 a[76:79],v246,22528
s_add_u32 m0, s68, 16400
m16 v[144:147],a[192:195],a[68:71],v[144:147]
r128 a[80:83],v246,24576
m16 v[176:179],a[192:195],a[72:75],v[176:179]
r128 a[84:87],v246,26624
m16 v[116:119],a[196:199],a[64:67],v[116:119]
r128 a[88:91],v247,22528
buffer_load_dwordx4 v244, s[12:15], s60 offen offset:0 lds
m16 v[148:151],a[196:199],a[68:71],v[148:151]
r128 a[92:95],v247,24576
m16 v[180:183],a[196:199],a[72:75],v[180:183]
r128 v[240:243],v247,26624
m16 v[120:123],a[200:203],a[64:67],v[120:123]
rtr a[0:1],v248,32800
m16 v[152:155],a[200:203],a[68:71],v[152:155]
rtr a[2:3],v248,33824
buffer_load_dwordx4 v244, s[12:15], s61 offen offset:1024 lds
m16 v[184:187],a[200:203],a[72:75],v[184:187]
rtr a[4:5],v248,32808
m16 v[124:127],a[204:207],a[64:67],v[124:127]
rtr a[6:7],v248,33832
m16 v[156:159],a[204:207],a[68:71],v[156:159]
m16 v[188:191],a[204:207],a[72:75],v[188:191]
rtr a[8:9],v249,32800
buffer_load_dwordx4 v244, s[12:15], s62 offen offset:2048 lds
m16 v[128:131],a[208:211],a[64:67],v[128:131]
rtr a[10:11],v249,33824
m16 v[160:163],a[208:211],a[68:71],v[160:163]
rtr a[12:13],v249,32808
m16 v[192:195],a[208:211],a[72:75],v[192:195]
rtr a[14:15],v249,33832
m16 v[132:135],a[212:215],a[64:67],v[132:135]
rtr a[16:17],v248,33312
buffer_load_dwordx4 v244, s[12:15], s63 offen offset:3072 lds
m16 v[164:167],a[212:215],a[68:71],v[164:167]
rtr a[18:19],v248,34336
m16 v[196:199],a[212:215],a[72:75],v[196:199]
rtr a[20:21],v248,33320
m16 v[136:139],a[216:219],a[64:67],v[136:139]
rtr a[22:23],v248,34344
m16 v[168:171],a[216:219],a[68:71],v[168:171]
rtr a[24:25],v249,33312
v_add_u32 v244, 262144, v244
m16 v[200:203],a[216:219],a[72:75],v[200:203]
m16 v[140:143],a[220:223],a[64:67],v[140:143]
rtr a[26:27],v249,34336
m16 v[172:175],a[220:223],a[68:71],v[172:175]
rtr a[28:29],v249,33320
m16 v[204:207],a[220:223],a[72:75],v[204:207]
rtr a[30:31],v249,34344
s_mov_b32 s28, 122880
m16 v[16:19],a[224:227],a[64:67],v[16:19]
rtr a[32:33],v248,36896
m16 v[48:51],a[224:227],a[68:71],v[48:51]
rtr a[34:35],v248,37920
m16 v[80:83],a[224:227],a[72:75],v[80:83]
rtr a[36:37],v248,36904
buffer_load_dwordx4 a[124:127], v14, s[16:19], s28 offen offset:256 nt
m16 v[20:23],a[228:231],a[64:67],v[20:23]
rtr a[38:39],v248,37928
m16 v[52:55],a[228:231],a[68:71],v[52:55]
rtr a[40:41],v249,36896
m16 v[84:87],a[228:231],a[72:75],v[84:87]
rtr a[42:43],v249,37920
m16 v[24:27],a[232:235],a[64:67],v[24:27]
rtr a[44:45],v249,36904
s_mov_b32 s28, 131072
m16 v[56:59],a[232:235],a[68:71],v[56:59]
m16 v[88:91],a[232:235],a[72:75],v[88:91]
rtr a[46:47],v249,37928
m16 v[28:31],a[236:239],a[64:67],v[28:31]
rtr a[48:49],v248,37408
m16 v[60:63],a[236:239],a[68:71],v[60:63]
rtr a[50:51],v248,38432
buffer_load_dwordx4 a[128:131], v14, s[20:23], s28 offen offset:0 nt
m16 v[92:95],a[236:239],a[72:75],v[92:95]
rtr a[52:53],v248,37416
m16 v[32:35],a[240:243],a[64:67],v[32:35]
rtr a[54:55],v248,38440
m16 v[64:67],a[240:243],a[68:71],v[64:67]
rtr a[56:57],v249,37408
m16 v[96:99],a[240:243],a[72:75],v[96:99]
rtr a[58:59],v249,38432
buffer_load_dword v255, v250, s[56:59], 0 offen
m16 v[36:39],a[244:247],a[64:67],v[36:39]
rtr a[60:61],v249,37416
m16 v[68:71],a[244:247],a[68:71],v[68:71]
rtr a[62:63],v249,38440
m16 v[100:103],a[244:247],a[72:75],v[100:103]
m16 v[40:43],a[248:251],a[64:67],v[40:43]
v_add_u32 v250, 640, v250
m16 v[72:75],a[248:251],a[68:71],v[72:75]
m16 v[104:107],a[248:251],a[72:75],v[104:107]
m16 v[44:47],a[252:255],a[64:67],v[44:47]
m16 v[76:79],a[252:255],a[68:71],v[76:79]
m16 v[108:111],a[252:255],a[72:75],v[108:111]
s_waitcnt vmcnt(15) lgkmcnt(0)
s_barrier
m16 v[112:115],a[0:3],a[76:79],v[112:115]
rtr a[192:193],v248,0
s_add_u32 m0, s68, 32800
m16 v[144:147],a[0:3],a[80:83],v[144:147]
rtr a[194:195],v248,1024
m16 v[176:179],a[0:3],a[84:87],v[176:179]
rtr a[196:197],v248,8
buffer_load_dwordx4 v244, s[12:15], s60 offen offset:0 lds
m16 v[116:119],a[4:7],a[76:79],v[116:119]
rtr a[198:199],v248,1032
m16 v[148:151],a[4:7],a[80:83],v[148:151]
buffer_load_dwordx4 v244, s[12:15], s61 offen offset:1024 lds
m16 v[180:183],a[4:7],a[84:87],v[180:183]
rtr a[200:201],v249,0
m16 v[120:123],a[8:11],a[76:79],v[120:123]
rtr a[202:203],v249,1024
buffer_load_dwordx4 v244, s[12:15], s62 offen offset:2048 lds
m16 v[152:155],a[8:11],a[80:83],v[152:155]
rtr a[204:205],v249,8
m16 v[184:187],a[8:11],a[84:87],v[184:187]
buffer_load_dwordx4 v244, s[12:15], s63 offen offset:3072 lds
m16 v[124:127],a[12:15],a[76:79],v[124:127]
rtr a[206:207],v249,1032
m16 v[156:159],a[12:15],a[80:83],v[156:159]
rtr a[208:209],v248,512
v_add_u32 v244, 262144, v244
m16 v[188:191],a[12:15],a[84:87],v[188:191]
rtr a[210:211],v248,1536
m16 v[128:131],a[16:19],a[76:79],v[128:131]
s_add_u32 m0, s69, 22528
m16 v[160:163],a[16:19],a[80:83],v[160:163]
rtr a[212:213],v248,520
m16 v[192:195],a[16:19],a[84:87],v[192:195]
rtr a[214:215],v248,1544
buffer_load_dwordx4 v245, s[8:11], s64 offen offset:0 lds
m16 v[132:135],a[20:23],a[76:79],v[132:135]
rtr a[216:217],v249,512
m16 v[164:167],a[20:23],a[80:83],v[164:167]
buffer_load_dwordx4 v251, s[8:11], s64 offen offset:1024 lds
m16 v[196:199],a[20:23],a[84:87],v[196:199]
rtr a[218:219],v249,1536
m16 v[136:139],a[24:27],a[76:79],v[136:139]
rtr a[220:221],v249,520
buffer_load_dwordx4 v245, s[8:11], s65 offen offset:2048 lds
m16 v[168:171],a[24:27],a[80:83],v[168:171]
rtr a[222:223],v249,1544
m16 v[200:203],a[24:27],a[84:87],v[200:203]
buffer_load_dwordx4 v251, s[8:11], s65 offen offset:3072 lds
m16 v[140:143],a[28:31],a[76:79],v[140:143]
rtr a[224:225],v248,4096
m16 v[172:175],a[28:31],a[80:83],v[172:175]
rtr a[226:227],v248,5120
m16 v[204:207],a[28:31],a[84:87],v[204:207]
rtr a[228:229],v248,4104
s_add_u32 m0, s69, 26624
m16 v[16:19],a[32:35],a[76:79],v[16:19]
rtr a[230:231],v248,5128
m16 v[48:51],a[32:35],a[80:83],v[48:51]
buffer_load_dwordx4 v245, s[8:11], s66 offen offset:0 lds
m16 v[80:83],a[32:35],a[84:87],v[80:83]
rtr a[232:233],v249,4096
m16 v[20:23],a[36:39],a[76:79],v[20:23]
rtr a[234:235],v249,5120
buffer_load_dwordx4 v251, s[8:11], s66 offen offset:1024 lds
m16 v[52:55],a[36:39],a[80:83],v[52:55]
rtr a[236:237],v249,4104
m16 v[84:87],a[36:39],a[84:87],v[84:87]
v_add_u32 v245, 128, v245
m16 v[24:27],a[40:43],a[76:79],v[24:27]
rtr a[238:239],v249,5128
m16 v[56:59],a[40:43],a[80:83],v[56:59]
rtr a[240:241],v248,4608
v_add_u32 v251, 128, v251
m16 v[88:91],a[40:43],a[84:87],v[88:91]
rtr a[242:243],v248,5632
m16 v[28:31],a[44:47],a[76:79],v[28:31]
s_mov_b32 s28, 131072
m16 v[60:63],a[44:47],a[80:83],v[60:63]
rtr a[244:245],v248,4616
m16 v[92:95],a[44:47],a[84:87],v[92:95]
rtr a[246:247],v248,5640
buffer_load_dwordx4 a[132:135], v14, s[20:23], s28 offen offset:256 nt
m16 v[32:35],a[48:51],a[76:79],v[32:35]
rtr a[248:249],v249,4608
m16 v[64:67],a[48:51],a[80:83],v[64:67]
s_mov_b32 s28, 139264
m16 v[96:99],a[48:51],a[84:87],v[96:99]
rtr a[250:251],v249,5632
m16 v[36:39],a[52:55],a[76:79],v[36:39]
rtr a[252:253],v249,4616
buffer_load_dwordx4 a[136:139], v14, s[20:23], s28 offen offset:0 nt
m16 v[68:71],a[52:55],a[80:83],v[68:71]
rtr a[254:255],v249,5640
m16 v[100:103],a[52:55],a[84:87],v[100:103]
buffer_load_dword v255, v250, s[56:59], 0 offen
m16 v[40:43],a[56:59],a[76:79],v[40:43]
m16 v[72:75],a[56:59],a[80:83],v[72:75]
v_add_u32 v250, 640, v250
m16 v[104:107],a[56:59],a[84:87],v[104:107]
m16 v[44:47],a[60:63],a[76:79],v[44:47]
m16 v[76:79],a[60:63],a[80:83],v[76:79]
m16 v[108:111],a[60:63],a[84:87],v[108:111]
s_waitcnt vmcnt(16) lgkmcnt(0)
s_barrier
m16 v[112:115],a[192:195],a[88:91],v[112:115]
r128 a[64:67],v246,0
s_add_u32 m0, s68, 0
m16 v[144:147],a[192:195],a[92:95],v[144:147]
r128 a[68:71],v246,2048
m16 v[176:179],a[192:195],v[240:243],v[176:179]
r128 a[72:75],v246,4096
m16 v[116:119],a[196:199],a[88:91],v[116:119]
r128 a[76:79],v247,0
m16 v[148:151],a[196:199],a[92:95],v[148:151]
r128 a[80:83],v247,2048
buffer_load_dwordx4 v244, s[12:15], s60 offen offset:0 lds
m16 v[180:183],a[196:199],v[240:243],v[180:183]
r128 a[84:87],v247,4096
m16 v[120:123],a[200:203],a[88:91],v[120:123]
rtr a[0:1],v248,16400
m16 v[152:155],a[200:203],a[92:95],v[152:155]
rtr a[2:3],v248,17424
m16 v[184:187],a[200:203],v[240:243],v[184:187]
rtr a[4:5],v248,16408
m16 v[124:127],a[204:207],a[88:91],v[124:127]
rtr a[6:7],v248,17432
buffer_load_dwordx4 v244, s[12:15], s61 offen offset:1024 lds
m16 v[156:159],a[204:207],a[92:95],v[156:159]
m16 v[188:191],a[204:207],v[240:243],v[188:191]
rtr a[8:9],v249,16400
m16 v[128:131],a[208:211],a[88:91],v[128:131]
rtr a[10:11],v249,17424
m16 v[160:163],a[208:211],a[92:95],v[160:163]
rtr a[12:13],v249,16408
buffer_load_dwordx4 v244, s[12:15], s62 offen offset:2048 lds
m16 v[192:195],a[208:211],v[240:243],v[192:195]
rtr a[14:15],v249,17432
m16 v[132:135],a[212:215],a[88:91],v[132:135]
rtr a[16:17],v248,16912
m16 v[164:167],a[212:215],a[92:95],v[164:167]
rtr a[18:19],v248,17936
m16 v[196:199],a[212:215],v[240:243],v[196:199]
rtr a[20:21],v248,16920
m16 v[136:139],a[216:219],a[88:91],v[136:139]
rtr a[22:23],v248,17944
buffer_load_dwordx4 v244, s[12:15], s63 offen offset:3072 lds
m16 v[168:171],a[216:219],a[92:95],v[168:171]
rtr a[24:25],v249,16912
m16 v[200:203],a[216:219],v[240:243],v[200:203]
m16 v[140:143],a[220:223],a[88:91],v[140:143]
rtr a[26:27],v249,17936
m16 v[172:175],a[220:223],a[92:95],v[172:175]
rtr a[28:29],v249,16920
m16 v[204:207],a[220:223],v[240:243],v[204:207]
rtr a[30:31],v249,17944
v_add_u32 v244, 262144, v244
m16 v[16:19],a[224:227],a[88:91],v[16:19]
rtr a[32:33],v248,20496
m16 v[48:51],a[224:227],a[92:95],v[48:51]
rtr a[34:35],v248,21520
m16 v[80:83],a[224:227],v[240:243],v[80:83]
rtr a[36:37],v248,20504
m16 v[20:23],a[228:231],a[88:91],v[20:23]
rtr a[38:39],v248,21528
s_mov_b32 s28, 139264
m16 v[52:55],a[228:231],a[92:95],v[52:55]
rtr a[40:41],v249,20496
m16 v[84:87],a[228:231],v[240:243],v[84:87]
rtr a[42:43],v249,21520
m16 v[24:27],a[232:235],a[88:91],v[24:27]
rtr a[44:45],v249,20504
m16 v[56:59],a[232:235],a[92:95],v[56:59]
m16 v[88:91],a[232:235],v[240:243],v[88:91]
rtr a[46:47],v249,21528
buffer_load_dwordx4 a[140:143], v14, s[20:23], s28 offen offset:256 nt
m16 v[28:31],a[236:239],a[88:91],v[28:31]
rtr a[48:49],v248,21008
m16 v[60:63],a[236:239],a[92:95],v[60:63]
rtr a[50:51],v248,22032
m16 v[92:95],a[236:239],v[240:243],v[92:95]
rtr a[52:53],v248,21016
m16 v[32:35],a[240:243],a[88:91],v[32:35]
rtr a[54:55],v248,22040
buffer_load_dword v255, v250, s[56:59], 0 offen
m16 v[64:67],a[240:243],a[92:95],v[64:67]
rtr a[56:57],v249,21008
m16 v[96:99],a[240:243],v[240:243],v[96:99]
rtr a[58:59],v249,22032
m16 v[36:39],a[244:247],a[88:91],v[36:39]
rtr a[60:61],v249,21016
m16 v[68:71],a[244:247],a[92:95],v[68:71]
rtr a[62:63],v249,22040
m16 v[100:103],a[244:247],v[240:243],v[100:103]
v_add_u32 v250, 640, v250
m16 v[40:43],a[248:251],a[88:91],v[40:43]
m16 v[72:75],a[248:251],a[92:95],v[72:75]
m16 v[104:107],a[248:251],v[240:243],v[104:107]
m16 v[44:47],a[252:255],a[88:91],v[44:47]
m16 v[76:79],a[252:255],a[92:95],v[76:79]
m16 v[108:111],a[252:255],v[240:243],v[108:111]
s_waitcnt vmcnt(15) lgkmcnt(0)
s_barrier
m16 v[112:115],a[0:3],a[64:67],v[112:115]
rtr a[192:193],v248,32800
s_add_u32 m0, s68, 16400
m16 v[144:147],a[0:3],a[68:71],v[144:147]
rtr a[194:195],v248,33824
m16 v[176:179],a[0:3],a[72:75],v[176:179]
rtr a[196:197],v248,32808
buffer_load_dwordx4 v244, s[12:15], s60 offen offset:0 lds
m16 v[116:119],a[4:7],a[64:67],v[116:119]
rtr a[198:199],v248,33832
m16 v[148:151],a[4:7],a[68:71],v[148:151]
buffer_load_dwordx4 v244, s[12:15], s61 offen offset:1024 lds
m16 v[180:183],a[4:7],a[72:75],v[180:183]
rtr a[200:201],v249,32800
m16 v[120:123],a[8:11],a[64:67],v[120:123]
rtr a[202:203],v249,33824
buffer_load_dwordx4 v244, s[12:15], s62 offen offset:2048 lds
m16 v[152:155],a[8:11],a[68:71],v[152:155]
rtr a[204:205],v249,32808
m16 v[184:187],a[8:11],a[72:75],v[184:187]
buffer_load_dwordx4 v244, s[12:15], s63 offen offset:3072 lds
m16 v[124:127],a[12:15],a[64:67],v[124:127]
rtr a[206:207],v249,33832
m16 v[156:159],a[12:15],a[68:71],v[156:159]
rtr a[208:209],v248,33312
v_add_u32 v244, 262144, v244
m16 v[188:191],a[12:15],a[72:75],v[188:191]
rtr a[210:211],v248,34336
m16 v[128:131],a[16:19],a[64:67],v[128:131]
s_add_u32 m0, s69, 0
m16 v[160:163],a[16:19],a[68:71],v[160:163]
rtr a[212:213],v248,33320
m16 v[192:195],a[16:19],a[72:75],v[192:195]
rtr a[214:215],v248,34344
buffer_load_dwordx4 v245, s[8:11], s64 offen offset:0 lds
m16 v[132:135],a[20:23],a[64:67],v[132:135]
rtr a[216:217],v249,33312
m16 v[164:167],a[20:23],a[68:71],v[164:167]
buffer_load_dwordx4 v251, s[8:11], s64 offen offset:1024 lds
m16 v[196:199],a[20:23],a[72:75],v[196:199]
rtr a[218:219],v249,34336
m16 v[136:139],a[24:27],a[64:67],v[136:139]
rtr a[220:221],v249,33320
buffer_load_dwordx4 v245, s[8:11], s65 offen offset:2048 lds
m16 v[168:171],a[24:27],a[68:71],v[168:171]
rtr a[222:223],v249,34344
m16 v[200:203],a[24:27],a[72:75],v[200:203]
buffer_load_dwordx4 v251, s[8:11], s65 offen offset:3072 lds
m16 v[140:143],a[28:31],a[64:67],v[140:143]
rtr a[224:225],v248,36896
m16 v[172:175],a[28:31],a[68:71],v[172:175]
rtr a[226:227],v248,37920
m16 v[204:207],a[28:31],a[72:75],v[204:207]
rtr a[228:229],v248,36904
s_add_u32 m0, s69, 4096
m16 v[16:19],a[32:35],a[64:67],v[16:19]
rtr a[230:231],v248,37928
m16 v[48:51],a[32:35],a[68:71],v[48:51]
buffer_load_dwordx4 v245, s[8:11], s66 offen offset:0 lds
m16 v[80:83],a[32:35],a[72:75],v[80:83]
rtr a[232:233],v249,36896
m16 v[20:23],a[36:39],a[64:67],v[20:23]
rtr a[234:235],v249,37920
buffer_load_dwordx4 v251, s[8:11], s66 offen offset:1024 lds
m16 v[52:55],a[36:39],a[68:71],v[52:55]
rtr a[236:237],v249,36904
m16 v[84:87],a[36:39],a[72:75],v[84:87]
v_add_u32 v245, 128, v245
m16 v[24:27],a[40:43],a[64:67],v[24:27]
rtr a[238:239],v249,37928
m16 v[56:59],a[40:43],a[68:71],v[56:59]
rtr a[240:241],v248,37408
v_add_u32 v251, 128, v251
m16 v[88:91],a[40:43],a[72:75],v[88:91]
rtr a[242:243],v248,38432
m16 v[28:31],a[44:47],a[64:67],v[28:31]
s_mov_b32 s28, 163840
m16 v[60:63],a[44:47],a[68:71],v[60:63]
rtr a[244:245],v248,37416
m16 v[92:95],a[44:47],a[72:75],v[92:95]
rtr a[246:247],v248,38440
buffer_load_dwordx4 a[144:147], v14, s[16:19], s28 offen offset:0 nt
m16 v[32:35],a[48:51],a[64:67],v[32:35]
rtr a[248:249],v249,37408
m16 v[64:67],a[48:51],a[68:71],v[64:67]
s_mov_b32 s28, 163840
m16 v[96:99],a[48:51],a[72:75],v[96:99]
rtr a[250:251],v249,38432
m16 v[36:39],a[52:55],a[64:67],v[36:39]
rtr a[252:253],v249,37416
buffer_load_dwordx4 a[148:151], v14, s[16:19], s28 offen offset:256 nt
m16 v[68:71],a[52:55],a[68:71],v[68:71]
rtr a[254:255],v249,38440
m16 v[100:103],a[52:55],a[72:75],v[100:103]
buffer_load_dword v255, v250, s[56:59], 0 offen
m16 v[40:43],a[56:59],a[64:67],v[40:43]
m16 v[72:75],a[56:59],a[68:71],v[72:75]
v_add_u32 v250, 640, v250
m16 v[104:107],a[56:59],a[72:75],v[104:107]
m16 v[44:47],a[60:63],a[64:67],v[44:47]
m16 v[76:79],a[60:63],a[68:71],v[76:79]
m16 v[108:111],a[60:63],a[72:75],v[108:111]
s_waitcnt vmcnt(15) lgkmcnt(0)
s_barrier
m16 v[112:115],a[192:195],a[76:79],v[112:115]
r128 a[88:91],v246,22528
s_add_u32 m0, s68, 32800
m16 v[144:147],a[192:195],a[80:83],v[144:147]
r128 a[92:95],v246,24576
m16 v[176:179],a[192:195],a[84:87],v[176:179]
r128 v[240:243],v246,26624
m16 v[116:119],a[196:199],a[76:79],v[116:119]
r128 a[64:67],v247,22528
m16 v[148:151],a[196:199],a[80:83],v[148:151]
r128 a[68:71],v247,24576
buffer_load_dwordx4 v244, s[12:15], s60 offen offset:0 lds
m16 v[180:183],a[196:199],a[84:87],v[180:183]
r128 a[72:75],v247,26624
m16 v[120:123],a[200:203],a[76:79],v[120:123]
rtr a[0:1],v248,0
m16 v[152:155],a[200:203],a[80:83],v[152:155]
rtr a[2:3],v248,1024
m16 v[184:187],a[200:203],a[84:87],v[184:187]
rtr a[4:5],v248,8
m16 v[124:127],a[204:207],a[76:79],v[124:127]
rtr a[6:7],v248,1032
buffer_load_dwordx4 v244, s[12:15], s61 offen offset:1024 lds
m16 v[156:159],a[204:207],a[80:83],v[156:159]
m16 v[188:191],a[204:207],a[84:87],v[188:191]
rtr a[8:9],v249,0
m16 v[128:131],a[208:211],a[76:79],v[128:131]
rtr a[10:11],v249,1024
m16 v[160:163],a[208:211],a[80:83],v[160:163]
rtr a[12:13],v249,8
buffer_load_dwordx4 v244, s[12:15], s62 offen offset:2048 lds
m16 v[192:195],a[208:211],a[84:87],v[192:195]
rtr a[14:15],v249,1032
m16 v[132:135],a[212:215],a[76:79],v[132:135]
rtr a[16:17],v248,512
m16 v[164:167],a[212:215],a[80:83],v[164:167]
rtr a[18:19],v248,1536
m16 v[196:199],a[212:215],a[84:87],v[196:199]
rtr a[20:21],v248,520
m16 v[136:139],a[216:219],a[76:79],v[136:139]
rtr a[22:23],v248,1544
buffer_load_dwordx4 v244, s[12:15], s63 offen offset:3072 lds
m16 v[168:171],a[216:219],a[80:83],v[168:171]
rtr a[24:25],v249,512
m16 v[200:203],a[216:219],a[84:87],v[200:203]
m16 v[140:143],a[220:223],a[76:79],v[140:143]
rtr a[26:27],v249,1536
m16 v[172:175],a[220:223],a[80:83],v[172:175]
rtr a[28:29],v249,520
m16 v[204:207],a[220:223],a[84:87],v[204:207]
rtr a[30:31],v249,1544
v_add_u32 v244, 262144, v244
m16 v[16:19],a[224:227],a[76:79],v[16:19]
rtr a[32:33],v248,4096
m16 v[48:51],a[224:227],a[80:83],v[48:51]
rtr a[34:35],v248,5120
m16 v[80:83],a[224:227],a[84:87],v[80:83]
rtr a[36:37],v248,4104
m16 v[20:23],a[228:231],a[76:79],v[20:23]
rtr a[38:39],v248,5128
s_mov_b32 s28, 172032
m16 v[52:55],a[228:231],a[80:83],v[52:55]
rtr a[40:41],v249,4096
m16 v[84:87],a[228:231],a[84:87],v[84:87]
rtr a[42:43],v249,5120
m16 v[24:27],a[232:235],a[76:79],v[24:27]
rtr a[44:45],v249,4104
m16 v[56:59],a[232:235],a[80:83],v[56:59]
m16 v[88:91],a[232:235],a[84:87],v[88:91]
rtr a[46:47],v249,5128
buffer_load_dwordx4 a[152:155], v14, s[16:19], s28 offen offset:0 nt
m16 v[28:31],a[236:239],a[76:79],v[28:31]
rtr a[48:49],v248,4608
m16 v[60:63],a[236:239],a[80:83],v[60:63]
rtr a[50:51],v248,5632
m16 v[92:95],a[236:239],a[84:87],v[92:95]
rtr a[52:53],v248,4616
m16 v[32:35],a[240:243],a[76:79],v[32:35]
rtr a[54:55],v248,5640
buffer_load_dword v255, v250, s[56:59], 0 offen
m16 v[64:67],a[240:243],a[80:83],v[64:67]
rtr a[56:57],v249,4608
m16 v[96:99],a[240:243],a[84:87],v[96:99]
rtr a[58:59],v249,5632
m16 v[36:39],a[244:247],a[76:79],v[36:39]
rtr a[60:61],v249,4616
m16 v[68:71],a[244:247],a[80:83],v[68:71]
rtr a[62:63],v249,5640
m16 v[100:103],a[244:247],a[84:87],v[100:103]
v_add_u32 v250, 640, v250
m16 v[40:43],a[248:251],a[76:79],v[40:43]
m16 v[72:75],a[248:251],a[80:83],v[72:75]
m16 v[104:107],a[248:251],a[84:87],v[104:107]
m16 v[44:47],a[252:255],a[76:79],v[44:47]
m16 v[76:79],a[252:255],a[80:83],v[76:79]
m16 v[108:111],a[252:255],a[84:87],v[108:111]
s_waitcnt vmcnt(15) lgkmcnt(0)
s_barrier
m16 v[112:115],a[0:3],a[88:91],v[112:115]
rtr a[192:193],v248,16400
s_add_u32 m0, s68, 0
m16 v[144:147],a[0:3],a[92:95],v[144:147]
rtr a[194:195],v248,17424
m16 v[176:179],a[0:3],v[240:243],v[176:179]
rtr a[196:197],v248,16408
buffer_load_dwordx4 v244, s[12:15], s60 offen offset:0 lds
m16 v[116:119],a[4:7],a[88:91],v[116:119]
rtr a[198:199],v248,17432
m16 v[148:151],a[4:7],a[92:95],v[148:151]
buffer_load_dwordx4 v244, s[12:15], s61 offen offset:1024 lds
m16 v[180:183],a[4:7],v[240:243],v[180:183]
rtr a[200:201],v249,16400
m16 v[120:123],a[8:11],a[88:91],v[120:123]
rtr a[202:203],v249,17424
buffer_load_dwordx4 v244, s[12:15], s62 offen offset:2048 lds
m16 v[152:155],a[8:11],a[92:95],v[152:155]
rtr a[204:205],v249,16408
m16 v[184:187],a[8:11],v[240:243],v[184:187]
buffer_load_dwordx4 v244, s[12:15], s63 offen offset:3072 lds
m16 v[124:127],a[12:15],a[88:91],v[124:127]
rtr a[206:207],v249,17432
m16 v[156:159],a[12:15],a[92:95],v[156:159]
rtr a[208:209],v248,16912
v_add_u32 v244, 262144, v244
m16 v[188:191],a[12:15],v[240:243],v[188:191]
rtr a[210:211],v248,17936
m16 v[128:131],a[16:19],a[88:91],v[128:131]
s_add_u32 m0, s69, 22528
m16 v[160:163],a[16:19],a[92:95],v[160:163]
rtr a[212:213],v248,16920
m16 v[192:195],a[16:19],v[240:243],v[192:195]
rtr a[214:215],v248,17944
buffer_load_dwordx4 v245, s[8:11], s64 offen offset:0 lds
m16 v[132:135],a[20:23],a[88:91],v[132:135]
rtr a[216:217],v249,16912
m16 v[164:167],a[20:23],a[92:95],v[164:167]
buffer_load_dwordx4 v251, s[8:11], s64 offen offset:1024 lds
m16 v[196:199],a[20:23],v[240:243],v[196:199]
rtr a[218:219],v249,17936
m16 v[136:139],a[24:27],a[88:91],v[136:139]
rtr a[220:221],v249,16920
buffer_load_dwordx4 v245, s[8:11], s65 offen offset:2048 lds
m16 v[168:171],a[24:27],a[92:95],v[168:171]
rtr a[222:223],v249,17944
m16 v[200:203],a[24:27],v[240:243],v[200:203]
buffer_load_dwordx4 v251, s[8:11], s65 offen offset:3072 lds
m16 v[140:143],a[28:31],a[88:91],v[140:143]
rtr a[224:225],v248,20496
m16 v[172:175],a[28:31],a[92:95],v[172:175]
rtr a[226:227],v248,21520
m16 v[204:207],a[28:31],v[240:243],v[204:207]
rtr a[228:229],v248,20504
s_add_u32 m0, s69, 26624
m16 v[16:19],a[32:35],a[88:91],v[16:19]
rtr a[230:231],v248,21528
m16 v[48:51],a[32:35],a[92:95],v[48:51]
buffer_load_dwordx4 v245, s[8:11], s66 offen offset:0 lds
m16 v[80:83],a[32:35],v[240:243],v[80:83]
rtr a[232:233],v249,20496
m16 v[20:23],a[36:39],a[88:91],v[20:23]
rtr a[234:235],v249,21520
buffer_load_dwordx4 v251, s[8:11], s66 offen offset:1024 lds
m16 v[52:55],a[36:39],a[92:95],v[52:55]
rtr a[236:237],v249,20504
m16 v[84:87],a[36:39],v[240:243],v[84:87]
v_add_u32 v245, 128, v245
m16 v[24:27],a[40:43],a[88:91],v[24:27]
rtr a[238:239],v249,21528
m16 v[56:59],a[40:43],a[92:95],v[56:59]
rtr a[240:241],v248,21008
v_add_u32 v251, 128, v251
m16 v[88:91],a[40:43],v[240:243],v[88:91]
rtr a[242:243],v248,22032
m16 v[28:31],a[44:47],a[88:91],v[28:31]
s_mov_b32 s28, 172032
m16 v[60:63],a[44:47],a[92:95],v[60:63]
rtr a[244:245],v248,21016
m16 v[92:95],a[44:47],v[240:243],v[92:95]
rtr a[246:247],v248,22040
buffer_load_dwordx4 a[156:159], v14, s[16:19], s28 offen offset:256 nt
m16 v[32:35],a[48:51],a[88:91],v[32:35]
rtr a[248:249],v249,21008
m16 v[64:67],a[48:51],a[92:95],v[64:67]
s_mov_b32 s28, 180224
m16 v[96:99],a[48:51],v[240:243],v[96:99]
rtr a[250:251],v249,22032
m16 v[36:39],a[52:55],a[88:91],v[36:39]
rtr a[252:253],v249,21016
buffer_load_dwordx4 a[160:163], v14, s[20:23], s28 offen offset:0 nt
m16 v[68:71],a[52:55],a[92:95],v[68:71]
rtr a[254:255],v249,22040
m16 v[100:103],a[52:55],v[240:243],v[100:103]
buffer_load_dword v255, v250, s[56:59], 0 offen
m16 v[40:43],a[56:59],a[88:91],v[40:43]
m16 v[72:75],a[56:59],a[92:95],v[72:75]
v_add_u32 v250, 640, v250
m16 v[104:107],a[56:59],v[240:243],v[104:107]
m16 v[44:47],a[60:63],a[88:91],v[44:47]
m16 v[76:79],a[60:63],a[92:95],v[76:79]
m16 v[108:111],a[60:63],v[240:243],v[108:111]
s_waitcnt vmcnt(15) lgkmcnt(0)
s_barrier
m16 v[112:115],a[192:195],a[64:67],v[112:115]
r128 a[76:79],v246,0
s_add_u32 m0, s68, 16400
m16 v[144:147],a[192:195],a[68:71],v[144:147]
r128 a[80:83],v246,2048
m16 v[176:179],a[192:195],a[72:75],v[176:179]
r128 a[84:87],v246,4096
m16 v[116:119],a[196:199],a[64:67],v[116:119]
r128 a[88:91],v247,0
m16 v[148:151],a[196:199],a[68:71],v[148:151]
r128 a[92:95],v247,2048
buffer_load_dwordx4 v244, s[12:15], s60 offen offset:0 lds
m16 v[180:183],a[196:199],a[72:75],v[180:183]
r128 v[240:243],v247,4096
m16 v[120:123],a[200:203],a[64:67],v[120:123]
rtr a[0:1],v248,32800
m16 v[152:155],a[200:203],a[68:71],v[152:155]
rtr a[2:3],v248,33824
m16 v[184:187],a[200:203],a[72:75],v[184:187]
rtr a[4:5],v248,32808
m16 v[124:127],a[204:207],a[64:67],v[124:127]
rtr a[6:7],v248,33832
buffer_load_dwordx4 v244, s[12:15], s61 offen offset:1024 lds
m16 v[156:159],a[204:207],a[68:71],v[156:159]
m16 v[188:191],a[204:207],a[72:75],v[188:191]
rtr a[8:9],v249,32800
m16 v[128:131],a[208:211],a[64:67],v[128:131]
rtr a[10:11],v249,33824
m16 v[160:163],a[208:211],a[68:71],v[160:163]
rtr a[12:13],v249,32808
buffer_load_dwordx4 v244, s[12:15], s62 offen offset:2048 lds
m16 v[192:195],a[208:211],a[72:75],v[192:195]
rtr a[14:15],v249,33832
m16 v[132:135],a[212:215],a[64:67],v[132:135]
rtr a[16:17],v248,33312
m16 v[164:167],a[212:215],a[68:71],v[164:167]
rtr a[18:19],v248,34336
m16 v[196:199],a[212:215],a[72:75],v[196:199]
rtr a[20:21],v248,33320
m16 v[136:139],a[216:219],a[64:67],v[136:139]
rtr a[22:23],v248,34344
buffer_load_dwordx4 v244, s[12:15], s63 offen offset:3072 lds
m16 v[168:171],a[216:219],a[68:71],v[168:171]
rtr a[24:25],v249,33312
m16 v[200:203],a[216:219],a[72:75],v[200:203]
m16 v[140:143],a[220:223],a[64:67],v[140:143]
rtr a[26:27],v249,34336
m16 v[172:175],a[220:223],a[68:71],v[172:175]
rtr a[28:29],v249,33320
m16 v[204:207],a[220:223],a[72:75],v[204:207]
rtr a[30:31],v249,34344
v_add_u32 v244, 262144, v244
m16 v[16:19],a[224:227],a[64:67],v[16:19]
rtr a[32:33],v248,36896
m16 v[48:51],a[224:227],a[68:71],v[48:51]
rtr a[34:35],v248,37920
m16 v[80:83],a[224:227],a[72:75],v[80:83]
rtr a[36:37],v248,36904
m16 v[20:23],a[228:231],a[64:67],v[20:23]
rtr a[38:39],v248,37928
s_mov_b32 s28, 180224
m16 v[52:55],a[228:231],a[68:71],v[52:55]
rtr a[40:41],v249,36896
m16 v[84:87],a[228:231],a[72:75],v[84:87]
rtr a[42:43],v249,37920
m16 v[24:27],a[232:235],a[64:67],v[24:27]
rtr a[44:45],v249,36904
m16 v[56:59],a[232:235],a[68:71],v[56:59]
m16 v[88:91],a[232:235],a[72:75],v[88:91]
rtr a[46:47],v249,37928
buffer_load_dwordx4 a[164:167], v14, s[20:23], s28 offen offset:256 nt
m16 v[28:31],a[236:239],a[64:67],v[28:31]
rtr a[48:49],v248,37408
m16 v[60:63],a[236:239],a[68:71],v[60:63]
rtr a[50:51],v248,38432
m16 v[92:95],a[236:239],a[72:75],v[92:95]
rtr a[52:53],v248,37416
m16 v[32:35],a[240:243],a[64:67],v[32:35]
rtr a[54:55],v248,38440
buffer_load_dword v255, v250, s[56:59], 0 offen
m16 v[64:67],a[240:243],a[68:71],v[64:67]
rtr a[56:57],v249,37408
m16 v[96:99],a[240:243],a[72:75],v[96:99]
rtr a[58:59],v249,38432
m16 v[36:39],a[244:247],a[64:67],v[36:39]
rtr a[60:61],v249,37416
m16 v[68:71],a[244:247],a[68:71],v[68:71]
rtr a[62:63],v249,38440
m16 v[100:103],a[244:247],a[72:75],v[100:103]
v_add_u32 v250, 640, v250
m16 v[40:43],a[248:251],a[64:67],v[40:43]
m16 v[72:75],a[248:251],a[68:71],v[72:75]
m16 v[104:107],a[248:251],a[72:75],v[104:107]
m16 v[44:47],a[252:255],a[64:67],v[44:47]
m16 v[76:79],a[252:255],a[68:71],v[76:79]
m16 v[108:111],a[252:255],a[72:75],v[108:111]
s_waitcnt vmcnt(15) lgkmcnt(0)
s_barrier
m16 v[112:115],a[0:3],a[76:79],v[112:115]
rtr a[192:193],v248,0
s_add_u32 m0, s68, 32800
m16 v[144:147],a[0:3],a[80:83],v[144:147]
rtr a[194:195],v248,1024
m16 v[176:179],a[0:3],a[84:87],v[176:179]
rtr a[196:197],v248,8
ds_write_b128 v253, v[208:211] offset:0
m16 v[116:119],a[4:7],a[76:79],v[116:119]
rtr a[198:199],v248,1032
buffer_load_dwordx4 v244, s[12:15], s60 offen offset:0 lds
m16 v[148:151],a[4:7],a[80:83],v[148:151]
m16 v[180:183],a[4:7],a[84:87],v[180:183]
rtr a[200:201],v249,0
m16 v[120:123],a[8:11],a[76:79],v[120:123]
rtr a[202:203],v249,1024
buffer_load_dwordx4 v244, s[12:15], s61 offen offset:1024 lds
m16 v[152:155],a[8:11],a[80:83],v[152:155]
rtr a[204:205],v249,8
m16 v[184:187],a[8:11],a[84:87],v[184:187]
m16 v[124:127],a[12:15],a[76:79],v[124:127]
rtr a[206:207],v249,1032
buffer_load_dwordx4 v244, s[12:15], s62 offen offset:2048 lds
m16 v[156:159],a[12:15],a[80:83],v[156:159]
rtr a[208:209],v248,512
m16 v[188:191],a[12:15],a[84:87],v[188:191]
rtr a[210:211],v248,1536
m16 v[128:131],a[16:19],a[76:79],v[128:131]
ds_write_b128 v253, v[212:215] offset:1056
m16 v[160:163],a[16:19],a[80:83],v[160:163]
rtr a[212:213],v248,520
buffer_load_dwordx4 v244, s[12:15], s63 offen offset:3072 lds
m16 v[192:195],a[16:19],a[84:87],v[192:195]
rtr a[214:215],v248,1544
m16 v[132:135],a[20:23],a[76:79],v[132:135]
rtr a[216:217],v249,512
m16 v[164:167],a[20:23],a[80:83],v[164:167]
v_add_u32 v244, 262144, v244
m16 v[196:199],a[20:23],a[84:87],v[196:199]
rtr a[218:219],v249,1536
m16 v[136:139],a[24:27],a[76:79],v[136:139]
rtr a[220:221],v249,520
m16 v[168:171],a[24:27],a[80:83],v[168:171]
rtr a[222:223],v249,1544
s_mov_b32 s28, 188416
m16 v[200:203],a[24:27],a[84:87],v[200:203]
m16 v[140:143],a[28:31],a[76:79],v[140:143]
rtr a[224:225],v248,4096
m16 v[172:175],a[28:31],a[80:83],v[172:175]
rtr a[226:227],v248,5120
ds_write_b128 v253, v[216:219] offset:8448
m16 v[204:207],a[28:31],a[84:87],v[204:207]
rtr a[228:229],v248,4104
buffer_load_dwordx4 a[168:171], v14, s[20:23], s28 offen offset:0 nt
m16 v[16:19],a[32:35],a[76:79],v[16:19]
rtr a[230:231],v248,5128
m16 v[48:51],a[32:35],a[80:83],v[48:51]
m16 v[80:83],a[32:35],a[84:87],v[80:83]
rtr a[232:233],v249,4096
s_mov_b32 s28, 188416
m16 v[20:23],a[36:39],a[76:79],v[20:23]
rtr a[234:235],v249,5120
m16 v[52:55],a[36:39],a[80:83],v[52:55]
rtr a[236:237],v249,4104
m16 v[84:87],a[36:39],a[84:87],v[84:87]
buffer_load_dwordx4 a[172:175], v14, s[20:23], s28 offen offset:256 nt
m16 v[24:27],a[40:43],a[76:79],v[24:27]
rtr a[238:239],v249,5128
m16 v[56:59],a[40:43],a[80:83],v[56:59]
rtr a[240:241],v248,4608
m16 v[88:91],a[40:43],a[84:87],v[88:91]
rtr a[242:243],v248,5632
buffer_load_dword v255, v250, s[56:59], 0 offen
m16 v[28:31],a[44:47],a[76:79],v[28:31]
ds_write_b128 v253, v[220:223] offset:9504
m16 v[60:63],a[44:47],a[80:83],v[60:63]
rtr a[244:245],v248,4616
m16 v[92:95],a[44:47],a[84:87],v[92:95]
rtr a[246:247],v248,5640
m16 v[32:35],a[48:51],a[76:79],v[32:35]
rtr a[248:249],v249,4608
v_add_u32 v250, 640, v250
m16 v[64:67],a[48:51],a[80:83],v[64:67]
m16 v[96:99],a[48:51],a[84:87],v[96:99]
rtr a[250:251],v249,5632
m16 v[36:39],a[52:55],a[76:79],v[36:39]
rtr a[252:253],v249,4616
buffer_load_dword v255, v250, s[56:59], 0 offen
m16 v[68:71],a[52:55],a[80:83],v[68:71]
rtr a[254:255],v249,5640
m16 v[100:103],a[52:55],a[84:87],v[100:103]
m16 v[40:43],a[56:59],a[76:79],v[40:43]
v_add_u32 v250, 640, v250
m16 v[72:75],a[56:59],a[80:83],v[72:75]
m16 v[104:107],a[56:59],a[84:87],v[104:107]
m16 v[44:47],a[60:63],a[76:79],v[44:47]
m16 v[76:79],a[60:63],a[80:83],v[76:79]
m16 v[108:111],a[60:63],a[84:87],v[108:111]
s_waitcnt vmcnt(10) lgkmcnt(0)
s_barrier
m16 v[112:115],a[192:195],a[88:91],v[112:115]
r128 a[64:67],v246,22528
s_mov_b32 s28, 212992
m16 v[144:147],a[192:195],a[92:95],v[144:147]
r128 a[68:71],v246,24576
m16 v[176:179],a[192:195],v[240:243],v[176:179]
r128 a[72:75],v246,26624
m16 v[116:119],a[196:199],a[88:91],v[116:119]
r128 a[76:79],v247,22528
m16 v[148:151],a[196:199],a[92:95],v[148:151]
r128 a[80:83],v247,24576
m16 v[180:183],a[196:199],v[240:243],v[180:183]
r128 a[84:87],v247,26624
m16 v[120:123],a[200:203],a[88:91],v[120:123]
rtr a[0:1],v248,16400
m16 v[152:155],a[200:203],a[92:95],v[152:155]
rtr a[2:3],v248,17424
buffer_load_dwordx4 a[176:179], v14, s[16:19], s28 offen offset:0 nt
m16 v[184:187],a[200:203],v[240:243],v[184:187]
rtr a[4:5],v248,16408
m16 v[124:127],a[204:207],a[88:91],v[124:127]
rtr a[6:7],v248,17432
m16 v[156:159],a[204:207],a[92:95],v[156:159]
m16 v[188:191],a[204:207],v[240:243],v[188:191]
rtr a[8:9],v249,16400
m16 v[128:131],a[208:211],a[88:91],v[128:131]
rtr a[10:11],v249,17424
m16 v[160:163],a[208:211],a[92:95],v[160:163]
rtr a[12:13],v249,16408
m16 v[192:195],a[208:211],v[240:243],v[192:195]
rtr a[14:15],v249,17432
m16 v[132:135],a[212:215],a[88:91],v[132:135]
rtr a[16:17],v248,16912
buffer_load_dword v255, v250, s[56:59], 0 offen
m16 v[164:167],a[212:215],a[92:95],v[164:167]
rtr a[18:19],v248,17936
m16 v[196:199],a[212:215],v[240:243],v[196:199]
rtr a[20:21],v248,16920
m16 v[136:139],a[216:219],a[88:91],v[136:139]
rtr a[22:23],v248,17944
m16 v[168:171],a[216:219],a[92:95],v[168:171]
rtr a[24:25],v249,16912
m16 v[200:203],a[216:219],v[240:243],v[200:203]
m16 v[140:143],a[220:223],a[88:91],v[140:143]
rtr a[26:27],v249,17936
m16 v[172:175],a[220:223],a[92:95],v[172:175]
rtr a[28:29],v249,16920
m16 v[204:207],a[220:223],v[240:243],v[204:207]
rtr a[30:31],v249,17944
v_add_u32 v250, 640, v250
m16 v[16:19],a[224:227],a[88:91],v[16:19]
rtr a[32:33],v248,20496
m16 v[48:51],a[224:227],a[92:95],v[48:51]
rtr a[34:35],v248,21520
m16 v[80:83],a[224:227],v[240:243],v[80:83]
rtr a[36:37],v248,20504
m16 v[20:23],a[228:231],a[88:91],v[20:23]
rtr a[38:39],v248,21528
m16 v[52:55],a[228:231],a[92:95],v[52:55]
rtr a[40:41],v249,20496
m16 v[84:87],a[228:231],v[240:243],v[84:87]
rtr a[42:43],v249,21520
m16 v[24:27],a[232:235],a[88:91],v[24:27]
rtr a[44:45],v249,20504
buffer_load_dword v255, v250, s[56:59], 0 offen
m16 v[56:59],a[232:235],a[92:95],v[56:59]
m16 v[88:91],a[232:235],v[240:243],v[88:91]
rtr a[46:47],v249,21528
m16 v[28:31],a[236:239],a[88:91],v[28:31]
rtr a[48:49],v248,21008
m16 v[60:63],a[236:239],a[92:95],v[60:63]
rtr a[50:51],v248,22032
m16 v[92:95],a[236:239],v[240:243],v[92:95]
rtr a[52:53],v248,21016
m16 v[32:35],a[240:243],a[88:91],v[32:35]
rtr a[54:55],v248,22040
m16 v[64:67],a[240:243],a[92:95],v[64:67]
rtr a[56:57],v249,21008
m16 v[96:99],a[240:243],v[240:243],v[96:99]
rtr a[58:59],v249,22032
v_add_u32 v250, 640, v250
m16 v[36:39],a[244:247],a[88:91],v[36:39]
rtr a[60:61],v249,21016
m16 v[68:71],a[244:247],a[92:95],v[68:71]
rtr a[62:63],v249,22040
m16 v[100:103],a[244:247],v[240:243],v[100:103]
m16 v[40:43],a[248:251],a[88:91],v[40:43]
m16 v[72:75],a[248:251],a[92:95],v[72:75]
m16 v[104:107],a[248:251],v[240:243],v[104:107]
m16 v[44:47],a[252:255],a[88:91],v[44:47]
m16 v[76:79],a[252:255],a[92:95],v[76:79]
m16 v[108:111],a[252:255],v[240:243],v[108:111]
s_waitcnt vmcnt(7) lgkmcnt(0)
s_barrier
m16 v[112:115],a[0:3],a[64:67],v[112:115]
rtr a[192:193],v248,32800
s_mov_b32 s28, 212992
m16 v[144:147],a[0:3],a[68:71],v[144:147]
rtr a[194:195],v248,33824
m16 v[176:179],a[0:3],a[72:75],v[176:179]
rtr a[196:197],v248,32808
buffer_load_dwordx4 a[180:183], v14, s[16:19], s28 offen offset:256 nt
m16 v[116:119],a[4:7],a[64:67],v[116:119]
ds_write_b128 v253, v[224:227] offset:16896
rtr a[198:199],v248,33832
m16 v[148:151],a[4:7],a[68:71],v[148:151]
s_mov_b32 s28, 221184
m16 v[180:183],a[4:7],a[72:75],v[180:183]
rtr a[200:201],v249,32800
m16 v[120:123],a[8:11],a[64:67],v[120:123]
rtr a[202:203],v249,33824
buffer_load_dwordx4 a[184:187], v14, s[16:19], s28 offen offset:0 nt
m16 v[152:155],a[8:11],a[68:71],v[152:155]
rtr a[204:205],v249,32808
m16 v[184:187],a[8:11],a[72:75],v[184:187]
m16 v[124:127],a[12:15],a[64:67],v[124:127]
rtr a[206:207],v249,33832
s_add_u32 m0, s100, 101376
m16 v[156:159],a[12:15],a[68:71],v[156:159]
rtr a[208:209],v248,33312
m16 v[188:191],a[12:15],a[72:75],v[188:191]
rtr a[210:211],v248,34336
s_mov_b32 s28, 49152
m16 v[128:131],a[16:19],a[64:67],v[128:131]
ds_write_b128 v253, v[228:231] offset:17952
m16 v[160:163],a[16:19],a[68:71],v[160:163]
rtr a[212:213],v248,33320
buffer_load_dwordx4 v14, s[16:19], s28 offen offset:0 nt lds
m16 v[192:195],a[16:19],a[72:75],v[192:195]
rtr a[214:215],v248,34344
m16 v[132:135],a[20:23],a[64:67],v[132:135]
rtr a[216:217],v249,33312
m16 v[164:167],a[20:23],a[68:71],v[164:167]
s_add_u32 m0, s100, 102176
m16 v[196:199],a[20:23],a[72:75],v[196:199]
rtr a[218:219],v249,34336
m16 v[136:139],a[24:27],a[64:67],v[136:139]
rtr a[220:221],v249,33320
s_mov_b32 s28, 49152
m16 v[168:171],a[24:27],a[68:71],v[168:171]
rtr a[222:223],v249,34344
m16 v[200:203],a[24:27],a[72:75],v[200:203]
buffer_load_dwordx4 v14, s[16:19], s28 offen offset:256 nt lds
m16 v[140:143],a[28:31],a[64:67],v[140:143]
rtr a[224:225],v248,36896
m16 v[172:175],a[28:31],a[68:71],v[172:175]
rtr a[226:227],v248,37920
ds_write_b128 v253, v[232:235] offset:25344
m16 v[204:207],a[28:31],a[72:75],v[204:207]
rtr a[228:229],v248,36904
s_add_u32 m0, s100, 109824
m16 v[16:19],a[32:35],a[64:67],v[16:19]
rtr a[230:231],v248,37928
m16 v[48:51],a[32:35],a[68:71],v[48:51]
s_mov_b32 s28, 57344
m16 v[80:83],a[32:35],a[72:75],v[80:83]
rtr a[232:233],v249,36896
m16 v[20:23],a[36:39],a[64:67],v[20:23]
rtr a[234:235],v249,37920
buffer_load_dwordx4 v14, s[16:19], s28 offen offset:0 nt lds
m16 v[52:55],a[36:39],a[68:71],v[52:55]
rtr a[236:237],v249,36904
m16 v[84:87],a[36:39],a[72:75],v[84:87]
s_add_u32 m0, s100, 110624
m16 v[24:27],a[40:43],a[64:67],v[24:27]
rtr a[238:239],v249,37928
m16 v[56:59],a[40:43],a[68:71],v[56:59]
rtr a[240:241],v248,37408
m16 v[88:91],a[40:43],a[72:75],v[88:91]
rtr a[242:243],v248,38432
s_mov_b32 s28, 57344
m16 v[28:31],a[44:47],a[64:67],v[28:31]
ds_write_b128 v253, v[236:239] offset:26400
m16 v[60:63],a[44:47],a[68:71],v[60:63]
rtr a[244:245],v248,37416
buffer_load_dwordx4 v14, s[16:19], s28 offen offset:256 nt lds
m16 v[92:95],a[44:47],a[72:75],v[92:95]
rtr a[246:247],v248,38440
m16 v[32:35],a[48:51],a[64:67],v[32:35]
rtr a[248:249],v249,37408
buffer_load_dword v255, v250, s[56:59], 0 offen
m16 v[64:67],a[48:51],a[68:71],v[64:67]
m16 v[96:99],a[48:51],a[72:75],v[96:99]
rtr a[250:251],v249,38432
m16 v[36:39],a[52:55],a[64:67],v[36:39]
rtr a[252:253],v249,37416
v_add_u32 v250, 640, v250
m16 v[68:71],a[52:55],a[68:71],v[68:71]
rtr a[254:255],v249,38440
m16 v[100:103],a[52:55],a[72:75],v[100:103]
buffer_load_dword v255, v250, s[56:59], 0 offen
m16 v[40:43],a[56:59],a[64:67],v[40:43]
m16 v[72:75],a[56:59],a[68:71],v[72:75]
v_add_u32 v250, 640, v250
m16 v[104:107],a[56:59],a[72:75],v[104:107]
m16 v[44:47],a[60:63],a[64:67],v[44:47]
m16 v[76:79],a[60:63],a[68:71],v[76:79]
m16 v[108:111],a[60:63],a[72:75],v[108:111]
s_waitcnt lgkmcnt(0)
s_barrier
m16 v[112:115],a[192:195],a[76:79],v[112:115]
s_mov_b32 s28, 221184
m16 v[144:147],a[192:195],a[80:83],v[144:147]
m16 v[176:179],a[192:195],a[84:87],v[176:179]
buffer_load_dwordx4 a[188:191], v14, s[16:19], s28 offen offset:256 nt
m16 v[116:119],a[196:199],a[76:79],v[116:119]
m16 v[148:151],a[196:199],a[80:83],v[148:151]
m16 v[180:183],a[196:199],a[84:87],v[180:183]
s_add_u32 m0, s100, 118272
m16 v[120:123],a[200:203],a[76:79],v[120:123]
m16 v[152:155],a[200:203],a[80:83],v[152:155]
s_mov_b32 s28, 49152
m16 v[184:187],a[200:203],a[84:87],v[184:187]
m16 v[124:127],a[204:207],a[76:79],v[124:127]
v_mul_f32 v112, s40, v112
v_mul_f32 v113, s40, v113
v_mul_f32 v114, s40, v114
m16 v[156:159],a[204:207],a[80:83],v[156:159]
buffer_load_dwordx4 v14, s[20:23], s28 offen offset:0 nt lds
v_mul_f32 v115, s40, v115
v_mul_f32 v116, s40, v116
m16 v[188:191],a[204:207],a[84:87],v[188:191]
v_mul_f32 v117, s40, v117
v_mul_f32 v118, s40, v118
v_mul_f32 v119, s40, v119
m16 v[128:131],a[208:211],a[76:79],v[128:131]
s_add_u32 m0, s100, 119072
cvt v112,v112,v113
cvt v113,v114,v115
m16 v[160:163],a[208:211],a[80:83],v[160:163]
cvt v114,v116,v117
cvt v115,v118,v119
v_accvgpr_write_b32 a0, v112
m16 v[192:195],a[208:211],a[84:87],v[192:195]
v_accvgpr_write_b32 a1, v113
v_accvgpr_write_b32 a2, v114
v_accvgpr_write_b32 a3, v115
m16 v[132:135],a[212:215],a[76:79],v[132:135]
s_mov_b32 s28, 49152
v_mul_f32 v144, s40, v144
v_mul_f32 v145, s40, v145
m16 v[164:167],a[212:215],a[80:83],v[164:167]
v_mul_f32 v146, s40, v146
v_mul_f32 v147, s40, v147
v_mul_f32 v148, s40, v148
m16 v[196:199],a[212:215],a[84:87],v[196:199]
buffer_load_dwordx4 v14, s[20:23], s28 offen offset:256 nt lds
v_mul_f32 v149, s40, v149
v_mul_f32 v150, s40, v150
m16 v[136:139],a[216:219],a[76:79],v[136:139]
v_mul_f32 v151, s40, v151
cvt v144,v144,v145
cvt v145,v146,v147
m16 v[168:171],a[216:219],a[80:83],v[168:171]
cvt v146,v148,v149
cvt v147,v150,v151
v_accvgpr_write_b32 a16, v144
m16 v[200:203],a[216:219],a[84:87],v[200:203]
s_add_u32 m0, s100, 126720
v_accvgpr_write_b32 a17, v145
v_accvgpr_write_b32 a18, v146
m16 v[140:143],a[220:223],a[76:79],v[140:143]
v_accvgpr_write_b32 a19, v147
v_mul_f32 v176, s40, v176
v_mul_f32 v177, s40, v177
m16 v[172:175],a[220:223],a[80:83],v[172:175]
v_mul_f32 v178, s40, v178
v_mul_f32 v179, s40, v179
v_mul_f32 v180, s40, v180
m16 v[204:207],a[220:223],a[84:87],v[204:207]
s_mov_b32 s28, 57344
v_mul_f32 v181, s40, v181
v_mul_f32 v182, s40, v182
m16 v[16:19],a[224:227],a[76:79],v[16:19]
v_mul_f32 v183, s40, v183
cvt v176,v176,v177
cvt v177,v178,v179
m16 v[48:51],a[224:227],a[80:83],v[48:51]
buffer_load_dwordx4 v14, s[20:23], s28 offen offset:0 nt lds
cvt v178,v180,v181
cvt v179,v182,v183
m16 v[80:83],a[224:227],a[84:87],v[80:83]
v_accvgpr_write_b32 a32, v176
v_accvgpr_write_b32 a33, v177
v_accvgpr_write_b32 a34, v178
m16 v[20:23],a[228:231],a[76:79],v[20:23]
v_accvgpr_write_b32 a35, v179
v_mul_f32 v120, s40, v120
v_mul_f32 v121, s40, v121
m16 v[52:55],a[228:231],a[80:83],v[52:55]
s_add_u32 m0, s100, 127520
v_mul_f32 v122, s40, v122
v_mul_f32 v123, s40, v123
m16 v[84:87],a[228:231],a[84:87],v[84:87]
v_mul_f32 v124, s40, v124
v_mul_f32 v125, s40, v125
v_mul_f32 v126, s40, v126
m16 v[24:27],a[232:235],a[76:79],v[24:27]
s_mov_b32 s28, 57344
v_mul_f32 v127, s40, v127
cvt v120,v120,v121
m16 v[56:59],a[232:235],a[80:83],v[56:59]
cvt v121,v122,v123
cvt v122,v124,v125
cvt v123,v126,v127
m16 v[88:91],a[232:235],a[84:87],v[88:91]
v_accvgpr_write_b32 a4, v120
v_accvgpr_write_b32 a5, v121
v_accvgpr_write_b32 a6, v122
m16 v[28:31],a[236:239],a[76:79],v[28:31]
buffer_load_dwordx4 v14, s[20:23], s28 offen offset:256 nt lds
v_accvgpr_write_b32 a7, v123
v_mul_f32 v152, s40, v152
m16 v[60:63],a[236:239],a[80:83],v[60:63]
v_mul_f32 v153, s40, v153
v_mul_f32 v154, s40, v154
v_mul_f32 v155, s40, v155
m16 v[92:95],a[236:239],a[84:87],v[92:95]
buffer_load_dword v255, v250, s[56:59], 0 offen
v_mul_f32 v156, s40, v156
v_mul_f32 v157, s40, v157
m16 v[32:35],a[240:243],a[76:79],v[32:35]
v_mul_f32 v158, s40, v158
v_mul_f32 v159, s40, v159
cvt v152,v152,v153
m16 v[64:67],a[240:243],a[80:83],v[64:67]
cvt v153,v154,v155
cvt v154,v156,v157
cvt v155,v158,v159
m16 v[96:99],a[240:243],a[84:87],v[96:99]
v_add_u32 v250, 640, v250
v_accvgpr_write_b32 a20, v152
v_accvgpr_write_b32 a21, v153
m16 v[36:39],a[244:247],a[76:79],v[36:39]
v_accvgpr_write_b32 a22, v154
v_accvgpr_write_b32 a23, v155
v_mul_f32 v184, s40, v184
m16 v[68:71],a[244:247],a[80:83],v[68:71]
buffer_load_dword v255, v250, s[56:59], 0 offen
v_mul_f32 v185, s40, v185
v_mul_f32 v186, s40, v186
m16 v[100:103],a[244:247],a[84:87],v[100:103]
v_mul_f32 v187, s40, v187
v_mul_f32 v188, s40, v188
v_mul_f32 v189, s40, v189
m16 v[40:43],a[248:251],a[76:79],v[40:43]
v_mul_f32 v190, s40, v190
v_mul_f32 v191, s40, v191
cvt v184,v184,v185
m16 v[72:75],a[248:251],a[80:83],v[72:75]
v_add_u32 v250, 640, v250
cvt v185,v186,v187
cvt v186,v188,v189
m16 v[104:107],a[248:251],a[84:87],v[104:107]
cvt v187,v190,v191
v_accvgpr_write_b32 a36, v184
v_accvgpr_write_b32 a37, v185
m16 v[44:47],a[252:255],a[76:79],v[44:47]
v_accvgpr_write_b32 a38, v186
v_accvgpr_write_b32 a39, v187
r128 a[192:195],v3,0
m16 v[76:79],a[252:255],a[80:83],v[76:79]
r128 a[196:199],v3,512
r128 a[200:203],v3,64
r128 a[204:207],v3,576
m16 v[108:111],a[252:255],a[84:87],v[108:111]
r128 a[208:211],v3,128
r128 a[212:215],v3,640
r128 a[216:219],v3,192
r128 a[220:223],v3,704
v_pk_mul_f32 v[128:129], v[128:129], s[40:41]
v_pk_mul_f32 v[130:131], v[130:131], s[40:41]
v_pk_mul_f32 v[132:133], v[132:133], s[40:41]
v_pk_mul_f32 v[134:135], v[134:135], s[40:41]
cvt v128,v128,v129
cvt v129,v130,v131
cvt v130,v132,v133
cvt v131,v134,v135
v_accvgpr_write_b32 a8, v128
v_accvgpr_write_b32 a9, v129
v_accvgpr_write_b32 a10, v130
v_accvgpr_write_b32 a11, v131
v_pk_mul_f32 v[160:161], v[160:161], s[40:41]
v_pk_mul_f32 v[162:163], v[162:163], s[40:41]
v_pk_mul_f32 v[164:165], v[164:165], s[40:41]
v_pk_mul_f32 v[166:167], v[166:167], s[40:41]
cvt v160,v160,v161
cvt v161,v162,v163
cvt v162,v164,v165
cvt v163,v166,v167
v_accvgpr_write_b32 a24, v160
v_accvgpr_write_b32 a25, v161
v_accvgpr_write_b32 a26, v162
v_accvgpr_write_b32 a27, v163
v_pk_mul_f32 v[192:193], v[192:193], s[40:41]
v_pk_mul_f32 v[194:195], v[194:195], s[40:41]
v_pk_mul_f32 v[196:197], v[196:197], s[40:41]
v_pk_mul_f32 v[198:199], v[198:199], s[40:41]
cvt v192,v192,v193
cvt v193,v194,v195
cvt v194,v196,v197
cvt v195,v198,v199
v_accvgpr_write_b32 a40, v192
v_accvgpr_write_b32 a41, v193
v_accvgpr_write_b32 a42, v194
v_accvgpr_write_b32 a43, v195
v_pk_mul_f32 v[136:137], v[136:137], s[40:41]
v_pk_mul_f32 v[138:139], v[138:139], s[40:41]
v_pk_mul_f32 v[140:141], v[140:141], s[40:41]
v_pk_mul_f32 v[142:143], v[142:143], s[40:41]
cvt v136,v136,v137
cvt v137,v138,v139
cvt v138,v140,v141
cvt v139,v142,v143
v_accvgpr_write_b32 a12, v136
v_accvgpr_write_b32 a13, v137
v_accvgpr_write_b32 a14, v138
v_accvgpr_write_b32 a15, v139
v_pk_mul_f32 v[168:169], v[168:169], s[40:41]
v_pk_mul_f32 v[170:171], v[170:171], s[40:41]
v_pk_mul_f32 v[172:173], v[172:173], s[40:41]
v_pk_mul_f32 v[174:175], v[174:175], s[40:41]
cvt v168,v168,v169
cvt v169,v170,v171
cvt v170,v172,v173
cvt v171,v174,v175
v_accvgpr_write_b32 a28, v168
v_accvgpr_write_b32 a29, v169
v_accvgpr_write_b32 a30, v170
v_accvgpr_write_b32 a31, v171
v_pk_mul_f32 v[200:201], v[200:201], s[40:41]
v_pk_mul_f32 v[202:203], v[202:203], s[40:41]
v_pk_mul_f32 v[204:205], v[204:205], s[40:41]
v_pk_mul_f32 v[206:207], v[206:207], s[40:41]
cvt v200,v200,v201
cvt v201,v202,v203
cvt v202,v204,v205
cvt v203,v206,v207
v_accvgpr_write_b32 a44, v200
v_accvgpr_write_b32 a45, v201
v_accvgpr_write_b32 a46, v202
v_accvgpr_write_b32 a47, v203
s_waitcnt lgkmcnt(0)
m16 v[112:115],a[192:195],a[0:3],0
v_pk_mul_f32 v[16:17], v[16:17], s[40:41]
v_pk_mul_f32 v[18:19], v[18:19], s[40:41]
m16 v[120:123],a[192:195],a[16:19],0
v_pk_mul_f32 v[20:21], v[20:21], s[40:41]
v_pk_mul_f32 v[22:23], v[22:23], s[40:41]
m16 v[128:131],a[192:195],a[32:35],0
cvt v16,v16,v17
cvt v17,v18,v19
m16 v[116:119],a[196:199],a[0:3],0
cvt v18,v20,v21
cvt v19,v22,v23
m16 v[124:127],a[196:199],a[16:19],0
v_accvgpr_write_b32 a48, v16
v_accvgpr_write_b32 a49, v17
m16 v[132:135],a[196:199],a[32:35],0
v_accvgpr_write_b32 a50, v18
v_accvgpr_write_b32 a51, v19
m16 v[112:115],a[200:203],a[4:7],v[112:115]
v_pk_mul_f32 v[48:49], v[48:49], s[40:41]
v_pk_mul_f32 v[50:51], v[50:51], s[40:41]
m16 v[120:123],a[200:203],a[20:23],v[120:123]
v_pk_mul_f32 v[52:53], v[52:53], s[40:41]
v_pk_mul_f32 v[54:55], v[54:55], s[40:41]
m16 v[128:131],a[200:203],a[36:39],v[128:131]
cvt v48,v48,v49
cvt v49,v50,v51
m16 v[116:119],a[204:207],a[4:7],v[116:119]
cvt v50,v52,v53
cvt v51,v54,v55
m16 v[124:127],a[204:207],a[20:23],v[124:127]
v_accvgpr_write_b32 a64, v48
v_accvgpr_write_b32 a65, v49
m16 v[132:135],a[204:207],a[36:39],v[132:135]
v_accvgpr_write_b32 a66, v50
v_accvgpr_write_b32 a67, v51
m16 v[112:115],a[208:211],a[8:11],v[112:115]
v_pk_mul_f32 v[80:81], v[80:81], s[40:41]
v_pk_mul_f32 v[82:83], v[82:83], s[40:41]
m16 v[120:123],a[208:211],a[24:27],v[120:123]
v_pk_mul_f32 v[84:85], v[84:85], s[40:41]
v_pk_mul_f32 v[86:87], v[86:87], s[40:41]
m16 v[128:131],a[208:211],a[40:43],v[128:131]
cvt v80,v80,v81
cvt v81,v82,v83
m16 v[116:119],a[212:215],a[8:11],v[116:119]
cvt v82,v84,v85
cvt v83,v86,v87
m16 v[124:127],a[212:215],a[24:27],v[124:127]
v_accvgpr_write_b32 a80, v80
v_accvgpr_write_b32 a81, v81
m16 v[132:135],a[212:215],a[40:43],v[132:135]
v_accvgpr_write_b32 a82, v82
v_accvgpr_write_b32 a83, v83
m16 v[112:115],a[216:219],a[12:15],v[112:115]
v_pk_mul_f32 v[24:25], v[24:25], s[40:41]
v_pk_mul_f32 v[26:27], v[26:27], s[40:41]
m16 v[120:123],a[216:219],a[28:31],v[120:123]
v_pk_mul_f32 v[28:29], v[28:29], s[40:41]
v_pk_mul_f32 v[30:31], v[30:31], s[40:41]
m16 v[128:131],a[216:219],a[44:47],v[128:131]
cvt v24,v24,v25
cvt v25,v26,v27
m16 v[116:119],a[220:223],a[12:15],v[116:119]
cvt v26,v28,v29
cvt v27,v30,v31
m16 v[124:127],a[220:223],a[28:31],v[124:127]
v_accvgpr_write_b32 a52, v24
v_accvgpr_write_b32 a53, v25
m16 v[132:135],a[220:223],a[44:47],v[132:135]
v_accvgpr_write_b32 a54, v26
v_accvgpr_write_b32 a55, v27
r128 a[192:195],v3,8448
r128 a[196:199],v3,8960
r128 a[200:203],v3,8512
r128 a[204:207],v3,9024
r128 a[208:211],v3,8576
r128 a[212:215],v3,9088
r128 a[216:219],v3,8640
r128 a[220:223],v3,9152
v_pk_mul_f32 v[56:57], v[56:57], s[40:41]
v_pk_mul_f32 v[58:59], v[58:59], s[40:41]
v_pk_mul_f32 v[60:61], v[60:61], s[40:41]
v_pk_mul_f32 v[62:63], v[62:63], s[40:41]
cvt v56,v56,v57
cvt v57,v58,v59
cvt v58,v60,v61
cvt v59,v62,v63
v_accvgpr_write_b32 a68, v56
v_accvgpr_write_b32 a69, v57
v_accvgpr_write_b32 a70, v58
v_accvgpr_write_b32 a71, v59
v_pk_mul_f32 v[88:89], v[88:89], s[40:41]
v_pk_mul_f32 v[90:91], v[90:91], s[40:41]
v_pk_mul_f32 v[92:93], v[92:93], s[40:41]
v_pk_mul_f32 v[94:95], v[94:95], s[40:41]
cvt v88,v88,v89
cvt v89,v90,v91
cvt v90,v92,v93
cvt v91,v94,v95
v_accvgpr_write_b32 a84, v88
v_accvgpr_write_b32 a85, v89
v_accvgpr_write_b32 a86, v90
v_accvgpr_write_b32 a87, v91
v_pk_mul_f32 v[32:33], v[32:33], s[40:41]
v_pk_mul_f32 v[34:35], v[34:35], s[40:41]
v_pk_mul_f32 v[36:37], v[36:37], s[40:41]
v_pk_mul_f32 v[38:39], v[38:39], s[40:41]
cvt v32,v32,v33
cvt v33,v34,v35
cvt v34,v36,v37
cvt v35,v38,v39
v_accvgpr_write_b32 a56, v32
v_accvgpr_write_b32 a57, v33
v_accvgpr_write_b32 a58, v34
v_accvgpr_write_b32 a59, v35
v_pk_mul_f32 v[64:65], v[64:65], s[40:41]
v_pk_mul_f32 v[66:67], v[66:67], s[40:41]
v_pk_mul_f32 v[68:69], v[68:69], s[40:41]
v_pk_mul_f32 v[70:71], v[70:71], s[40:41]
cvt v64,v64,v65
cvt v65,v66,v67
cvt v66,v68,v69
cvt v67,v70,v71
v_accvgpr_write_b32 a72, v64
v_accvgpr_write_b32 a73, v65
v_accvgpr_write_b32 a74, v66
v_accvgpr_write_b32 a75, v67
v_pk_mul_f32 v[96:97], v[96:97], s[40:41]
v_pk_mul_f32 v[98:99], v[98:99], s[40:41]
v_pk_mul_f32 v[100:101], v[100:101], s[40:41]
v_pk_mul_f32 v[102:103], v[102:103], s[40:41]
cvt v96,v96,v97
cvt v97,v98,v99
cvt v98,v100,v101
cvt v99,v102,v103
v_accvgpr_write_b32 a88, v96
v_accvgpr_write_b32 a89, v97
v_accvgpr_write_b32 a90, v98
v_accvgpr_write_b32 a91, v99
v_pk_mul_f32 v[40:41], v[40:41], s[40:41]
v_pk_mul_f32 v[42:43], v[42:43], s[40:41]
v_pk_mul_f32 v[44:45], v[44:45], s[40:41]
v_pk_mul_f32 v[46:47], v[46:47], s[40:41]
cvt v40,v40,v41
cvt v41,v42,v43
cvt v42,v44,v45
cvt v43,v46,v47
v_accvgpr_write_b32 a60, v40
v_accvgpr_write_b32 a61, v41
v_accvgpr_write_b32 a62, v42
v_accvgpr_write_b32 a63, v43
v_pk_mul_f32 v[72:73], v[72:73], s[40:41]
v_pk_mul_f32 v[74:75], v[74:75], s[40:41]
v_pk_mul_f32 v[76:77], v[76:77], s[40:41]
v_pk_mul_f32 v[78:79], v[78:79], s[40:41]
cvt v72,v72,v73
cvt v73,v74,v75
cvt v74,v76,v77
cvt v75,v78,v79
v_accvgpr_write_b32 a76, v72
v_accvgpr_write_b32 a77, v73
v_accvgpr_write_b32 a78, v74
v_accvgpr_write_b32 a79, v75
v_pk_mul_f32 v[104:105], v[104:105], s[40:41]
v_pk_mul_f32 v[106:107], v[106:107], s[40:41]
v_pk_mul_f32 v[108:109], v[108:109], s[40:41]
v_pk_mul_f32 v[110:111], v[110:111], s[40:41]
cvt v104,v104,v105
cvt v105,v106,v107
cvt v106,v108,v109
cvt v107,v110,v111
v_accvgpr_write_b32 a92, v104
v_accvgpr_write_b32 a93, v105
v_accvgpr_write_b32 a94, v106
v_accvgpr_write_b32 a95, v107
v_mov_b32 v241, 163824
v_mov_b32 v242, 0
v_mov_b32 v243, 0
ds_write_b64 v241, v[242:243]
v_add_u32 v209, 67584, v15
v_mov_b32 v220, 0x3f803f80
v_mov_b32 v221, 0x3f803f80
v_mov_b32 v222, 0x3f803f80
v_mov_b32 v223, 0x3f803f80
v_mov_b32 v224, 0xff800000
v_mov_b32 v225, 0xff800000
v_mov_b32 v226, 0xff800000
v_mov_b32 v227, 0xff800000
v_mov_b32 v228, 0xff800000
v_mov_b32 v229, 0xff800000
La_attn:
v_max3_f32 v230, v112, v113, v224
v_max3_f32 v232, v120, v121, v225
v_max3_f32 v234, v128, v129, v226
v_max3_f32 v230, v230, v114, v115
v_max3_f32 v232, v232, v122, v123
v_max3_f32 v234, v234, v130, v131
v_max3_f32 v230, v230, v116, v117
v_max3_f32 v232, v232, v124, v125
v_max3_f32 v234, v234, v132, v133
v_max3_f32 v230, v230, v118, v119
v_max3_f32 v232, v232, v126, v127
v_max3_f32 v234, v234, v134, v135
v_mov_b32 v231, v230
v_mov_b32 v233, v232
v_mov_b32 v235, v234
v_permlane16_swap_b32 v230, v231
v_permlane16_swap_b32 v232, v233
v_permlane16_swap_b32 v234, v235
v_max_f32 v230, v230, v231
v_max_f32 v232, v232, v233
v_max_f32 v234, v234, v235
v_mov_b32 v231, v230
v_mov_b32 v233, v232
v_mov_b32 v235, v234
v_permlane32_swap_b32 v230, v231
v_permlane32_swap_b32 v232, v233
v_permlane32_swap_b32 v234, v235
v_max_f32 v230, v230, v231
v_max_f32 v232, v232, v233
v_max_f32 v234, v234, v235
v_sub_f32 v184, 0, v230
v_sub_f32 v188, 0, v232
v_sub_f32 v192, 0, v234
v_sub_f32 v185, 0, v230
v_sub_f32 v189, 0, v232
v_sub_f32 v193, 0, v234
v_sub_f32 v186, 0, v230
v_sub_f32 v190, 0, v232
v_sub_f32 v194, 0, v234
v_sub_f32 v187, 0, v230
v_sub_f32 v191, 0, v232
v_sub_f32 v195, 0, v234
v_sub_f32 v112, v112, v230
v_sub_f32 v120, v120, v232
v_sub_f32 v128, v128, v234
v_sub_f32 v113, v113, v230
v_sub_f32 v121, v121, v232
v_sub_f32 v129, v129, v234
v_sub_f32 v114, v114, v230
v_sub_f32 v122, v122, v232
v_sub_f32 v130, v130, v234
v_sub_f32 v115, v115, v230
v_sub_f32 v123, v123, v232
v_sub_f32 v131, v131, v234
v_sub_f32 v116, v116, v230
v_sub_f32 v124, v124, v232
v_sub_f32 v132, v132, v234
v_sub_f32 v117, v117, v230
v_sub_f32 v125, v125, v232
v_sub_f32 v133, v133, v234
v_sub_f32 v118, v118, v230
v_sub_f32 v126, v126, v232
v_sub_f32 v134, v134, v234
v_sub_f32 v119, v119, v230
v_sub_f32 v127, v127, v232
v_sub_f32 v135, v135, v234
s_waitcnt lgkmcnt(1)
m16 v[136:139],a[192:195],a[0:3],v[184:187]
v_exp_f32 v112, v112
m16 v[144:147],a[192:195],a[16:19],v[188:191]
v_exp_f32 v113, v113
m16 v[152:155],a[192:195],a[32:35],v[192:195]
v_exp_f32 v114, v114
m16 v[140:143],a[196:199],a[0:3],v[184:187]
v_exp_f32 v115, v115
m16 v[148:151],a[196:199],a[16:19],v[188:191]
v_exp_f32 v116, v116
m16 v[156:159],a[196:199],a[32:35],v[192:195]
v_exp_f32 v117, v117
m16 v[136:139],a[200:203],a[4:7],v[136:139]
v_exp_f32 v118, v118
m16 v[144:147],a[200:203],a[20:23],v[144:147]
v_exp_f32 v119, v119
m16 v[152:155],a[200:203],a[36:39],v[152:155]
v_exp_f32 v120, v120
m16 v[140:143],a[204:207],a[4:7],v[140:143]
v_exp_f32 v121, v121
m16 v[148:151],a[204:207],a[20:23],v[148:151]
v_exp_f32 v122, v122
m16 v[156:159],a[204:207],a[36:39],v[156:159]
v_exp_f32 v123, v123
m16 v[136:139],a[208:211],a[8:11],v[136:139]
v_exp_f32 v124, v124
m16 v[144:147],a[208:211],a[24:27],v[144:147]
v_exp_f32 v125, v125
m16 v[152:155],a[208:211],a[40:43],v[152:155]
v_exp_f32 v126, v126
m16 v[140:143],a[212:215],a[8:11],v[140:143]
v_exp_f32 v127, v127
m16 v[148:151],a[212:215],a[24:27],v[148:151]
v_exp_f32 v128, v128
m16 v[156:159],a[212:215],a[40:43],v[156:159]
v_exp_f32 v129, v129
m16 v[136:139],a[216:219],a[12:15],v[136:139]
v_exp_f32 v130, v130
m16 v[144:147],a[216:219],a[28:31],v[144:147]
v_exp_f32 v131, v131
m16 v[152:155],a[216:219],a[44:47],v[152:155]
v_exp_f32 v132, v132
m16 v[140:143],a[220:223],a[12:15],v[140:143]
v_exp_f32 v133, v133
m16 v[148:151],a[220:223],a[28:31],v[148:151]
v_exp_f32 v134, v134
m16 v[156:159],a[220:223],a[44:47],v[156:159]
v_exp_f32 v135, v135
cvt v160,v112,v113
cvt v161,v114,v115
cvt v162,v116,v117
cvt v163,v118,v119
cvt v164,v120,v121
cvt v165,v122,v123
cvt v166,v124,v125
cvt v167,v126,v127
cvt v168,v128,v129
cvt v169,v130,v131
cvt v170,v132,v133
cvt v171,v134,v135
s_waitcnt lgkmcnt(0)
s_barrier
r128 a[192:195],v3,33792
s_add_u32 m0, s100, 0
r128 a[196:199],v3,34304
r128 a[200:203],v3,33856
r128 a[204:207],v3,34368
s_mov_b32 s28, 65536
r128 a[208:211],v3,33920
r128 a[212:215],v3,34432
r128 a[216:219],v3,33984
buffer_load_dwordx4 v14, s[16:19], s28 offen offset:0 nt lds
r128 a[220:223],v3,34496
s_waitcnt lgkmcnt(0)
m16 v[112:115],a[192:195],a[0:3],v[184:187]
v_exp_f32 v136, v136
m16 v[120:123],a[192:195],a[16:19],v[188:191]
rtr a[224:225],v4,0
s_add_u32 m0, s100, 800
m16 v[128:131],a[192:195],a[32:35],v[192:195]
rtr a[226:227],v4,512
rtr a[228:229],v4,32
m16 v[116:119],a[196:199],a[0:3],v[184:187]
v_exp_f32 v137, v137
m16 v[124:127],a[196:199],a[16:19],v[188:191]
v_exp_f32 v138, v138
m16 v[132:135],a[196:199],a[32:35],v[192:195]
rtr a[230:231],v4,544
rtr a[232:233],v4,64
m16 v[112:115],a[200:203],a[4:7],v[112:115]
s_mov_b32 s28, 65536
rtr a[234:235],v4,576
m16 v[120:123],a[200:203],a[20:23],v[120:123]
v_exp_f32 v139, v139
m16 v[128:131],a[200:203],a[36:39],v[128:131]
v_exp_f32 v140, v140
m16 v[116:119],a[204:207],a[4:7],v[116:119]
rtr a[236:237],v4,96
rtr a[238:239],v4,608
m16 v[124:127],a[204:207],a[20:23],v[124:127]
v_exp_f32 v141, v141
m16 v[132:135],a[204:207],a[36:39],v[132:135]
buffer_load_dwordx4 v14, s[16:19], s28 offen offset:256 nt lds
rtr a[240:241],v4,128
m16 v[112:115],a[208:211],a[8:11],v[112:115]
v_exp_f32 v142, v142
m16 v[120:123],a[208:211],a[24:27],v[120:123]
rtr a[242:243],v4,640
rtr a[244:245],v4,160
m16 v[128:131],a[208:211],a[40:43],v[128:131]
v_exp_f32 v143, v143
m16 v[116:119],a[212:215],a[8:11],v[116:119]
rtr a[246:247],v4,672
cvt v172,v136,v137
m16 v[124:127],a[212:215],a[24:27],v[124:127]
v_exp_f32 v144, v144
m16 v[132:135],a[212:215],a[40:43],v[132:135]
rtr a[248:249],v4,192
s_add_u32 m0, s100, 8448
m16 v[112:115],a[216:219],a[12:15],v[112:115]
rtr a[250:251],v4,704
cvt v173,v138,v139
m16 v[120:123],a[216:219],a[28:31],v[120:123]
v_exp_f32 v145, v145
m16 v[128:131],a[216:219],a[44:47],v[128:131]
rtr a[252:253],v4,224
rtr a[254:255],v4,736
m16 v[116:119],a[220:223],a[12:15],v[116:119]
v_exp_f32 v146, v146
m16 v[124:127],a[220:223],a[28:31],v[124:127]
s_mov_b32 s28, 73728
cvt v174,v140,v141
m16 v[132:135],a[220:223],a[44:47],v[132:135]
v_exp_f32 v147, v147
m16 v[196:199],v[220:223],v[160:163],0
r128 a[192:195],v3,42240
cvt v175,v142,v143
m16 v[200:203],v[220:223],v[164:167],0
v_exp_f32 v148, v148
m16 v[204:207],v[220:223],v[168:171],0
r128 a[196:199],v3,42752
s_waitcnt lgkmcnt(10)
m16 v[16:19],a[224:227],v[160:163],0
v_exp_f32 v149, v149
m16 v[48:51],a[224:227],v[164:167],0
buffer_load_dwordx4 v14, s[16:19], s28 offen offset:0 nt lds
r128 a[200:203],v3,42304
m16 v[80:83],a[224:227],v[168:171],0
v_exp_f32 v150, v150
m16 v[20:23],a[228:231],v[160:163],0
v_exp_f32 v151, v151
m16 v[52:55],a[228:231],v[164:167],0
r128 a[204:207],v3,42816
cvt v176,v144,v145
m16 v[84:87],a[228:231],v[168:171],0
v_exp_f32 v152, v152
m16 v[24:27],a[232:235],v[160:163],0
s_add_u32 m0, s100, 9248
cvt v177,v146,v147
m16 v[56:59],a[232:235],v[164:167],0
r128 a[208:211],v3,42368
cvt v178,v148,v149
m16 v[88:91],a[232:235],v[168:171],0
v_exp_f32 v153, v153
m16 v[28:31],a[236:239],v[160:163],0
r128 a[212:215],v3,42880
cvt v179,v150,v151
m16 v[60:63],a[236:239],v[164:167],0
v_exp_f32 v154, v154
m16 v[92:95],a[236:239],v[168:171],0
s_mov_b32 s28, 73728
s_waitcnt lgkmcnt(6)
m16 v[32:35],a[240:243],v[160:163],0
v_exp_f32 v155, v155
m16 v[64:67],a[240:243],v[164:167],0
r128 a[216:219],v3,42432
cvt v180,v152,v153
m16 v[96:99],a[240:243],v[168:171],0
v_exp_f32 v156, v156
m16 v[36:39],a[244:247],v[160:163],0
r128 a[220:223],v3,42944
cvt v181,v154,v155
m16 v[68:71],a[244:247],v[164:167],0
v_exp_f32 v157, v157
m16 v[100:103],a[244:247],v[168:171],0
buffer_load_dwordx4 v14, s[16:19], s28 offen offset:256 nt lds
cvt v182,v156,v157
m16 v[40:43],a[248:251],v[160:163],0
v_exp_f32 v158, v158
m16 v[72:75],a[248:251],v[164:167],0
v_exp_f32 v159, v159
m16 v[104:107],a[248:251],v[168:171],0
cvt v183,v158,v159
m16 v[44:47],a[252:255],v[160:163],0
m16 v[76:79],a[252:255],v[164:167],0
m16 v[108:111],a[252:255],v[168:171],0
s_waitcnt lgkmcnt(0)
m16 v[136:139],a[192:195],a[0:3],v[184:187]
v_exp_f32 v112, v112
m16 v[144:147],a[192:195],a[16:19],v[188:191]
rtr a[224:225],v4,8448
rtr a[226:227],v4,8960
m16 v[152:155],a[192:195],a[32:35],v[192:195]
v_exp_f32 v113, v113
m16 v[140:143],a[196:199],a[0:3],v[184:187]
rtr a[228:229],v4,8480
cvt v160,v112,v113
m16 v[148:151],a[196:199],a[16:19],v[188:191]
v_exp_f32 v114, v114
m16 v[156:159],a[196:199],a[32:35],v[192:195]
rtr a[230:231],v4,8992
rtr a[232:233],v4,8512
m16 v[136:139],a[200:203],a[4:7],v[136:139]
v_exp_f32 v115, v115
m16 v[144:147],a[200:203],a[20:23],v[144:147]
rtr a[234:235],v4,9024
cvt v161,v114,v115
m16 v[152:155],a[200:203],a[36:39],v[152:155]
v_exp_f32 v116, v116
m16 v[140:143],a[204:207],a[4:7],v[140:143]
rtr a[236:237],v4,8544
rtr a[238:239],v4,9056
m16 v[148:151],a[204:207],a[20:23],v[148:151]
v_exp_f32 v117, v117
m16 v[156:159],a[204:207],a[36:39],v[156:159]
rtr a[240:241],v4,8576
cvt v162,v116,v117
m16 v[136:139],a[208:211],a[8:11],v[136:139]
v_exp_f32 v118, v118
m16 v[144:147],a[208:211],a[24:27],v[144:147]
rtr a[242:243],v4,9088
rtr a[244:245],v4,8608
m16 v[152:155],a[208:211],a[40:43],v[152:155]
v_exp_f32 v119, v119
m16 v[140:143],a[212:215],a[8:11],v[140:143]
rtr a[246:247],v4,9120
cvt v163,v118,v119
m16 v[148:151],a[212:215],a[24:27],v[148:151]
v_exp_f32 v120, v120
m16 v[156:159],a[212:215],a[40:43],v[156:159]
rtr a[248:249],v4,8640
rtr a[250:251],v4,9152
m16 v[136:139],a[216:219],a[12:15],v[136:139]
v_exp_f32 v121, v121
m16 v[144:147],a[216:219],a[28:31],v[144:147]
rtr a[252:253],v4,8672
cvt v164,v120,v121
m16 v[152:155],a[216:219],a[44:47],v[152:155]
v_exp_f32 v122, v122
m16 v[140:143],a[220:223],a[12:15],v[140:143]
rtr a[254:255],v4,9184
m16 v[148:151],a[220:223],a[28:31],v[148:151]
v_exp_f32 v123, v123
m16 v[156:159],a[220:223],a[44:47],v[156:159]
v_exp_f32 v124, v124
m16 v[196:199],v[220:223],v[172:175],v[196:199]
v_exp_f32 v125, v125
m16 v[200:203],v[220:223],v[176:179],v[200:203]
v_exp_f32 v126, v126
m16 v[204:207],v[220:223],v[180:183],v[204:207]
cvt v165,v122,v123
s_waitcnt lgkmcnt(8)
m16 v[16:19],a[224:227],v[172:175],v[16:19]
s_waitcnt lgkmcnt(0)
s_barrier
m16 v[48:51],a[224:227],v[176:179],v[48:51]
v_exp_f32 v127, v127
m16 v[80:83],a[224:227],v[180:183],v[80:83]
r128 a[192:195],v1,0
s_add_u32 m0, s100, 16896
m16 v[20:23],a[228:231],v[172:175],v[20:23]
v_exp_f32 v128, v128
m16 v[52:55],a[228:231],v[176:179],v[52:55]
r128 a[196:199],v1,512
cvt v166,v124,v125
m16 v[84:87],a[228:231],v[180:183],v[84:87]
v_exp_f32 v129, v129
m16 v[24:27],a[232:235],v[172:175],v[24:27]
r128 a[200:203],v1,64
cvt v167,v126,v127
m16 v[56:59],a[232:235],v[176:179],v[56:59]
v_exp_f32 v130, v130
m16 v[88:91],a[232:235],v[180:183],v[88:91]
r128 a[204:207],v1,576
s_mov_b32 s28, 65536
m16 v[28:31],a[236:239],v[172:175],v[28:31]
v_exp_f32 v131, v131
m16 v[60:63],a[236:239],v[176:179],v[60:63]
r128 a[208:211],v1,128
cvt v168,v128,v129
m16 v[92:95],a[236:239],v[180:183],v[92:95]
v_exp_f32 v132, v132
m16 v[32:35],a[240:243],v[172:175],v[32:35]
r128 a[212:215],v1,640
cvt v169,v130,v131
m16 v[64:67],a[240:243],v[176:179],v[64:67]
v_exp_f32 v133, v133
m16 v[96:99],a[240:243],v[180:183],v[96:99]
r128 a[216:219],v1,192
cvt v170,v132,v133
m16 v[36:39],a[244:247],v[172:175],v[36:39]
buffer_load_dwordx4 v14, s[20:23], s28 offen offset:0 nt lds
m16 v[68:71],a[244:247],v[176:179],v[68:71]
r128 a[220:223],v1,704
m16 v[100:103],a[244:247],v[180:183],v[100:103]
v_exp_f32 v134, v134
m16 v[40:43],a[248:251],v[172:175],v[40:43]
v_exp_f32 v135, v135
m16 v[72:75],a[248:251],v[176:179],v[72:75]
cvt v171,v134,v135
m16 v[104:107],a[248:251],v[180:183],v[104:107]
m16 v[44:47],a[252:255],v[172:175],v[44:47]
m16 v[76:79],a[252:255],v[176:179],v[76:79]
m16 v[108:111],a[252:255],v[180:183],v[108:111]
s_waitcnt lgkmcnt(0)
m16 v[112:115],a[192:195],a[0:3],v[184:187]
v_exp_f32 v136, v136
m16 v[120:123],a[192:195],a[16:19],v[188:191]
rtr a[224:225],v4,33792
s_add_u32 m0, s100, 17696
m16 v[128:131],a[192:195],a[32:35],v[192:195]
rtr a[226:227],v4,34304
rtr a[228:229],v4,33824
m16 v[116:119],a[196:199],a[0:3],v[184:187]
v_exp_f32 v137, v137
m16 v[124:127],a[196:199],a[16:19],v[188:191]
ds_write_b128 v15, a[96:99] offset:33792
rtr a[230:231],v4,34336
m16 v[132:135],a[196:199],a[32:35],v[192:195]
v_exp_f32 v138, v138
m16 v[112:115],a[200:203],a[4:7],v[112:115]
rtr a[232:233],v4,33856
s_mov_b32 s28, 65536
m16 v[120:123],a[200:203],a[20:23],v[120:123]
v_exp_f32 v139, v139
m16 v[128:131],a[200:203],a[36:39],v[128:131]
rtr a[234:235],v4,34368
rtr a[236:237],v4,33888
m16 v[116:119],a[204:207],a[4:7],v[116:119]
v_exp_f32 v140, v140
m16 v[124:127],a[204:207],a[20:23],v[124:127]
rtr a[238:239],v4,34400
buffer_load_dwordx4 v14, s[20:23], s28 offen offset:256 nt lds
m16 v[132:135],a[204:207],a[36:39],v[132:135]
v_exp_f32 v141, v141
m16 v[112:115],a[208:211],a[8:11],v[112:115]
rtr a[240:241],v4,33920
rtr a[242:243],v4,34432
m16 v[120:123],a[208:211],a[24:27],v[120:123]
v_exp_f32 v142, v142
m16 v[128:131],a[208:211],a[40:43],v[128:131]
rtr a[244:245],v4,33952
ds_write_b128 v15, a[100:103] offset:34848
m16 v[116:119],a[212:215],a[8:11],v[116:119]
v_exp_f32 v143, v143
m16 v[124:127],a[212:215],a[24:27],v[124:127]
rtr a[246:247],v4,34464
rtr a[248:249],v4,33984
m16 v[132:135],a[212:215],a[40:43],v[132:135]
v_exp_f32 v144, v144
m16 v[112:115],a[216:219],a[12:15],v[112:115]
s_add_u32 m0, s100, 25344
rtr a[250:251],v4,34496
m16 v[120:123],a[216:219],a[28:31],v[120:123]
v_exp_f32 v145, v145
m16 v[128:131],a[216:219],a[44:47],v[128:131]
rtr a[252:253],v4,34016
rtr a[254:255],v4,34528
m16 v[116:119],a[220:223],a[12:15],v[116:119]
v_exp_f32 v146, v146
m16 v[124:127],a[220:223],a[28:31],v[124:127]
s_mov_b32 s28, 73728
cvt v172,v136,v137
m16 v[132:135],a[220:223],a[44:47],v[132:135]
v_exp_f32 v147, v147
m16 v[196:199],v[220:223],v[160:163],v[196:199]
r128 a[192:195],v1,8448
cvt v173,v138,v139
m16 v[200:203],v[220:223],v[164:167],v[200:203]
v_exp_f32 v148, v148
m16 v[204:207],v[220:223],v[168:171],v[204:207]
ds_write_b128 v15, a[104:107] offset:42240
r128 a[196:199],v1,8960
s_waitcnt lgkmcnt(12)
m16 v[16:19],a[224:227],v[160:163],v[16:19]
v_exp_f32 v149, v149
m16 v[48:51],a[224:227],v[164:167],v[48:51]
buffer_load_dwordx4 v14, s[20:23], s28 offen offset:0 nt lds
r128 a[200:203],v1,8512
m16 v[80:83],a[224:227],v[168:171],v[80:83]
v_exp_f32 v150, v150
m16 v[20:23],a[228:231],v[160:163],v[20:23]
v_exp_f32 v151, v151
m16 v[52:55],a[228:231],v[164:167],v[52:55]
r128 a[204:207],v1,9024
cvt v174,v140,v141
m16 v[84:87],a[228:231],v[168:171],v[84:87]
v_exp_f32 v152, v152
m16 v[24:27],a[232:235],v[160:163],v[24:27]
s_add_u32 m0, s100, 26144
cvt v175,v142,v143
m16 v[56:59],a[232:235],v[164:167],v[56:59]
r128 a[208:211],v1,8576
cvt v176,v144,v145
m16 v[88:91],a[232:235],v[168:171],v[88:91]
v_exp_f32 v153, v153
m16 v[28:31],a[236:239],v[160:163],v[28:31]
ds_write_b128 v15, a[108:111] offset:43296
r128 a[212:215],v1,9088
m16 v[60:63],a[236:239],v[164:167],v[60:63]
v_exp_f32 v154, v154
m16 v[92:95],a[236:239],v[168:171],v[92:95]
s_mov_b32 s28, 73728
s_waitcnt lgkmcnt(8)
m16 v[32:35],a[240:243],v[160:163],v[32:35]
v_exp_f32 v155, v155
m16 v[64:67],a[240:243],v[164:167],v[64:67]
r128 a[216:219],v1,8640
cvt v177,v146,v147
m16 v[96:99],a[240:243],v[168:171],v[96:99]
v_exp_f32 v156, v156
m16 v[36:39],a[244:247],v[160:163],v[36:39]
r128 a[220:223],v1,9152
cvt v178,v148,v149
m16 v[68:71],a[244:247],v[164:167],v[68:71]
v_exp_f32 v157, v157
m16 v[100:103],a[244:247],v[168:171],v[100:103]
buffer_load_dwordx4 v14, s[20:23], s28 offen offset:256 nt lds
cvt v179,v150,v151
m16 v[40:43],a[248:251],v[160:163],v[40:43]
v_exp_f32 v158, v158
m16 v[72:75],a[248:251],v[164:167],v[72:75]
v_exp_f32 v159, v159
m16 v[104:107],a[248:251],v[168:171],v[104:107]
cvt v180,v152,v153
cvt v181,v154,v155
m16 v[44:47],a[252:255],v[160:163],v[44:47]
cvt v182,v156,v157
cvt v183,v158,v159
m16 v[76:79],a[252:255],v[164:167],v[76:79]
m16 v[108:111],a[252:255],v[168:171],v[108:111]
s_waitcnt lgkmcnt(0)
m16 v[136:139],a[192:195],a[0:3],v[184:187]
v_exp_f32 v112, v112
m16 v[144:147],a[192:195],a[16:19],v[188:191]
rtr a[224:225],v4,42240
rtr a[226:227],v4,42752
m16 v[152:155],a[192:195],a[32:35],v[192:195]
v_exp_f32 v113, v113
m16 v[140:143],a[196:199],a[0:3],v[184:187]
rtr a[228:229],v4,42272
cvt v160,v112,v113
m16 v[148:151],a[196:199],a[16:19],v[188:191]
v_exp_f32 v114, v114
m16 v[156:159],a[196:199],a[32:35],v[192:195]
rtr a[230:231],v4,42784
rtr a[232:233],v4,42304
m16 v[136:139],a[200:203],a[4:7],v[136:139]
v_exp_f32 v115, v115
m16 v[144:147],a[200:203],a[20:23],v[144:147]
rtr a[234:235],v4,42816
cvt v161,v114,v115
m16 v[152:155],a[200:203],a[36:39],v[152:155]
v_exp_f32 v116, v116
m16 v[140:143],a[204:207],a[4:7],v[140:143]
rtr a[236:237],v4,42336
rtr a[238:239],v4,42848
m16 v[148:151],a[204:207],a[20:23],v[148:151]
v_exp_f32 v117, v117
m16 v[156:159],a[204:207],a[36:39],v[156:159]
rtr a[240:241],v4,42368
cvt v162,v116,v117
m16 v[136:139],a[208:211],a[8:11],v[136:139]
v_exp_f32 v118, v118
m16 v[144:147],a[208:211],a[24:27],v[144:147]
rtr a[242:243],v4,42880
rtr a[244:245],v4,42400
m16 v[152:155],a[208:211],a[40:43],v[152:155]
v_exp_f32 v119, v119
m16 v[140:143],a[212:215],a[8:11],v[140:143]
rtr a[246:247],v4,42912
cvt v163,v118,v119
m16 v[148:151],a[212:215],a[24:27],v[148:151]
v_exp_f32 v120, v120
m16 v[156:159],a[212:215],a[40:43],v[156:159]
rtr a[248:249],v4,42432
rtr a[250:251],v4,42944
m16 v[136:139],a[216:219],a[12:15],v[136:139]
v_exp_f32 v121, v121
m16 v[144:147],a[216:219],a[28:31],v[144:147]
rtr a[252:253],v4,42464
cvt v164,v120,v121
m16 v[152:155],a[216:219],a[44:47],v[152:155]
v_exp_f32 v122, v122
m16 v[140:143],a[220:223],a[12:15],v[140:143]
rtr a[254:255],v4,42976
m16 v[148:151],a[220:223],a[28:31],v[148:151]
v_exp_f32 v123, v123
m16 v[156:159],a[220:223],a[44:47],v[156:159]
v_exp_f32 v124, v124
m16 v[196:199],v[220:223],v[172:175],v[196:199]
v_exp_f32 v125, v125
m16 v[200:203],v[220:223],v[176:179],v[200:203]
v_exp_f32 v126, v126
m16 v[204:207],v[220:223],v[180:183],v[204:207]
cvt v165,v122,v123
s_waitcnt lgkmcnt(8)
m16 v[16:19],a[224:227],v[172:175],v[16:19]
s_waitcnt vmcnt(17) lgkmcnt(0)
s_barrier
m16 v[48:51],a[224:227],v[176:179],v[48:51]
v_exp_f32 v127, v127
m16 v[80:83],a[224:227],v[180:183],v[80:83]
r128 a[192:195],v1,33792
s_add_u32 m0, s100, 50688
m16 v[20:23],a[228:231],v[172:175],v[20:23]
v_exp_f32 v128, v128
m16 v[52:55],a[228:231],v[176:179],v[52:55]
r128 a[196:199],v1,34304
cvt v166,v124,v125
m16 v[84:87],a[228:231],v[180:183],v[84:87]
v_exp_f32 v129, v129
m16 v[24:27],a[232:235],v[172:175],v[24:27]
r128 a[200:203],v1,33856
cvt v167,v126,v127
m16 v[56:59],a[232:235],v[176:179],v[56:59]
v_exp_f32 v130, v130
m16 v[88:91],a[232:235],v[180:183],v[88:91]
r128 a[204:207],v1,34368
s_mov_b32 s28, 81920
m16 v[28:31],a[236:239],v[172:175],v[28:31]
v_exp_f32 v131, v131
m16 v[60:63],a[236:239],v[176:179],v[60:63]
r128 a[208:211],v1,33920
cvt v168,v128,v129
m16 v[92:95],a[236:239],v[180:183],v[92:95]
v_exp_f32 v132, v132
m16 v[32:35],a[240:243],v[172:175],v[32:35]
r128 a[212:215],v1,34432
cvt v169,v130,v131
m16 v[64:67],a[240:243],v[176:179],v[64:67]
v_exp_f32 v133, v133
m16 v[96:99],a[240:243],v[180:183],v[96:99]
r128 a[216:219],v1,33984
cvt v170,v132,v133
m16 v[36:39],a[244:247],v[172:175],v[36:39]
buffer_load_dwordx4 v14, s[20:23], s28 offen offset:0 nt lds
m16 v[68:71],a[244:247],v[176:179],v[68:71]
r128 a[220:223],v1,34496
m16 v[100:103],a[244:247],v[180:183],v[100:103]
v_exp_f32 v134, v134
m16 v[40:43],a[248:251],v[172:175],v[40:43]
v_exp_f32 v135, v135
m16 v[72:75],a[248:251],v[176:179],v[72:75]
cvt v171,v134,v135
m16 v[104:107],a[248:251],v[180:183],v[104:107]
m16 v[44:47],a[252:255],v[172:175],v[44:47]
m16 v[76:79],a[252:255],v[176:179],v[76:79]
m16 v[108:111],a[252:255],v[180:183],v[108:111]
s_waitcnt lgkmcnt(0)
m16 v[112:115],a[192:195],a[0:3],v[184:187]
v_exp_f32 v136, v136
m16 v[120:123],a[192:195],a[16:19],v[188:191]
rtr a[224:225],v2,0
s_add_u32 m0, s100, 51488
m16 v[128:131],a[192:195],a[32:35],v[192:195]
rtr a[226:227],v2,512
rtr a[228:229],v2,32
m16 v[116:119],a[196:199],a[0:3],v[184:187]
v_exp_f32 v137, v137
m16 v[124:127],a[196:199],a[16:19],v[188:191]
v_exp_f32 v138, v138
m16 v[132:135],a[196:199],a[32:35],v[192:195]
rtr a[230:231],v2,544
s_mov_b32 s28, 81920
m16 v[112:115],a[200:203],a[4:7],v[112:115]
rtr a[232:233],v2,64
rtr a[234:235],v2,576
m16 v[120:123],a[200:203],a[20:23],v[120:123]
v_exp_f32 v139, v139
m16 v[128:131],a[200:203],a[36:39],v[128:131]
v_exp_f32 v140, v140
m16 v[116:119],a[204:207],a[4:7],v[116:119]
rtr a[236:237],v2,96
buffer_load_dwordx4 v14, s[20:23], s28 offen offset:256 nt lds
m16 v[124:127],a[204:207],a[20:23],v[124:127]
rtr a[238:239],v2,608
cvt v172,v136,v137
m16 v[132:135],a[204:207],a[36:39],v[132:135]
v_exp_f32 v141, v141
m16 v[112:115],a[208:211],a[8:11],v[112:115]
rtr a[240:241],v2,128
rtr a[242:243],v2,640
m16 v[120:123],a[208:211],a[24:27],v[120:123]
v_exp_f32 v142, v142
m16 v[128:131],a[208:211],a[40:43],v[128:131]
s_add_u32 m0, s100, 59136
rtr a[244:245],v2,160
m16 v[116:119],a[212:215],a[8:11],v[116:119]
v_exp_f32 v143, v143
m16 v[124:127],a[212:215],a[24:27],v[124:127]
rtr a[246:247],v2,672
rtr a[248:249],v2,192
m16 v[132:135],a[212:215],a[40:43],v[132:135]
v_exp_f32 v144, v144
m16 v[112:115],a[216:219],a[12:15],v[112:115]
s_mov_b32 s28, 90112
rtr a[250:251],v2,704
m16 v[120:123],a[216:219],a[28:31],v[120:123]
v_exp_f32 v145, v145
m16 v[128:131],a[216:219],a[44:47],v[128:131]
rtr a[252:253],v2,224
rtr a[254:255],v2,736
m16 v[116:119],a[220:223],a[12:15],v[116:119]
v_exp_f32 v146, v146
m16 v[124:127],a[220:223],a[28:31],v[124:127]
buffer_load_dwordx4 v14, s[20:23], s28 offen offset:0 nt lds
cvt v173,v138,v139
m16 v[132:135],a[220:223],a[44:47],v[132:135]
v_exp_f32 v147, v147
m16 v[196:199],v[220:223],v[160:163],v[196:199]
r128 a[192:195],v1,42240
s_add_u32 m0, s100, 59936
m16 v[200:203],v[220:223],v[164:167],v[200:203]
v_exp_f32 v148, v148
m16 v[204:207],v[220:223],v[168:171],v[204:207]
r128 a[196:199],v1,42752
s_waitcnt lgkmcnt(10)
m16 v[16:19],a[224:227],v[160:163],v[16:19]
v_exp_f32 v149, v149
m16 v[48:51],a[224:227],v[164:167],v[48:51]
r128 a[200:203],v1,42304
s_mov_b32 s28, 90112
m16 v[80:83],a[224:227],v[168:171],v[80:83]
v_exp_f32 v150, v150
m16 v[20:23],a[228:231],v[160:163],v[20:23]
v_exp_f32 v151, v151
m16 v[52:55],a[228:231],v[164:167],v[52:55]
r128 a[204:207],v1,42816
cvt v174,v140,v141
m16 v[84:87],a[228:231],v[168:171],v[84:87]
v_exp_f32 v152, v152
m16 v[24:27],a[232:235],v[160:163],v[24:27]
buffer_load_dwordx4 v14, s[20:23], s28 offen offset:256 nt lds
cvt v175,v142,v143
m16 v[56:59],a[232:235],v[164:167],v[56:59]
r128 a[208:211],v1,42368
cvt v176,v144,v145
m16 v[88:91],a[232:235],v[168:171],v[88:91]
v_exp_f32 v153, v153
m16 v[28:31],a[236:239],v[160:163],v[28:31]
r128 a[212:215],v1,42880
s_add_u32 m0, s100, 67584
m16 v[60:63],a[236:239],v[164:167],v[60:63]
v_exp_f32 v154, v154
m16 v[92:95],a[236:239],v[168:171],v[92:95]
cvt v177,v146,v147
s_waitcnt lgkmcnt(6)
m16 v[32:35],a[240:243],v[160:163],v[32:35]
v_exp_f32 v155, v155
m16 v[64:67],a[240:243],v[164:167],v[64:67]
r128 a[216:219],v1,42432
s_mov_b32 s28, 98304
m16 v[96:99],a[240:243],v[168:171],v[96:99]
v_exp_f32 v156, v156
m16 v[36:39],a[244:247],v[160:163],v[36:39]
r128 a[220:223],v1,42944
cvt v178,v148,v149
m16 v[68:71],a[244:247],v[164:167],v[68:71]
v_exp_f32 v157, v157
m16 v[100:103],a[244:247],v[168:171],v[100:103]
v_exp_f32 v158, v158
m16 v[40:43],a[248:251],v[160:163],v[40:43]
buffer_load_dwordx4 v14, s[16:19], s28 offen offset:0 nt lds
cvt v179,v150,v151
m16 v[72:75],a[248:251],v[164:167],v[72:75]
v_exp_f32 v159, v159
m16 v[104:107],a[248:251],v[168:171],v[104:107]
cvt v180,v152,v153
cvt v181,v154,v155
m16 v[44:47],a[252:255],v[160:163],v[44:47]
cvt v182,v156,v157
cvt v183,v158,v159
m16 v[76:79],a[252:255],v[164:167],v[76:79]
m16 v[108:111],a[252:255],v[168:171],v[108:111]
s_waitcnt lgkmcnt(0)
m16 v[136:139],a[192:195],a[0:3],v[184:187]
v_exp_f32 v112, v112
m16 v[144:147],a[192:195],a[16:19],v[188:191]
rtr a[224:225],v2,8448
rtr a[226:227],v2,8960
m16 v[152:155],a[192:195],a[32:35],v[192:195]
v_exp_f32 v113, v113
m16 v[140:143],a[196:199],a[0:3],v[184:187]
rtr a[228:229],v2,8480
cvt v160,v112,v113
m16 v[148:151],a[196:199],a[16:19],v[188:191]
v_exp_f32 v114, v114
m16 v[156:159],a[196:199],a[32:35],v[192:195]
rtr a[230:231],v2,8992
rtr a[232:233],v2,8512
m16 v[136:139],a[200:203],a[4:7],v[136:139]
v_exp_f32 v115, v115
m16 v[144:147],a[200:203],a[20:23],v[144:147]
rtr a[234:235],v2,9024
cvt v161,v114,v115
m16 v[152:155],a[200:203],a[36:39],v[152:155]
v_exp_f32 v116, v116
m16 v[140:143],a[204:207],a[4:7],v[140:143]
rtr a[236:237],v2,8544
rtr a[238:239],v2,9056
m16 v[148:151],a[204:207],a[20:23],v[148:151]
v_exp_f32 v117, v117
m16 v[156:159],a[204:207],a[36:39],v[156:159]
rtr a[240:241],v2,8576
cvt v162,v116,v117
m16 v[136:139],a[208:211],a[8:11],v[136:139]
v_exp_f32 v118, v118
m16 v[144:147],a[208:211],a[24:27],v[144:147]
rtr a[242:243],v2,9088
rtr a[244:245],v2,8608
m16 v[152:155],a[208:211],a[40:43],v[152:155]
v_exp_f32 v119, v119
m16 v[140:143],a[212:215],a[8:11],v[140:143]
rtr a[246:247],v2,9120
cvt v163,v118,v119
m16 v[148:151],a[212:215],a[24:27],v[148:151]
v_exp_f32 v120, v120
m16 v[156:159],a[212:215],a[40:43],v[156:159]
rtr a[248:249],v2,8640
rtr a[250:251],v2,9152
m16 v[136:139],a[216:219],a[12:15],v[136:139]
v_exp_f32 v121, v121
m16 v[144:147],a[216:219],a[28:31],v[144:147]
rtr a[252:253],v2,8672
cvt v164,v120,v121
m16 v[152:155],a[216:219],a[44:47],v[152:155]
v_exp_f32 v122, v122
m16 v[140:143],a[220:223],a[12:15],v[140:143]
rtr a[254:255],v2,9184
m16 v[148:151],a[220:223],a[28:31],v[148:151]
v_exp_f32 v123, v123
m16 v[156:159],a[220:223],a[44:47],v[156:159]
v_exp_f32 v124, v124
m16 v[196:199],v[220:223],v[172:175],v[196:199]
v_exp_f32 v125, v125
m16 v[200:203],v[220:223],v[176:179],v[200:203]
v_exp_f32 v126, v126
m16 v[204:207],v[220:223],v[180:183],v[204:207]
cvt v165,v122,v123
s_waitcnt lgkmcnt(8)
m16 v[16:19],a[224:227],v[172:175],v[16:19]
s_waitcnt vmcnt(9) lgkmcnt(0)
s_barrier
m16 v[48:51],a[224:227],v[176:179],v[48:51]
v_exp_f32 v127, v127
m16 v[80:83],a[224:227],v[180:183],v[80:83]
r128 a[192:195],v3,0
s_add_u32 m0, s100, 68384
m16 v[20:23],a[228:231],v[172:175],v[20:23]
v_exp_f32 v128, v128
m16 v[52:55],a[228:231],v[176:179],v[52:55]
r128 a[196:199],v3,512
cvt v166,v124,v125
m16 v[84:87],a[228:231],v[180:183],v[84:87]
v_exp_f32 v129, v129
m16 v[24:27],a[232:235],v[172:175],v[24:27]
r128 a[200:203],v3,64
cvt v167,v126,v127
m16 v[56:59],a[232:235],v[176:179],v[56:59]
v_exp_f32 v130, v130
m16 v[88:91],a[232:235],v[180:183],v[88:91]
r128 a[204:207],v3,576
s_mov_b32 s28, 98304
m16 v[28:31],a[236:239],v[172:175],v[28:31]
v_exp_f32 v131, v131
m16 v[60:63],a[236:239],v[176:179],v[60:63]
r128 a[208:211],v3,128
cvt v168,v128,v129
m16 v[92:95],a[236:239],v[180:183],v[92:95]
v_exp_f32 v132, v132
m16 v[32:35],a[240:243],v[172:175],v[32:35]
r128 a[212:215],v3,640
cvt v169,v130,v131
m16 v[64:67],a[240:243],v[176:179],v[64:67]
v_exp_f32 v133, v133
m16 v[96:99],a[240:243],v[180:183],v[96:99]
r128 a[216:219],v3,192
cvt v170,v132,v133
m16 v[36:39],a[244:247],v[172:175],v[36:39]
buffer_load_dwordx4 v14, s[16:19], s28 offen offset:256 nt lds
m16 v[68:71],a[244:247],v[176:179],v[68:71]
r128 a[220:223],v3,704
m16 v[100:103],a[244:247],v[180:183],v[100:103]
v_exp_f32 v134, v134
m16 v[40:43],a[248:251],v[172:175],v[40:43]
v_exp_f32 v135, v135
m16 v[72:75],a[248:251],v[176:179],v[72:75]
cvt v171,v134,v135
m16 v[104:107],a[248:251],v[180:183],v[104:107]
m16 v[44:47],a[252:255],v[172:175],v[44:47]
m16 v[76:79],a[252:255],v[176:179],v[76:79]
m16 v[108:111],a[252:255],v[180:183],v[108:111]
s_waitcnt lgkmcnt(0)
m16 v[112:115],a[192:195],a[0:3],v[184:187]
v_exp_f32 v136, v136
rtr a[224:225],v2,33792
m16 v[120:123],a[192:195],a[16:19],v[188:191]
s_add_u32 m0, s100, 76032
rtr a[226:227],v2,34304
m16 v[128:131],a[192:195],a[32:35],v[192:195]
v_exp_f32 v137, v137
m16 v[116:119],a[196:199],a[0:3],v[184:187]
rtr a[228:229],v2,33824
cvt v172,v136,v137
m16 v[124:127],a[196:199],a[16:19],v[188:191]
ds_write_b128 v209, a[112:115] offset:33792
rtr a[230:231],v2,34336
m16 v[132:135],a[196:199],a[32:35],v[192:195]
v_exp_f32 v138, v138
m16 v[112:115],a[200:203],a[4:7],v[112:115]
s_mov_b32 s28, 106496
rtr a[232:233],v2,33856
m16 v[120:123],a[200:203],a[20:23],v[120:123]
v_exp_f32 v139, v139
m16 v[128:131],a[200:203],a[36:39],v[128:131]
rtr a[234:235],v2,34368
rtr a[236:237],v2,33888
m16 v[116:119],a[204:207],a[4:7],v[116:119]
v_exp_f32 v140, v140
m16 v[124:127],a[204:207],a[20:23],v[124:127]
buffer_load_dwordx4 v14, s[16:19], s28 offen offset:0 nt lds
rtr a[238:239],v2,34400
m16 v[132:135],a[204:207],a[36:39],v[132:135]
v_exp_f32 v141, v141
m16 v[112:115],a[208:211],a[8:11],v[112:115]
rtr a[240:241],v2,33920
rtr a[242:243],v2,34432
m16 v[120:123],a[208:211],a[24:27],v[120:123]
v_exp_f32 v142, v142
m16 v[128:131],a[208:211],a[40:43],v[128:131]
s_add_u32 m0, s100, 76832
rtr a[244:245],v2,33952
m16 v[116:119],a[212:215],a[8:11],v[116:119]
ds_write_b128 v209, a[116:119] offset:34848
rtr a[246:247],v2,34464
m16 v[124:127],a[212:215],a[24:27],v[124:127]
v_exp_f32 v143, v143
m16 v[132:135],a[212:215],a[40:43],v[132:135]
v_exp_f32 v144, v144
m16 v[112:115],a[216:219],a[12:15],v[112:115]
rtr a[248:249],v2,33984
s_mov_b32 s28, 106496
m16 v[120:123],a[216:219],a[28:31],v[120:123]
rtr a[250:251],v2,34496
rtr a[252:253],v2,34016
m16 v[128:131],a[216:219],a[44:47],v[128:131]
v_exp_f32 v145, v145
m16 v[116:119],a[220:223],a[12:15],v[116:119]
v_exp_f32 v146, v146
m16 v[124:127],a[220:223],a[28:31],v[124:127]
rtr a[254:255],v2,34528
buffer_load_dwordx4 v14, s[16:19], s28 offen offset:256 nt lds
m16 v[132:135],a[220:223],a[44:47],v[132:135]
v_exp_f32 v147, v147
m16 v[196:199],v[220:223],v[160:163],v[196:199]
r128 a[192:195],v3,8448
s_add_u32 m0, s100, 84480
m16 v[200:203],v[220:223],v[164:167],v[200:203]
v_exp_f32 v148, v148
m16 v[204:207],v[220:223],v[168:171],v[204:207]
ds_write_b128 v209, a[120:123] offset:42240
r128 a[196:199],v3,8960
s_waitcnt lgkmcnt(12)
m16 v[16:19],a[224:227],v[160:163],v[16:19]
v_exp_f32 v149, v149
m16 v[48:51],a[224:227],v[164:167],v[48:51]
r128 a[200:203],v3,8512
s_mov_b32 s28, 98304
m16 v[80:83],a[224:227],v[168:171],v[80:83]
v_exp_f32 v150, v150
m16 v[20:23],a[228:231],v[160:163],v[20:23]
v_exp_f32 v151, v151
m16 v[52:55],a[228:231],v[164:167],v[52:55]
r128 a[204:207],v3,9024
cvt v173,v138,v139
m16 v[84:87],a[228:231],v[168:171],v[84:87]
v_exp_f32 v152, v152
m16 v[24:27],a[232:235],v[160:163],v[24:27]
buffer_load_dwordx4 v14, s[20:23], s28 offen offset:0 nt lds
cvt v174,v140,v141
m16 v[56:59],a[232:235],v[164:167],v[56:59]
r128 a[208:211],v3,8576
cvt v175,v142,v143
m16 v[88:91],a[232:235],v[168:171],v[88:91]
v_exp_f32 v153, v153
m16 v[28:31],a[236:239],v[160:163],v[28:31]
ds_write_b128 v209, a[124:127] offset:43296
r128 a[212:215],v3,9088
m16 v[60:63],a[236:239],v[164:167],v[60:63]
v_exp_f32 v154, v154
m16 v[92:95],a[236:239],v[168:171],v[92:95]
s_add_u32 m0, s100, 85280
s_waitcnt lgkmcnt(8)
m16 v[32:35],a[240:243],v[160:163],v[32:35]
v_exp_f32 v155, v155
m16 v[64:67],a[240:243],v[164:167],v[64:67]
r128 a[216:219],v3,8640
s_mov_b32 s28, 98304
m16 v[96:99],a[240:243],v[168:171],v[96:99]
v_exp_f32 v156, v156
m16 v[36:39],a[244:247],v[160:163],v[36:39]
r128 a[220:223],v3,9152
cvt v176,v144,v145
m16 v[68:71],a[244:247],v[164:167],v[68:71]
v_exp_f32 v157, v157
m16 v[100:103],a[244:247],v[168:171],v[100:103]
v_exp_f32 v158, v158
m16 v[40:43],a[248:251],v[160:163],v[40:43]
buffer_load_dwordx4 v14, s[20:23], s28 offen offset:256 nt lds
cvt v177,v146,v147
m16 v[72:75],a[248:251],v[164:167],v[72:75]
v_exp_f32 v159, v159
m16 v[104:107],a[248:251],v[168:171],v[104:107]
cvt v178,v148,v149
cvt v179,v150,v151
m16 v[44:47],a[252:255],v[160:163],v[44:47]
cvt v180,v152,v153
cvt v181,v154,v155
m16 v[76:79],a[252:255],v[164:167],v[76:79]
cvt v182,v156,v157
cvt v183,v158,v159
m16 v[108:111],a[252:255],v[168:171],v[108:111]
s_waitcnt lgkmcnt(0)
m16 v[136:139],a[192:195],a[0:3],v[184:187]
v_exp_f32 v112, v112
m16 v[144:147],a[192:195],a[16:19],v[188:191]
rtr a[224:225],v2,42240
rtr a[226:227],v2,42752
m16 v[152:155],a[192:195],a[32:35],v[192:195]
v_exp_f32 v113, v113
m16 v[140:143],a[196:199],a[0:3],v[184:187]
rtr a[228:229],v2,42272
cvt v160,v112,v113
m16 v[148:151],a[196:199],a[16:19],v[188:191]
v_exp_f32 v114, v114
m16 v[156:159],a[196:199],a[32:35],v[192:195]
rtr a[230:231],v2,42784
rtr a[232:233],v2,42304
m16 v[136:139],a[200:203],a[4:7],v[136:139]
v_exp_f32 v115, v115
m16 v[144:147],a[200:203],a[20:23],v[144:147]
rtr a[234:235],v2,42816
cvt v161,v114,v115
m16 v[152:155],a[200:203],a[36:39],v[152:155]
v_exp_f32 v116, v116
m16 v[140:143],a[204:207],a[4:7],v[140:143]
rtr a[236:237],v2,42336
rtr a[238:239],v2,42848
m16 v[148:151],a[204:207],a[20:23],v[148:151]
v_exp_f32 v117, v117
m16 v[156:159],a[204:207],a[36:39],v[156:159]
rtr a[240:241],v2,42368
cvt v162,v116,v117
m16 v[136:139],a[208:211],a[8:11],v[136:139]
v_exp_f32 v118, v118
m16 v[144:147],a[208:211],a[24:27],v[144:147]
rtr a[242:243],v2,42880
rtr a[244:245],v2,42400
m16 v[152:155],a[208:211],a[40:43],v[152:155]
v_exp_f32 v119, v119
m16 v[140:143],a[212:215],a[8:11],v[140:143]
rtr a[246:247],v2,42912
cvt v163,v118,v119
m16 v[148:151],a[212:215],a[24:27],v[148:151]
v_exp_f32 v120, v120
m16 v[156:159],a[212:215],a[40:43],v[156:159]
rtr a[248:249],v2,42432
rtr a[250:251],v2,42944
m16 v[136:139],a[216:219],a[12:15],v[136:139]
v_exp_f32 v121, v121
m16 v[144:147],a[216:219],a[28:31],v[144:147]
rtr a[252:253],v2,42464
cvt v164,v120,v121
m16 v[152:155],a[216:219],a[44:47],v[152:155]
v_exp_f32 v122, v122
m16 v[140:143],a[220:223],a[12:15],v[140:143]
rtr a[254:255],v2,42976
m16 v[148:151],a[220:223],a[28:31],v[148:151]
v_exp_f32 v123, v123
m16 v[156:159],a[220:223],a[44:47],v[156:159]
v_exp_f32 v124, v124
m16 v[196:199],v[220:223],v[172:175],v[196:199]
v_exp_f32 v125, v125
m16 v[200:203],v[220:223],v[176:179],v[200:203]
v_exp_f32 v126, v126
m16 v[204:207],v[220:223],v[180:183],v[204:207]
cvt v165,v122,v123
s_waitcnt lgkmcnt(8)
m16 v[16:19],a[224:227],v[172:175],v[16:19]
s_waitcnt vmcnt(10) lgkmcnt(0)
s_barrier
m16 v[48:51],a[224:227],v[176:179],v[48:51]
v_exp_f32 v127, v127
m16 v[80:83],a[224:227],v[180:183],v[80:83]
r128 a[192:195],v3,33792
s_add_u32 m0, s100, 92928
m16 v[20:23],a[228:231],v[172:175],v[20:23]
v_exp_f32 v128, v128
m16 v[52:55],a[228:231],v[176:179],v[52:55]
r128 a[196:199],v3,34304
cvt v166,v124,v125
m16 v[84:87],a[228:231],v[180:183],v[84:87]
v_exp_f32 v129, v129
m16 v[24:27],a[232:235],v[172:175],v[24:27]
r128 a[200:203],v3,33856
cvt v167,v126,v127
m16 v[56:59],a[232:235],v[176:179],v[56:59]
v_exp_f32 v130, v130
m16 v[88:91],a[232:235],v[180:183],v[88:91]
r128 a[204:207],v3,34368
s_mov_b32 s28, 106496
m16 v[28:31],a[236:239],v[172:175],v[28:31]
v_exp_f32 v131, v131
m16 v[60:63],a[236:239],v[176:179],v[60:63]
r128 a[208:211],v3,33920
cvt v168,v128,v129
m16 v[92:95],a[236:239],v[180:183],v[92:95]
v_exp_f32 v132, v132
m16 v[32:35],a[240:243],v[172:175],v[32:35]
r128 a[212:215],v3,34432
cvt v169,v130,v131
m16 v[64:67],a[240:243],v[176:179],v[64:67]
v_exp_f32 v133, v133
m16 v[96:99],a[240:243],v[180:183],v[96:99]
r128 a[216:219],v3,33984
cvt v170,v132,v133
m16 v[36:39],a[244:247],v[172:175],v[36:39]
buffer_load_dwordx4 v14, s[20:23], s28 offen offset:0 nt lds
m16 v[68:71],a[244:247],v[176:179],v[68:71]
r128 a[220:223],v3,34496
m16 v[100:103],a[244:247],v[180:183],v[100:103]
v_exp_f32 v134, v134
m16 v[40:43],a[248:251],v[172:175],v[40:43]
v_exp_f32 v135, v135
m16 v[72:75],a[248:251],v[176:179],v[72:75]
cvt v171,v134,v135
m16 v[104:107],a[248:251],v[180:183],v[104:107]
m16 v[44:47],a[252:255],v[172:175],v[44:47]
m16 v[76:79],a[252:255],v[176:179],v[76:79]
m16 v[108:111],a[252:255],v[180:183],v[108:111]
s_waitcnt lgkmcnt(0)
m16 v[112:115],a[192:195],a[0:3],v[184:187]
v_exp_f32 v136, v136
m16 v[120:123],a[192:195],a[16:19],v[188:191]
rtr a[224:225],v4,0
s_add_u32 m0, s100, 93728
m16 v[128:131],a[192:195],a[32:35],v[192:195]
rtr a[226:227],v4,512
rtr a[228:229],v4,32
m16 v[116:119],a[196:199],a[0:3],v[184:187]
v_exp_f32 v137, v137
m16 v[124:127],a[196:199],a[16:19],v[188:191]
v_exp_f32 v138, v138
m16 v[132:135],a[196:199],a[32:35],v[192:195]
rtr a[230:231],v4,544
s_mov_b32 s28, 106496
m16 v[112:115],a[200:203],a[4:7],v[112:115]
rtr a[232:233],v4,64
rtr a[234:235],v4,576
m16 v[120:123],a[200:203],a[20:23],v[120:123]
v_exp_f32 v139, v139
m16 v[128:131],a[200:203],a[36:39],v[128:131]
v_exp_f32 v140, v140
m16 v[116:119],a[204:207],a[4:7],v[116:119]
rtr a[236:237],v4,96
buffer_load_dwordx4 v14, s[20:23], s28 offen offset:256 nt lds
m16 v[124:127],a[204:207],a[20:23],v[124:127]
rtr a[238:239],v4,608
cvt v172,v136,v137
m16 v[132:135],a[204:207],a[36:39],v[132:135]
v_exp_f32 v141, v141
m16 v[112:115],a[208:211],a[8:11],v[112:115]
rtr a[240:241],v4,128
rtr a[242:243],v4,640
m16 v[120:123],a[208:211],a[24:27],v[120:123]
v_exp_f32 v142, v142
m16 v[128:131],a[208:211],a[40:43],v[128:131]
s_add_u32 m0, s100, 118272
rtr a[244:245],v4,160
m16 v[116:119],a[212:215],a[8:11],v[116:119]
v_exp_f32 v143, v143
m16 v[124:127],a[212:215],a[24:27],v[124:127]
rtr a[246:247],v4,672
rtr a[248:249],v4,192
m16 v[132:135],a[212:215],a[40:43],v[132:135]
v_exp_f32 v144, v144
m16 v[112:115],a[216:219],a[12:15],v[112:115]
s_mov_b32 s28, 114688
rtr a[250:251],v4,704
m16 v[120:123],a[216:219],a[28:31],v[120:123]
v_exp_f32 v145, v145
m16 v[128:131],a[216:219],a[44:47],v[128:131]
rtr a[252:253],v4,224
rtr a[254:255],v4,736
m16 v[116:119],a[220:223],a[12:15],v[116:119]
v_exp_f32 v146, v146
m16 v[124:127],a[220:223],a[28:31],v[124:127]
buffer_load_dwordx4 v14, s[20:23], s28 offen offset:0 nt lds
cvt v173,v138,v139
m16 v[132:135],a[220:223],a[44:47],v[132:135]
v_exp_f32 v147, v147
m16 v[196:199],v[220:223],v[160:163],v[196:199]
r128 a[192:195],v3,42240
s_add_u32 m0, s100, 119072
m16 v[200:203],v[220:223],v[164:167],v[200:203]
v_exp_f32 v148, v148
m16 v[204:207],v[220:223],v[168:171],v[204:207]
r128 a[196:199],v3,42752
s_waitcnt lgkmcnt(10)
m16 v[16:19],a[224:227],v[160:163],v[16:19]
v_exp_f32 v149, v149
m16 v[48:51],a[224:227],v[164:167],v[48:51]
r128 a[200:203],v3,42304
s_mov_b32 s28, 114688
m16 v[80:83],a[224:227],v[168:171],v[80:83]
v_exp_f32 v150, v150
m16 v[20:23],a[228:231],v[160:163],v[20:23]
v_exp_f32 v151, v151
m16 v[52:55],a[228:231],v[164:167],v[52:55]
r128 a[204:207],v3,42816
cvt v174,v140,v141
m16 v[84:87],a[228:231],v[168:171],v[84:87]
v_exp_f32 v152, v152
m16 v[24:27],a[232:235],v[160:163],v[24:27]
buffer_load_dwordx4 v14, s[20:23], s28 offen offset:256 nt lds
cvt v175,v142,v143
m16 v[56:59],a[232:235],v[164:167],v[56:59]
r128 a[208:211],v3,42368
cvt v176,v144,v145
m16 v[88:91],a[232:235],v[168:171],v[88:91]
v_exp_f32 v153, v153
m16 v[28:31],a[236:239],v[160:163],v[28:31]
r128 a[212:215],v3,42880
s_add_u32 m0, s100, 126720
m16 v[60:63],a[236:239],v[164:167],v[60:63]
v_exp_f32 v154, v154
m16 v[92:95],a[236:239],v[168:171],v[92:95]
cvt v177,v146,v147
s_waitcnt lgkmcnt(6)
m16 v[32:35],a[240:243],v[160:163],v[32:35]
v_exp_f32 v155, v155
m16 v[64:67],a[240:243],v[164:167],v[64:67]
r128 a[216:219],v3,42432
s_mov_b32 s28, 122880
m16 v[96:99],a[240:243],v[168:171],v[96:99]
v_exp_f32 v156, v156
m16 v[36:39],a[244:247],v[160:163],v[36:39]
r128 a[220:223],v3,42944
cvt v178,v148,v149
m16 v[68:71],a[244:247],v[164:167],v[68:71]
v_exp_f32 v157, v157
m16 v[100:103],a[244:247],v[168:171],v[100:103]
v_exp_f32 v158, v158
m16 v[40:43],a[248:251],v[160:163],v[40:43]
buffer_load_dwordx4 v14, s[20:23], s28 offen offset:0 nt lds
cvt v179,v150,v151
m16 v[72:75],a[248:251],v[164:167],v[72:75]
v_exp_f32 v159, v159
m16 v[104:107],a[248:251],v[168:171],v[104:107]
cvt v180,v152,v153
cvt v181,v154,v155
m16 v[44:47],a[252:255],v[160:163],v[44:47]
cvt v182,v156,v157
cvt v183,v158,v159
m16 v[76:79],a[252:255],v[164:167],v[76:79]
m16 v[108:111],a[252:255],v[168:171],v[108:111]
s_waitcnt lgkmcnt(0)
m16 v[136:139],a[192:195],a[0:3],v[184:187]
v_exp_f32 v112, v112
m16 v[144:147],a[192:195],a[16:19],v[188:191]
rtr a[224:225],v4,8448
rtr a[226:227],v4,8960
m16 v[152:155],a[192:195],a[32:35],v[192:195]
v_exp_f32 v113, v113
m16 v[140:143],a[196:199],a[0:3],v[184:187]
rtr a[228:229],v4,8480
cvt v160,v112,v113
m16 v[148:151],a[196:199],a[16:19],v[188:191]
v_exp_f32 v114, v114
m16 v[156:159],a[196:199],a[32:35],v[192:195]
rtr a[230:231],v4,8992
rtr a[232:233],v4,8512
m16 v[136:139],a[200:203],a[4:7],v[136:139]
v_exp_f32 v115, v115
m16 v[144:147],a[200:203],a[20:23],v[144:147]
rtr a[234:235],v4,9024
cvt v161,v114,v115
m16 v[152:155],a[200:203],a[36:39],v[152:155]
v_exp_f32 v116, v116
m16 v[140:143],a[204:207],a[4:7],v[140:143]
rtr a[236:237],v4,8544
rtr a[238:239],v4,9056
m16 v[148:151],a[204:207],a[20:23],v[148:151]
v_exp_f32 v117, v117
m16 v[156:159],a[204:207],a[36:39],v[156:159]
rtr a[240:241],v4,8576
cvt v162,v116,v117
m16 v[136:139],a[208:211],a[8:11],v[136:139]
v_exp_f32 v118, v118
m16 v[144:147],a[208:211],a[24:27],v[144:147]
rtr a[242:243],v4,9088
rtr a[244:245],v4,8608
m16 v[152:155],a[208:211],a[40:43],v[152:155]
v_exp_f32 v119, v119
m16 v[140:143],a[212:215],a[8:11],v[140:143]
rtr a[246:247],v4,9120
cvt v163,v118,v119
m16 v[148:151],a[212:215],a[24:27],v[148:151]
v_exp_f32 v120, v120
m16 v[156:159],a[212:215],a[40:43],v[156:159]
rtr a[248:249],v4,8640
rtr a[250:251],v4,9152
m16 v[136:139],a[216:219],a[12:15],v[136:139]
v_exp_f32 v121, v121
m16 v[144:147],a[216:219],a[28:31],v[144:147]
rtr a[252:253],v4,8672
cvt v164,v120,v121
m16 v[152:155],a[216:219],a[44:47],v[152:155]
v_exp_f32 v122, v122
m16 v[140:143],a[220:223],a[12:15],v[140:143]
rtr a[254:255],v4,9184
m16 v[148:151],a[220:223],a[28:31],v[148:151]
v_exp_f32 v123, v123
m16 v[156:159],a[220:223],a[44:47],v[156:159]
v_exp_f32 v124, v124
m16 v[196:199],v[220:223],v[172:175],v[196:199]
v_exp_f32 v125, v125
m16 v[200:203],v[220:223],v[176:179],v[200:203]
v_exp_f32 v126, v126
m16 v[204:207],v[220:223],v[180:183],v[204:207]
cvt v165,v122,v123
s_waitcnt lgkmcnt(8)
m16 v[16:19],a[224:227],v[172:175],v[16:19]
s_waitcnt vmcnt(7) lgkmcnt(0)
s_barrier
m16 v[48:51],a[224:227],v[176:179],v[48:51]
v_exp_f32 v127, v127
m16 v[80:83],a[224:227],v[180:183],v[80:83]
r128 a[192:195],v1,0
s_add_u32 m0, s100, 127520
m16 v[20:23],a[228:231],v[172:175],v[20:23]
v_exp_f32 v128, v128
m16 v[52:55],a[228:231],v[176:179],v[52:55]
r128 a[196:199],v1,512
cvt v166,v124,v125
m16 v[84:87],a[228:231],v[180:183],v[84:87]
v_exp_f32 v129, v129
m16 v[24:27],a[232:235],v[172:175],v[24:27]
r128 a[200:203],v1,64
cvt v167,v126,v127
m16 v[56:59],a[232:235],v[176:179],v[56:59]
v_exp_f32 v130, v130
m16 v[88:91],a[232:235],v[180:183],v[88:91]
r128 a[204:207],v1,576
s_mov_b32 s28, 122880
m16 v[28:31],a[236:239],v[172:175],v[28:31]
v_exp_f32 v131, v131
m16 v[60:63],a[236:239],v[176:179],v[60:63]
r128 a[208:211],v1,128
cvt v168,v128,v129
m16 v[92:95],a[236:239],v[180:183],v[92:95]
v_exp_f32 v132, v132
m16 v[32:35],a[240:243],v[172:175],v[32:35]
r128 a[212:215],v1,640
cvt v169,v130,v131
m16 v[64:67],a[240:243],v[176:179],v[64:67]
v_exp_f32 v133, v133
m16 v[96:99],a[240:243],v[180:183],v[96:99]
r128 a[216:219],v1,192
cvt v170,v132,v133
m16 v[36:39],a[244:247],v[172:175],v[36:39]
buffer_load_dwordx4 v14, s[20:23], s28 offen offset:256 nt lds
m16 v[68:71],a[244:247],v[176:179],v[68:71]
r128 a[220:223],v1,704
m16 v[100:103],a[244:247],v[180:183],v[100:103]
v_exp_f32 v134, v134
m16 v[40:43],a[248:251],v[172:175],v[40:43]
v_exp_f32 v135, v135
m16 v[72:75],a[248:251],v[176:179],v[72:75]
cvt v171,v134,v135
m16 v[104:107],a[248:251],v[180:183],v[104:107]
m16 v[44:47],a[252:255],v[172:175],v[44:47]
m16 v[76:79],a[252:255],v[176:179],v[76:79]
m16 v[108:111],a[252:255],v[180:183],v[108:111]
s_waitcnt lgkmcnt(0)
m16 v[112:115],a[192:195],a[0:3],v[184:187]
v_exp_f32 v136, v136
rtr a[224:225],v4,33792
m16 v[120:123],a[192:195],a[16:19],v[188:191]
s_add_u32 m0, s100, 0
rtr a[226:227],v4,34304
m16 v[128:131],a[192:195],a[32:35],v[192:195]
v_exp_f32 v137, v137
m16 v[116:119],a[196:199],a[0:3],v[184:187]
rtr a[228:229],v4,33824
cvt v172,v136,v137
m16 v[124:127],a[196:199],a[16:19],v[188:191]
ds_write_b128 v15, a[128:131] offset:16896
rtr a[230:231],v4,34336
m16 v[132:135],a[196:199],a[32:35],v[192:195]
v_exp_f32 v138, v138
m16 v[112:115],a[200:203],a[4:7],v[112:115]
s_mov_b32 s28, 131072
rtr a[232:233],v4,33856
m16 v[120:123],a[200:203],a[20:23],v[120:123]
v_exp_f32 v139, v139
m16 v[128:131],a[200:203],a[36:39],v[128:131]
rtr a[234:235],v4,34368
rtr a[236:237],v4,33888
m16 v[116:119],a[204:207],a[4:7],v[116:119]
v_exp_f32 v140, v140
m16 v[124:127],a[204:207],a[20:23],v[124:127]
buffer_load_dwordx4 v14, s[16:19], s28 offen offset:0 nt lds
rtr a[238:239],v4,34400
m16 v[132:135],a[204:207],a[36:39],v[132:135]
v_exp_f32 v141, v141
m16 v[112:115],a[208:211],a[8:11],v[112:115]
rtr a[240:241],v4,33920
rtr a[242:243],v4,34432
m16 v[120:123],a[208:211],a[24:27],v[120:123]
v_exp_f32 v142, v142
m16 v[128:131],a[208:211],a[40:43],v[128:131]
s_add_u32 m0, s100, 800
rtr a[244:245],v4,33952
m16 v[116:119],a[212:215],a[8:11],v[116:119]
ds_write_b128 v15, a[132:135] offset:17952
rtr a[246:247],v4,34464
m16 v[124:127],a[212:215],a[24:27],v[124:127]
v_exp_f32 v143, v143
m16 v[132:135],a[212:215],a[40:43],v[132:135]
v_exp_f32 v144, v144
m16 v[112:115],a[216:219],a[12:15],v[112:115]
rtr a[248:249],v4,33984
s_mov_b32 s28, 131072
m16 v[120:123],a[216:219],a[28:31],v[120:123]
rtr a[250:251],v4,34496
rtr a[252:253],v4,34016
m16 v[128:131],a[216:219],a[44:47],v[128:131]
v_exp_f32 v145, v145
m16 v[116:119],a[220:223],a[12:15],v[116:119]
v_exp_f32 v146, v146
m16 v[124:127],a[220:223],a[28:31],v[124:127]
rtr a[254:255],v4,34528
buffer_load_dwordx4 v14, s[16:19], s28 offen offset:256 nt lds
m16 v[132:135],a[220:223],a[44:47],v[132:135]
v_exp_f32 v147, v147
m16 v[196:199],v[220:223],v[160:163],v[196:199]
r128 a[192:195],v1,8448
s_add_u32 m0, s100, 8448
m16 v[200:203],v[220:223],v[164:167],v[200:203]
v_exp_f32 v148, v148
m16 v[204:207],v[220:223],v[168:171],v[204:207]
ds_write_b128 v15, a[136:139] offset:25344
r128 a[196:199],v1,8960
s_waitcnt lgkmcnt(12)
m16 v[16:19],a[224:227],v[160:163],v[16:19]
v_exp_f32 v149, v149
m16 v[48:51],a[224:227],v[164:167],v[48:51]
r128 a[200:203],v1,8512
s_mov_b32 s28, 139264
m16 v[80:83],a[224:227],v[168:171],v[80:83]
v_exp_f32 v150, v150
m16 v[20:23],a[228:231],v[160:163],v[20:23]
v_exp_f32 v151, v151
m16 v[52:55],a[228:231],v[164:167],v[52:55]
r128 a[204:207],v1,9024
cvt v173,v138,v139
m16 v[84:87],a[228:231],v[168:171],v[84:87]
v_exp_f32 v152, v152
m16 v[24:27],a[232:235],v[160:163],v[24:27]
buffer_load_dwordx4 v14, s[16:19], s28 offen offset:0 nt lds
cvt v174,v140,v141
m16 v[56:59],a[232:235],v[164:167],v[56:59]
r128 a[208:211],v1,8576
cvt v175,v142,v143
m16 v[88:91],a[232:235],v[168:171],v[88:91]
v_exp_f32 v153, v153
m16 v[28:31],a[236:239],v[160:163],v[28:31]
ds_write_b128 v15, a[140:143] offset:26400
r128 a[212:215],v1,9088
m16 v[60:63],a[236:239],v[164:167],v[60:63]
v_exp_f32 v154, v154
m16 v[92:95],a[236:239],v[168:171],v[92:95]
s_add_u32 m0, s100, 9248
s_waitcnt lgkmcnt(8)
m16 v[32:35],a[240:243],v[160:163],v[32:35]
v_exp_f32 v155, v155
m16 v[64:67],a[240:243],v[164:167],v[64:67]
r128 a[216:219],v1,8640
s_mov_b32 s28, 139264
m16 v[96:99],a[240:243],v[168:171],v[96:99]
v_exp_f32 v156, v156
m16 v[36:39],a[244:247],v[160:163],v[36:39]
r128 a[220:223],v1,9152
cvt v176,v144,v145
m16 v[68:71],a[244:247],v[164:167],v[68:71]
v_exp_f32 v157, v157
m16 v[100:103],a[244:247],v[168:171],v[100:103]
v_exp_f32 v158, v158
m16 v[40:43],a[248:251],v[160:163],v[40:43]
buffer_load_dwordx4 v14, s[16:19], s28 offen offset:256 nt lds
cvt v177,v146,v147
m16 v[72:75],a[248:251],v[164:167],v[72:75]
v_exp_f32 v159, v159
m16 v[104:107],a[248:251],v[168:171],v[104:107]
cvt v178,v148,v149
cvt v179,v150,v151
m16 v[44:47],a[252:255],v[160:163],v[44:47]
cvt v180,v152,v153
cvt v181,v154,v155
m16 v[76:79],a[252:255],v[164:167],v[76:79]
cvt v182,v156,v157
cvt v183,v158,v159
m16 v[108:111],a[252:255],v[168:171],v[108:111]
s_waitcnt lgkmcnt(0)
m16 v[136:139],a[192:195],a[0:3],v[184:187]
v_exp_f32 v112, v112
m16 v[144:147],a[192:195],a[16:19],v[188:191]
rtr a[224:225],v4,42240
rtr a[226:227],v4,42752
m16 v[152:155],a[192:195],a[32:35],v[192:195]
v_exp_f32 v113, v113
m16 v[140:143],a[196:199],a[0:3],v[184:187]
rtr a[228:229],v4,42272
cvt v160,v112,v113
m16 v[148:151],a[196:199],a[16:19],v[188:191]
v_exp_f32 v114, v114
m16 v[156:159],a[196:199],a[32:35],v[192:195]
rtr a[230:231],v4,42784
rtr a[232:233],v4,42304
m16 v[136:139],a[200:203],a[4:7],v[136:139]
v_exp_f32 v115, v115
m16 v[144:147],a[200:203],a[20:23],v[144:147]
rtr a[234:235],v4,42816
cvt v161,v114,v115
m16 v[152:155],a[200:203],a[36:39],v[152:155]
v_exp_f32 v116, v116
m16 v[140:143],a[204:207],a[4:7],v[140:143]
rtr a[236:237],v4,42336
rtr a[238:239],v4,42848
m16 v[148:151],a[204:207],a[20:23],v[148:151]
v_exp_f32 v117, v117
m16 v[156:159],a[204:207],a[36:39],v[156:159]
rtr a[240:241],v4,42368
cvt v162,v116,v117
m16 v[136:139],a[208:211],a[8:11],v[136:139]
v_exp_f32 v118, v118
m16 v[144:147],a[208:211],a[24:27],v[144:147]
rtr a[242:243],v4,42880
rtr a[244:245],v4,42400
m16 v[152:155],a[208:211],a[40:43],v[152:155]
v_exp_f32 v119, v119
m16 v[140:143],a[212:215],a[8:11],v[140:143]
rtr a[246:247],v4,42912
cvt v163,v118,v119
m16 v[148:151],a[212:215],a[24:27],v[148:151]
v_exp_f32 v120, v120
m16 v[156:159],a[212:215],a[40:43],v[156:159]
rtr a[248:249],v4,42432
rtr a[250:251],v4,42944
m16 v[136:139],a[216:219],a[12:15],v[136:139]
v_exp_f32 v121, v121
m16 v[144:147],a[216:219],a[28:31],v[144:147]
rtr a[252:253],v4,42464
cvt v164,v120,v121
m16 v[152:155],a[216:219],a[44:47],v[152:155]
v_exp_f32 v122, v122
m16 v[140:143],a[220:223],a[12:15],v[140:143]
rtr a[254:255],v4,42976
m16 v[148:151],a[220:223],a[28:31],v[148:151]
v_exp_f32 v123, v123
m16 v[156:159],a[220:223],a[44:47],v[156:159]
v_exp_f32 v124, v124
m16 v[196:199],v[220:223],v[172:175],v[196:199]
v_exp_f32 v125, v125
m16 v[200:203],v[220:223],v[176:179],v[200:203]
v_exp_f32 v126, v126
m16 v[204:207],v[220:223],v[180:183],v[204:207]
cvt v165,v122,v123
s_waitcnt lgkmcnt(8)
m16 v[16:19],a[224:227],v[172:175],v[16:19]
s_waitcnt vmcnt(8) lgkmcnt(0)
s_barrier
m16 v[48:51],a[224:227],v[176:179],v[48:51]
v_exp_f32 v127, v127
m16 v[80:83],a[224:227],v[180:183],v[80:83]
r128 a[192:195],v1,33792
s_add_u32 m0, s100, 33792
m16 v[20:23],a[228:231],v[172:175],v[20:23]
v_exp_f32 v128, v128
m16 v[52:55],a[228:231],v[176:179],v[52:55]
r128 a[196:199],v1,34304
cvt v166,v124,v125
m16 v[84:87],a[228:231],v[180:183],v[84:87]
v_exp_f32 v129, v129
m16 v[24:27],a[232:235],v[172:175],v[24:27]
r128 a[200:203],v1,33856
cvt v167,v126,v127
m16 v[56:59],a[232:235],v[176:179],v[56:59]
v_exp_f32 v130, v130
m16 v[88:91],a[232:235],v[180:183],v[88:91]
r128 a[204:207],v1,34368
s_mov_b32 s28, 147456
m16 v[28:31],a[236:239],v[172:175],v[28:31]
v_exp_f32 v131, v131
m16 v[60:63],a[236:239],v[176:179],v[60:63]
r128 a[208:211],v1,33920
cvt v168,v128,v129
m16 v[92:95],a[236:239],v[180:183],v[92:95]
v_exp_f32 v132, v132
m16 v[32:35],a[240:243],v[172:175],v[32:35]
r128 a[212:215],v1,34432
cvt v169,v130,v131
m16 v[64:67],a[240:243],v[176:179],v[64:67]
v_exp_f32 v133, v133
m16 v[96:99],a[240:243],v[180:183],v[96:99]
r128 a[216:219],v1,33984
cvt v170,v132,v133
m16 v[36:39],a[244:247],v[172:175],v[36:39]
buffer_load_dwordx4 v14, s[16:19], s28 offen offset:0 nt lds
m16 v[68:71],a[244:247],v[176:179],v[68:71]
r128 a[220:223],v1,34496
m16 v[100:103],a[244:247],v[180:183],v[100:103]
v_exp_f32 v134, v134
m16 v[40:43],a[248:251],v[172:175],v[40:43]
v_exp_f32 v135, v135
m16 v[72:75],a[248:251],v[176:179],v[72:75]
cvt v171,v134,v135
m16 v[104:107],a[248:251],v[180:183],v[104:107]
m16 v[44:47],a[252:255],v[172:175],v[44:47]
m16 v[76:79],a[252:255],v[176:179],v[76:79]
m16 v[108:111],a[252:255],v[180:183],v[108:111]
s_waitcnt lgkmcnt(0)
m16 v[112:115],a[192:195],a[0:3],v[184:187]
v_exp_f32 v136, v136
rtr a[224:225],v2,0
m16 v[120:123],a[192:195],a[16:19],v[188:191]
s_add_u32 m0, s100, 34592
rtr a[226:227],v2,512
m16 v[128:131],a[192:195],a[32:35],v[192:195]
v_exp_f32 v137, v137
m16 v[116:119],a[196:199],a[0:3],v[184:187]
rtr a[228:229],v2,32
cvt v172,v136,v137
m16 v[124:127],a[196:199],a[16:19],v[188:191]
ds_write_b128 v209, a[144:147] offset:0
rtr a[230:231],v2,544
m16 v[132:135],a[196:199],a[32:35],v[192:195]
v_exp_f32 v138, v138
m16 v[112:115],a[200:203],a[4:7],v[112:115]
s_mov_b32 s28, 147456
rtr a[232:233],v2,64
m16 v[120:123],a[200:203],a[20:23],v[120:123]
v_exp_f32 v139, v139
m16 v[128:131],a[200:203],a[36:39],v[128:131]
rtr a[234:235],v2,576
rtr a[236:237],v2,96
m16 v[116:119],a[204:207],a[4:7],v[116:119]
v_exp_f32 v140, v140
m16 v[124:127],a[204:207],a[20:23],v[124:127]
buffer_load_dwordx4 v14, s[16:19], s28 offen offset:256 nt lds
rtr a[238:239],v2,608
m16 v[132:135],a[204:207],a[36:39],v[132:135]
v_exp_f32 v141, v141
m16 v[112:115],a[208:211],a[8:11],v[112:115]
rtr a[240:241],v2,128
rtr a[242:243],v2,640
m16 v[120:123],a[208:211],a[24:27],v[120:123]
v_exp_f32 v142, v142
m16 v[128:131],a[208:211],a[40:43],v[128:131]
s_add_u32 m0, s100, 42240
rtr a[244:245],v2,160
m16 v[116:119],a[212:215],a[8:11],v[116:119]
ds_write_b128 v209, a[148:151] offset:1056
rtr a[246:247],v2,672
m16 v[124:127],a[212:215],a[24:27],v[124:127]
v_exp_f32 v143, v143
m16 v[132:135],a[212:215],a[40:43],v[132:135]
v_exp_f32 v144, v144
m16 v[112:115],a[216:219],a[12:15],v[112:115]
rtr a[248:249],v2,192
s_mov_b32 s28, 155648
m16 v[120:123],a[216:219],a[28:31],v[120:123]
rtr a[250:251],v2,704
rtr a[252:253],v2,224
m16 v[128:131],a[216:219],a[44:47],v[128:131]
v_exp_f32 v145, v145
m16 v[116:119],a[220:223],a[12:15],v[116:119]
v_exp_f32 v146, v146
m16 v[124:127],a[220:223],a[28:31],v[124:127]
rtr a[254:255],v2,736
buffer_load_dwordx4 v14, s[16:19], s28 offen offset:0 nt lds
m16 v[132:135],a[220:223],a[44:47],v[132:135]
v_exp_f32 v147, v147
m16 v[196:199],v[220:223],v[160:163],v[196:199]
r128 a[192:195],v1,42240
s_add_u32 m0, s100, 43040
m16 v[200:203],v[220:223],v[164:167],v[200:203]
v_exp_f32 v148, v148
m16 v[204:207],v[220:223],v[168:171],v[204:207]
ds_write_b128 v209, a[152:155] offset:8448
r128 a[196:199],v1,42752
s_waitcnt lgkmcnt(12)
m16 v[16:19],a[224:227],v[160:163],v[16:19]
v_exp_f32 v149, v149
m16 v[48:51],a[224:227],v[164:167],v[48:51]
r128 a[200:203],v1,42304
s_mov_b32 s28, 155648
m16 v[80:83],a[224:227],v[168:171],v[80:83]
v_exp_f32 v150, v150
m16 v[20:23],a[228:231],v[160:163],v[20:23]
v_exp_f32 v151, v151
m16 v[52:55],a[228:231],v[164:167],v[52:55]
r128 a[204:207],v1,42816
cvt v173,v138,v139
m16 v[84:87],a[228:231],v[168:171],v[84:87]
v_exp_f32 v152, v152
m16 v[24:27],a[232:235],v[160:163],v[24:27]
buffer_load_dwordx4 v14, s[16:19], s28 offen offset:256 nt lds
cvt v174,v140,v141
m16 v[56:59],a[232:235],v[164:167],v[56:59]
r128 a[208:211],v1,42368
cvt v175,v142,v143
m16 v[88:91],a[232:235],v[168:171],v[88:91]
v_exp_f32 v153, v153
m16 v[28:31],a[236:239],v[160:163],v[28:31]
ds_write_b128 v209, a[156:159] offset:9504
r128 a[212:215],v1,42880
m16 v[60:63],a[236:239],v[164:167],v[60:63]
v_exp_f32 v154, v154
m16 v[92:95],a[236:239],v[168:171],v[92:95]
s_add_u32 m0, s100, 50688
s_waitcnt lgkmcnt(8)
m16 v[32:35],a[240:243],v[160:163],v[32:35]
v_exp_f32 v155, v155
m16 v[64:67],a[240:243],v[164:167],v[64:67]
r128 a[216:219],v1,42432
s_mov_b32 s28, 147456
m16 v[96:99],a[240:243],v[168:171],v[96:99]
v_exp_f32 v156, v156
m16 v[36:39],a[244:247],v[160:163],v[36:39]
r128 a[220:223],v1,42944
cvt v176,v144,v145
m16 v[68:71],a[244:247],v[164:167],v[68:71]
v_exp_f32 v157, v157
m16 v[100:103],a[244:247],v[168:171],v[100:103]
v_exp_f32 v158, v158
m16 v[40:43],a[248:251],v[160:163],v[40:43]
buffer_load_dwordx4 v14, s[20:23], s28 offen offset:0 nt lds
cvt v177,v146,v147
m16 v[72:75],a[248:251],v[164:167],v[72:75]
v_exp_f32 v159, v159
m16 v[104:107],a[248:251],v[168:171],v[104:107]
cvt v178,v148,v149
cvt v179,v150,v151
m16 v[44:47],a[252:255],v[160:163],v[44:47]
cvt v180,v152,v153
cvt v181,v154,v155
m16 v[76:79],a[252:255],v[164:167],v[76:79]
cvt v182,v156,v157
cvt v183,v158,v159
m16 v[108:111],a[252:255],v[168:171],v[108:111]
s_waitcnt lgkmcnt(0)
m16 v[136:139],a[192:195],a[0:3],v[184:187]
v_exp_f32 v112, v112
m16 v[144:147],a[192:195],a[16:19],v[188:191]
rtr a[224:225],v2,8448
rtr a[226:227],v2,8960
m16 v[152:155],a[192:195],a[32:35],v[192:195]
v_exp_f32 v113, v113
m16 v[140:143],a[196:199],a[0:3],v[184:187]
rtr a[228:229],v2,8480
cvt v160,v112,v113
m16 v[148:151],a[196:199],a[16:19],v[188:191]
v_exp_f32 v114, v114
m16 v[156:159],a[196:199],a[32:35],v[192:195]
rtr a[230:231],v2,8992
rtr a[232:233],v2,8512
m16 v[136:139],a[200:203],a[4:7],v[136:139]
v_exp_f32 v115, v115
m16 v[144:147],a[200:203],a[20:23],v[144:147]
rtr a[234:235],v2,9024
cvt v161,v114,v115
m16 v[152:155],a[200:203],a[36:39],v[152:155]
v_exp_f32 v116, v116
m16 v[140:143],a[204:207],a[4:7],v[140:143]
rtr a[236:237],v2,8544
rtr a[238:239],v2,9056
m16 v[148:151],a[204:207],a[20:23],v[148:151]
v_exp_f32 v117, v117
m16 v[156:159],a[204:207],a[36:39],v[156:159]
rtr a[240:241],v2,8576
cvt v162,v116,v117
m16 v[136:139],a[208:211],a[8:11],v[136:139]
v_exp_f32 v118, v118
m16 v[144:147],a[208:211],a[24:27],v[144:147]
rtr a[242:243],v2,9088
rtr a[244:245],v2,8608
m16 v[152:155],a[208:211],a[40:43],v[152:155]
v_exp_f32 v119, v119
m16 v[140:143],a[212:215],a[8:11],v[140:143]
rtr a[246:247],v2,9120
cvt v163,v118,v119
m16 v[148:151],a[212:215],a[24:27],v[148:151]
v_exp_f32 v120, v120
m16 v[156:159],a[212:215],a[40:43],v[156:159]
rtr a[248:249],v2,8640
rtr a[250:251],v2,9152
m16 v[136:139],a[216:219],a[12:15],v[136:139]
v_exp_f32 v121, v121
m16 v[144:147],a[216:219],a[28:31],v[144:147]
rtr a[252:253],v2,8672
cvt v164,v120,v121
m16 v[152:155],a[216:219],a[44:47],v[152:155]
v_exp_f32 v122, v122
m16 v[140:143],a[220:223],a[12:15],v[140:143]
rtr a[254:255],v2,9184
m16 v[148:151],a[220:223],a[28:31],v[148:151]
v_exp_f32 v123, v123
m16 v[156:159],a[220:223],a[44:47],v[156:159]
v_exp_f32 v124, v124
m16 v[196:199],v[220:223],v[172:175],v[196:199]
v_exp_f32 v125, v125
m16 v[200:203],v[220:223],v[176:179],v[200:203]
v_exp_f32 v126, v126
m16 v[204:207],v[220:223],v[180:183],v[204:207]
cvt v165,v122,v123
s_waitcnt lgkmcnt(8)
m16 v[16:19],a[224:227],v[172:175],v[16:19]
s_waitcnt vmcnt(5) lgkmcnt(0)
s_barrier
m16 v[48:51],a[224:227],v[176:179],v[48:51]
v_exp_f32 v127, v127
m16 v[80:83],a[224:227],v[180:183],v[80:83]
r128 a[192:195],v3,0
s_add_u32 m0, s100, 51488
m16 v[20:23],a[228:231],v[172:175],v[20:23]
v_exp_f32 v128, v128
m16 v[52:55],a[228:231],v[176:179],v[52:55]
r128 a[196:199],v3,512
cvt v166,v124,v125
m16 v[84:87],a[228:231],v[180:183],v[84:87]
v_exp_f32 v129, v129
m16 v[24:27],a[232:235],v[172:175],v[24:27]
r128 a[200:203],v3,64
cvt v167,v126,v127
m16 v[56:59],a[232:235],v[176:179],v[56:59]
v_exp_f32 v130, v130
m16 v[88:91],a[232:235],v[180:183],v[88:91]
r128 a[204:207],v3,576
s_mov_b32 s28, 147456
m16 v[28:31],a[236:239],v[172:175],v[28:31]
v_exp_f32 v131, v131
m16 v[60:63],a[236:239],v[176:179],v[60:63]
r128 a[208:211],v3,128
cvt v168,v128,v129
m16 v[92:95],a[236:239],v[180:183],v[92:95]
v_exp_f32 v132, v132
m16 v[32:35],a[240:243],v[172:175],v[32:35]
r128 a[212:215],v3,640
cvt v169,v130,v131
m16 v[64:67],a[240:243],v[176:179],v[64:67]
v_exp_f32 v133, v133
m16 v[96:99],a[240:243],v[180:183],v[96:99]
r128 a[216:219],v3,192
cvt v170,v132,v133
m16 v[36:39],a[244:247],v[172:175],v[36:39]
buffer_load_dwordx4 v14, s[20:23], s28 offen offset:256 nt lds
m16 v[68:71],a[244:247],v[176:179],v[68:71]
r128 a[220:223],v3,704
m16 v[100:103],a[244:247],v[180:183],v[100:103]
v_exp_f32 v134, v134
m16 v[40:43],a[248:251],v[172:175],v[40:43]
v_exp_f32 v135, v135
m16 v[72:75],a[248:251],v[176:179],v[72:75]
cvt v171,v134,v135
m16 v[104:107],a[248:251],v[180:183],v[104:107]
m16 v[44:47],a[252:255],v[172:175],v[44:47]
m16 v[76:79],a[252:255],v[176:179],v[76:79]
m16 v[108:111],a[252:255],v[180:183],v[108:111]
s_waitcnt lgkmcnt(0)
m16 v[112:115],a[192:195],a[48:51],0
v_exp_f32 v136, v136
rtr a[224:225],v2,33792
m16 v[120:123],a[192:195],a[64:67],0
s_add_u32 m0, s100, 59136
rtr a[226:227],v2,34304
m16 v[128:131],a[192:195],a[80:83],0
v_exp_f32 v137, v137
rtr a[228:229],v2,33824
m16 v[116:119],a[196:199],a[48:51],0
v_exp_f32 v138, v138
cvt v172,v136,v137
m16 v[124:127],a[196:199],a[64:67],0
rtr a[230:231],v2,34336
s_mov_b32 s28, 155648
m16 v[132:135],a[196:199],a[80:83],0
rtr a[232:233],v2,33856
v_exp_f32 v139, v139
m16 v[112:115],a[200:203],a[52:55],v[112:115]
rtr a[234:235],v2,34368
v_exp_f32 v140, v140
m16 v[120:123],a[200:203],a[68:71],v[120:123]
v_exp_f32 v141, v141
cvt v173,v138,v139
m16 v[128:131],a[200:203],a[84:87],v[128:131]
rtr a[236:237],v2,33888
buffer_load_dwordx4 v14, s[20:23], s28 offen offset:0 nt lds
cvt v174,v140,v141
m16 v[116:119],a[204:207],a[52:55],v[116:119]
rtr a[238:239],v2,34400
v_exp_f32 v142, v142
m16 v[124:127],a[204:207],a[68:71],v[124:127]
v_exp_f32 v143, v143
m16 v[132:135],a[204:207],a[84:87],v[132:135]
rtr a[240:241],v2,33920
v_exp_f32 v144, v144
m16 v[112:115],a[208:211],a[56:59],v[112:115]
rtr a[242:243],v2,34432
s_add_u32 m0, s100, 59936
cvt v175,v142,v143
m16 v[120:123],a[208:211],a[72:75],v[120:123]
rtr a[244:245],v2,33952
v_exp_f32 v145, v145
m16 v[128:131],a[208:211],a[88:91],v[128:131]
v_exp_f32 v146, v146
cvt v176,v144,v145
m16 v[116:119],a[212:215],a[56:59],v[116:119]
rtr a[246:247],v2,34464
v_exp_f32 v147, v147
m16 v[124:127],a[212:215],a[72:75],v[124:127]
rtr a[248:249],v2,33984
s_mov_b32 s28, 155648
cvt v177,v146,v147
m16 v[132:135],a[212:215],a[88:91],v[132:135]
rtr a[250:251],v2,34496
v_exp_f32 v148, v148
m16 v[112:115],a[216:219],a[60:63],v[112:115]
v_exp_f32 v149, v149
m16 v[120:123],a[216:219],a[76:79],v[120:123]
rtr a[252:253],v2,34016
v_exp_f32 v150, v150
m16 v[128:131],a[216:219],a[92:95],v[128:131]
rtr a[254:255],v2,34528
buffer_load_dwordx4 v14, s[20:23], s28 offen offset:256 nt lds
cvt v178,v148,v149
m16 v[116:119],a[220:223],a[60:63],v[116:119]
v_exp_f32 v151, v151
m16 v[124:127],a[220:223],a[76:79],v[124:127]
v_exp_f32 v152, v152
cvt v179,v150,v151
m16 v[132:135],a[220:223],a[92:95],v[132:135]
r128 a[192:195],v3,8448
v_exp_f32 v153, v153
m16 v[196:199],v[220:223],v[160:163],v[196:199]
s_add_u32 m0, s100, 84480
v_exp_f32 v154, v154
m16 v[200:203],v[220:223],v[164:167],v[200:203]
r128 a[196:199],v3,8960
v_exp_f32 v155, v155
m16 v[204:207],v[220:223],v[168:171],v[204:207]
v_exp_f32 v156, v156
s_waitcnt lgkmcnt(10)
m16 v[16:19],a[224:227],v[160:163],v[16:19]
v_exp_f32 v157, v157
cvt v180,v152,v153
m16 v[48:51],a[224:227],v[164:167],v[48:51]
v_max3_f32 v230, v112, v113, v227
v_max3_f32 v232, v120, v121, v228
v_max3_f32 v234, v128, v129, v229
m16 v[80:83],a[224:227],v[168:171],v[80:83]
r128 a[200:203],v3,8512
v_max3_f32 v230, v230, v114, v115
v_max3_f32 v232, v232, v122, v123
v_max3_f32 v234, v234, v130, v131
m16 v[20:23],a[228:231],v[160:163],v[20:23]
s_mov_b32 s28, 163840
v_max3_f32 v230, v230, v116, v117
v_max3_f32 v232, v232, v124, v125
v_max3_f32 v234, v234, v132, v133
m16 v[52:55],a[228:231],v[164:167],v[52:55]
v_max3_f32 v230, v230, v118, v119
v_max3_f32 v232, v232, v126, v127
v_max3_f32 v234, v234, v134, v135
m16 v[84:87],a[228:231],v[168:171],v[84:87]
r128 a[204:207],v3,9024
v_mov_b32 v231, v230
v_mov_b32 v233, v232
v_mov_b32 v235, v234
m16 v[24:27],a[232:235],v[160:163],v[24:27]
v_permlane16_swap_b32 v230, v231
v_permlane16_swap_b32 v232, v233
v_permlane16_swap_b32 v234, v235
m16 v[56:59],a[232:235],v[164:167],v[56:59]
buffer_load_dwordx4 v14, s[20:23], s28 offen offset:0 nt lds
v_max_f32 v230, v230, v231
v_max_f32 v232, v232, v233
v_max_f32 v234, v234, v235
m16 v[88:91],a[232:235],v[168:171],v[88:91]
r128 a[208:211],v3,8576
v_mov_b32 v231, v230
v_mov_b32 v233, v232
v_mov_b32 v235, v234
v_permlane32_swap_b32 v230, v231
m16 v[28:31],a[236:239],v[160:163],v[28:31]
v_permlane32_swap_b32 v232, v233
v_permlane32_swap_b32 v234, v235
v_max_f32 v230, v230, v231
m16 v[60:63],a[236:239],v[164:167],v[60:63]
r128 a[212:215],v3,9088
v_max_f32 v232, v232, v233
v_max_f32 v234, v234, v235
v_sub_f32 v184, 0, v230
m16 v[92:95],a[236:239],v[168:171],v[92:95]
s_add_u32 m0, s100, 85280
v_sub_f32 v188, 0, v232
v_sub_f32 v192, 0, v234
v_sub_f32 v185, 0, v230
s_waitcnt lgkmcnt(6)
m16 v[32:35],a[240:243],v[160:163],v[32:35]
v_sub_f32 v189, 0, v232
v_sub_f32 v193, 0, v234
v_sub_f32 v186, 0, v230
m16 v[64:67],a[240:243],v[164:167],v[64:67]
r128 a[216:219],v3,8640
v_sub_f32 v190, 0, v232
v_sub_f32 v194, 0, v234
v_sub_f32 v187, 0, v230
m16 v[96:99],a[240:243],v[168:171],v[96:99]
v_sub_f32 v191, 0, v232
v_sub_f32 v195, 0, v234
v_sub_f32 v112, v112, v230
m16 v[36:39],a[244:247],v[160:163],v[36:39]
s_mov_b32 s28, 163840
v_sub_f32 v120, v120, v232
v_sub_f32 v128, v128, v234
v_sub_f32 v113, v113, v230
v_sub_f32 v121, v121, v232
m16 v[68:71],a[244:247],v[164:167],v[68:71]
r128 a[220:223],v3,9152
v_sub_f32 v129, v129, v234
v_sub_f32 v114, v114, v230
v_sub_f32 v122, v122, v232
m16 v[100:103],a[244:247],v[168:171],v[100:103]
v_sub_f32 v130, v130, v234
v_sub_f32 v115, v115, v230
v_sub_f32 v123, v123, v232
m16 v[40:43],a[248:251],v[160:163],v[40:43]
v_sub_f32 v131, v131, v234
v_sub_f32 v116, v116, v230
v_sub_f32 v124, v124, v232
m16 v[72:75],a[248:251],v[164:167],v[72:75]
v_exp_f32 v158, v158
buffer_load_dwordx4 v14, s[20:23], s28 offen offset:256 nt lds
v_sub_f32 v132, v132, v234
v_sub_f32 v117, v117, v230
v_sub_f32 v125, v125, v232
m16 v[104:107],a[248:251],v[168:171],v[104:107]
v_sub_f32 v133, v133, v234
v_sub_f32 v118, v118, v230
v_sub_f32 v126, v126, v232
m16 v[44:47],a[252:255],v[160:163],v[44:47]
v_exp_f32 v159, v159
v_sub_f32 v134, v134, v234
v_sub_f32 v119, v119, v230
v_sub_f32 v127, v127, v232
m16 v[76:79],a[252:255],v[164:167],v[76:79]
v_sub_f32 v135, v135, v234
cvt v181,v154,v155
cvt v182,v156,v157
m16 v[108:111],a[252:255],v[168:171],v[108:111]
cvt v183,v158,v159
s_waitcnt lgkmcnt(0)
m16 v[136:139],a[192:195],a[48:51],v[184:187]
v_exp_f32 v112, v112
rtr a[224:225],v2,42240
m16 v[144:147],a[192:195],a[64:67],v[188:191]
rtr a[226:227],v2,42752
v_exp_f32 v113, v113
m16 v[152:155],a[192:195],a[80:83],v[192:195]
rtr a[228:229],v2,42272
v_exp_f32 v114, v114
m16 v[140:143],a[196:199],a[48:51],v[184:187]
v_exp_f32 v115, v115
cvt v160,v112,v113
m16 v[148:151],a[196:199],a[64:67],v[188:191]
rtr a[230:231],v2,42784
v_exp_f32 v116, v116
m16 v[156:159],a[196:199],a[80:83],v[192:195]
rtr a[232:233],v2,42304
v_exp_f32 v117, v117
m16 v[136:139],a[200:203],a[52:55],v[136:139]
rtr a[234:235],v2,42816
v_exp_f32 v118, v118
m16 v[144:147],a[200:203],a[68:71],v[144:147]
v_exp_f32 v119, v119
cvt v161,v114,v115
m16 v[152:155],a[200:203],a[84:87],v[152:155]
rtr a[236:237],v2,42336
v_exp_f32 v120, v120
m16 v[140:143],a[204:207],a[52:55],v[140:143]
rtr a[238:239],v2,42848
v_exp_f32 v121, v121
m16 v[148:151],a[204:207],a[68:71],v[148:151]
v_exp_f32 v122, v122
cvt v162,v116,v117
m16 v[156:159],a[204:207],a[84:87],v[156:159]
rtr a[240:241],v2,42368
v_exp_f32 v123, v123
m16 v[136:139],a[208:211],a[56:59],v[136:139]
rtr a[242:243],v2,42880
v_exp_f32 v124, v124
m16 v[144:147],a[208:211],a[72:75],v[144:147]
rtr a[244:245],v2,42400
v_exp_f32 v125, v125
m16 v[152:155],a[208:211],a[88:91],v[152:155]
v_exp_f32 v126, v126
cvt v163,v118,v119
m16 v[140:143],a[212:215],a[56:59],v[140:143]
rtr a[246:247],v2,42912
v_exp_f32 v127, v127
m16 v[148:151],a[212:215],a[72:75],v[148:151]
rtr a[248:249],v2,42432
v_exp_f32 v128, v128
m16 v[156:159],a[212:215],a[88:91],v[156:159]
rtr a[250:251],v2,42944
v_exp_f32 v129, v129
m16 v[136:139],a[216:219],a[60:63],v[136:139]
v_exp_f32 v130, v130
cvt v164,v120,v121
m16 v[144:147],a[216:219],a[76:79],v[144:147]
rtr a[252:253],v2,42464
v_exp_f32 v131, v131
m16 v[152:155],a[216:219],a[92:95],v[152:155]
rtr a[254:255],v2,42976
v_exp_f32 v132, v132
m16 v[140:143],a[220:223],a[60:63],v[140:143]
v_exp_f32 v133, v133
cvt v165,v122,v123
m16 v[148:151],a[220:223],a[76:79],v[148:151]
v_exp_f32 v134, v134
cvt v166,v124,v125
m16 v[156:159],a[220:223],a[92:95],v[156:159]
v_exp_f32 v135, v135
cvt v167,v126,v127
m16 v[196:199],v[220:223],v[172:175],v[196:199]
cvt v168,v128,v129
cvt v169,v130,v131
cvt v170,v132,v133
m16 v[200:203],v[220:223],v[176:179],v[200:203]
cvt v171,v134,v135
m16 v[204:207],v[220:223],v[180:183],v[204:207]
s_waitcnt lgkmcnt(8)
m16 v[16:19],a[224:227],v[172:175],v[16:19]
s_waitcnt vmcnt(6) lgkmcnt(0)
s_barrier
m16 v[48:51],a[224:227],v[176:179],v[48:51]
m16 v[80:83],a[224:227],v[180:183],v[80:83]
r128 a[192:195],v3,33792
s_add_u32 m0, s100, 92928
m16 v[20:23],a[228:231],v[172:175],v[20:23]
v_rcp_f32 v230, v196
m16 v[52:55],a[228:231],v[176:179],v[52:55]
r128 a[196:199],v3,34304
v_rcp_f32 v232, v200
m16 v[84:87],a[228:231],v[180:183],v[84:87]
v_rcp_f32 v234, v204
v_add_f32 v236, v196, v200
m16 v[24:27],a[232:235],v[172:175],v[24:27]
r128 a[200:203],v3,33856
v_add_f32 v236, v236, v204
v_mov_b32 v231, v230
m16 v[56:59],a[232:235],v[176:179],v[56:59]
v_mov_b32 v233, v232
v_mov_b32 v235, v234
v_mov_b32 v237, 0x53800000
m16 v[88:91],a[232:235],v[180:183],v[88:91]
r128 a[204:207],v3,34368
s_mov_b32 s28, 172032
v_cmp_nle_f32 vcc, v236, v237
m16 v[28:31],a[236:239],v[172:175],v[28:31]
v_mov_b32 v236, 163824
s_nop 0
v_cndmask_b32 v237, 0, 1, vcc
m16 v[60:63],a[236:239],v[176:179],v[60:63]
r128 a[208:211],v3,33920
ds_or_b32 v236, v237
v_mul_f32 v16, v16, v230
m16 v[92:95],a[236:239],v[180:183],v[92:95]
v_mul_f32 v17, v17, v230
v_mul_f32 v18, v18, v230
v_mul_f32 v19, v19, v230
m16 v[32:35],a[240:243],v[172:175],v[32:35]
r128 a[212:215],v3,34432
v_mul_f32 v20, v20, v230
v_mul_f32 v21, v21, v230
m16 v[64:67],a[240:243],v[176:179],v[64:67]
v_mul_f32 v22, v22, v230
v_mul_f32 v23, v23, v230
s_mov_b32 s29, 0
m16 v[96:99],a[240:243],v[180:183],v[96:99]
cvt v238,v16,v17
r128 a[216:219],v3,33984
cvt v239,v18,v19
m16 v[36:39],a[244:247],v[172:175],v[36:39]
cvt v240,v20,v21
cvt v241,v22,v23
buffer_store_dwordx4 v[238:241], v5, s[24:27], s29 offen offset:0 sc1
m16 v[68:71],a[244:247],v[176:179],v[68:71]
v_mul_f32 v48, v48, v232
v_mul_f32 v49, v49, v232
v_mul_f32 v50, v50, v232
v_mul_f32 v51, v51, v232
m16 v[100:103],a[244:247],v[180:183],v[100:103]
buffer_load_dwordx4 v14, s[20:23], s28 offen offset:0 nt lds
r128 a[220:223],v3,34496
v_mul_f32 v52, v52, v232
v_mul_f32 v53, v53, v232
v_mul_f32 v54, v54, v232
m16 v[40:43],a[248:251],v[172:175],v[40:43]
v_mul_f32 v55, v55, v232
cvt v242,v48,v49
cvt v243,v50,v51
cvt v244,v52,v53
m16 v[72:75],a[248:251],v[176:179],v[72:75]
cvt v245,v54,v55
buffer_store_dwordx4 v[242:245], v5, s[24:27], s29 offen offset:1024 sc1
v_mul_f32 v80, v80, v234
v_mul_f32 v81, v81, v234
m16 v[104:107],a[248:251],v[180:183],v[104:107]
v_mul_f32 v82, v82, v234
v_mul_f32 v83, v83, v234
v_mul_f32 v84, v84, v234
m16 v[44:47],a[252:255],v[172:175],v[44:47]
v_mul_f32 v85, v85, v234
v_mul_f32 v86, v86, v234
v_mul_f32 v87, v87, v234
cvt v246,v80,v81
m16 v[76:79],a[252:255],v[176:179],v[76:79]
cvt v247,v82,v83
cvt v248,v84,v85
cvt v249,v86,v87
m16 v[108:111],a[252:255],v[180:183],v[108:111]
buffer_store_dwordx4 v[246:249], v5, s[24:27], s29 offen offset:2048 sc1
s_waitcnt lgkmcnt(0)
m16 v[112:115],a[192:195],a[48:51],v[184:187]
v_mul_f32 v24, v24, v230
v_mul_f32 v25, v25, v230
v_mul_f32 v26, v26, v230
m16 v[120:123],a[192:195],a[64:67],v[188:191]
v_mul_f32 v27, v27, v230
v_mul_f32 v28, v28, v230
rtr a[224:225],v4,0
m16 v[128:131],a[192:195],a[80:83],v[192:195]
v_exp_f32 v136, v136
s_add_u32 m0, s100, 93728
v_mul_f32 v29, v29, v230
v_mul_f32 v30, v30, v230
v_mul_f32 v31, v31, v230
m16 v[116:119],a[196:199],a[48:51],v[184:187]
rtr a[226:227],v4,512
s_mov_b32 s29, 11264
cvt v250,v24,v25
m16 v[124:127],a[196:199],a[64:67],v[188:191]
v_exp_f32 v137, v137
rtr a[228:229],v4,32
cvt v251,v26,v27
cvt v252,v28,v29
cvt v253,v30,v31
m16 v[132:135],a[196:199],a[80:83],v[192:195]
ds_write_b128 v209, a[160:163] offset:50688
buffer_store_dwordx4 v[250:253], v5, s[24:27], s29 offen offset:0 sc1
v_mul_f32 v56, v56, v232
v_mul_f32 v57, v57, v232
m16 v[112:115],a[200:203],a[52:55],v[112:115]
v_exp_f32 v138, v138
rtr a[230:231],v4,544
s_mov_b32 s28, 172032
v_mul_f32 v58, v58, v232
v_mul_f32 v59, v59, v232
v_mul_f32 v60, v60, v232
m16 v[120:123],a[200:203],a[68:71],v[120:123]
rtr a[232:233],v4,64
v_mul_f32 v61, v61, v232
v_mul_f32 v62, v62, v232
m16 v[128:131],a[200:203],a[84:87],v[128:131]
v_exp_f32 v139, v139
rtr a[234:235],v4,576
v_mul_f32 v63, v63, v232
cvt v238,v56,v57
cvt v239,v58,v59
m16 v[116:119],a[204:207],a[52:55],v[116:119]
cvt v240,v60,v61
cvt v241,v62,v63
buffer_store_dwordx4 v[238:241], v5, s[24:27], s29 offen offset:1024 sc1
m16 v[124:127],a[204:207],a[68:71],v[124:127]
v_exp_f32 v140, v140
rtr a[236:237],v4,96
buffer_load_dwordx4 v14, s[20:23], s28 offen offset:256 nt lds
v_mul_f32 v88, v88, v234
v_mul_f32 v89, v89, v234
m16 v[132:135],a[204:207],a[84:87],v[132:135]
rtr a[238:239],v4,608
v_mul_f32 v90, v90, v234
v_mul_f32 v91, v91, v234
v_mul_f32 v92, v92, v234
m16 v[112:115],a[208:211],a[56:59],v[112:115]
v_exp_f32 v141, v141
v_mul_f32 v93, v93, v234
v_mul_f32 v94, v94, v234
v_mul_f32 v95, v95, v234
m16 v[120:123],a[208:211],a[72:75],v[120:123]
rtr a[240:241],v4,128
cvt v242,v88,v89
cvt v243,v90,v91
cvt v244,v92,v93
m16 v[128:131],a[208:211],a[88:91],v[128:131]
v_exp_f32 v142, v142
rtr a[242:243],v4,640
s_add_u32 m0, s100, 101376
cvt v245,v94,v95
buffer_store_dwordx4 v[242:245], v5, s[24:27], s29 offen offset:2048 sc1
m16 v[116:119],a[212:215],a[56:59],v[116:119]
rtr a[244:245],v4,160
ds_write_b128 v209, a[164:167] offset:51744
v_mul_f32 v32, v32, v230
v_mul_f32 v33, v33, v230
v_mul_f32 v34, v34, v230
m16 v[124:127],a[212:215],a[72:75],v[124:127]
v_exp_f32 v143, v143
v_mul_f32 v35, v35, v230
v_mul_f32 v36, v36, v230
v_mul_f32 v37, v37, v230
m16 v[132:135],a[212:215],a[88:91],v[132:135]
rtr a[246:247],v4,672
v_mul_f32 v38, v38, v230
v_mul_f32 v39, v39, v230
s_mov_b32 s29, 22528
m16 v[112:115],a[216:219],a[60:63],v[112:115]
v_exp_f32 v144, v144
rtr a[248:249],v4,192
s_mov_b32 s28, 180224
cvt v246,v32,v33
cvt v247,v34,v35
m16 v[120:123],a[216:219],a[76:79],v[120:123]
rtr a[250:251],v4,704
cvt v248,v36,v37
cvt v249,v38,v39
buffer_store_dwordx4 v[246:249], v5, s[24:27], s29 offen offset:0 sc1
m16 v[128:131],a[216:219],a[92:95],v[128:131]
v_exp_f32 v145, v145
v_mul_f32 v64, v64, v232
v_mul_f32 v65, v65, v232
v_mul_f32 v66, v66, v232
m16 v[116:119],a[220:223],a[60:63],v[116:119]
rtr a[252:253],v4,224
v_mul_f32 v67, v67, v232
v_mul_f32 v68, v68, v232
m16 v[124:127],a[220:223],a[76:79],v[124:127]
v_exp_f32 v146, v146
rtr a[254:255],v4,736
buffer_load_dwordx4 v14, s[16:19], s28 offen offset:0 nt lds
v_mul_f32 v69, v69, v232
v_mul_f32 v70, v70, v232
v_mul_f32 v71, v71, v232
m16 v[132:135],a[220:223],a[92:95],v[132:135]
cvt v250,v64,v65
cvt v251,v66,v67
cvt v252,v68,v69
m16 v[196:199],v[220:223],v[160:163],0
v_exp_f32 v147, v147
r128 a[192:195],v3,42240
cvt v253,v70,v71
buffer_store_dwordx4 v[250:253], v5, s[24:27], s29 offen offset:1024 sc1
v_mul_f32 v96, v96, v234
m16 v[200:203],v[220:223],v[164:167],0
v_mul_f32 v97, v97, v234
v_mul_f32 v98, v98, v234
s_add_u32 m0, s100, 102176
m16 v[204:207],v[220:223],v[168:171],0
v_exp_f32 v148, v148
ds_write_b128 v209, a[168:171] offset:59136
r128 a[196:199],v3,42752
v_mul_f32 v99, v99, v234
v_mul_f32 v100, v100, v234
v_mul_f32 v101, v101, v234
s_waitcnt lgkmcnt(12)
m16 v[16:19],a[224:227],v[160:163],0
v_mul_f32 v102, v102, v234
v_mul_f32 v103, v103, v234
cvt v238,v96,v97
m16 v[48:51],a[224:227],v[164:167],0
v_exp_f32 v149, v149
cvt v239,v98,v99
cvt v240,v100,v101
cvt v241,v102,v103
m16 v[80:83],a[224:227],v[168:171],0
r128 a[200:203],v3,42304
buffer_store_dwordx4 v[238:241], v5, s[24:27], s29 offen offset:2048 sc1
v_mul_f32 v40, v40, v230
m16 v[20:23],a[228:231],v[160:163],0
v_exp_f32 v150, v150
s_mov_b32 s28, 180224
v_mul_f32 v41, v41, v230
v_mul_f32 v42, v42, v230
v_mul_f32 v43, v43, v230
m16 v[52:55],a[228:231],v[164:167],0
v_mul_f32 v44, v44, v230
v_mul_f32 v45, v45, v230
v_mul_f32 v46, v46, v230
m16 v[84:87],a[228:231],v[168:171],0
v_exp_f32 v151, v151
r128 a[204:207],v3,42816
v_mul_f32 v47, v47, v230
s_mov_b32 s29, 33792
m16 v[24:27],a[232:235],v[160:163],0
cvt v242,v40,v41
cvt v243,v42,v43
cvt v244,v44,v45
m16 v[56:59],a[232:235],v[164:167],0
v_exp_f32 v152, v152
buffer_load_dwordx4 v14, s[16:19], s28 offen offset:256 nt lds
cvt v245,v46,v47
buffer_store_dwordx4 v[242:245], v5, s[24:27], s29 offen offset:0 sc1
v_mul_f32 v72, v72, v232
m16 v[88:91],a[232:235],v[168:171],0
r128 a[208:211],v3,42368
v_mul_f32 v73, v73, v232
v_mul_f32 v74, v74, v232
v_mul_f32 v75, v75, v232
m16 v[28:31],a[236:239],v[160:163],0
v_exp_f32 v153, v153
v_mul_f32 v76, v76, v232
v_mul_f32 v77, v77, v232
m16 v[60:63],a[236:239],v[164:167],0
ds_write_b128 v209, a[172:175] offset:60192
r128 a[212:215],v3,42880
v_mul_f32 v78, v78, v232
v_mul_f32 v79, v79, v232
cvt v246,v72,v73
m16 v[92:95],a[236:239],v[168:171],0
v_exp_f32 v154, v154
s_add_u32 m0, s100, 109824
cvt v247,v74,v75
cvt v248,v76,v77
cvt v249,v78,v79
s_waitcnt lgkmcnt(8)
m16 v[32:35],a[240:243],v[160:163],0
buffer_store_dwordx4 v[246:249], v5, s[24:27], s29 offen offset:1024 sc1
v_mul_f32 v104, v104, v234
v_mul_f32 v105, v105, v234
m16 v[64:67],a[240:243],v[164:167],0
v_exp_f32 v155, v155
r128 a[216:219],v3,42432
v_mul_f32 v106, v106, v234
v_mul_f32 v107, v107, v234
m16 v[96:99],a[240:243],v[168:171],0
v_mul_f32 v108, v108, v234
v_mul_f32 v109, v109, v234
v_mul_f32 v110, v110, v234
m16 v[36:39],a[244:247],v[160:163],0
v_exp_f32 v156, v156
s_mov_b32 s28, 188416
v_mul_f32 v111, v111, v234
cvt v250,v104,v105
cvt v251,v106,v107
m16 v[68:71],a[244:247],v[164:167],0
r128 a[220:223],v3,42944
cvt v252,v108,v109
cvt v253,v110,v111
m16 v[100:103],a[244:247],v[168:171],0
v_exp_f32 v157, v157
buffer_store_dwordx4 v[250:253], v5, s[24:27], s29 offen offset:2048 sc1
m16 v[40:43],a[248:251],v[160:163],0
v_exp_f32 v158, v158
buffer_load_dwordx4 v14, s[16:19], s28 offen offset:0 nt lds
m16 v[72:75],a[248:251],v[164:167],0
v_exp_f32 v159, v159
cvt v172,v136,v137
m16 v[104:107],a[248:251],v[168:171],0
cvt v173,v138,v139
cvt v174,v140,v141
cvt v175,v142,v143
m16 v[44:47],a[252:255],v[160:163],0
cvt v176,v144,v145
cvt v177,v146,v147
cvt v178,v148,v149
m16 v[76:79],a[252:255],v[164:167],0
cvt v179,v150,v151
cvt v180,v152,v153
cvt v181,v154,v155
m16 v[108:111],a[252:255],v[168:171],0
cvt v182,v156,v157
cvt v183,v158,v159
s_waitcnt lgkmcnt(0)
m16 v[136:139],a[192:195],a[48:51],v[184:187]
v_exp_f32 v112, v112
m16 v[144:147],a[192:195],a[64:67],v[188:191]
rtr a[224:225],v4,8448
rtr a[226:227],v4,8960
m16 v[152:155],a[192:195],a[80:83],v[192:195]
v_exp_f32 v113, v113
m16 v[140:143],a[196:199],a[48:51],v[184:187]
rtr a[228:229],v4,8480
cvt v160,v112,v113
m16 v[148:151],a[196:199],a[64:67],v[188:191]
v_exp_f32 v114, v114
m16 v[156:159],a[196:199],a[80:83],v[192:195]
rtr a[230:231],v4,8992
rtr a[232:233],v4,8512
m16 v[136:139],a[200:203],a[52:55],v[136:139]
v_exp_f32 v115, v115
m16 v[144:147],a[200:203],a[68:71],v[144:147]
rtr a[234:235],v4,9024
cvt v161,v114,v115
m16 v[152:155],a[200:203],a[84:87],v[152:155]
v_exp_f32 v116, v116
m16 v[140:143],a[204:207],a[52:55],v[140:143]
rtr a[236:237],v4,8544
rtr a[238:239],v4,9056
m16 v[148:151],a[204:207],a[68:71],v[148:151]
v_exp_f32 v117, v117
m16 v[156:159],a[204:207],a[84:87],v[156:159]
rtr a[240:241],v4,8576
cvt v162,v116,v117
m16 v[136:139],a[208:211],a[56:59],v[136:139]
v_exp_f32 v118, v118
m16 v[144:147],a[208:211],a[72:75],v[144:147]
rtr a[242:243],v4,9088
rtr a[244:245],v4,8608
m16 v[152:155],a[208:211],a[88:91],v[152:155]
v_exp_f32 v119, v119
m16 v[140:143],a[212:215],a[56:59],v[140:143]
rtr a[246:247],v4,9120
cvt v163,v118,v119
m16 v[148:151],a[212:215],a[72:75],v[148:151]
v_exp_f32 v120, v120
m16 v[156:159],a[212:215],a[88:91],v[156:159]
rtr a[248:249],v4,8640
rtr a[250:251],v4,9152
m16 v[136:139],a[216:219],a[60:63],v[136:139]
v_exp_f32 v121, v121
m16 v[144:147],a[216:219],a[76:79],v[144:147]
rtr a[252:253],v4,8672
cvt v164,v120,v121
m16 v[152:155],a[216:219],a[92:95],v[152:155]
v_exp_f32 v122, v122
m16 v[140:143],a[220:223],a[60:63],v[140:143]
rtr a[254:255],v4,9184
m16 v[148:151],a[220:223],a[76:79],v[148:151]
v_exp_f32 v123, v123
m16 v[156:159],a[220:223],a[92:95],v[156:159]
v_exp_f32 v124, v124
m16 v[196:199],v[220:223],v[172:175],v[196:199]
v_exp_f32 v125, v125
m16 v[200:203],v[220:223],v[176:179],v[200:203]
v_exp_f32 v126, v126
m16 v[204:207],v[220:223],v[180:183],v[204:207]
cvt v165,v122,v123
s_waitcnt lgkmcnt(8)
m16 v[16:19],a[224:227],v[172:175],v[16:19]
s_waitcnt vmcnt(19) lgkmcnt(0)
s_barrier
m16 v[48:51],a[224:227],v[176:179],v[48:51]
v_exp_f32 v127, v127
m16 v[80:83],a[224:227],v[180:183],v[80:83]
r128 a[192:195],v1,0
s_add_u32 m0, s100, 110624
m16 v[20:23],a[228:231],v[172:175],v[20:23]
v_exp_f32 v128, v128
m16 v[52:55],a[228:231],v[176:179],v[52:55]
r128 a[196:199],v1,512
cvt v166,v124,v125
m16 v[84:87],a[228:231],v[180:183],v[84:87]
s_mov_b32 s28, 188416
cvt v167,v126,v127
m16 v[24:27],a[232:235],v[172:175],v[24:27]
r128 a[200:203],v1,64
m16 v[56:59],a[232:235],v[176:179],v[56:59]
v_exp_f32 v129, v129
m16 v[88:91],a[232:235],v[180:183],v[88:91]
r128 a[204:207],v1,576
buffer_load_dwordx4 v14, s[16:19], s28 offen offset:256 nt lds
m16 v[28:31],a[236:239],v[172:175],v[28:31]
v_exp_f32 v130, v130
m16 v[60:63],a[236:239],v[176:179],v[60:63]
r128 a[208:211],v1,128
cvt v168,v128,v129
m16 v[92:95],a[236:239],v[180:183],v[92:95]
v_exp_f32 v131, v131
m16 v[32:35],a[240:243],v[172:175],v[32:35]
r128 a[212:215],v1,640
s_add_u32 m0, s100, 0
m16 v[64:67],a[240:243],v[176:179],v[64:67]
v_exp_f32 v132, v132
m16 v[96:99],a[240:243],v[180:183],v[96:99]
r128 a[216:219],v1,192
cvt v169,v130,v131
m16 v[36:39],a[244:247],v[172:175],v[36:39]
v_exp_f32 v133, v133
m16 v[68:71],a[244:247],v[176:179],v[68:71]
s_mov_b32 s28, 196608
r128 a[220:223],v1,704
m16 v[100:103],a[244:247],v[180:183],v[100:103]
v_exp_f32 v134, v134
m16 v[40:43],a[248:251],v[172:175],v[40:43]
buffer_load_dwordx4 v14, s[16:19], s28 offen offset:0 nt lds
cvt v170,v132,v133
m16 v[72:75],a[248:251],v[176:179],v[72:75]
v_exp_f32 v135, v135
m16 v[104:107],a[248:251],v[180:183],v[104:107]
cvt v171,v134,v135
m16 v[44:47],a[252:255],v[172:175],v[44:47]
m16 v[76:79],a[252:255],v[176:179],v[76:79]
m16 v[108:111],a[252:255],v[180:183],v[108:111]
s_waitcnt lgkmcnt(0)
m16 v[112:115],a[192:195],a[48:51],v[184:187]
v_exp_f32 v136, v136
rtr a[224:225],v4,33792
m16 v[120:123],a[192:195],a[64:67],v[188:191]
s_add_u32 m0, s100, 800
rtr a[226:227],v4,34304
m16 v[128:131],a[192:195],a[80:83],v[192:195]
v_exp_f32 v137, v137
m16 v[116:119],a[196:199],a[48:51],v[184:187]
rtr a[228:229],v4,33824
cvt v172,v136,v137
m16 v[124:127],a[196:199],a[64:67],v[188:191]
ds_write_b128 v15, a[176:179] offset:33792
rtr a[230:231],v4,34336
m16 v[132:135],a[196:199],a[80:83],v[192:195]
v_exp_f32 v138, v138
m16 v[112:115],a[200:203],a[52:55],v[112:115]
s_mov_b32 s28, 196608
rtr a[232:233],v4,33856
m16 v[120:123],a[200:203],a[68:71],v[120:123]
v_exp_f32 v139, v139
m16 v[128:131],a[200:203],a[84:87],v[128:131]
rtr a[234:235],v4,34368
rtr a[236:237],v4,33888
m16 v[116:119],a[204:207],a[52:55],v[116:119]
v_exp_f32 v140, v140
m16 v[124:127],a[204:207],a[68:71],v[124:127]
buffer_load_dwordx4 v14, s[16:19], s28 offen offset:256 nt lds
rtr a[238:239],v4,34400
m16 v[132:135],a[204:207],a[84:87],v[132:135]
v_exp_f32 v141, v141
m16 v[112:115],a[208:211],a[56:59],v[112:115]
rtr a[240:241],v4,33920
rtr a[242:243],v4,34432
m16 v[120:123],a[208:211],a[72:75],v[120:123]
v_exp_f32 v142, v142
m16 v[128:131],a[208:211],a[88:91],v[128:131]
s_add_u32 m0, s100, 8448
rtr a[244:245],v4,33952
m16 v[116:119],a[212:215],a[56:59],v[116:119]
ds_write_b128 v15, a[180:183] offset:34848
rtr a[246:247],v4,34464
m16 v[124:127],a[212:215],a[72:75],v[124:127]
v_exp_f32 v143, v143
m16 v[132:135],a[212:215],a[88:91],v[132:135]
v_exp_f32 v144, v144
m16 v[112:115],a[216:219],a[60:63],v[112:115]
rtr a[248:249],v4,33984
s_mov_b32 s28, 204800
m16 v[120:123],a[216:219],a[76:79],v[120:123]
rtr a[250:251],v4,34496
rtr a[252:253],v4,34016
m16 v[128:131],a[216:219],a[92:95],v[128:131]
v_exp_f32 v145, v145
m16 v[116:119],a[220:223],a[60:63],v[116:119]
v_exp_f32 v146, v146
m16 v[124:127],a[220:223],a[76:79],v[124:127]
rtr a[254:255],v4,34528
buffer_load_dwordx4 v14, s[16:19], s28 offen offset:0 nt lds
m16 v[132:135],a[220:223],a[92:95],v[132:135]
v_exp_f32 v147, v147
m16 v[196:199],v[220:223],v[160:163],v[196:199]
r128 a[192:195],v1,8448
s_add_u32 m0, s100, 9248
m16 v[200:203],v[220:223],v[164:167],v[200:203]
v_exp_f32 v148, v148
m16 v[204:207],v[220:223],v[168:171],v[204:207]
ds_write_b128 v15, a[184:187] offset:42240
r128 a[196:199],v1,8960
s_waitcnt lgkmcnt(12)
m16 v[16:19],a[224:227],v[160:163],v[16:19]
v_exp_f32 v149, v149
m16 v[48:51],a[224:227],v[164:167],v[48:51]
r128 a[200:203],v1,8512
s_mov_b32 s28, 204800
m16 v[80:83],a[224:227],v[168:171],v[80:83]
v_exp_f32 v150, v150
m16 v[20:23],a[228:231],v[160:163],v[20:23]
v_exp_f32 v151, v151
m16 v[52:55],a[228:231],v[164:167],v[52:55]
r128 a[204:207],v1,9024
cvt v173,v138,v139
m16 v[84:87],a[228:231],v[168:171],v[84:87]
v_exp_f32 v152, v152
m16 v[24:27],a[232:235],v[160:163],v[24:27]
buffer_load_dwordx4 v14, s[16:19], s28 offen offset:256 nt lds
cvt v174,v140,v141
m16 v[56:59],a[232:235],v[164:167],v[56:59]
r128 a[208:211],v1,8576
cvt v175,v142,v143
m16 v[88:91],a[232:235],v[168:171],v[88:91]
v_exp_f32 v153, v153
m16 v[28:31],a[236:239],v[160:163],v[28:31]
ds_write_b128 v15, a[188:191] offset:43296
r128 a[212:215],v1,9088
m16 v[60:63],a[236:239],v[164:167],v[60:63]
v_exp_f32 v154, v154
m16 v[92:95],a[236:239],v[168:171],v[92:95]
s_add_u32 m0, s100, 16896
s_waitcnt lgkmcnt(8)
m16 v[32:35],a[240:243],v[160:163],v[32:35]
v_exp_f32 v155, v155
m16 v[64:67],a[240:243],v[164:167],v[64:67]
r128 a[216:219],v1,8640
s_mov_b32 s28, 196608
m16 v[96:99],a[240:243],v[168:171],v[96:99]
v_exp_f32 v156, v156
m16 v[36:39],a[244:247],v[160:163],v[36:39]
r128 a[220:223],v1,9152
cvt v176,v144,v145
m16 v[68:71],a[244:247],v[164:167],v[68:71]
v_exp_f32 v157, v157
m16 v[100:103],a[244:247],v[168:171],v[100:103]
v_exp_f32 v158, v158
m16 v[40:43],a[248:251],v[160:163],v[40:43]
buffer_load_dwordx4 v14, s[20:23], s28 offen offset:0 nt lds
cvt v177,v146,v147
m16 v[72:75],a[248:251],v[164:167],v[72:75]
v_exp_f32 v159, v159
m16 v[104:107],a[248:251],v[168:171],v[104:107]
cvt v178,v148,v149
cvt v179,v150,v151
m16 v[44:47],a[252:255],v[160:163],v[44:47]
cvt v180,v152,v153
cvt v181,v154,v155
m16 v[76:79],a[252:255],v[164:167],v[76:79]
cvt v182,v156,v157
cvt v183,v158,v159
m16 v[108:111],a[252:255],v[168:171],v[108:111]
s_waitcnt lgkmcnt(0)
m16 v[136:139],a[192:195],a[48:51],v[184:187]
v_exp_f32 v112, v112
m16 v[144:147],a[192:195],a[64:67],v[188:191]
rtr a[224:225],v4,42240
rtr a[226:227],v4,42752
m16 v[152:155],a[192:195],a[80:83],v[192:195]
v_exp_f32 v113, v113
m16 v[140:143],a[196:199],a[48:51],v[184:187]
rtr a[228:229],v4,42272
cvt v160,v112,v113
m16 v[148:151],a[196:199],a[64:67],v[188:191]
v_exp_f32 v114, v114
m16 v[156:159],a[196:199],a[80:83],v[192:195]
rtr a[230:231],v4,42784
rtr a[232:233],v4,42304
m16 v[136:139],a[200:203],a[52:55],v[136:139]
v_exp_f32 v115, v115
m16 v[144:147],a[200:203],a[68:71],v[144:147]
rtr a[234:235],v4,42816
cvt v161,v114,v115
m16 v[152:155],a[200:203],a[84:87],v[152:155]
v_exp_f32 v116, v116
m16 v[140:143],a[204:207],a[52:55],v[140:143]
rtr a[236:237],v4,42336
rtr a[238:239],v4,42848
m16 v[148:151],a[204:207],a[68:71],v[148:151]
v_exp_f32 v117, v117
m16 v[156:159],a[204:207],a[84:87],v[156:159]
rtr a[240:241],v4,42368
cvt v162,v116,v117
m16 v[136:139],a[208:211],a[56:59],v[136:139]
v_exp_f32 v118, v118
m16 v[144:147],a[208:211],a[72:75],v[144:147]
rtr a[242:243],v4,42880
rtr a[244:245],v4,42400
m16 v[152:155],a[208:211],a[88:91],v[152:155]
v_exp_f32 v119, v119
m16 v[140:143],a[212:215],a[56:59],v[140:143]
rtr a[246:247],v4,42912
cvt v163,v118,v119
m16 v[148:151],a[212:215],a[72:75],v[148:151]
v_exp_f32 v120, v120
m16 v[156:159],a[212:215],a[88:91],v[156:159]
rtr a[248:249],v4,42432
rtr a[250:251],v4,42944
m16 v[136:139],a[216:219],a[60:63],v[136:139]
v_exp_f32 v121, v121
m16 v[144:147],a[216:219],a[76:79],v[144:147]
rtr a[252:253],v4,42464
cvt v164,v120,v121
m16 v[152:155],a[216:219],a[92:95],v[152:155]
v_exp_f32 v122, v122
m16 v[140:143],a[220:223],a[60:63],v[140:143]
rtr a[254:255],v4,42976
m16 v[148:151],a[220:223],a[76:79],v[148:151]
v_exp_f32 v123, v123
m16 v[156:159],a[220:223],a[92:95],v[156:159]
v_exp_f32 v124, v124
m16 v[196:199],v[220:223],v[172:175],v[196:199]
v_exp_f32 v125, v125
m16 v[200:203],v[220:223],v[176:179],v[200:203]
v_exp_f32 v126, v126
m16 v[204:207],v[220:223],v[180:183],v[204:207]
cvt v165,v122,v123
s_waitcnt lgkmcnt(8)
m16 v[16:19],a[224:227],v[172:175],v[16:19]
s_waitcnt vmcnt(5) lgkmcnt(0)
s_barrier
m16 v[48:51],a[224:227],v[176:179],v[48:51]
v_exp_f32 v127, v127
m16 v[80:83],a[224:227],v[180:183],v[80:83]
r128 a[192:195],v1,33792
s_add_u32 m0, s100, 17696
m16 v[20:23],a[228:231],v[172:175],v[20:23]
v_exp_f32 v128, v128
m16 v[52:55],a[228:231],v[176:179],v[52:55]
r128 a[196:199],v1,34304
cvt v166,v124,v125
m16 v[84:87],a[228:231],v[180:183],v[84:87]
s_mov_b32 s28, 196608
cvt v167,v126,v127
m16 v[24:27],a[232:235],v[172:175],v[24:27]
r128 a[200:203],v1,33856
m16 v[56:59],a[232:235],v[176:179],v[56:59]
v_exp_f32 v129, v129
m16 v[88:91],a[232:235],v[180:183],v[88:91]
r128 a[204:207],v1,34368
buffer_load_dwordx4 v14, s[20:23], s28 offen offset:256 nt lds
m16 v[28:31],a[236:239],v[172:175],v[28:31]
v_exp_f32 v130, v130
m16 v[60:63],a[236:239],v[176:179],v[60:63]
r128 a[208:211],v1,33920
cvt v168,v128,v129
m16 v[92:95],a[236:239],v[180:183],v[92:95]
v_exp_f32 v131, v131
m16 v[32:35],a[240:243],v[172:175],v[32:35]
r128 a[212:215],v1,34432
s_add_u32 m0, s100, 25344
m16 v[64:67],a[240:243],v[176:179],v[64:67]
v_exp_f32 v132, v132
m16 v[96:99],a[240:243],v[180:183],v[96:99]
r128 a[216:219],v1,33984
cvt v169,v130,v131
m16 v[36:39],a[244:247],v[172:175],v[36:39]
v_exp_f32 v133, v133
m16 v[68:71],a[244:247],v[176:179],v[68:71]
s_mov_b32 s28, 204800
r128 a[220:223],v1,34496
m16 v[100:103],a[244:247],v[180:183],v[100:103]
v_exp_f32 v134, v134
m16 v[40:43],a[248:251],v[172:175],v[40:43]
buffer_load_dwordx4 v14, s[20:23], s28 offen offset:0 nt lds
cvt v170,v132,v133
m16 v[72:75],a[248:251],v[176:179],v[72:75]
v_exp_f32 v135, v135
m16 v[104:107],a[248:251],v[180:183],v[104:107]
cvt v171,v134,v135
m16 v[44:47],a[252:255],v[172:175],v[44:47]
m16 v[76:79],a[252:255],v[176:179],v[76:79]
m16 v[108:111],a[252:255],v[180:183],v[108:111]
s_waitcnt lgkmcnt(0)
m16 v[112:115],a[192:195],a[48:51],v[184:187]
v_exp_f32 v136, v136
m16 v[120:123],a[192:195],a[64:67],v[188:191]
rtr a[224:225],v2,0
s_add_u32 m0, s100, 26144
m16 v[128:131],a[192:195],a[80:83],v[192:195]
rtr a[226:227],v2,512
rtr a[228:229],v2,32
m16 v[116:119],a[196:199],a[48:51],v[184:187]
v_exp_f32 v137, v137
m16 v[124:127],a[196:199],a[64:67],v[188:191]
v_exp_f32 v138, v138
m16 v[132:135],a[196:199],a[80:83],v[192:195]
rtr a[230:231],v2,544
s_mov_b32 s28, 204800
m16 v[112:115],a[200:203],a[52:55],v[112:115]
rtr a[232:233],v2,64
rtr a[234:235],v2,576
m16 v[120:123],a[200:203],a[68:71],v[120:123]
v_exp_f32 v139, v139
m16 v[128:131],a[200:203],a[84:87],v[128:131]
v_exp_f32 v140, v140
m16 v[116:119],a[204:207],a[52:55],v[116:119]
rtr a[236:237],v2,96
buffer_load_dwordx4 v14, s[20:23], s28 offen offset:256 nt lds
m16 v[124:127],a[204:207],a[68:71],v[124:127]
rtr a[238:239],v2,608
cvt v172,v136,v137
m16 v[132:135],a[204:207],a[84:87],v[132:135]
v_exp_f32 v141, v141
m16 v[112:115],a[208:211],a[56:59],v[112:115]
rtr a[240:241],v2,128
rtr a[242:243],v2,640
m16 v[120:123],a[208:211],a[72:75],v[120:123]
v_exp_f32 v142, v142
m16 v[128:131],a[208:211],a[88:91],v[128:131]
s_add_u32 m0, s100, 50688
rtr a[244:245],v2,160
m16 v[116:119],a[212:215],a[56:59],v[116:119]
v_exp_f32 v143, v143
m16 v[124:127],a[212:215],a[72:75],v[124:127]
rtr a[246:247],v2,672
rtr a[248:249],v2,192
m16 v[132:135],a[212:215],a[88:91],v[132:135]
v_exp_f32 v144, v144
m16 v[112:115],a[216:219],a[60:63],v[112:115]
s_mov_b32 s28, 212992
rtr a[250:251],v2,704
m16 v[120:123],a[216:219],a[76:79],v[120:123]
v_exp_f32 v145, v145
m16 v[128:131],a[216:219],a[92:95],v[128:131]
rtr a[252:253],v2,224
rtr a[254:255],v2,736
m16 v[116:119],a[220:223],a[60:63],v[116:119]
v_exp_f32 v146, v146
m16 v[124:127],a[220:223],a[76:79],v[124:127]
buffer_load_dwordx4 v14, s[20:23], s28 offen offset:0 nt lds
cvt v173,v138,v139
m16 v[132:135],a[220:223],a[92:95],v[132:135]
v_exp_f32 v147, v147
m16 v[196:199],v[220:223],v[160:163],v[196:199]
r128 a[192:195],v1,42240
s_add_u32 m0, s100, 51488
m16 v[200:203],v[220:223],v[164:167],v[200:203]
v_exp_f32 v148, v148
m16 v[204:207],v[220:223],v[168:171],v[204:207]
r128 a[196:199],v1,42752
s_waitcnt lgkmcnt(10)
m16 v[16:19],a[224:227],v[160:163],v[16:19]
v_exp_f32 v149, v149
m16 v[48:51],a[224:227],v[164:167],v[48:51]
r128 a[200:203],v1,42304
s_mov_b32 s28, 212992
m16 v[80:83],a[224:227],v[168:171],v[80:83]
v_exp_f32 v150, v150
m16 v[20:23],a[228:231],v[160:163],v[20:23]
v_exp_f32 v151, v151
m16 v[52:55],a[228:231],v[164:167],v[52:55]
r128 a[204:207],v1,42816
cvt v174,v140,v141
m16 v[84:87],a[228:231],v[168:171],v[84:87]
v_exp_f32 v152, v152
m16 v[24:27],a[232:235],v[160:163],v[24:27]
buffer_load_dwordx4 v14, s[20:23], s28 offen offset:256 nt lds
cvt v175,v142,v143
m16 v[56:59],a[232:235],v[164:167],v[56:59]
r128 a[208:211],v1,42368
cvt v176,v144,v145
m16 v[88:91],a[232:235],v[168:171],v[88:91]
v_exp_f32 v153, v153
m16 v[28:31],a[236:239],v[160:163],v[28:31]
r128 a[212:215],v1,42880
s_add_u32 m0, s100, 59136
m16 v[60:63],a[236:239],v[164:167],v[60:63]
v_exp_f32 v154, v154
m16 v[92:95],a[236:239],v[168:171],v[92:95]
cvt v177,v146,v147
s_waitcnt lgkmcnt(6)
m16 v[32:35],a[240:243],v[160:163],v[32:35]
v_exp_f32 v155, v155
m16 v[64:67],a[240:243],v[164:167],v[64:67]
r128 a[216:219],v1,42432
s_mov_b32 s28, 221184
m16 v[96:99],a[240:243],v[168:171],v[96:99]
v_exp_f32 v156, v156
m16 v[36:39],a[244:247],v[160:163],v[36:39]
r128 a[220:223],v1,42944
cvt v178,v148,v149
m16 v[68:71],a[244:247],v[164:167],v[68:71]
v_exp_f32 v157, v157
m16 v[100:103],a[244:247],v[168:171],v[100:103]
v_exp_f32 v158, v158
m16 v[40:43],a[248:251],v[160:163],v[40:43]
buffer_load_dwordx4 v14, s[20:23], s28 offen offset:0 nt lds
cvt v179,v150,v151
m16 v[72:75],a[248:251],v[164:167],v[72:75]
v_exp_f32 v159, v159
m16 v[104:107],a[248:251],v[168:171],v[104:107]
cvt v180,v152,v153
cvt v181,v154,v155
m16 v[44:47],a[252:255],v[160:163],v[44:47]
cvt v182,v156,v157
cvt v183,v158,v159
m16 v[76:79],a[252:255],v[164:167],v[76:79]
m16 v[108:111],a[252:255],v[168:171],v[108:111]
s_waitcnt lgkmcnt(0)
m16 v[136:139],a[192:195],a[48:51],v[184:187]
v_exp_f32 v112, v112
m16 v[144:147],a[192:195],a[64:67],v[188:191]
rtr a[224:225],v2,8448
rtr a[226:227],v2,8960
m16 v[152:155],a[192:195],a[80:83],v[192:195]
v_exp_f32 v113, v113
m16 v[140:143],a[196:199],a[48:51],v[184:187]
rtr a[228:229],v2,8480
cvt v160,v112,v113
m16 v[148:151],a[196:199],a[64:67],v[188:191]
v_exp_f32 v114, v114
m16 v[156:159],a[196:199],a[80:83],v[192:195]
rtr a[230:231],v2,8992
rtr a[232:233],v2,8512
m16 v[136:139],a[200:203],a[52:55],v[136:139]
v_exp_f32 v115, v115
m16 v[144:147],a[200:203],a[68:71],v[144:147]
rtr a[234:235],v2,9024
cvt v161,v114,v115
m16 v[152:155],a[200:203],a[84:87],v[152:155]
v_exp_f32 v116, v116
m16 v[140:143],a[204:207],a[52:55],v[140:143]
rtr a[236:237],v2,8544
rtr a[238:239],v2,9056
m16 v[148:151],a[204:207],a[68:71],v[148:151]
v_exp_f32 v117, v117
m16 v[156:159],a[204:207],a[84:87],v[156:159]
rtr a[240:241],v2,8576
cvt v162,v116,v117
m16 v[136:139],a[208:211],a[56:59],v[136:139]
v_exp_f32 v118, v118
m16 v[144:147],a[208:211],a[72:75],v[144:147]
rtr a[242:243],v2,9088
rtr a[244:245],v2,8608
m16 v[152:155],a[208:211],a[88:91],v[152:155]
v_exp_f32 v119, v119
m16 v[140:143],a[212:215],a[56:59],v[140:143]
rtr a[246:247],v2,9120
cvt v163,v118,v119
m16 v[148:151],a[212:215],a[72:75],v[148:151]
v_exp_f32 v120, v120
m16 v[156:159],a[212:215],a[88:91],v[156:159]
rtr a[248:249],v2,8640
rtr a[250:251],v2,9152
m16 v[136:139],a[216:219],a[60:63],v[136:139]
v_exp_f32 v121, v121
m16 v[144:147],a[216:219],a[76:79],v[144:147]
rtr a[252:253],v2,8672
cvt v164,v120,v121
m16 v[152:155],a[216:219],a[92:95],v[152:155]
v_exp_f32 v122, v122
m16 v[140:143],a[220:223],a[60:63],v[140:143]
rtr a[254:255],v2,9184
m16 v[148:151],a[220:223],a[76:79],v[148:151]
v_exp_f32 v123, v123
m16 v[156:159],a[220:223],a[92:95],v[156:159]
v_exp_f32 v124, v124
m16 v[196:199],v[220:223],v[172:175],v[196:199]
v_exp_f32 v125, v125
m16 v[200:203],v[220:223],v[176:179],v[200:203]
v_exp_f32 v126, v126
m16 v[204:207],v[220:223],v[180:183],v[204:207]
cvt v165,v122,v123
s_waitcnt lgkmcnt(8)
m16 v[16:19],a[224:227],v[172:175],v[16:19]
s_waitcnt vmcnt(7) lgkmcnt(0)
s_barrier
s_cmp_eq_u32 s36, 0
s_cbranch_scc0 1f
v_mov_b32 v236, 163824
v_mov_b32 v234, s39
v_mov_b32 v235, 1
ds_read_b32 v237, v236
s_waitcnt lgkmcnt(0)
v_readfirstlane_b32 s28, v237
s_nop 1
s_and_b32 s28, s28, s42
s_or_b32 s28, s28, s43
s_cmp_lg_u32 s28, 0
s_cbranch_scc1 1f
s_mov_b32 s43, 1
s_mov_b64 exec, 1
buffer_store_byte v235, v234, s[52:55], 0 offen sc1
s_mov_b64 exec, -1
s_nop 3
1:
m16 v[48:51],a[224:227],v[176:179],v[48:51]
v_exp_f32 v127, v127
m16 v[80:83],a[224:227],v[180:183],v[80:83]
r128 a[192:195],v3,0
s_add_u32 m0, s100, 59936
m16 v[20:23],a[228:231],v[172:175],v[20:23]
v_exp_f32 v128, v128
m16 v[52:55],a[228:231],v[176:179],v[52:55]
r128 a[196:199],v3,512
cvt v166,v124,v125
m16 v[84:87],a[228:231],v[180:183],v[84:87]
s_mov_b32 s28, 221184
cvt v167,v126,v127
m16 v[24:27],a[232:235],v[172:175],v[24:27]
r128 a[200:203],v3,64
m16 v[56:59],a[232:235],v[176:179],v[56:59]
v_exp_f32 v129, v129
m16 v[88:91],a[232:235],v[180:183],v[88:91]
r128 a[204:207],v3,576
buffer_load_dwordx4 v14, s[20:23], s28 offen offset:256 nt lds
m16 v[28:31],a[236:239],v[172:175],v[28:31]
v_exp_f32 v130, v130
m16 v[60:63],a[236:239],v[176:179],v[60:63]
r128 a[208:211],v3,128
cvt v168,v128,v129
m16 v[92:95],a[236:239],v[180:183],v[92:95]
v_exp_f32 v131, v131
m16 v[32:35],a[240:243],v[172:175],v[32:35]
r128 a[212:215],v3,640
s_add_u32 m0, s100, 67584
m16 v[64:67],a[240:243],v[176:179],v[64:67]
v_exp_f32 v132, v132
m16 v[96:99],a[240:243],v[180:183],v[96:99]
r128 a[216:219],v3,192
cvt v169,v130,v131
m16 v[36:39],a[244:247],v[172:175],v[36:39]
v_exp_f32 v133, v133
m16 v[68:71],a[244:247],v[176:179],v[68:71]
s_mov_b32 s28, 229376
r128 a[220:223],v3,704
m16 v[100:103],a[244:247],v[180:183],v[100:103]
v_exp_f32 v134, v134
m16 v[40:43],a[248:251],v[172:175],v[40:43]
buffer_load_dwordx4 v14, s[16:19], s28 offen offset:0 nt lds
cvt v170,v132,v133
m16 v[72:75],a[248:251],v[176:179],v[72:75]
v_exp_f32 v135, v135
m16 v[104:107],a[248:251],v[180:183],v[104:107]
cvt v171,v134,v135
m16 v[44:47],a[252:255],v[172:175],v[44:47]
m16 v[76:79],a[252:255],v[176:179],v[76:79]
m16 v[108:111],a[252:255],v[180:183],v[108:111]
s_waitcnt lgkmcnt(0)
m16 v[112:115],a[192:195],a[48:51],v[184:187]
v_exp_f32 v136, v136
m16 v[120:123],a[192:195],a[64:67],v[188:191]
rtr a[224:225],v2,33792
s_add_u32 m0, s100, 68384
m16 v[128:131],a[192:195],a[80:83],v[192:195]
rtr a[226:227],v2,34304
rtr a[228:229],v2,33824
m16 v[116:119],a[196:199],a[48:51],v[184:187]
v_exp_f32 v137, v137
m16 v[124:127],a[196:199],a[64:67],v[188:191]
v_exp_f32 v138, v138
m16 v[132:135],a[196:199],a[80:83],v[192:195]
rtr a[230:231],v2,34336
s_mov_b32 s28, 229376
m16 v[112:115],a[200:203],a[52:55],v[112:115]
rtr a[232:233],v2,33856
rtr a[234:235],v2,34368
m16 v[120:123],a[200:203],a[68:71],v[120:123]
v_exp_f32 v139, v139
m16 v[128:131],a[200:203],a[84:87],v[128:131]
v_exp_f32 v140, v140
m16 v[116:119],a[204:207],a[52:55],v[116:119]
rtr a[236:237],v2,33888
buffer_load_dwordx4 v14, s[16:19], s28 offen offset:256 nt lds
m16 v[124:127],a[204:207],a[68:71],v[124:127]
rtr a[238:239],v2,34400
cvt v172,v136,v137
m16 v[132:135],a[204:207],a[84:87],v[132:135]
v_exp_f32 v141, v141
m16 v[112:115],a[208:211],a[56:59],v[112:115]
rtr a[240:241],v2,33920
rtr a[242:243],v2,34432
m16 v[120:123],a[208:211],a[72:75],v[120:123]
v_exp_f32 v142, v142
m16 v[128:131],a[208:211],a[88:91],v[128:131]
s_add_u32 m0, s100, 76032
rtr a[244:245],v2,33952
m16 v[116:119],a[212:215],a[56:59],v[116:119]
v_exp_f32 v143, v143
m16 v[124:127],a[212:215],a[72:75],v[124:127]
rtr a[246:247],v2,34464
rtr a[248:249],v2,33984
m16 v[132:135],a[212:215],a[88:91],v[132:135]
v_exp_f32 v144, v144
m16 v[112:115],a[216:219],a[60:63],v[112:115]
s_mov_b32 s28, 237568
rtr a[250:251],v2,34496
m16 v[120:123],a[216:219],a[76:79],v[120:123]
v_exp_f32 v145, v145
m16 v[128:131],a[216:219],a[92:95],v[128:131]
rtr a[252:253],v2,34016
rtr a[254:255],v2,34528
m16 v[116:119],a[220:223],a[60:63],v[116:119]
v_exp_f32 v146, v146
m16 v[124:127],a[220:223],a[76:79],v[124:127]
buffer_load_dwordx4 v14, s[16:19], s28 offen offset:0 nt lds
cvt v173,v138,v139
m16 v[132:135],a[220:223],a[92:95],v[132:135]
v_exp_f32 v147, v147
m16 v[196:199],v[220:223],v[160:163],v[196:199]
r128 a[192:195],v3,8448
s_add_u32 m0, s100, 76832
m16 v[200:203],v[220:223],v[164:167],v[200:203]
v_exp_f32 v148, v148
m16 v[204:207],v[220:223],v[168:171],v[204:207]
r128 a[196:199],v3,8960
s_waitcnt lgkmcnt(10)
m16 v[16:19],a[224:227],v[160:163],v[16:19]
v_exp_f32 v149, v149
m16 v[48:51],a[224:227],v[164:167],v[48:51]
r128 a[200:203],v3,8512
s_mov_b32 s28, 237568
m16 v[80:83],a[224:227],v[168:171],v[80:83]
v_exp_f32 v150, v150
m16 v[20:23],a[228:231],v[160:163],v[20:23]
v_exp_f32 v151, v151
m16 v[52:55],a[228:231],v[164:167],v[52:55]
r128 a[204:207],v3,9024
cvt v174,v140,v141
m16 v[84:87],a[228:231],v[168:171],v[84:87]
v_exp_f32 v152, v152
m16 v[24:27],a[232:235],v[160:163],v[24:27]
buffer_load_dwordx4 v14, s[16:19], s28 offen offset:256 nt lds
cvt v175,v142,v143
m16 v[56:59],a[232:235],v[164:167],v[56:59]
r128 a[208:211],v3,8576
cvt v176,v144,v145
m16 v[88:91],a[232:235],v[168:171],v[88:91]
v_exp_f32 v153, v153
m16 v[28:31],a[236:239],v[160:163],v[28:31]
r128 a[212:215],v3,9088
s_add_u32 m0, s100, 84480
m16 v[60:63],a[236:239],v[164:167],v[60:63]
v_exp_f32 v154, v154
m16 v[92:95],a[236:239],v[168:171],v[92:95]
cvt v177,v146,v147
s_waitcnt lgkmcnt(6)
m16 v[32:35],a[240:243],v[160:163],v[32:35]
v_exp_f32 v155, v155
m16 v[64:67],a[240:243],v[164:167],v[64:67]
r128 a[216:219],v3,8640
s_mov_b32 s28, 229376
m16 v[96:99],a[240:243],v[168:171],v[96:99]
v_exp_f32 v156, v156
m16 v[36:39],a[244:247],v[160:163],v[36:39]
r128 a[220:223],v3,9152
cvt v178,v148,v149
m16 v[68:71],a[244:247],v[164:167],v[68:71]
v_exp_f32 v157, v157
m16 v[100:103],a[244:247],v[168:171],v[100:103]
v_exp_f32 v158, v158
m16 v[40:43],a[248:251],v[160:163],v[40:43]
buffer_load_dwordx4 v14, s[20:23], s28 offen offset:0 nt lds
cvt v179,v150,v151
m16 v[72:75],a[248:251],v[164:167],v[72:75]
v_exp_f32 v159, v159
m16 v[104:107],a[248:251],v[168:171],v[104:107]
cvt v180,v152,v153
cvt v181,v154,v155
m16 v[44:47],a[252:255],v[160:163],v[44:47]
cvt v182,v156,v157
cvt v183,v158,v159
m16 v[76:79],a[252:255],v[164:167],v[76:79]
m16 v[108:111],a[252:255],v[168:171],v[108:111]
s_waitcnt lgkmcnt(0)
m16 v[136:139],a[192:195],a[48:51],v[184:187]
v_exp_f32 v112, v112
m16 v[144:147],a[192:195],a[64:67],v[188:191]
rtr a[224:225],v2,42240
rtr a[226:227],v2,42752
m16 v[152:155],a[192:195],a[80:83],v[192:195]
v_exp_f32 v113, v113
m16 v[140:143],a[196:199],a[48:51],v[184:187]
rtr a[228:229],v2,42272
cvt v160,v112,v113
m16 v[148:151],a[196:199],a[64:67],v[188:191]
v_exp_f32 v114, v114
m16 v[156:159],a[196:199],a[80:83],v[192:195]
rtr a[230:231],v2,42784
rtr a[232:233],v2,42304
m16 v[136:139],a[200:203],a[52:55],v[136:139]
v_exp_f32 v115, v115
m16 v[144:147],a[200:203],a[68:71],v[144:147]
rtr a[234:235],v2,42816
cvt v161,v114,v115
m16 v[152:155],a[200:203],a[84:87],v[152:155]
v_exp_f32 v116, v116
m16 v[140:143],a[204:207],a[52:55],v[140:143]
rtr a[236:237],v2,42336
rtr a[238:239],v2,42848
m16 v[148:151],a[204:207],a[68:71],v[148:151]
v_exp_f32 v117, v117
m16 v[156:159],a[204:207],a[84:87],v[156:159]
rtr a[240:241],v2,42368
cvt v162,v116,v117
m16 v[136:139],a[208:211],a[56:59],v[136:139]
v_exp_f32 v118, v118
m16 v[144:147],a[208:211],a[72:75],v[144:147]
rtr a[242:243],v2,42880
rtr a[244:245],v2,42400
m16 v[152:155],a[208:211],a[88:91],v[152:155]
v_exp_f32 v119, v119
m16 v[140:143],a[212:215],a[56:59],v[140:143]
rtr a[246:247],v2,42912
cvt v163,v118,v119
m16 v[148:151],a[212:215],a[72:75],v[148:151]
v_exp_f32 v120, v120
m16 v[156:159],a[212:215],a[88:91],v[156:159]
rtr a[248:249],v2,42432
rtr a[250:251],v2,42944
m16 v[136:139],a[216:219],a[60:63],v[136:139]
v_exp_f32 v121, v121
m16 v[144:147],a[216:219],a[76:79],v[144:147]
rtr a[252:253],v2,42464
cvt v164,v120,v121
m16 v[152:155],a[216:219],a[92:95],v[152:155]
v_exp_f32 v122, v122
m16 v[140:143],a[220:223],a[60:63],v[140:143]
rtr a[254:255],v2,42976
m16 v[148:151],a[220:223],a[76:79],v[148:151]
v_exp_f32 v123, v123
m16 v[156:159],a[220:223],a[92:95],v[156:159]
v_exp_f32 v124, v124
m16 v[196:199],v[220:223],v[172:175],v[196:199]
v_exp_f32 v125, v125
m16 v[200:203],v[220:223],v[176:179],v[200:203]
v_exp_f32 v126, v126
m16 v[204:207],v[220:223],v[180:183],v[204:207]
cvt v165,v122,v123
s_waitcnt lgkmcnt(8)
m16 v[16:19],a[224:227],v[172:175],v[16:19]
s_waitcnt vmcnt(9) lgkmcnt(0)
s_barrier
m16 v[48:51],a[224:227],v[176:179],v[48:51]
v_exp_f32 v127, v127
m16 v[80:83],a[224:227],v[180:183],v[80:83]
r128 a[192:195],v3,33792
s_add_u32 m0, s100, 85280
m16 v[20:23],a[228:231],v[172:175],v[20:23]
v_exp_f32 v128, v128
m16 v[52:55],a[228:231],v[176:179],v[52:55]
r128 a[196:199],v3,34304
s_mov_b32 s28, 229376
m16 v[84:87],a[228:231],v[180:183],v[84:87]
v_exp_f32 v129, v129
m16 v[24:27],a[232:235],v[172:175],v[24:27]
r128 a[200:203],v3,33856
buffer_load_dwordx4 v14, s[20:23], s28 offen offset:256 nt lds
m16 v[56:59],a[232:235],v[176:179],v[56:59]
v_exp_f32 v130, v130
m16 v[88:91],a[232:235],v[180:183],v[88:91]
r128 a[204:207],v3,34368
s_add_u32 m0, s100, 92928
m16 v[28:31],a[236:239],v[172:175],v[28:31]
v_exp_f32 v131, v131
m16 v[60:63],a[236:239],v[176:179],v[60:63]
r128 a[208:211],v3,33920
s_mov_b32 s28, 237568
m16 v[92:95],a[236:239],v[180:183],v[92:95]
v_exp_f32 v132, v132
m16 v[32:35],a[240:243],v[172:175],v[32:35]
r128 a[212:215],v3,34432
cvt v166,v124,v125
m16 v[64:67],a[240:243],v[176:179],v[64:67]
buffer_load_dwordx4 v14, s[20:23], s28 offen offset:0 nt lds
cvt v167,v126,v127
m16 v[96:99],a[240:243],v[180:183],v[96:99]
r128 a[216:219],v3,33984
cvt v168,v128,v129
m16 v[36:39],a[244:247],v[172:175],v[36:39]
v_exp_f32 v133, v133
m16 v[68:71],a[244:247],v[176:179],v[68:71]
s_add_u32 m0, s100, 93728
r128 a[220:223],v3,34496
m16 v[100:103],a[244:247],v[180:183],v[100:103]
v_exp_f32 v134, v134
m16 v[40:43],a[248:251],v[172:175],v[40:43]
s_mov_b32 s28, 237568
cvt v169,v130,v131
m16 v[72:75],a[248:251],v[176:179],v[72:75]
v_exp_f32 v135, v135
m16 v[104:107],a[248:251],v[180:183],v[104:107]
buffer_load_dwordx4 v14, s[20:23], s28 offen offset:256 nt lds
cvt v170,v132,v133
m16 v[44:47],a[252:255],v[172:175],v[44:47]
cvt v171,v134,v135
m16 v[76:79],a[252:255],v[176:179],v[76:79]
m16 v[108:111],a[252:255],v[180:183],v[108:111]
s_waitcnt lgkmcnt(0)
m16 v[112:115],a[192:195],a[48:51],v[184:187]
v_exp_f32 v136, v136
rtr a[224:225],v4,0
m16 v[120:123],a[192:195],a[64:67],v[188:191]
s_add_u32 m0, s100, 101376
rtr a[226:227],v4,512
m16 v[128:131],a[192:195],a[80:83],v[192:195]
v_exp_f32 v137, v137
rtr a[228:229],v4,32
m16 v[116:119],a[196:199],a[48:51],v[184:187]
s_mov_b32 s28, 245760
v_exp_f32 v138, v138
m16 v[124:127],a[196:199],a[64:67],v[188:191]
rtr a[230:231],v4,544
buffer_load_dwordx4 v14, s[16:19], s28 offen offset:0 nt lds
cvt v172,v136,v137
m16 v[132:135],a[196:199],a[80:83],v[192:195]
rtr a[232:233],v4,64
v_exp_f32 v139, v139
m16 v[112:115],a[200:203],a[52:55],v[112:115]
rtr a[234:235],v4,576
v_exp_f32 v140, v140
m16 v[120:123],a[200:203],a[68:71],v[120:123]
s_add_u32 m0, s100, 102176
cvt v173,v138,v139
m16 v[128:131],a[200:203],a[84:87],v[128:131]
rtr a[236:237],v4,96
m16 v[116:119],a[204:207],a[52:55],v[116:119]
rtr a[238:239],v4,608
s_mov_b32 s28, 245760
m16 v[124:127],a[204:207],a[68:71],v[124:127]
v_exp_f32 v141, v141
m16 v[132:135],a[204:207],a[84:87],v[132:135]
rtr a[240:241],v4,128
buffer_load_dwordx4 v14, s[16:19], s28 offen offset:256 nt lds
cvt v174,v140,v141
m16 v[112:115],a[208:211],a[56:59],v[112:115]
v_exp_f32 v142, v142
m16 v[120:123],a[208:211],a[72:75],v[120:123]
rtr a[242:243],v4,640
rtr a[244:245],v4,160
m16 v[128:131],a[208:211],a[88:91],v[128:131]
v_exp_f32 v143, v143
m16 v[116:119],a[212:215],a[56:59],v[116:119]
s_add_u32 m0, s100, 109824
rtr a[246:247],v4,672
m16 v[124:127],a[212:215],a[72:75],v[124:127]
v_exp_f32 v144, v144
m16 v[132:135],a[212:215],a[88:91],v[132:135]
rtr a[248:249],v4,192
s_mov_b32 s28, 253952
m16 v[112:115],a[216:219],a[60:63],v[112:115]
rtr a[250:251],v4,704
buffer_load_dwordx4 v14, s[16:19], s28 offen offset:0 nt lds
m16 v[120:123],a[216:219],a[76:79],v[120:123]
v_exp_f32 v145, v145
m16 v[128:131],a[216:219],a[92:95],v[128:131]
rtr a[252:253],v4,224
rtr a[254:255],v4,736
m16 v[116:119],a[220:223],a[60:63],v[116:119]
v_exp_f32 v146, v146
m16 v[124:127],a[220:223],a[76:79],v[124:127]
v_mov_b32 v210, v6
cvt v175,v142,v143
m16 v[132:135],a[220:223],a[92:95],v[132:135]
v_exp_f32 v147, v147
m16 v[196:199],v[220:223],v[160:163],v[196:199]
r128 a[192:195],v3,42240
s_add_u32 m0, s70, 147424
m16 v[200:203],v[220:223],v[164:167],v[200:203]
v_exp_f32 v148, v148
m16 v[204:207],v[220:223],v[168:171],v[204:207]
r128 a[196:199],v3,42752
s_waitcnt lgkmcnt(10)
m16 v[16:19],a[224:227],v[160:163],v[16:19]
buffer_load_dwordx4 v210, s[56:59], 0 offen offset:0 lds
cvt v176,v144,v145
m16 v[48:51],a[224:227],v[164:167],v[48:51]
v_exp_f32 v149, v149
m16 v[80:83],a[224:227],v[168:171],v[80:83]
r128 a[200:203],v3,42304
buffer_load_dwordx4 v210, s[56:59], s44 offen offset:1024 lds
m16 v[20:23],a[228:231],v[160:163],v[20:23]
v_exp_f32 v150, v150
m16 v[52:55],a[228:231],v[164:167],v[52:55]
v_exp_f32 v151, v151
m16 v[84:87],a[228:231],v[168:171],v[84:87]
buffer_load_dwordx4 v210, s[56:59], s45 offen offset:2048 lds
r128 a[204:207],v3,42816
m16 v[24:27],a[232:235],v[160:163],v[24:27]
v_exp_f32 v152, v152
m16 v[56:59],a[232:235],v[164:167],v[56:59]
buffer_load_dwordx4 v210, s[56:59], s46 offen offset:3072 lds
r128 a[208:211],v3,42368
m16 v[88:91],a[232:235],v[168:171],v[88:91]
v_exp_f32 v153, v153
m16 v[28:31],a[236:239],v[160:163],v[28:31]
v_add_u32 v210, 0x20000, v210
r128 a[212:215],v3,42880
m16 v[60:63],a[236:239],v[164:167],v[60:63]
v_exp_f32 v154, v154
m16 v[92:95],a[236:239],v[168:171],v[92:95]
s_add_u32 m0, s70, 0
s_waitcnt lgkmcnt(6)
m16 v[32:35],a[240:243],v[160:163],v[32:35]
v_exp_f32 v155, v155
m16 v[64:67],a[240:243],v[164:167],v[64:67]
r128 a[216:219],v3,42432
buffer_load_dwordx4 v210, s[56:59], 0 offen offset:0 lds
m16 v[96:99],a[240:243],v[168:171],v[96:99]
v_exp_f32 v156, v156
m16 v[36:39],a[244:247],v[160:163],v[36:39]
r128 a[220:223],v3,42944
buffer_load_dwordx4 v210, s[56:59], s44 offen offset:1024 lds
m16 v[68:71],a[244:247],v[164:167],v[68:71]
v_exp_f32 v157, v157
m16 v[100:103],a[244:247],v[168:171],v[100:103]
v_exp_f32 v158, v158
m16 v[40:43],a[248:251],v[160:163],v[40:43]
buffer_load_dwordx4 v210, s[56:59], s45 offen offset:2048 lds
cvt v177,v146,v147
m16 v[72:75],a[248:251],v[164:167],v[72:75]
v_exp_f32 v159, v159
m16 v[104:107],a[248:251],v[168:171],v[104:107]
buffer_load_dwordx4 v210, s[56:59], s46 offen offset:3072 lds
cvt v178,v148,v149
m16 v[44:47],a[252:255],v[160:163],v[44:47]
cvt v179,v150,v151
cvt v180,v152,v153
m16 v[76:79],a[252:255],v[164:167],v[76:79]
cvt v181,v154,v155
cvt v182,v156,v157
m16 v[108:111],a[252:255],v[168:171],v[108:111]
cvt v183,v158,v159
s_waitcnt lgkmcnt(0)
m16 v[136:139],a[192:195],a[48:51],v[184:187]
v_exp_f32 v112, v112
m16 v[144:147],a[192:195],a[64:67],v[188:191]
rtr a[224:225],v4,8448
rtr a[226:227],v4,8960
m16 v[152:155],a[192:195],a[80:83],v[192:195]
v_exp_f32 v113, v113
m16 v[140:143],a[196:199],a[48:51],v[184:187]
rtr a[228:229],v4,8480
cvt v160,v112,v113
m16 v[148:151],a[196:199],a[64:67],v[188:191]
v_exp_f32 v114, v114
m16 v[156:159],a[196:199],a[80:83],v[192:195]
rtr a[230:231],v4,8992
rtr a[232:233],v4,8512
m16 v[136:139],a[200:203],a[52:55],v[136:139]
v_exp_f32 v115, v115
m16 v[144:147],a[200:203],a[68:71],v[144:147]
rtr a[234:235],v4,9024
cvt v161,v114,v115
m16 v[152:155],a[200:203],a[84:87],v[152:155]
v_exp_f32 v116, v116
m16 v[140:143],a[204:207],a[52:55],v[140:143]
rtr a[236:237],v4,8544
rtr a[238:239],v4,9056
m16 v[148:151],a[204:207],a[68:71],v[148:151]
v_exp_f32 v117, v117
m16 v[156:159],a[204:207],a[84:87],v[156:159]
rtr a[240:241],v4,8576
cvt v162,v116,v117
m16 v[136:139],a[208:211],a[56:59],v[136:139]
v_exp_f32 v118, v118
m16 v[144:147],a[208:211],a[72:75],v[144:147]
rtr a[242:243],v4,9088
rtr a[244:245],v4,8608
m16 v[152:155],a[208:211],a[88:91],v[152:155]
v_exp_f32 v119, v119
m16 v[140:143],a[212:215],a[56:59],v[140:143]
rtr a[246:247],v4,9120
cvt v163,v118,v119
m16 v[148:151],a[212:215],a[72:75],v[148:151]
v_exp_f32 v120, v120
m16 v[156:159],a[212:215],a[88:91],v[156:159]
rtr a[248:249],v4,8640
rtr a[250:251],v4,9152
m16 v[136:139],a[216:219],a[60:63],v[136:139]
v_exp_f32 v121, v121
m16 v[144:147],a[216:219],a[76:79],v[144:147]
rtr a[252:253],v4,8672
cvt v164,v120,v121
m16 v[152:155],a[216:219],a[92:95],v[152:155]
v_exp_f32 v122, v122
m16 v[140:143],a[220:223],a[60:63],v[140:143]
rtr a[254:255],v4,9184
m16 v[148:151],a[220:223],a[76:79],v[148:151]
v_exp_f32 v123, v123
m16 v[156:159],a[220:223],a[92:95],v[156:159]
v_exp_f32 v124, v124
m16 v[196:199],v[220:223],v[172:175],v[196:199]
v_exp_f32 v125, v125
m16 v[200:203],v[220:223],v[176:179],v[200:203]
v_exp_f32 v126, v126
m16 v[204:207],v[220:223],v[180:183],v[204:207]
cvt v165,v122,v123
s_waitcnt lgkmcnt(8)
m16 v[16:19],a[224:227],v[172:175],v[16:19]
s_waitcnt vmcnt(15) lgkmcnt(0)
s_barrier
m16 v[48:51],a[224:227],v[176:179],v[48:51]
v_exp_f32 v127, v127
m16 v[80:83],a[224:227],v[180:183],v[80:83]
r128 a[192:195],v1,0
s_add_u32 m0, s100, 110624
m16 v[20:23],a[228:231],v[172:175],v[20:23]
v_exp_f32 v128, v128
m16 v[52:55],a[228:231],v[176:179],v[52:55]
r128 a[196:199],v1,512
s_mov_b32 s28, 253952
m16 v[84:87],a[228:231],v[180:183],v[84:87]
v_exp_f32 v129, v129
m16 v[24:27],a[232:235],v[172:175],v[24:27]
r128 a[200:203],v1,64
buffer_load_dwordx4 v14, s[16:19], s28 offen offset:256 nt lds
m16 v[56:59],a[232:235],v[176:179],v[56:59]
v_exp_f32 v130, v130
m16 v[88:91],a[232:235],v[180:183],v[88:91]
r128 a[204:207],v1,576
s_add_u32 m0, s100, 118272
m16 v[28:31],a[236:239],v[172:175],v[28:31]
v_exp_f32 v131, v131
m16 v[60:63],a[236:239],v[176:179],v[60:63]
r128 a[208:211],v1,128
s_mov_b32 s28, 245760
m16 v[92:95],a[236:239],v[180:183],v[92:95]
v_exp_f32 v132, v132
m16 v[32:35],a[240:243],v[172:175],v[32:35]
r128 a[212:215],v1,640
cvt v166,v124,v125
m16 v[64:67],a[240:243],v[176:179],v[64:67]
buffer_load_dwordx4 v14, s[20:23], s28 offen offset:0 nt lds
cvt v167,v126,v127
m16 v[96:99],a[240:243],v[180:183],v[96:99]
r128 a[216:219],v1,192
cvt v168,v128,v129
m16 v[36:39],a[244:247],v[172:175],v[36:39]
v_exp_f32 v133, v133
m16 v[68:71],a[244:247],v[176:179],v[68:71]
s_add_u32 m0, s100, 119072
r128 a[220:223],v1,704
m16 v[100:103],a[244:247],v[180:183],v[100:103]
v_exp_f32 v134, v134
m16 v[40:43],a[248:251],v[172:175],v[40:43]
s_mov_b32 s28, 245760
cvt v169,v130,v131
m16 v[72:75],a[248:251],v[176:179],v[72:75]
v_exp_f32 v135, v135
m16 v[104:107],a[248:251],v[180:183],v[104:107]
buffer_load_dwordx4 v14, s[20:23], s28 offen offset:256 nt lds
cvt v170,v132,v133
m16 v[44:47],a[252:255],v[172:175],v[44:47]
cvt v171,v134,v135
m16 v[76:79],a[252:255],v[176:179],v[76:79]
m16 v[108:111],a[252:255],v[180:183],v[108:111]
s_waitcnt lgkmcnt(0)
m16 v[112:115],a[192:195],a[48:51],v[184:187]
v_exp_f32 v136, v136
rtr a[224:225],v4,33792
m16 v[120:123],a[192:195],a[64:67],v[188:191]
s_add_u32 m0, s100, 126720
rtr a[226:227],v4,34304
m16 v[128:131],a[192:195],a[80:83],v[192:195]
v_exp_f32 v137, v137
rtr a[228:229],v4,33824
m16 v[116:119],a[196:199],a[48:51],v[184:187]
s_mov_b32 s28, 253952
v_exp_f32 v138, v138
m16 v[124:127],a[196:199],a[64:67],v[188:191]
rtr a[230:231],v4,34336
cvt v172,v136,v137
m16 v[132:135],a[196:199],a[80:83],v[192:195]
rtr a[232:233],v4,33856
buffer_load_dwordx4 v14, s[20:23], s28 offen offset:0 nt lds
m16 v[112:115],a[200:203],a[52:55],v[112:115]
v_exp_f32 v139, v139
m16 v[120:123],a[200:203],a[68:71],v[120:123]
rtr a[234:235],v4,34368
cvt v173,v138,v139
m16 v[128:131],a[200:203],a[84:87],v[128:131]
v_exp_f32 v140, v140
m16 v[116:119],a[204:207],a[52:55],v[116:119]
rtr a[236:237],v4,33888
s_add_u32 m0, s100, 127520
m16 v[124:127],a[204:207],a[68:71],v[124:127]
rtr a[238:239],v4,34400
s_mov_b32 s28, 253952
m16 v[132:135],a[204:207],a[84:87],v[132:135]
v_exp_f32 v141, v141
m16 v[112:115],a[208:211],a[56:59],v[112:115]
rtr a[240:241],v4,33920
rtr a[242:243],v4,34432
m16 v[120:123],a[208:211],a[72:75],v[120:123]
v_exp_f32 v142, v142
m16 v[128:131],a[208:211],a[88:91],v[128:131]
rtr a[244:245],v4,33952
buffer_load_dwordx4 v14, s[20:23], s28 offen offset:256 nt lds
m16 v[116:119],a[212:215],a[56:59],v[116:119]
v_exp_f32 v143, v143
m16 v[124:127],a[212:215],a[72:75],v[124:127]
rtr a[246:247],v4,34464
rtr a[248:249],v4,33984
m16 v[132:135],a[212:215],a[88:91],v[132:135]
v_exp_f32 v144, v144
m16 v[112:115],a[216:219],a[60:63],v[112:115]
v_add_u32 v210, 0x60000, v210
rtr a[250:251],v4,34496
m16 v[120:123],a[216:219],a[76:79],v[120:123]
v_exp_f32 v145, v145
m16 v[128:131],a[216:219],a[92:95],v[128:131]
rtr a[252:253],v4,34016
s_add_u32 m0, s70, 33792
m16 v[116:119],a[220:223],a[60:63],v[116:119]
v_exp_f32 v146, v146
m16 v[124:127],a[220:223],a[76:79],v[124:127]
rtr a[254:255],v4,34528
buffer_load_dwordx4 v210, s[56:59], 0 offen offset:0 lds
m16 v[132:135],a[220:223],a[92:95],v[132:135]
v_exp_f32 v147, v147
m16 v[196:199],v[220:223],v[160:163],v[196:199]
r128 a[192:195],v1,8448
buffer_load_dwordx4 v210, s[56:59], s44 offen offset:1024 lds
m16 v[200:203],v[220:223],v[164:167],v[200:203]
v_exp_f32 v148, v148
m16 v[204:207],v[220:223],v[168:171],v[204:207]
r128 a[196:199],v1,8960
s_waitcnt lgkmcnt(10)
m16 v[16:19],a[224:227],v[160:163],v[16:19]
v_exp_f32 v149, v149
m16 v[48:51],a[224:227],v[164:167],v[48:51]
buffer_load_dwordx4 v210, s[56:59], s45 offen offset:2048 lds
r128 a[200:203],v1,8512
m16 v[80:83],a[224:227],v[168:171],v[80:83]
v_exp_f32 v150, v150
m16 v[20:23],a[228:231],v[160:163],v[20:23]
buffer_load_dwordx4 v210, s[56:59], s46 offen offset:3072 lds
cvt v174,v140,v141
m16 v[52:55],a[228:231],v[164:167],v[52:55]
v_exp_f32 v151, v151
m16 v[84:87],a[228:231],v[168:171],v[84:87]
r128 a[204:207],v1,9024
v_add_u32 v210, 0x20000, v210
m16 v[24:27],a[232:235],v[160:163],v[24:27]
v_exp_f32 v152, v152
m16 v[56:59],a[232:235],v[164:167],v[56:59]
r128 a[208:211],v1,8576
cvt v175,v142,v143
m16 v[88:91],a[232:235],v[168:171],v[88:91]
v_exp_f32 v153, v153
m16 v[28:31],a[236:239],v[160:163],v[28:31]
s_add_u32 m0, s70, 16896
r128 a[212:215],v1,9088
m16 v[60:63],a[236:239],v[164:167],v[60:63]
v_exp_f32 v154, v154
m16 v[92:95],a[236:239],v[168:171],v[92:95]
buffer_load_dwordx4 v210, s[56:59], 0 offen offset:0 lds
s_waitcnt lgkmcnt(6)
m16 v[32:35],a[240:243],v[160:163],v[32:35]
v_exp_f32 v155, v155
m16 v[64:67],a[240:243],v[164:167],v[64:67]
r128 a[216:219],v1,8640
buffer_load_dwordx4 v210, s[56:59], s44 offen offset:1024 lds
m16 v[96:99],a[240:243],v[168:171],v[96:99]
v_exp_f32 v156, v156
m16 v[36:39],a[244:247],v[160:163],v[36:39]
r128 a[220:223],v1,9152
cvt v176,v144,v145
m16 v[68:71],a[244:247],v[164:167],v[68:71]
v_exp_f32 v157, v157
m16 v[100:103],a[244:247],v[168:171],v[100:103]
buffer_load_dwordx4 v210, s[56:59], s45 offen offset:2048 lds
cvt v177,v146,v147
m16 v[40:43],a[248:251],v[160:163],v[40:43]
v_exp_f32 v158, v158
m16 v[72:75],a[248:251],v[164:167],v[72:75]
v_exp_f32 v159, v159
m16 v[104:107],a[248:251],v[168:171],v[104:107]
buffer_load_dwordx4 v210, s[56:59], s46 offen offset:3072 lds
cvt v178,v148,v149
m16 v[44:47],a[252:255],v[160:163],v[44:47]
cvt v179,v150,v151
cvt v180,v152,v153
m16 v[76:79],a[252:255],v[164:167],v[76:79]
cvt v181,v154,v155
cvt v182,v156,v157
m16 v[108:111],a[252:255],v[168:171],v[108:111]
cvt v183,v158,v159
s_waitcnt lgkmcnt(0)
m16 v[136:139],a[192:195],a[48:51],v[184:187]
v_exp_f32 v112, v112
m16 v[144:147],a[192:195],a[64:67],v[188:191]
rtr a[224:225],v4,42240
rtr a[226:227],v4,42752
m16 v[152:155],a[192:195],a[80:83],v[192:195]
v_exp_f32 v113, v113
m16 v[140:143],a[196:199],a[48:51],v[184:187]
rtr a[228:229],v4,42272
cvt v160,v112,v113
m16 v[148:151],a[196:199],a[64:67],v[188:191]
v_exp_f32 v114, v114
m16 v[156:159],a[196:199],a[80:83],v[192:195]
rtr a[230:231],v4,42784
rtr a[232:233],v4,42304
m16 v[136:139],a[200:203],a[52:55],v[136:139]
v_exp_f32 v115, v115
m16 v[144:147],a[200:203],a[68:71],v[144:147]
rtr a[234:235],v4,42816
cvt v161,v114,v115
m16 v[152:155],a[200:203],a[84:87],v[152:155]
v_exp_f32 v116, v116
m16 v[140:143],a[204:207],a[52:55],v[140:143]
rtr a[236:237],v4,42336
rtr a[238:239],v4,42848
m16 v[148:151],a[204:207],a[68:71],v[148:151]
v_exp_f32 v117, v117
m16 v[156:159],a[204:207],a[84:87],v[156:159]
rtr a[240:241],v4,42368
cvt v162,v116,v117
m16 v[136:139],a[208:211],a[56:59],v[136:139]
v_exp_f32 v118, v118
m16 v[144:147],a[208:211],a[72:75],v[144:147]
rtr a[242:243],v4,42880
rtr a[244:245],v4,42400
m16 v[152:155],a[208:211],a[88:91],v[152:155]
v_exp_f32 v119, v119
m16 v[140:143],a[212:215],a[56:59],v[140:143]
rtr a[246:247],v4,42912
cvt v163,v118,v119
m16 v[148:151],a[212:215],a[72:75],v[148:151]
v_exp_f32 v120, v120
m16 v[156:159],a[212:215],a[88:91],v[156:159]
rtr a[248:249],v4,42432
rtr a[250:251],v4,42944
m16 v[136:139],a[216:219],a[60:63],v[136:139]
v_exp_f32 v121, v121
m16 v[144:147],a[216:219],a[76:79],v[144:147]
rtr a[252:253],v4,42464
cvt v164,v120,v121
m16 v[152:155],a[216:219],a[92:95],v[152:155]
v_exp_f32 v122, v122
m16 v[140:143],a[220:223],a[60:63],v[140:143]
rtr a[254:255],v4,42976
m16 v[148:151],a[220:223],a[76:79],v[148:151]
v_exp_f32 v123, v123
m16 v[156:159],a[220:223],a[92:95],v[156:159]
v_exp_f32 v124, v124
m16 v[196:199],v[220:223],v[172:175],v[196:199]
v_exp_f32 v125, v125
m16 v[200:203],v[220:223],v[176:179],v[200:203]
v_exp_f32 v126, v126
m16 v[204:207],v[220:223],v[180:183],v[204:207]
cvt v165,v122,v123
s_waitcnt lgkmcnt(8)
m16 v[16:19],a[224:227],v[172:175],v[16:19]
s_waitcnt vmcnt(12) lgkmcnt(0)
s_barrier
m16 v[48:51],a[224:227],v[176:179],v[48:51]
v_exp_f32 v127, v127
m16 v[80:83],a[224:227],v[180:183],v[80:83]
r128 a[192:195],v1,33792
v_add_u32 v210, 0x60000, v210
m16 v[20:23],a[228:231],v[172:175],v[20:23]
v_exp_f32 v128, v128
m16 v[52:55],a[228:231],v[176:179],v[52:55]
r128 a[196:199],v1,34304
cvt v166,v124,v125
m16 v[84:87],a[228:231],v[180:183],v[84:87]
v_exp_f32 v129, v129
m16 v[24:27],a[232:235],v[172:175],v[24:27]
r128 a[200:203],v1,33856
cvt v167,v126,v127
m16 v[56:59],a[232:235],v[176:179],v[56:59]
v_exp_f32 v130, v130
m16 v[88:91],a[232:235],v[180:183],v[88:91]
r128 a[204:207],v1,34368
s_add_u32 m0, s70, 67584
m16 v[28:31],a[236:239],v[172:175],v[28:31]
v_exp_f32 v131, v131
m16 v[60:63],a[236:239],v[176:179],v[60:63]
r128 a[208:211],v1,33920
cvt v168,v128,v129
m16 v[92:95],a[236:239],v[180:183],v[92:95]
v_exp_f32 v132, v132
m16 v[32:35],a[240:243],v[172:175],v[32:35]
r128 a[212:215],v1,34432
cvt v169,v130,v131
m16 v[64:67],a[240:243],v[176:179],v[64:67]
v_exp_f32 v133, v133
m16 v[96:99],a[240:243],v[180:183],v[96:99]
r128 a[216:219],v1,33984
cvt v170,v132,v133
m16 v[36:39],a[244:247],v[172:175],v[36:39]
buffer_load_dwordx4 v210, s[56:59], 0 offen offset:0 lds
m16 v[68:71],a[244:247],v[176:179],v[68:71]
r128 a[220:223],v1,34496
m16 v[100:103],a[244:247],v[180:183],v[100:103]
v_exp_f32 v134, v134
m16 v[40:43],a[248:251],v[172:175],v[40:43]
v_exp_f32 v135, v135
m16 v[72:75],a[248:251],v[176:179],v[72:75]
cvt v171,v134,v135
m16 v[104:107],a[248:251],v[180:183],v[104:107]
m16 v[44:47],a[252:255],v[172:175],v[44:47]
m16 v[76:79],a[252:255],v[176:179],v[76:79]
m16 v[108:111],a[252:255],v[180:183],v[108:111]
s_waitcnt lgkmcnt(0)
m16 v[112:115],a[192:195],a[48:51],v[184:187]
v_exp_f32 v136, v136
m16 v[120:123],a[192:195],a[64:67],v[188:191]
rtr a[224:225],v2,0
buffer_load_dwordx4 v210, s[56:59], s44 offen offset:1024 lds
m16 v[128:131],a[192:195],a[80:83],v[192:195]
buffer_load_dword v254, v9, s[52:55], 0 offen sc1
rtr a[226:227],v2,512
m16 v[116:119],a[196:199],a[48:51],v[184:187]
v_exp_f32 v137, v137
m16 v[124:127],a[196:199],a[64:67],v[188:191]
rtr a[228:229],v2,32
rtr a[230:231],v2,544
m16 v[132:135],a[196:199],a[80:83],v[192:195]
v_exp_f32 v138, v138
m16 v[112:115],a[200:203],a[52:55],v[112:115]
rtr a[232:233],v2,64
buffer_load_dwordx4 v210, s[56:59], s45 offen offset:2048 lds
m16 v[120:123],a[200:203],a[68:71],v[120:123]
v_exp_f32 v139, v139
m16 v[128:131],a[200:203],a[84:87],v[128:131]
rtr a[234:235],v2,576
rtr a[236:237],v2,96
m16 v[116:119],a[204:207],a[52:55],v[116:119]
v_exp_f32 v140, v140
m16 v[124:127],a[204:207],a[68:71],v[124:127]
rtr a[238:239],v2,608
buffer_load_dwordx4 v210, s[56:59], s46 offen offset:3072 lds
m16 v[132:135],a[204:207],a[84:87],v[132:135]
v_exp_f32 v141, v141
m16 v[112:115],a[208:211],a[56:59],v[112:115]
rtr a[240:241],v2,128
rtr a[242:243],v2,640
m16 v[120:123],a[208:211],a[72:75],v[120:123]
v_exp_f32 v142, v142
m16 v[128:131],a[208:211],a[88:91],v[128:131]
rtr a[244:245],v2,160
cvt v172,v136,v137
m16 v[116:119],a[212:215],a[56:59],v[116:119]
v_exp_f32 v143, v143
m16 v[124:127],a[212:215],a[72:75],v[124:127]
rtr a[246:247],v2,672
rtr a[248:249],v2,192
m16 v[132:135],a[212:215],a[88:91],v[132:135]
v_exp_f32 v144, v144
m16 v[112:115],a[216:219],a[60:63],v[112:115]
v_add_u32 v210, 0x20000, v210
rtr a[250:251],v2,704
m16 v[120:123],a[216:219],a[76:79],v[120:123]
v_exp_f32 v145, v145
m16 v[128:131],a[216:219],a[92:95],v[128:131]
rtr a[252:253],v2,224
rtr a[254:255],v2,736
m16 v[116:119],a[220:223],a[60:63],v[116:119]
v_exp_f32 v146, v146
m16 v[124:127],a[220:223],a[76:79],v[124:127]
s_add_u32 m0, s70, 50688
cvt v173,v138,v139
m16 v[132:135],a[220:223],a[92:95],v[132:135]
v_exp_f32 v147, v147
m16 v[196:199],v[220:223],v[160:163],v[196:199]
r128 a[192:195],v1,42240
cvt v174,v140,v141
m16 v[200:203],v[220:223],v[164:167],v[200:203]
v_exp_f32 v148, v148
m16 v[204:207],v[220:223],v[168:171],v[204:207]
r128 a[196:199],v1,42752
s_waitcnt lgkmcnt(10)
m16 v[16:19],a[224:227],v[160:163],v[16:19]
v_exp_f32 v149, v149
m16 v[48:51],a[224:227],v[164:167],v[48:51]
buffer_load_dwordx4 v210, s[56:59], 0 offen offset:0 lds
r128 a[200:203],v1,42304
m16 v[80:83],a[224:227],v[168:171],v[80:83]
v_exp_f32 v150, v150
m16 v[20:23],a[228:231],v[160:163],v[20:23]
v_exp_f32 v151, v151
m16 v[52:55],a[228:231],v[164:167],v[52:55]
r128 a[204:207],v1,42816
cvt v175,v142,v143
m16 v[84:87],a[228:231],v[168:171],v[84:87]
v_exp_f32 v152, v152
m16 v[24:27],a[232:235],v[160:163],v[24:27]
buffer_load_dwordx4 v210, s[56:59], s44 offen offset:1024 lds
cvt v176,v144,v145
m16 v[56:59],a[232:235],v[164:167],v[56:59]
r128 a[208:211],v1,42368
cvt v177,v146,v147
m16 v[88:91],a[232:235],v[168:171],v[88:91]
v_exp_f32 v153, v153
m16 v[28:31],a[236:239],v[160:163],v[28:31]
r128 a[212:215],v1,42880
cvt v178,v148,v149
m16 v[60:63],a[236:239],v[164:167],v[60:63]
v_exp_f32 v154, v154
m16 v[92:95],a[236:239],v[168:171],v[92:95]
buffer_load_dwordx4 v210, s[56:59], s45 offen offset:2048 lds
s_waitcnt lgkmcnt(6)
m16 v[32:35],a[240:243],v[160:163],v[32:35]
v_exp_f32 v155, v155
m16 v[64:67],a[240:243],v[164:167],v[64:67]
r128 a[216:219],v1,42432
cvt v179,v150,v151
m16 v[96:99],a[240:243],v[168:171],v[96:99]
v_exp_f32 v156, v156
m16 v[36:39],a[244:247],v[160:163],v[36:39]
r128 a[220:223],v1,42944
cvt v180,v152,v153
m16 v[68:71],a[244:247],v[164:167],v[68:71]
v_exp_f32 v157, v157
m16 v[100:103],a[244:247],v[168:171],v[100:103]
buffer_load_dwordx4 v210, s[56:59], s46 offen offset:3072 lds
cvt v181,v154,v155
m16 v[40:43],a[248:251],v[160:163],v[40:43]
v_exp_f32 v158, v158
m16 v[72:75],a[248:251],v[164:167],v[72:75]
v_exp_f32 v159, v159
m16 v[104:107],a[248:251],v[168:171],v[104:107]
cvt v182,v156,v157
cvt v183,v158,v159
m16 v[44:47],a[252:255],v[160:163],v[44:47]
m16 v[76:79],a[252:255],v[164:167],v[76:79]
m16 v[108:111],a[252:255],v[168:171],v[108:111]
s_waitcnt lgkmcnt(0)
m16 v[136:139],a[192:195],a[48:51],v[184:187]
v_exp_f32 v112, v112
rtr a[224:225],v2,8448
m16 v[144:147],a[192:195],a[64:67],v[188:191]
rtr a[226:227],v2,8960
v_exp_f32 v113, v113
m16 v[152:155],a[192:195],a[80:83],v[192:195]
rtr a[228:229],v2,8480
v_exp_f32 v114, v114
m16 v[140:143],a[196:199],a[48:51],v[184:187]
v_exp_f32 v115, v115
m16 v[148:151],a[196:199],a[64:67],v[188:191]
rtr a[230:231],v2,8992
cvt v160,v112,v113
m16 v[156:159],a[196:199],a[80:83],v[192:195]
rtr a[232:233],v2,8512
cvt v161,v114,v115
m16 v[136:139],a[200:203],a[52:55],v[136:139]
rtr a[234:235],v2,9024
m16 v[144:147],a[200:203],a[68:71],v[144:147]
v_exp_f32 v116, v116
m16 v[152:155],a[200:203],a[84:87],v[152:155]
rtr a[236:237],v2,8544
v_exp_f32 v117, v117
m16 v[140:143],a[204:207],a[52:55],v[140:143]
rtr a[238:239],v2,9056
cvt v162,v116,v117
m16 v[148:151],a[204:207],a[68:71],v[148:151]
v_exp_f32 v118, v118
m16 v[156:159],a[204:207],a[84:87],v[156:159]
rtr a[240:241],v2,8576
m16 v[136:139],a[208:211],a[56:59],v[136:139]
rtr a[242:243],v2,9088
v_exp_f32 v119, v119
m16 v[144:147],a[208:211],a[72:75],v[144:147]
rtr a[244:245],v2,8608
cvt v163,v118,v119
m16 v[152:155],a[208:211],a[88:91],v[152:155]
v_exp_f32 v120, v120
m16 v[140:143],a[212:215],a[56:59],v[140:143]
rtr a[246:247],v2,9120
m16 v[148:151],a[212:215],a[72:75],v[148:151]
rtr a[248:249],v2,8640
v_exp_f32 v121, v121
m16 v[156:159],a[212:215],a[88:91],v[156:159]
rtr a[250:251],v2,9152
cvt v164,v120,v121
m16 v[136:139],a[216:219],a[60:63],v[136:139]
v_exp_f32 v122, v122
m16 v[144:147],a[216:219],a[76:79],v[144:147]
rtr a[252:253],v2,8672
m16 v[152:155],a[216:219],a[92:95],v[152:155]
rtr a[254:255],v2,9184
v_exp_f32 v123, v123
m16 v[140:143],a[220:223],a[60:63],v[140:143]
v_exp_f32 v124, v124
m16 v[148:151],a[220:223],a[76:79],v[148:151]
v_exp_f32 v125, v125
m16 v[156:159],a[220:223],a[92:95],v[156:159]
v_exp_f32 v126, v126
m16 v[196:199],v[220:223],v[172:175],v[196:199]
v_exp_f32 v127, v127
m16 v[200:203],v[220:223],v[176:179],v[200:203]
v_exp_f32 v128, v128
m16 v[204:207],v[220:223],v[180:183],v[204:207]
cvt v165,v122,v123
s_waitcnt lgkmcnt(8)
m16 v[16:19],a[224:227],v[172:175],v[16:19]
s_waitcnt vmcnt(17) lgkmcnt(0)
s_barrier
m16 v[48:51],a[224:227],v[176:179],v[48:51]
v_exp_f32 v129, v129
m16 v[80:83],a[224:227],v[180:183],v[80:83]
s_waitcnt vmcnt(6)
v_cmp_ne_u32 vcc, 0x01010101, v254
s_mov_b32 s28, 0
s_nop 0
s_cmp_eq_u64 vcc, 0
s_cbranch_scc1 La_p0_ok
s_mov_b32 s29, 20000
v_mov_b32 v254, 163824
ds_read_b32 v254, v254
s_waitcnt lgkmcnt(0)
v_readfirstlane_b32 s28, v254
s_nop 1
s_and_b32 s28, s28, s42
s_cmp_eq_u32 s28, 0
s_cbranch_scc1 La_p0
v_or_b32 v7, 0x40000000, v7
s_branch La_p0_ok
La_p0:
s_sleep 2
buffer_load_dword v254, v9, s[52:55], 0 offen sc1
s_waitcnt vmcnt(0)
s_sub_u32 s29, s29, 1
s_cmp_eq_u32 s29, 0
s_cbranch_scc1 La_p0_ok
v_cmp_ne_u32 vcc, 0x01010101, v254
s_mov_b32 s28, 0
s_nop 0
s_cmp_eq_u64 vcc, 0
s_cbranch_scc0 La_p0
La_p0_ok:
rtr a[192:193],v2,33792
m16 v[20:23],a[228:231],v[172:175],v[20:23]
rtr a[194:195],v2,34304
cvt v166,v124,v125
m16 v[52:55],a[228:231],v[176:179],v[52:55]
v_mov_b32 v211, v7
buffer_load_dwordx4 a[96:99], v211, s[24:27], 0 offen offset:0 sc1
rtr a[196:197],v2,33824
m16 v[84:87],a[228:231],v[180:183],v[84:87]
rtr a[198:199],v2,34336
cvt v167,v126,v127
m16 v[24:27],a[232:235],v[172:175],v[24:27]
buffer_load_dwordx4 a[100:103], v211, s[24:27], 0 offen offset:1024 sc1
rtr a[200:201],v2,33856
m16 v[56:59],a[232:235],v[176:179],v[56:59]
rtr a[202:203],v2,34368
cvt v168,v128,v129
m16 v[88:91],a[232:235],v[180:183],v[88:91]
v_exp_f32 v130, v130
m16 v[28:31],a[236:239],v[172:175],v[28:31]
buffer_load_dwordx4 a[104:107], v211, s[24:27], 0 offen offset:2048 sc1
rtr a[204:205],v2,33888
m16 v[60:63],a[236:239],v[176:179],v[60:63]
rtr a[206:207],v2,34400
m16 v[92:95],a[236:239],v[180:183],v[92:95]
buffer_load_dwordx4 a[108:111], v211, s[24:27], s47 offen offset:0 sc1
v_exp_f32 v131, v131
m16 v[32:35],a[240:243],v[172:175],v[32:35]
rtr a[208:209],v2,33920
rtr a[210:211],v2,34432
m16 v[64:67],a[240:243],v[176:179],v[64:67]
buffer_load_dwordx4 a[112:115], v211, s[24:27], s47 offen offset:1024 sc1
rtr a[212:213],v2,33952
m16 v[96:99],a[240:243],v[180:183],v[96:99]
v_exp_f32 v132, v132
m16 v[36:39],a[244:247],v[172:175],v[36:39]
v_exp_f32 v133, v133
m16 v[68:71],a[244:247],v[176:179],v[68:71]
rtr a[214:215],v2,34464
buffer_load_dwordx4 a[116:119], v211, s[24:27], s47 offen offset:2048 sc1
m16 v[100:103],a[244:247],v[180:183],v[100:103]
rtr a[216:217],v2,33984
rtr a[218:219],v2,34496
m16 v[40:43],a[248:251],v[172:175],v[40:43]
v_exp_f32 v134, v134
m16 v[72:75],a[248:251],v[176:179],v[72:75]
v_add_u32 v211, 0x5800, v211
buffer_load_dwordx4 a[120:123], v211, s[24:27], 0 offen offset:0 sc1
rtr a[220:221],v2,34016
m16 v[104:107],a[248:251],v[180:183],v[104:107]
v_exp_f32 v135, v135
m16 v[44:47],a[252:255],v[172:175],v[44:47]
rtr a[222:223],v2,34528
buffer_load_dwordx4 a[124:127], v211, s[24:27], 0 offen offset:1024 sc1
m16 v[76:79],a[252:255],v[176:179],v[76:79]
cvt v169,v130,v131
cvt v170,v132,v133
m16 v[108:111],a[252:255],v[180:183],v[108:111]
cvt v171,v134,v135
m16 v[196:199],v[220:223],v[160:163],v[196:199]
v_exp_f32 v136, v136
rtr a[224:225],v2,42240
m16 v[200:203],v[220:223],v[164:167],v[200:203]
v_add_u32 v210, 0x60000, v210
buffer_load_dwordx4 a[128:131], v211, s[24:27], 0 offen offset:2048 sc1
rtr a[226:227],v2,42752
m16 v[204:207],v[220:223],v[168:171],v[204:207]
v_exp_f32 v137, v137
s_waitcnt lgkmcnt(10)
m16 v[16:19],a[192:195],v[160:163],v[16:19]
v_exp_f32 v138, v138
rtr a[228:229],v2,42272
m16 v[48:51],a[192:195],v[164:167],v[48:51]
v_exp_f32 v139, v139
rtr a[230:231],v2,42784
buffer_load_dwordx4 a[132:135], v211, s[24:27], s47 offen offset:0 sc1
m16 v[80:83],a[192:195],v[168:171],v[80:83]
v_exp_f32 v140, v140
s_add_u32 m0, s70, 101376
m16 v[20:23],a[196:199],v[160:163],v[20:23]
v_exp_f32 v141, v141
rtr a[232:233],v2,42304
m16 v[52:55],a[196:199],v[164:167],v[52:55]
v_exp_f32 v142, v142
rtr a[234:235],v2,42816
buffer_load_dwordx4 a[136:139], v211, s[24:27], s47 offen offset:1024 sc1
m16 v[84:87],a[196:199],v[168:171],v[84:87]
v_exp_f32 v143, v143
rtr a[236:237],v2,42336
m16 v[24:27],a[200:203],v[160:163],v[24:27]
v_exp_f32 v144, v144
buffer_load_dwordx4 v210, s[56:59], 0 offen offset:0 lds
m16 v[56:59],a[200:203],v[164:167],v[56:59]
v_exp_f32 v145, v145
rtr a[238:239],v2,42848
buffer_load_dwordx4 a[140:143], v211, s[24:27], s47 offen offset:2048 sc1
m16 v[88:91],a[200:203],v[168:171],v[88:91]
v_exp_f32 v146, v146
rtr a[240:241],v2,42368
m16 v[28:31],a[204:207],v[160:163],v[28:31]
v_exp_f32 v147, v147
rtr a[242:243],v2,42880
m16 v[60:63],a[204:207],v[164:167],v[60:63]
v_exp_f32 v148, v148
buffer_load_dwordx4 v210, s[56:59], s44 offen offset:1024 lds
m16 v[92:95],a[204:207],v[168:171],v[92:95]
v_exp_f32 v149, v149
rtr a[244:245],v2,42400
v_add_u32 v211, 0x10800, v211
buffer_load_dwordx4 a[144:147], v211, s[24:27], 0 offen offset:0 sc1
s_waitcnt lgkmcnt(11)
m16 v[32:35],a[208:211],v[160:163],v[32:35]
v_exp_f32 v150, v150
rtr a[246:247],v2,42912
m16 v[64:67],a[208:211],v[164:167],v[64:67]
v_exp_f32 v151, v151
rtr a[248:249],v2,42432
m16 v[96:99],a[208:211],v[168:171],v[96:99]
buffer_load_dwordx4 a[148:151], v211, s[24:27], 0 offen offset:1024 sc1
v_exp_f32 v152, v152
m16 v[36:39],a[212:215],v[160:163],v[36:39]
buffer_load_dwordx4 v210, s[56:59], s45 offen offset:2048 lds
v_exp_f32 v153, v153
m16 v[68:71],a[212:215],v[164:167],v[68:71]
rtr a[250:251],v2,42944
v_exp_f32 v154, v154
m16 v[100:103],a[212:215],v[168:171],v[100:103]
rtr a[252:253],v2,42464
buffer_load_dwordx4 a[152:155], v211, s[24:27], 0 offen offset:2048 sc1
rtr a[254:255],v2,42976
m16 v[40:43],a[216:219],v[160:163],v[40:43]
v_exp_f32 v155, v155
buffer_load_dwordx4 v210, s[56:59], s46 offen offset:3072 lds
m16 v[72:75],a[216:219],v[164:167],v[72:75]
v_exp_f32 v156, v156
buffer_load_dwordx4 a[156:159], v211, s[24:27], s47 offen offset:0 sc1
m16 v[104:107],a[216:219],v[168:171],v[104:107]
v_exp_f32 v157, v157
cvt v172,v136,v137
m16 v[44:47],a[220:223],v[160:163],v[44:47]
v_exp_f32 v158, v158
cvt v173,v138,v139
m16 v[76:79],a[220:223],v[164:167],v[76:79]
v_exp_f32 v159, v159
cvt v174,v140,v141
m16 v[108:111],a[220:223],v[168:171],v[108:111]
cvt v175,v142,v143
cvt v176,v144,v145
cvt v177,v146,v147
cvt v178,v148,v149
cvt v179,v150,v151
cvt v180,v152,v153
cvt v181,v154,v155
cvt v182,v156,v157
cvt v183,v158,v159
m16 v[196:199],v[220:223],v[172:175],v[196:199]
rtr a[192:193],v12,0
rtr a[194:195],v12,1024
m16 v[200:203],v[220:223],v[176:179],v[200:203]
rtr a[196:197],v12,8
m16 v[204:207],v[220:223],v[180:183],v[204:207]
rtr a[198:199],v12,1032
s_waitcnt lgkmcnt(12)
m16 v[16:19],a[224:227],v[172:175],v[16:19]
rtr a[200:201],v12,256
m16 v[48:51],a[224:227],v[176:179],v[48:51]
rtr a[202:203],v12,1280
rtr a[204:205],v12,264
m16 v[80:83],a[224:227],v[180:183],v[80:83]
rtr a[206:207],v12,1288
m16 v[20:23],a[228:231],v[172:175],v[20:23]
rtr a[208:209],v12,512
m16 v[52:55],a[228:231],v[176:179],v[52:55]
rtr a[210:211],v12,1536
v_rcp_f32 v230, v196
m16 v[84:87],a[228:231],v[180:183],v[84:87]
rtr a[212:213],v12,520
rtr a[214:215],v12,1544
m16 v[24:27],a[232:235],v[172:175],v[24:27]
rtr a[216:217],v12,768
m16 v[56:59],a[232:235],v[176:179],v[56:59]
rtr a[218:219],v12,1792
v_rcp_f32 v232, v200
m16 v[88:91],a[232:235],v[180:183],v[88:91]
rtr a[220:221],v12,776
m16 v[28:31],a[236:239],v[172:175],v[28:31]
rtr a[222:223],v12,1800
v_rcp_f32 v234, v204
m16 v[60:63],a[236:239],v[176:179],v[60:63]
rtr a[160:161],v12,4096
rtr a[162:163],v12,5120
m16 v[92:95],a[236:239],v[180:183],v[92:95]
rtr a[164:165],v12,4104
v_add_f32 v236, v196, v200
s_waitcnt lgkmcnt(15)
m16 v[32:35],a[240:243],v[172:175],v[32:35]
rtr a[166:167],v12,5128
v_add_f32 v236, v236, v204
m16 v[64:67],a[240:243],v[176:179],v[64:67]
rtr a[168:169],v12,4352
v_mov_b32 v231, v230
m16 v[96:99],a[240:243],v[180:183],v[96:99]
rtr a[170:171],v12,5376
rtr a[172:173],v12,4360
m16 v[36:39],a[244:247],v[172:175],v[36:39]
rtr a[174:175],v12,5384
v_mov_b32 v233, v232
m16 v[68:71],a[244:247],v[176:179],v[68:71]
rtr a[176:177],v12,4608
v_mov_b32 v235, v234
m16 v[100:103],a[244:247],v[180:183],v[100:103]
rtr a[178:179],v12,5632
v_mov_b32 v237, 0x53800000
m16 v[40:43],a[248:251],v[172:175],v[40:43]
rtr a[180:181],v12,4616
rtr a[182:183],v12,5640
m16 v[72:75],a[248:251],v[176:179],v[72:75]
rtr a[184:185],v12,4864
v_cmp_nle_f32 vcc, v236, v237
m16 v[104:107],a[248:251],v[180:183],v[104:107]
rtr a[186:187],v12,5888
v_mov_b32 v236, 163824
m16 v[44:47],a[252:255],v[172:175],v[44:47]
rtr a[188:189],v12,4872
s_nop 0
m16 v[76:79],a[252:255],v[176:179],v[76:79]
v_cndmask_b32 v237, 0, 1, vcc
ds_or_b32 v236, v237
m16 v[108:111],a[252:255],v[180:183],v[108:111]
rtr a[190:191],v12,5896
s_waitcnt vmcnt(14)
s_waitcnt lgkmcnt(0)
s_barrier
ds_read_b32 v237, v236
s_waitcnt lgkmcnt(0)
v_readfirstlane_b32 s28, v237
s_nop 1
s_and_b32 s28, s28, s42
s_cmp_eq_u32 s28, 0
s_cbranch_scc1 La_phc
s_mov_b32 s42, 0
v_and_b32 v7, 0x3fffffff, v7
s_mov_b32 s29, 0
La_mx0:
s_waitcnt vmcnt(0) lgkmcnt(0)
s_barrier
s_add_u32 m0, s100, 0
s_nop 0
buffer_load_dwordx4 v14, s[16:19], s29 offen offset:0 lds
s_add_u32 m0, s100, 800
s_nop 0
buffer_load_dwordx4 v14, s[16:19], s29 offen offset:256 lds
s_waitcnt vmcnt(0) lgkmcnt(0)
s_barrier
r128 a[192:195],v3,0
r128 a[196:199],v3,512
r128 a[200:203],v3,64
r128 a[204:207],v3,576
r128 a[208:211],v3,128
r128 a[212:215],v3,640
r128 a[216:219],v3,192
r128 a[220:223],v3,704
s_waitcnt vmcnt(0) lgkmcnt(0)
m16 v[112:115],a[192:195],a[0:3],0
m16 v[120:123],a[192:195],a[16:19],0
m16 v[128:131],a[192:195],a[32:35],0
m16 v[116:119],a[196:199],a[0:3],0
m16 v[124:127],a[196:199],a[16:19],0
m16 v[132:135],a[196:199],a[32:35],0
m16 v[112:115],a[200:203],a[4:7],v[112:115]
m16 v[120:123],a[200:203],a[20:23],v[120:123]
m16 v[128:131],a[200:203],a[36:39],v[128:131]
m16 v[116:119],a[204:207],a[4:7],v[116:119]
m16 v[124:127],a[204:207],a[20:23],v[124:127]
m16 v[132:135],a[204:207],a[36:39],v[132:135]
m16 v[112:115],a[208:211],a[8:11],v[112:115]
m16 v[120:123],a[208:211],a[24:27],v[120:123]
m16 v[128:131],a[208:211],a[40:43],v[128:131]
m16 v[116:119],a[212:215],a[8:11],v[116:119]
m16 v[124:127],a[212:215],a[24:27],v[124:127]
m16 v[132:135],a[212:215],a[40:43],v[132:135]
m16 v[112:115],a[216:219],a[12:15],v[112:115]
m16 v[120:123],a[216:219],a[28:31],v[120:123]
m16 v[128:131],a[216:219],a[44:47],v[128:131]
m16 v[116:119],a[220:223],a[12:15],v[116:119]
m16 v[124:127],a[220:223],a[28:31],v[124:127]
m16 v[132:135],a[220:223],a[44:47],v[132:135]
s_nop 2
v_max3_f32 v224, v224, v112, v113
v_max3_f32 v224, v224, v114, v115
s_nop 0
v_max3_f32 v224, v224, v116, v117
v_max3_f32 v224, v224, v118, v119
v_max3_f32 v225, v225, v120, v121
v_max3_f32 v225, v225, v122, v123
v_max3_f32 v225, v225, v124, v125
v_max3_f32 v225, v225, v126, v127
v_max3_f32 v226, v226, v128, v129
v_max3_f32 v226, v226, v130, v131
v_max3_f32 v226, v226, v132, v133
v_max3_f32 v226, v226, v134, v135
s_add_u32 s29, s29, 8192
s_cmp_lt_u32 s29, 131072
s_cbranch_scc1 La_mx0
s_mov_b32 s29, 131072
La_mx1:
s_waitcnt vmcnt(0) lgkmcnt(0)
s_barrier
s_add_u32 m0, s100, 0
s_nop 0
buffer_load_dwordx4 v14, s[16:19], s29 offen offset:0 lds
s_add_u32 m0, s100, 800
s_nop 0
buffer_load_dwordx4 v14, s[16:19], s29 offen offset:256 lds
s_waitcnt vmcnt(0) lgkmcnt(0)
s_barrier
r128 a[192:195],v3,0
r128 a[196:199],v3,512
r128 a[200:203],v3,64
r128 a[204:207],v3,576
r128 a[208:211],v3,128
r128 a[212:215],v3,640
r128 a[216:219],v3,192
r128 a[220:223],v3,704
s_waitcnt vmcnt(0) lgkmcnt(0)
m16 v[112:115],a[192:195],a[48:51],0
m16 v[120:123],a[192:195],a[64:67],0
m16 v[128:131],a[192:195],a[80:83],0
m16 v[116:119],a[196:199],a[48:51],0
m16 v[124:127],a[196:199],a[64:67],0
m16 v[132:135],a[196:199],a[80:83],0
m16 v[112:115],a[200:203],a[52:55],v[112:115]
m16 v[120:123],a[200:203],a[68:71],v[120:123]
m16 v[128:131],a[200:203],a[84:87],v[128:131]
m16 v[116:119],a[204:207],a[52:55],v[116:119]
m16 v[124:127],a[204:207],a[68:71],v[124:127]
m16 v[132:135],a[204:207],a[84:87],v[132:135]
m16 v[112:115],a[208:211],a[56:59],v[112:115]
m16 v[120:123],a[208:211],a[72:75],v[120:123]
m16 v[128:131],a[208:211],a[88:91],v[128:131]
m16 v[116:119],a[212:215],a[56:59],v[116:119]
m16 v[124:127],a[212:215],a[72:75],v[124:127]
m16 v[132:135],a[212:215],a[88:91],v[132:135]
m16 v[112:115],a[216:219],a[60:63],v[112:115]
m16 v[120:123],a[216:219],a[76:79],v[120:123]
m16 v[128:131],a[216:219],a[92:95],v[128:131]
m16 v[116:119],a[220:223],a[60:63],v[116:119]
m16 v[124:127],a[220:223],a[76:79],v[124:127]
m16 v[132:135],a[220:223],a[92:95],v[132:135]
s_nop 2
v_max3_f32 v227, v227, v112, v113
v_max3_f32 v227, v227, v114, v115
s_nop 0
v_max3_f32 v227, v227, v116, v117
v_max3_f32 v227, v227, v118, v119
v_max3_f32 v228, v228, v120, v121
v_max3_f32 v228, v228, v122, v123
v_max3_f32 v228, v228, v124, v125
v_max3_f32 v228, v228, v126, v127
v_max3_f32 v229, v229, v128, v129
v_max3_f32 v229, v229, v130, v131
v_max3_f32 v229, v229, v132, v133
v_max3_f32 v229, v229, v134, v135
s_add_u32 s29, s29, 8192
s_cmp_lt_u32 s29, 262144
s_cbranch_scc1 La_mx1
s_barrier
s_add_u32 m0, s100, 0
s_mov_b32 s28, 0
buffer_load_dwordx4 v14, s[16:19], s28 offen offset:0 nt lds
s_add_u32 m0, s100, 800
s_mov_b32 s28, 0
buffer_load_dwordx4 v14, s[16:19], s28 offen offset:256 nt lds
s_add_u32 m0, s100, 8448
s_mov_b32 s28, 8192
buffer_load_dwordx4 v14, s[16:19], s28 offen offset:0 nt lds
s_add_u32 m0, s100, 9248
s_mov_b32 s28, 8192
buffer_load_dwordx4 v14, s[16:19], s28 offen offset:256 nt lds
s_add_u32 m0, s100, 16896
s_mov_b32 s28, 0
buffer_load_dwordx4 v14, s[20:23], s28 offen offset:0 nt lds
s_add_u32 m0, s100, 17696
s_mov_b32 s28, 0
buffer_load_dwordx4 v14, s[20:23], s28 offen offset:256 nt lds
s_add_u32 m0, s100, 25344
s_mov_b32 s28, 8192
buffer_load_dwordx4 v14, s[20:23], s28 offen offset:0 nt lds
s_add_u32 m0, s100, 26144
s_mov_b32 s28, 8192
buffer_load_dwordx4 v14, s[20:23], s28 offen offset:256 nt lds
s_add_u32 m0, s100, 33792
s_mov_b32 s28, 16384
buffer_load_dwordx4 v14, s[16:19], s28 offen offset:0 nt lds
s_add_u32 m0, s100, 34592
s_mov_b32 s28, 16384
buffer_load_dwordx4 v14, s[16:19], s28 offen offset:256 nt lds
s_add_u32 m0, s100, 42240
s_mov_b32 s28, 24576
buffer_load_dwordx4 v14, s[16:19], s28 offen offset:0 nt lds
s_add_u32 m0, s100, 43040
s_mov_b32 s28, 24576
buffer_load_dwordx4 v14, s[16:19], s28 offen offset:256 nt lds
s_add_u32 m0, s100, 50688
s_mov_b32 s28, 16384
buffer_load_dwordx4 v14, s[20:23], s28 offen offset:0 nt lds
s_add_u32 m0, s100, 51488
s_mov_b32 s28, 16384
buffer_load_dwordx4 v14, s[20:23], s28 offen offset:256 nt lds
s_add_u32 m0, s100, 59136
s_mov_b32 s28, 24576
buffer_load_dwordx4 v14, s[20:23], s28 offen offset:0 nt lds
s_add_u32 m0, s100, 59936
s_mov_b32 s28, 24576
buffer_load_dwordx4 v14, s[20:23], s28 offen offset:256 nt lds
s_add_u32 m0, s100, 67584
s_mov_b32 s28, 32768
buffer_load_dwordx4 v14, s[16:19], s28 offen offset:0 nt lds
s_add_u32 m0, s100, 68384
s_mov_b32 s28, 32768
buffer_load_dwordx4 v14, s[16:19], s28 offen offset:256 nt lds
s_add_u32 m0, s100, 76032
s_mov_b32 s28, 40960
buffer_load_dwordx4 v14, s[16:19], s28 offen offset:0 nt lds
s_add_u32 m0, s100, 76832
s_mov_b32 s28, 40960
buffer_load_dwordx4 v14, s[16:19], s28 offen offset:256 nt lds
s_add_u32 m0, s100, 84480
s_mov_b32 s28, 32768
buffer_load_dwordx4 v14, s[20:23], s28 offen offset:0 nt lds
s_add_u32 m0, s100, 85280
s_mov_b32 s28, 32768
buffer_load_dwordx4 v14, s[20:23], s28 offen offset:256 nt lds
s_add_u32 m0, s100, 92928
s_mov_b32 s28, 40960
buffer_load_dwordx4 v14, s[20:23], s28 offen offset:0 nt lds
s_add_u32 m0, s100, 93728
s_mov_b32 s28, 40960
buffer_load_dwordx4 v14, s[20:23], s28 offen offset:256 nt lds
s_add_u32 m0, s100, 101376
s_mov_b32 s28, 49152
buffer_load_dwordx4 v14, s[16:19], s28 offen offset:0 nt lds
s_add_u32 m0, s100, 102176
s_mov_b32 s28, 49152
buffer_load_dwordx4 v14, s[16:19], s28 offen offset:256 nt lds
s_add_u32 m0, s100, 109824
s_mov_b32 s28, 57344
buffer_load_dwordx4 v14, s[16:19], s28 offen offset:0 nt lds
s_add_u32 m0, s100, 110624
s_mov_b32 s28, 57344
buffer_load_dwordx4 v14, s[16:19], s28 offen offset:256 nt lds
s_add_u32 m0, s100, 118272
s_mov_b32 s28, 49152
buffer_load_dwordx4 v14, s[20:23], s28 offen offset:0 nt lds
s_add_u32 m0, s100, 119072
s_mov_b32 s28, 49152
buffer_load_dwordx4 v14, s[20:23], s28 offen offset:256 nt lds
s_add_u32 m0, s100, 126720
s_mov_b32 s28, 57344
buffer_load_dwordx4 v14, s[20:23], s28 offen offset:0 nt lds
s_add_u32 m0, s100, 127520
s_mov_b32 s28, 57344
buffer_load_dwordx4 v14, s[20:23], s28 offen offset:256 nt lds
s_mov_b32 s28, 81920
buffer_load_dwordx4 a[96:99], v14, s[16:19], s28 offen offset:0 nt
s_mov_b32 s28, 81920
buffer_load_dwordx4 a[100:103], v14, s[16:19], s28 offen offset:256 nt
s_mov_b32 s28, 90112
buffer_load_dwordx4 a[104:107], v14, s[16:19], s28 offen offset:0 nt
s_mov_b32 s28, 90112
buffer_load_dwordx4 a[108:111], v14, s[16:19], s28 offen offset:256 nt
s_mov_b32 s28, 114688
buffer_load_dwordx4 a[112:115], v14, s[16:19], s28 offen offset:0 nt
s_mov_b32 s28, 114688
buffer_load_dwordx4 a[116:119], v14, s[16:19], s28 offen offset:256 nt
s_mov_b32 s28, 122880
buffer_load_dwordx4 a[120:123], v14, s[16:19], s28 offen offset:0 nt
s_mov_b32 s28, 122880
buffer_load_dwordx4 a[124:127], v14, s[16:19], s28 offen offset:256 nt
s_mov_b32 s28, 131072
buffer_load_dwordx4 a[128:131], v14, s[20:23], s28 offen offset:0 nt
s_mov_b32 s28, 131072
buffer_load_dwordx4 a[132:135], v14, s[20:23], s28 offen offset:256 nt
s_mov_b32 s28, 139264
buffer_load_dwordx4 a[136:139], v14, s[20:23], s28 offen offset:0 nt
s_mov_b32 s28, 139264
buffer_load_dwordx4 a[140:143], v14, s[20:23], s28 offen offset:256 nt
s_mov_b32 s28, 163840
buffer_load_dwordx4 a[144:147], v14, s[16:19], s28 offen offset:0 nt
s_mov_b32 s28, 163840
buffer_load_dwordx4 a[148:151], v14, s[16:19], s28 offen offset:256 nt
s_mov_b32 s28, 172032
buffer_load_dwordx4 a[152:155], v14, s[16:19], s28 offen offset:0 nt
s_mov_b32 s28, 172032
buffer_load_dwordx4 a[156:159], v14, s[16:19], s28 offen offset:256 nt
s_mov_b32 s28, 180224
buffer_load_dwordx4 a[160:163], v14, s[20:23], s28 offen offset:0 nt
s_mov_b32 s28, 180224
buffer_load_dwordx4 a[164:167], v14, s[20:23], s28 offen offset:256 nt
s_mov_b32 s28, 188416
buffer_load_dwordx4 a[168:171], v14, s[20:23], s28 offen offset:0 nt
s_mov_b32 s28, 188416
buffer_load_dwordx4 a[172:175], v14, s[20:23], s28 offen offset:256 nt
s_mov_b32 s28, 212992
buffer_load_dwordx4 a[176:179], v14, s[16:19], s28 offen offset:0 nt
s_mov_b32 s28, 212992
buffer_load_dwordx4 a[180:183], v14, s[16:19], s28 offen offset:256 nt
s_mov_b32 s28, 221184
buffer_load_dwordx4 a[184:187], v14, s[16:19], s28 offen offset:0 nt
s_mov_b32 s28, 221184
buffer_load_dwordx4 a[188:191], v14, s[16:19], s28 offen offset:256 nt
s_waitcnt vmcnt(0) lgkmcnt(0)
s_barrier
r128 a[192:195],v3,0
r128 a[196:199],v3,512
r128 a[200:203],v3,64
r128 a[204:207],v3,576
r128 a[208:211],v3,128
r128 a[212:215],v3,640
r128 a[216:219],v3,192
r128 a[220:223],v3,704
s_waitcnt vmcnt(0) lgkmcnt(0)
m16 v[112:115],a[192:195],a[0:3],0
m16 v[120:123],a[192:195],a[16:19],0
m16 v[128:131],a[192:195],a[32:35],0
m16 v[116:119],a[196:199],a[0:3],0
m16 v[124:127],a[196:199],a[16:19],0
m16 v[132:135],a[196:199],a[32:35],0
m16 v[112:115],a[200:203],a[4:7],v[112:115]
m16 v[120:123],a[200:203],a[20:23],v[120:123]
m16 v[128:131],a[200:203],a[36:39],v[128:131]
m16 v[116:119],a[204:207],a[4:7],v[116:119]
m16 v[124:127],a[204:207],a[20:23],v[124:127]
m16 v[132:135],a[204:207],a[36:39],v[132:135]
m16 v[112:115],a[208:211],a[8:11],v[112:115]
m16 v[120:123],a[208:211],a[24:27],v[120:123]
m16 v[128:131],a[208:211],a[40:43],v[128:131]
m16 v[116:119],a[212:215],a[8:11],v[116:119]
m16 v[124:127],a[212:215],a[24:27],v[124:127]
m16 v[132:135],a[212:215],a[40:43],v[132:135]
m16 v[112:115],a[216:219],a[12:15],v[112:115]
m16 v[120:123],a[216:219],a[28:31],v[120:123]
m16 v[128:131],a[216:219],a[44:47],v[128:131]
m16 v[116:119],a[220:223],a[12:15],v[116:119]
m16 v[124:127],a[220:223],a[28:31],v[124:127]
m16 v[132:135],a[220:223],a[44:47],v[132:135]
r128 a[192:195],v3,8448
r128 a[196:199],v3,8960
r128 a[200:203],v3,8512
r128 a[204:207],v3,9024
r128 a[208:211],v3,8576
r128 a[212:215],v3,9088
r128 a[216:219],v3,8640
r128 a[220:223],v3,9152
s_nop 7
s_branch La_attn
La_phc:
s_waitcnt lgkmcnt(0)
m16 v[112:115],a[192:195],a[96:99],0
rtr a[224:225],v10,0
v_add_u32 v210, 0x20000, v210
m16 v[144:147],a[192:195],a[100:103],0
v_mul_f32 v16, v16, v230
rtr a[226:227],v10,1024
m16 v[176:179],a[192:195],a[104:107],0
buffer_load_dwordx4 a[32:35], v211, s[24:27], s47 offen offset:1024 sc1
v_mul_f32 v17, v17, v230
m16 v[116:119],a[196:199],a[96:99],0
rtr a[228:229],v10,8
v_mul_f32 v18, v18, v230
m16 v[148:151],a[196:199],a[100:103],0
rtr a[230:231],v10,1032
v_mul_f32 v19, v19, v230
m16 v[180:183],a[196:199],a[104:107],0
v_mul_f32 v20, v20, v230
rtr a[232:233],v10,256
m16 v[120:123],a[200:203],a[96:99],0
rtr a[234:235],v10,1280
buffer_load_dwordx4 a[36:39], v211, s[24:27], s47 offen offset:2048 sc1
m16 v[152:155],a[200:203],a[100:103],0
v_mul_f32 v21, v21, v230
rtr a[236:237],v10,264
m16 v[184:187],a[200:203],a[104:107],0
s_add_u32 m0, s70, 84480
v_mul_f32 v22, v22, v230
m16 v[124:127],a[204:207],a[96:99],0
v_mul_f32 v23, v23, v230
rtr a[238:239],v10,1288
m16 v[156:159],a[204:207],a[100:103],0
s_mov_b32 s29, 45056
rtr a[240:241],v10,512
m16 v[188:191],a[204:207],a[104:107],0
cvt v238,v16,v17
rtr a[242:243],v10,1536
m16 v[128:131],a[208:211],a[96:99],0
cvt v239,v18,v19
v_add_u32 v211, 0x5800, v211
buffer_load_dwordx4 a[40:43], v211, s[24:27], 0 offen offset:0 sc1
m16 v[160:163],a[208:211],a[100:103],0
rtr a[244:245],v10,520
cvt v240,v20,v21
m16 v[192:195],a[208:211],a[104:107],0
rtr a[246:247],v10,1544
cvt v241,v22,v23
m16 v[132:135],a[212:215],a[96:99],0
rtr a[248:249],v10,768
buffer_load_dwordx4 v210, s[56:59], 0 offen offset:0 lds
m16 v[164:167],a[212:215],a[100:103],0
buffer_store_dwordx4 v[238:241], v5, s[24:27], s29 offen offset:0 sc1
v_mul_f32 v48, v48, v232
m16 v[196:199],a[212:215],a[104:107],0
rtr a[250:251],v10,1792
buffer_load_dwordx4 a[44:47], v211, s[24:27], 0 offen offset:1024 sc1
m16 v[136:139],a[216:219],a[96:99],0
v_mul_f32 v49, v49, v232
rtr a[252:253],v10,776
m16 v[168:171],a[216:219],a[100:103],0
v_mul_f32 v50, v50, v232
rtr a[254:255],v10,1800
m16 v[200:203],a[216:219],a[104:107],0
v_mul_f32 v51, v51, v232
v_mul_f32 v52, v52, v232
m16 v[140:143],a[220:223],a[96:99],0
rtr a[0:1],v10,4096
v_mul_f32 v53, v53, v232
m16 v[172:175],a[220:223],a[100:103],0
rtr a[2:3],v10,5120
v_mul_f32 v54, v54, v232
m16 v[204:207],a[220:223],a[104:107],0
rtr a[4:5],v10,4104
buffer_load_dwordx4 v210, s[56:59], s44 offen offset:1024 lds
m16 v[112:115],a[160:163],a[108:111],v[112:115]
buffer_load_dwordx4 a[48:51], v211, s[24:27], 0 offen offset:2048 sc1
rtr a[6:7],v10,5128
m16 v[144:147],a[160:163],a[112:115],v[144:147]
v_mul_f32 v55, v55, v232
cvt v242,v48,v49
m16 v[176:179],a[160:163],a[116:119],v[176:179]
rtr a[8:9],v10,4352
cvt v243,v50,v51
m16 v[116:119],a[164:167],a[108:111],v[116:119]
rtr a[10:11],v10,5376
cvt v244,v52,v53
m16 v[148:151],a[164:167],a[112:115],v[148:151]
rtr a[12:13],v10,4360
cvt v245,v54,v55
m16 v[180:183],a[164:167],a[116:119],v[180:183]
buffer_load_dwordx4 a[52:55], v211, s[24:27], s47 offen offset:0 sc1
buffer_store_dwordx4 v[242:245], v5, s[24:27], s29 offen offset:1024 sc1
m16 v[120:123],a[168:171],a[108:111],v[120:123]
rtr a[14:15],v10,5384
buffer_load_dwordx4 v210, s[56:59], s45 offen offset:2048 lds
m16 v[152:155],a[168:171],a[112:115],v[152:155]
rtr a[16:17],v10,4608
v_mul_f32 v80, v80, v234
m16 v[184:187],a[168:171],a[116:119],v[184:187]
rtr a[18:19],v10,5632
v_mul_f32 v81, v81, v234
m16 v[124:127],a[172:175],a[108:111],v[124:127]
v_mul_f32 v82, v82, v234
v_mul_f32 v83, v83, v234
m16 v[156:159],a[172:175],a[112:115],v[156:159]
rtr a[20:21],v10,4616
buffer_load_dwordx4 a[56:59], v211, s[24:27], s47 offen offset:1024 sc1
m16 v[188:191],a[172:175],a[116:119],v[188:191]
rtr a[22:23],v10,5640
v_mul_f32 v84, v84, v234
m16 v[128:131],a[176:179],a[108:111],v[128:131]
rtr a[24:25],v10,4864
v_mul_f32 v85, v85, v234
m16 v[160:163],a[176:179],a[112:115],v[160:163]
v_mul_f32 v86, v86, v234
v_mul_f32 v87, v87, v234
m16 v[192:195],a[176:179],a[116:119],v[192:195]
rtr a[26:27],v10,5888
buffer_load_dwordx4 v210, s[56:59], s46 offen offset:3072 lds
m16 v[132:135],a[180:183],a[108:111],v[132:135]
rtr a[28:29],v10,4872
cvt v246,v80,v81
m16 v[164:167],a[180:183],a[112:115],v[164:167]
rtr a[30:31],v10,5896
buffer_load_dwordx4 a[60:63], v211, s[24:27], s47 offen offset:2048 sc1
m16 v[196:199],a[180:183],a[116:119],v[196:199]
cvt v247,v82,v83
cvt v248,v84,v85
m16 v[136:139],a[184:187],a[108:111],v[136:139]
cvt v249,v86,v87
buffer_store_dwordx4 v[246:249], v5, s[24:27], s29 offen offset:2048 sc1
m16 v[168:171],a[184:187],a[112:115],v[168:171]
m16 v[200:203],a[184:187],a[116:119],v[200:203]
m16 v[140:143],a[188:191],a[108:111],v[140:143]
m16 v[172:175],a[188:191],a[112:115],v[172:175]
m16 v[204:207],a[188:191],a[116:119],v[204:207]
s_waitcnt vmcnt(22) lgkmcnt(0)
m16 v[112:115],a[224:227],a[120:123],v[112:115]
rtr a[192:193],v10,33792
v_add_u32 v210, 0x60000, v210
m16 v[144:147],a[224:227],a[124:127],v[144:147]
v_mul_f32 v24, v24, v230
rtr a[194:195],v10,34816
m16 v[176:179],a[224:227],a[128:131],v[176:179]
v_add_u32 v211, 0x10800, v211
buffer_load_dwordx4 a[64:67], v211, s[24:27], 0 offen offset:0 sc1
v_mul_f32 v25, v25, v230
m16 v[116:119],a[228:231],a[120:123],v[116:119]
rtr a[196:197],v10,33800
v_mul_f32 v26, v26, v230
m16 v[148:151],a[228:231],a[124:127],v[148:151]
rtr a[198:199],v10,34824
v_mul_f32 v27, v27, v230
m16 v[180:183],a[228:231],a[128:131],v[180:183]
v_mul_f32 v28, v28, v230
rtr a[200:201],v10,34048
m16 v[120:123],a[232:235],a[120:123],v[120:123]
rtr a[202:203],v10,35072
v_mul_f32 v29, v29, v230
m16 v[152:155],a[232:235],a[124:127],v[152:155]
rtr a[204:205],v10,34056
s_add_u32 m0, s70, 118272
m16 v[184:187],a[232:235],a[128:131],v[184:187]
buffer_load_dwordx4 a[68:71], v211, s[24:27], 0 offen offset:1024 sc1
v_mul_f32 v30, v30, v230
m16 v[124:127],a[236:239],a[120:123],v[124:127]
v_mul_f32 v31, v31, v230
rtr a[206:207],v10,35080
m16 v[156:159],a[236:239],a[124:127],v[156:159]
s_mov_b32 s29, 56320
rtr a[208:209],v10,34304
m16 v[188:191],a[236:239],a[128:131],v[188:191]
cvt v250,v24,v25
rtr a[210:211],v10,35328
m16 v[128:131],a[240:243],a[120:123],v[128:131]
cvt v251,v26,v27
cvt v252,v28,v29
m16 v[160:163],a[240:243],a[124:127],v[160:163]
rtr a[212:213],v10,34312
buffer_load_dwordx4 a[72:75], v211, s[24:27], 0 offen offset:2048 sc1
m16 v[192:195],a[240:243],a[128:131],v[192:195]
rtr a[214:215],v10,35336
cvt v253,v30,v31
m16 v[132:135],a[244:247],a[120:123],v[132:135]
rtr a[216:217],v10,34560
buffer_load_dwordx4 v210, s[56:59], 0 offen offset:0 lds
m16 v[164:167],a[244:247],a[124:127],v[164:167]
buffer_store_dwordx4 v[250:253], v5, s[24:27], s29 offen offset:0 sc1
v_mul_f32 v56, v56, v232
m16 v[196:199],a[244:247],a[128:131],v[196:199]
rtr a[218:219],v10,35584
v_mul_f32 v57, v57, v232
m16 v[136:139],a[248:251],a[120:123],v[136:139]
rtr a[220:221],v10,34568
v_mul_f32 v58, v58, v232
m16 v[168:171],a[248:251],a[124:127],v[168:171]
rtr a[222:223],v10,35592
v_mul_f32 v59, v59, v232
m16 v[200:203],a[248:251],a[128:131],v[200:203]
buffer_load_dwordx4 a[76:79], v211, s[24:27], s47 offen offset:0 sc1
v_mul_f32 v60, v60, v232
m16 v[140:143],a[252:255],a[120:123],v[140:143]
rtr a[160:161],v10,37888
v_mul_f32 v61, v61, v232
m16 v[172:175],a[252:255],a[124:127],v[172:175]
rtr a[162:163],v10,38912
v_mul_f32 v62, v62, v232
m16 v[204:207],a[252:255],a[128:131],v[204:207]
rtr a[164:165],v10,37896
buffer_load_dwordx4 v210, s[56:59], s44 offen offset:1024 lds
m16 v[112:115],a[0:3],a[132:135],v[112:115]
rtr a[166:167],v10,38920
v_mul_f32 v63, v63, v232
m16 v[144:147],a[0:3],a[136:139],v[144:147]
cvt v238,v56,v57
cvt v239,v58,v59
m16 v[176:179],a[0:3],a[140:143],v[176:179]
rtr a[168:169],v10,38144
buffer_load_dwordx4 a[80:83], v211, s[24:27], s47 offen offset:1024 sc1
m16 v[116:119],a[4:7],a[132:135],v[116:119]
rtr a[170:171],v10,39168
cvt v240,v60,v61
m16 v[148:151],a[4:7],a[136:139],v[148:151]
rtr a[172:173],v10,38152
cvt v241,v62,v63
m16 v[180:183],a[4:7],a[140:143],v[180:183]
buffer_store_dwordx4 v[238:241], v5, s[24:27], s29 offen offset:1024 sc1
v_mul_f32 v88, v88, v234
m16 v[120:123],a[8:11],a[132:135],v[120:123]
rtr a[174:175],v10,39176
buffer_load_dwordx4 v210, s[56:59], s45 offen offset:2048 lds
m16 v[152:155],a[8:11],a[136:139],v[152:155]
rtr a[176:177],v10,38400
v_mul_f32 v89, v89, v234
m16 v[184:187],a[8:11],a[140:143],v[184:187]
rtr a[178:179],v10,39424
v_mul_f32 v90, v90, v234
m16 v[124:127],a[12:15],a[132:135],v[124:127]
buffer_load_dwordx4 a[84:87], v211, s[24:27], s47 offen offset:2048 sc1
v_mul_f32 v91, v91, v234
m16 v[156:159],a[12:15],a[136:139],v[156:159]
rtr a[180:181],v10,38408
v_mul_f32 v92, v92, v234
m16 v[188:191],a[12:15],a[140:143],v[188:191]
rtr a[182:183],v10,39432
v_mul_f32 v93, v93, v234
m16 v[128:131],a[16:19],a[132:135],v[128:131]
rtr a[184:185],v10,38656
v_mul_f32 v94, v94, v234
m16 v[160:163],a[16:19],a[136:139],v[160:163]
v_mul_f32 v95, v95, v234
cvt v242,v88,v89
m16 v[192:195],a[16:19],a[140:143],v[192:195]
rtr a[186:187],v10,39680
buffer_load_dwordx4 v210, s[56:59], s46 offen offset:3072 lds
m16 v[132:135],a[20:23],a[132:135],v[132:135]
rtr a[188:189],v10,38664
v_add_u32 v211, 0x5800, v211
buffer_load_dwordx4 a[88:91], v211, s[24:27], 0 offen offset:0 sc1
m16 v[164:167],a[20:23],a[136:139],v[164:167]
rtr a[190:191],v10,39688
cvt v243,v90,v91
m16 v[196:199],a[20:23],a[140:143],v[196:199]
cvt v244,v92,v93
cvt v245,v94,v95
m16 v[136:139],a[24:27],a[132:135],v[136:139]
buffer_store_dwordx4 v[242:245], v5, s[24:27], s29 offen offset:2048 sc1
m16 v[168:171],a[24:27],a[136:139],v[168:171]
m16 v[200:203],a[24:27],a[140:143],v[200:203]
m16 v[140:143],a[28:31],a[132:135],v[140:143]
m16 v[172:175],a[28:31],a[136:139],v[172:175]
m16 v[204:207],a[28:31],a[140:143],v[204:207]
s_waitcnt vmcnt(27) lgkmcnt(0)
s_barrier
m16 v[112:115],a[192:195],a[144:147],v[112:115]
rtr a[224:225],v10,16896
v_add_u32 v210, 0x20000, v210
m16 v[144:147],a[192:195],a[148:151],v[144:147]
v_mul_f32 v32, v32, v230
rtr a[226:227],v10,17920
m16 v[176:179],a[192:195],a[152:155],v[176:179]
buffer_load_dwordx4 a[92:95], v211, s[24:27], 0 offen offset:1024 sc1
v_mul_f32 v33, v33, v230
m16 v[116:119],a[196:199],a[144:147],v[116:119]
rtr a[228:229],v10,16904
v_mul_f32 v34, v34, v230
m16 v[148:151],a[196:199],a[148:151],v[148:151]
rtr a[230:231],v10,17928
v_mul_f32 v35, v35, v230
m16 v[180:183],a[196:199],a[152:155],v[180:183]
v_mul_f32 v36, v36, v230
rtr a[232:233],v10,17152
m16 v[120:123],a[200:203],a[144:147],v[120:123]
rtr a[234:235],v10,18176
m16 v[152:155],a[200:203],a[148:151],v[152:155]
v_mul_f32 v37, v37, v230
rtr a[236:237],v10,17160
m16 v[184:187],a[200:203],a[152:155],v[184:187]
s_add_u32 m0, s70, 147424
v_mul_f32 v38, v38, v230
m16 v[124:127],a[204:207],a[144:147],v[124:127]
v_mul_f32 v39, v39, v230
rtr a[238:239],v10,18184
m16 v[156:159],a[204:207],a[148:151],v[156:159]
s_mov_b32 s29, 67584
rtr a[240:241],v10,17408
m16 v[188:191],a[204:207],a[152:155],v[188:191]
cvt v246,v32,v33
rtr a[242:243],v10,18432
m16 v[128:131],a[208:211],a[144:147],v[128:131]
cvt v247,v34,v35
m16 v[160:163],a[208:211],a[148:151],v[160:163]
rtr a[244:245],v10,17416
cvt v248,v36,v37
m16 v[192:195],a[208:211],a[152:155],v[192:195]
rtr a[246:247],v10,18440
cvt v249,v38,v39
m16 v[132:135],a[212:215],a[144:147],v[132:135]
rtr a[248:249],v10,17664
buffer_load_dwordx4 v210, s[56:59], 0 offen offset:0 lds
m16 v[164:167],a[212:215],a[148:151],v[164:167]
buffer_store_dwordx4 v[246:249], v5, s[24:27], s29 offen offset:0 sc1
v_mul_f32 v64, v64, v232
m16 v[196:199],a[212:215],a[152:155],v[196:199]
rtr a[250:251],v10,18688
m16 v[136:139],a[216:219],a[144:147],v[136:139]
v_mul_f32 v65, v65, v232
rtr a[252:253],v10,17672
m16 v[168:171],a[216:219],a[148:151],v[168:171]
v_mul_f32 v66, v66, v232
rtr a[254:255],v10,18696
m16 v[200:203],a[216:219],a[152:155],v[200:203]
v_mul_f32 v67, v67, v232
v_mul_f32 v68, v68, v232
m16 v[140:143],a[220:223],a[144:147],v[140:143]
rtr a[0:1],v10,20992
v_mul_f32 v69, v69, v232
m16 v[172:175],a[220:223],a[148:151],v[172:175]
rtr a[2:3],v10,22016
v_mul_f32 v70, v70, v232
m16 v[204:207],a[220:223],a[152:155],v[204:207]
rtr a[4:5],v10,21000
buffer_load_dwordx4 v210, s[56:59], s44 offen offset:1024 lds
m16 v[112:115],a[160:163],a[156:159],v[112:115]
rtr a[6:7],v10,22024
m16 v[144:147],a[160:163],a[32:35],v[144:147]
v_mul_f32 v71, v71, v232
cvt v250,v64,v65
m16 v[176:179],a[160:163],a[36:39],v[176:179]
rtr a[8:9],v10,21248
cvt v251,v66,v67
m16 v[116:119],a[164:167],a[156:159],v[116:119]
rtr a[10:11],v10,22272
cvt v252,v68,v69
m16 v[148:151],a[164:167],a[32:35],v[148:151]
rtr a[12:13],v10,21256
cvt v253,v70,v71
m16 v[180:183],a[164:167],a[36:39],v[180:183]
buffer_store_dwordx4 v[250:253], v5, s[24:27], s29 offen offset:1024 sc1
m16 v[120:123],a[168:171],a[156:159],v[120:123]
rtr a[14:15],v10,22280
buffer_load_dwordx4 v210, s[56:59], s45 offen offset:2048 lds
m16 v[152:155],a[168:171],a[32:35],v[152:155]
rtr a[16:17],v10,21504
v_mul_f32 v96, v96, v234
m16 v[184:187],a[168:171],a[36:39],v[184:187]
rtr a[18:19],v10,22528
v_mul_f32 v97, v97, v234
m16 v[124:127],a[172:175],a[156:159],v[124:127]
v_mul_f32 v98, v98, v234
v_mul_f32 v99, v99, v234
m16 v[156:159],a[172:175],a[32:35],v[156:159]
rtr a[20:21],v10,21512
m16 v[188:191],a[172:175],a[36:39],v[188:191]
rtr a[22:23],v10,22536
v_mul_f32 v100, v100, v234
m16 v[128:131],a[176:179],a[156:159],v[128:131]
rtr a[24:25],v10,21760
v_mul_f32 v101, v101, v234
m16 v[160:163],a[176:179],a[32:35],v[160:163]
v_mul_f32 v102, v102, v234
v_mul_f32 v103, v103, v234
m16 v[192:195],a[176:179],a[36:39],v[192:195]
rtr a[26:27],v10,22784
buffer_load_dwordx4 v210, s[56:59], s46 offen offset:3072 lds
m16 v[132:135],a[180:183],a[156:159],v[132:135]
rtr a[28:29],v10,21768
cvt v238,v96,v97
m16 v[164:167],a[180:183],a[32:35],v[164:167]
rtr a[30:31],v10,22792
m16 v[196:199],a[180:183],a[36:39],v[196:199]
cvt v239,v98,v99
cvt v240,v100,v101
m16 v[136:139],a[184:187],a[156:159],v[136:139]
cvt v241,v102,v103
buffer_store_dwordx4 v[238:241], v5, s[24:27], s29 offen offset:2048 sc1
m16 v[168:171],a[184:187],a[32:35],v[168:171]
m16 v[200:203],a[184:187],a[36:39],v[200:203]
m16 v[140:143],a[188:191],a[156:159],v[140:143]
m16 v[172:175],a[188:191],a[32:35],v[172:175]
m16 v[204:207],a[188:191],a[36:39],v[204:207]
s_waitcnt vmcnt(23) lgkmcnt(0)
m16 v[112:115],a[224:227],a[40:43],v[112:115]
rtr a[192:193],v11,0
v_add_u32 v210, 0x60000, v210
m16 v[144:147],a[224:227],a[44:47],v[144:147]
v_mul_f32 v40, v40, v230
rtr a[194:195],v11,1024
m16 v[176:179],a[224:227],a[48:51],v[176:179]
v_mul_f32 v41, v41, v230
m16 v[116:119],a[228:231],a[40:43],v[116:119]
rtr a[196:197],v11,8
v_mul_f32 v42, v42, v230
m16 v[148:151],a[228:231],a[44:47],v[148:151]
rtr a[198:199],v11,1032
v_mul_f32 v43, v43, v230
m16 v[180:183],a[228:231],a[48:51],v[180:183]
v_mul_f32 v44, v44, v230
rtr a[200:201],v11,256
m16 v[120:123],a[232:235],a[40:43],v[120:123]
rtr a[202:203],v11,1280
v_mul_f32 v45, v45, v230
m16 v[152:155],a[232:235],a[44:47],v[152:155]
rtr a[204:205],v11,264
s_add_u32 m0, s70, 0
m16 v[184:187],a[232:235],a[48:51],v[184:187]
v_mul_f32 v46, v46, v230
m16 v[124:127],a[236:239],a[40:43],v[124:127]
v_mul_f32 v47, v47, v230
rtr a[206:207],v11,1288
m16 v[156:159],a[236:239],a[44:47],v[156:159]
s_mov_b32 s29, 78848
rtr a[208:209],v11,512
m16 v[188:191],a[236:239],a[48:51],v[188:191]
cvt v242,v40,v41
rtr a[210:211],v11,1536
m16 v[128:131],a[240:243],a[40:43],v[128:131]
cvt v243,v42,v43
cvt v244,v44,v45
m16 v[160:163],a[240:243],a[44:47],v[160:163]
rtr a[212:213],v11,520
m16 v[192:195],a[240:243],a[48:51],v[192:195]
rtr a[214:215],v11,1544
cvt v245,v46,v47
m16 v[132:135],a[244:247],a[40:43],v[132:135]
rtr a[216:217],v11,768
buffer_load_dwordx4 v210, s[56:59], 0 offen offset:0 lds
m16 v[164:167],a[244:247],a[44:47],v[164:167]
buffer_store_dwordx4 v[242:245], v5, s[24:27], s29 offen offset:0 sc1
v_mul_f32 v72, v72, v232
m16 v[196:199],a[244:247],a[48:51],v[196:199]
rtr a[218:219],v11,1792
v_mul_f32 v73, v73, v232
m16 v[136:139],a[248:251],a[40:43],v[136:139]
rtr a[220:221],v11,776
v_mul_f32 v74, v74, v232
m16 v[168:171],a[248:251],a[44:47],v[168:171]
rtr a[222:223],v11,1800
v_mul_f32 v75, v75, v232
m16 v[200:203],a[248:251],a[48:51],v[200:203]
v_mul_f32 v76, v76, v232
m16 v[140:143],a[252:255],a[40:43],v[140:143]
rtr a[160:161],v11,4096
v_mul_f32 v77, v77, v232
m16 v[172:175],a[252:255],a[44:47],v[172:175]
rtr a[162:163],v11,5120
v_mul_f32 v78, v78, v232
m16 v[204:207],a[252:255],a[48:51],v[204:207]
rtr a[164:165],v11,4104
buffer_load_dwordx4 v210, s[56:59], s44 offen offset:1024 lds
m16 v[112:115],a[0:3],a[52:55],v[112:115]
rtr a[166:167],v11,5128
v_mul_f32 v79, v79, v232
m16 v[144:147],a[0:3],a[56:59],v[144:147]
cvt v246,v72,v73
cvt v247,v74,v75
m16 v[176:179],a[0:3],a[60:63],v[176:179]
rtr a[168:169],v11,4352
m16 v[116:119],a[4:7],a[52:55],v[116:119]
rtr a[170:171],v11,5376
cvt v248,v76,v77
m16 v[148:151],a[4:7],a[56:59],v[148:151]
rtr a[172:173],v11,4360
cvt v249,v78,v79
m16 v[180:183],a[4:7],a[60:63],v[180:183]
buffer_store_dwordx4 v[246:249], v5, s[24:27], s29 offen offset:1024 sc1
v_mul_f32 v104, v104, v234
m16 v[120:123],a[8:11],a[52:55],v[120:123]
rtr a[174:175],v11,5384
buffer_load_dwordx4 v210, s[56:59], s45 offen offset:2048 lds
m16 v[152:155],a[8:11],a[56:59],v[152:155]
rtr a[176:177],v11,4608
v_mul_f32 v105, v105, v234
m16 v[184:187],a[8:11],a[60:63],v[184:187]
rtr a[178:179],v11,5632
v_mul_f32 v106, v106, v234
m16 v[124:127],a[12:15],a[52:55],v[124:127]
v_mul_f32 v107, v107, v234
m16 v[156:159],a[12:15],a[56:59],v[156:159]
rtr a[180:181],v11,4616
v_mul_f32 v108, v108, v234
m16 v[188:191],a[12:15],a[60:63],v[188:191]
rtr a[182:183],v11,5640
v_mul_f32 v109, v109, v234
m16 v[128:131],a[16:19],a[52:55],v[128:131]
rtr a[184:185],v11,4864
v_mul_f32 v110, v110, v234
m16 v[160:163],a[16:19],a[56:59],v[160:163]
v_mul_f32 v111, v111, v234
cvt v250,v104,v105
m16 v[192:195],a[16:19],a[60:63],v[192:195]
rtr a[186:187],v11,5888
buffer_load_dwordx4 v210, s[56:59], s46 offen offset:3072 lds
m16 v[132:135],a[20:23],a[52:55],v[132:135]
rtr a[188:189],v11,4872
m16 v[164:167],a[20:23],a[56:59],v[164:167]
rtr a[190:191],v11,5896
cvt v251,v106,v107
m16 v[196:199],a[20:23],a[60:63],v[196:199]
cvt v252,v108,v109
cvt v253,v110,v111
m16 v[136:139],a[24:27],a[52:55],v[136:139]
buffer_store_dwordx4 v[250:253], v5, s[24:27], s29 offen offset:2048 sc1
m16 v[168:171],a[24:27],a[56:59],v[168:171]
m16 v[200:203],a[24:27],a[60:63],v[200:203]
m16 v[140:143],a[28:31],a[52:55],v[140:143]
m16 v[172:175],a[28:31],a[56:59],v[172:175]
m16 v[204:207],a[28:31],a[60:63],v[204:207]
s_waitcnt vmcnt(18) lgkmcnt(0)
s_barrier
m16 v[112:115],a[192:195],a[64:67],v[112:115]
rtr a[224:225],v10,50688
v_add_u32 v210, 0x20000, v210
m16 v[144:147],a[192:195],a[68:71],v[144:147]
rtr a[226:227],v10,51712
buffer_load_dwordx4 v[16:19], v211, s[24:27], 0 offen offset:2048 sc1
m16 v[176:179],a[192:195],a[72:75],v[176:179]
rtr a[228:229],v10,50696
m16 v[116:119],a[196:199],a[64:67],v[116:119]
rtr a[230:231],v10,51720
m16 v[148:151],a[196:199],a[68:71],v[148:151]
m16 v[180:183],a[196:199],a[72:75],v[180:183]
rtr a[232:233],v10,50944
m16 v[120:123],a[200:203],a[64:67],v[120:123]
rtr a[234:235],v10,51968
buffer_load_dwordx4 v[20:23], v211, s[24:27], s47 offen offset:0 sc1
m16 v[152:155],a[200:203],a[68:71],v[152:155]
rtr a[236:237],v10,50952
s_add_u32 m0, s70, 33792
m16 v[184:187],a[200:203],a[72:75],v[184:187]
m16 v[124:127],a[204:207],a[64:67],v[124:127]
rtr a[238:239],v10,51976
m16 v[156:159],a[204:207],a[68:71],v[156:159]
rtr a[240:241],v10,51200
m16 v[188:191],a[204:207],a[72:75],v[188:191]
rtr a[242:243],v10,52224
m16 v[128:131],a[208:211],a[64:67],v[128:131]
buffer_load_dwordx4 v[24:27], v211, s[24:27], s47 offen offset:1024 sc1
m16 v[160:163],a[208:211],a[68:71],v[160:163]
rtr a[244:245],v10,51208
m16 v[192:195],a[208:211],a[72:75],v[192:195]
rtr a[246:247],v10,52232
m16 v[132:135],a[212:215],a[64:67],v[132:135]
rtr a[248:249],v10,51456
buffer_load_dwordx4 v210, s[56:59], 0 offen offset:0 lds
m16 v[164:167],a[212:215],a[68:71],v[164:167]
m16 v[196:199],a[212:215],a[72:75],v[196:199]
rtr a[250:251],v10,52480
buffer_load_dwordx4 v[28:31], v211, s[24:27], s47 offen offset:2048 sc1
m16 v[136:139],a[216:219],a[64:67],v[136:139]
rtr a[252:253],v10,51464
m16 v[168:171],a[216:219],a[68:71],v[168:171]
rtr a[254:255],v10,52488
m16 v[200:203],a[216:219],a[72:75],v[200:203]
m16 v[140:143],a[220:223],a[64:67],v[140:143]
rtr a[0:1],v10,54784
m16 v[172:175],a[220:223],a[68:71],v[172:175]
rtr a[2:3],v10,55808
m16 v[204:207],a[220:223],a[72:75],v[204:207]
rtr a[4:5],v10,54792
buffer_load_dwordx4 v210, s[56:59], s44 offen offset:1024 lds
m16 v[112:115],a[160:163],a[76:79],v[112:115]
v_add_u32 v211, 0x10800, v211
buffer_load_dwordx4 v[32:35], v211, s[24:27], 0 offen offset:0 sc1
rtr a[6:7],v10,55816
m16 v[144:147],a[160:163],a[80:83],v[144:147]
m16 v[176:179],a[160:163],a[84:87],v[176:179]
rtr a[8:9],v10,55040
m16 v[116:119],a[164:167],a[76:79],v[116:119]
rtr a[10:11],v10,56064
m16 v[148:151],a[164:167],a[80:83],v[148:151]
rtr a[12:13],v10,55048
m16 v[180:183],a[164:167],a[84:87],v[180:183]
buffer_load_dwordx4 v[36:39], v211, s[24:27], 0 offen offset:1024 sc1
m16 v[120:123],a[168:171],a[76:79],v[120:123]
rtr a[14:15],v10,56072
buffer_load_dwordx4 v210, s[56:59], s45 offen offset:2048 lds
m16 v[152:155],a[168:171],a[80:83],v[152:155]
rtr a[16:17],v10,55296
m16 v[184:187],a[168:171],a[84:87],v[184:187]
rtr a[18:19],v10,56320
m16 v[124:127],a[172:175],a[76:79],v[124:127]
m16 v[156:159],a[172:175],a[80:83],v[156:159]
rtr a[20:21],v10,55304
buffer_load_dwordx4 v[40:43], v211, s[24:27], 0 offen offset:2048 sc1
m16 v[188:191],a[172:175],a[84:87],v[188:191]
rtr a[22:23],v10,56328
m16 v[128:131],a[176:179],a[76:79],v[128:131]
rtr a[24:25],v10,55552
m16 v[160:163],a[176:179],a[80:83],v[160:163]
m16 v[192:195],a[176:179],a[84:87],v[192:195]
rtr a[26:27],v10,56576
buffer_load_dwordx4 v210, s[56:59], s46 offen offset:3072 lds
m16 v[132:135],a[180:183],a[76:79],v[132:135]
rtr a[28:29],v10,55560
m16 v[164:167],a[180:183],a[80:83],v[164:167]
rtr a[30:31],v10,56584
buffer_load_dwordx4 v[44:47], v211, s[24:27], s47 offen offset:0 sc1
m16 v[196:199],a[180:183],a[84:87],v[196:199]
m16 v[136:139],a[184:187],a[76:79],v[136:139]
m16 v[168:171],a[184:187],a[80:83],v[168:171]
m16 v[200:203],a[184:187],a[84:87],v[200:203]
m16 v[140:143],a[188:191],a[76:79],v[140:143]
m16 v[172:175],a[188:191],a[80:83],v[172:175]
m16 v[204:207],a[188:191],a[84:87],v[204:207]
s_waitcnt vmcnt(7) lgkmcnt(0)
m16 v[112:115],a[224:227],a[88:91],v[112:115]
rtr a[192:193],v11,33792
v_add_u32 v210, 0x60000, v210
m16 v[144:147],a[224:227],a[92:95],v[144:147]
rtr a[194:195],v11,34816
buffer_load_dwordx4 v[48:51], v211, s[24:27], s47 offen offset:1024 sc1
m16 v[176:179],a[224:227],v[16:19],v[176:179]
rtr a[196:197],v11,33800
m16 v[116:119],a[228:231],a[88:91],v[116:119]
rtr a[198:199],v11,34824
m16 v[148:151],a[228:231],a[92:95],v[148:151]
m16 v[180:183],a[228:231],v[16:19],v[180:183]
rtr a[200:201],v11,34048
m16 v[120:123],a[232:235],a[88:91],v[120:123]
rtr a[202:203],v11,35072
m16 v[152:155],a[232:235],a[92:95],v[152:155]
rtr a[204:205],v11,34056
s_add_u32 m0, s70, 16896
m16 v[184:187],a[232:235],v[16:19],v[184:187]
buffer_load_dwordx4 v[52:55], v211, s[24:27], s47 offen offset:2048 sc1
m16 v[124:127],a[236:239],a[88:91],v[124:127]
rtr a[206:207],v11,35080
m16 v[156:159],a[236:239],a[92:95],v[156:159]
rtr a[208:209],v11,34304
m16 v[188:191],a[236:239],v[16:19],v[188:191]
rtr a[210:211],v11,35328
m16 v[128:131],a[240:243],a[88:91],v[128:131]
m16 v[160:163],a[240:243],a[92:95],v[160:163]
rtr a[212:213],v11,34312
v_add_u32 v211, 0x5800, v211
buffer_load_dwordx4 v[56:59], v211, s[24:27], 0 offen offset:0 sc1
m16 v[192:195],a[240:243],v[16:19],v[192:195]
rtr a[214:215],v11,35336
m16 v[132:135],a[244:247],a[88:91],v[132:135]
rtr a[216:217],v11,34560
buffer_load_dwordx4 v210, s[56:59], 0 offen offset:0 lds
m16 v[164:167],a[244:247],a[92:95],v[164:167]
m16 v[196:199],a[244:247],v[16:19],v[196:199]
rtr a[218:219],v11,35584
m16 v[136:139],a[248:251],a[88:91],v[136:139]
rtr a[220:221],v11,34568
m16 v[168:171],a[248:251],a[92:95],v[168:171]
rtr a[222:223],v11,35592
m16 v[200:203],a[248:251],v[16:19],v[200:203]
buffer_load_dwordx4 v[60:63], v211, s[24:27], 0 offen offset:1024 sc1
m16 v[140:143],a[252:255],a[88:91],v[140:143]
rtr a[160:161],v11,37888
m16 v[172:175],a[252:255],a[92:95],v[172:175]
rtr a[162:163],v11,38912
m16 v[204:207],a[252:255],v[16:19],v[204:207]
rtr a[164:165],v11,37896
buffer_load_dwordx4 v210, s[56:59], s44 offen offset:1024 lds
m16 v[112:115],a[0:3],v[20:23],v[112:115]
rtr a[166:167],v11,38920
m16 v[144:147],a[0:3],v[24:27],v[144:147]
m16 v[176:179],a[0:3],v[28:31],v[176:179]
rtr a[168:169],v11,38144
buffer_load_dwordx4 v[64:67], v211, s[24:27], 0 offen offset:2048 sc1
m16 v[116:119],a[4:7],v[20:23],v[116:119]
rtr a[170:171],v11,39168
m16 v[148:151],a[4:7],v[24:27],v[148:151]
rtr a[172:173],v11,38152
m16 v[180:183],a[4:7],v[28:31],v[180:183]
m16 v[120:123],a[8:11],v[20:23],v[120:123]
rtr a[174:175],v11,39176
buffer_load_dwordx4 v210, s[56:59], s45 offen offset:2048 lds
m16 v[152:155],a[8:11],v[24:27],v[152:155]
rtr a[176:177],v11,38400
m16 v[184:187],a[8:11],v[28:31],v[184:187]
rtr a[178:179],v11,39424
m16 v[124:127],a[12:15],v[20:23],v[124:127]
buffer_load_dwordx4 v[68:71], v211, s[24:27], s47 offen offset:0 sc1
m16 v[156:159],a[12:15],v[24:27],v[156:159]
rtr a[180:181],v11,38408
m16 v[188:191],a[12:15],v[28:31],v[188:191]
rtr a[182:183],v11,39432
m16 v[128:131],a[16:19],v[20:23],v[128:131]
rtr a[184:185],v11,38656
m16 v[160:163],a[16:19],v[24:27],v[160:163]
m16 v[192:195],a[16:19],v[28:31],v[192:195]
rtr a[186:187],v11,39680
buffer_load_dwordx4 v210, s[56:59], s46 offen offset:3072 lds
m16 v[132:135],a[20:23],v[20:23],v[132:135]
rtr a[188:189],v11,38664
buffer_load_dwordx4 v[72:75], v211, s[24:27], s47 offen offset:1024 sc1
m16 v[164:167],a[20:23],v[24:27],v[164:167]
rtr a[190:191],v11,39688
m16 v[196:199],a[20:23],v[28:31],v[196:199]
m16 v[136:139],a[24:27],v[20:23],v[136:139]
m16 v[168:171],a[24:27],v[24:27],v[168:171]
m16 v[200:203],a[24:27],v[28:31],v[200:203]
m16 v[140:143],a[28:31],v[20:23],v[140:143]
m16 v[172:175],a[28:31],v[24:27],v[172:175]
m16 v[204:207],a[28:31],v[28:31],v[204:207]
s_waitcnt vmcnt(9) lgkmcnt(0)
s_barrier
m16 v[112:115],a[192:195],v[32:35],v[112:115]
rtr a[224:225],v11,16896
v_add_u32 v210, 0x20000, v210
m16 v[144:147],a[192:195],v[36:39],v[144:147]
rtr a[226:227],v11,17920
buffer_load_dwordx4 v[76:79], v211, s[24:27], s47 offen offset:2048 sc1
m16 v[176:179],a[192:195],v[40:43],v[176:179]
rtr a[228:229],v11,16904
m16 v[116:119],a[196:199],v[32:35],v[116:119]
rtr a[230:231],v11,17928
m16 v[148:151],a[196:199],v[36:39],v[148:151]
m16 v[180:183],a[196:199],v[40:43],v[180:183]
rtr a[232:233],v11,17152
m16 v[120:123],a[200:203],v[32:35],v[120:123]
rtr a[234:235],v11,18176
v_add_u32 v211, 0x10800, v211
buffer_load_dwordx4 v[80:83], v211, s[24:27], 0 offen offset:0 sc1
m16 v[152:155],a[200:203],v[36:39],v[152:155]
rtr a[236:237],v11,17160
s_add_u32 m0, s70, 67584
m16 v[184:187],a[200:203],v[40:43],v[184:187]
m16 v[124:127],a[204:207],v[32:35],v[124:127]
rtr a[238:239],v11,18184
m16 v[156:159],a[204:207],v[36:39],v[156:159]
rtr a[240:241],v11,17408
m16 v[188:191],a[204:207],v[40:43],v[188:191]
rtr a[242:243],v11,18432
m16 v[128:131],a[208:211],v[32:35],v[128:131]
buffer_load_dwordx4 v[84:87], v211, s[24:27], 0 offen offset:1024 sc1
m16 v[160:163],a[208:211],v[36:39],v[160:163]
rtr a[244:245],v11,17416
m16 v[192:195],a[208:211],v[40:43],v[192:195]
rtr a[246:247],v11,18440
m16 v[132:135],a[212:215],v[32:35],v[132:135]
rtr a[248:249],v11,17664
buffer_load_dwordx4 v210, s[56:59], 0 offen offset:0 lds
m16 v[164:167],a[212:215],v[36:39],v[164:167]
m16 v[196:199],a[212:215],v[40:43],v[196:199]
rtr a[250:251],v11,18688
buffer_load_dwordx4 v[88:91], v211, s[24:27], 0 offen offset:2048 sc1
m16 v[136:139],a[216:219],v[32:35],v[136:139]
rtr a[252:253],v11,17672
m16 v[168:171],a[216:219],v[36:39],v[168:171]
rtr a[254:255],v11,18696
m16 v[200:203],a[216:219],v[40:43],v[200:203]
m16 v[140:143],a[220:223],v[32:35],v[140:143]
rtr a[0:1],v11,20992
m16 v[172:175],a[220:223],v[36:39],v[172:175]
rtr a[2:3],v11,22016
m16 v[204:207],a[220:223],v[40:43],v[204:207]
rtr a[4:5],v11,21000
buffer_load_dwordx4 v210, s[56:59], s44 offen offset:1024 lds
m16 v[112:115],a[160:163],v[44:47],v[112:115]
buffer_load_dwordx4 v[92:95], v211, s[24:27], s47 offen offset:0 sc1
rtr a[6:7],v11,22024
m16 v[144:147],a[160:163],v[48:51],v[144:147]
m16 v[176:179],a[160:163],v[52:55],v[176:179]
rtr a[8:9],v11,21248
m16 v[116:119],a[164:167],v[44:47],v[116:119]
rtr a[10:11],v11,22272
m16 v[148:151],a[164:167],v[48:51],v[148:151]
rtr a[12:13],v11,21256
m16 v[180:183],a[164:167],v[52:55],v[180:183]
buffer_load_dwordx4 v[96:99], v211, s[24:27], s47 offen offset:1024 sc1
m16 v[120:123],a[168:171],v[44:47],v[120:123]
rtr a[14:15],v11,22280
buffer_load_dwordx4 v210, s[56:59], s45 offen offset:2048 lds
m16 v[152:155],a[168:171],v[48:51],v[152:155]
rtr a[16:17],v11,21504
m16 v[184:187],a[168:171],v[52:55],v[184:187]
rtr a[18:19],v11,22528
m16 v[124:127],a[172:175],v[44:47],v[124:127]
m16 v[156:159],a[172:175],v[48:51],v[156:159]
rtr a[20:21],v11,21512
buffer_load_dwordx4 v[100:103], v211, s[24:27], s47 offen offset:2048 sc1
m16 v[188:191],a[172:175],v[52:55],v[188:191]
rtr a[22:23],v11,22536
m16 v[128:131],a[176:179],v[44:47],v[128:131]
rtr a[24:25],v11,21760
m16 v[160:163],a[176:179],v[48:51],v[160:163]
m16 v[192:195],a[176:179],v[52:55],v[192:195]
rtr a[26:27],v11,22784
buffer_load_dwordx4 v210, s[56:59], s46 offen offset:3072 lds
m16 v[132:135],a[180:183],v[44:47],v[132:135]
rtr a[28:29],v11,21768
m16 v[164:167],a[180:183],v[48:51],v[164:167]
rtr a[30:31],v11,22792
v_add_u32 v211, 0x5800, v211
buffer_load_dwordx4 v[104:107], v211, s[24:27], 0 offen offset:0 sc1
m16 v[196:199],a[180:183],v[52:55],v[196:199]
m16 v[136:139],a[184:187],v[44:47],v[136:139]
m16 v[168:171],a[184:187],v[48:51],v[168:171]
m16 v[200:203],a[184:187],v[52:55],v[200:203]
m16 v[140:143],a[188:191],v[44:47],v[140:143]
m16 v[172:175],a[188:191],v[48:51],v[172:175]
m16 v[204:207],a[188:191],v[52:55],v[204:207]
s_waitcnt vmcnt(11) lgkmcnt(0)
m16 v[112:115],a[224:227],v[56:59],v[112:115]
rtr a[192:193],v11,50688
v_add_u32 v210, 0x60000, v210
m16 v[144:147],a[224:227],v[60:63],v[144:147]
rtr a[194:195],v11,51712
buffer_load_dwordx4 v[108:111], v211, s[24:27], 0 offen offset:1024 sc1
m16 v[176:179],a[224:227],v[64:67],v[176:179]
rtr a[196:197],v11,50696
m16 v[116:119],a[228:231],v[56:59],v[116:119]
rtr a[198:199],v11,51720
m16 v[148:151],a[228:231],v[60:63],v[148:151]
m16 v[180:183],a[228:231],v[64:67],v[180:183]
rtr a[200:201],v11,50944
m16 v[120:123],a[232:235],v[56:59],v[120:123]
rtr a[202:203],v11,51968
m16 v[152:155],a[232:235],v[60:63],v[152:155]
rtr a[204:205],v11,50952
s_add_u32 m0, s70, 50688
m16 v[184:187],a[232:235],v[64:67],v[184:187]
buffer_load_dwordx4 a[96:99], v211, s[24:27], 0 offen offset:2048 sc1
m16 v[124:127],a[236:239],v[56:59],v[124:127]
rtr a[206:207],v11,51976
m16 v[156:159],a[236:239],v[60:63],v[156:159]
rtr a[208:209],v11,51200
m16 v[188:191],a[236:239],v[64:67],v[188:191]
rtr a[210:211],v11,52224
m16 v[128:131],a[240:243],v[56:59],v[128:131]
m16 v[160:163],a[240:243],v[60:63],v[160:163]
rtr a[212:213],v11,51208
buffer_load_dwordx4 a[100:103], v211, s[24:27], s47 offen offset:0 sc1
m16 v[192:195],a[240:243],v[64:67],v[192:195]
rtr a[214:215],v11,52232
m16 v[132:135],a[244:247],v[56:59],v[132:135]
rtr a[216:217],v11,51456
buffer_load_dwordx4 v210, s[56:59], 0 offen offset:0 lds
m16 v[164:167],a[244:247],v[60:63],v[164:167]
m16 v[196:199],a[244:247],v[64:67],v[196:199]
rtr a[218:219],v11,52480
m16 v[136:139],a[248:251],v[56:59],v[136:139]
rtr a[220:221],v11,51464
m16 v[168:171],a[248:251],v[60:63],v[168:171]
rtr a[222:223],v11,52488
m16 v[200:203],a[248:251],v[64:67],v[200:203]
buffer_load_dwordx4 a[104:107], v211, s[24:27], s47 offen offset:1024 sc1
m16 v[140:143],a[252:255],v[56:59],v[140:143]
rtr a[160:161],v11,54784
m16 v[172:175],a[252:255],v[60:63],v[172:175]
rtr a[162:163],v11,55808
m16 v[204:207],a[252:255],v[64:67],v[204:207]
rtr a[164:165],v11,54792
buffer_load_dwordx4 v210, s[56:59], s44 offen offset:1024 lds
m16 v[112:115],a[0:3],v[68:71],v[112:115]
rtr a[166:167],v11,55816
m16 v[144:147],a[0:3],v[72:75],v[144:147]
m16 v[176:179],a[0:3],v[76:79],v[176:179]
rtr a[168:169],v11,55040
buffer_load_dwordx4 a[108:111], v211, s[24:27], s47 offen offset:2048 sc1
m16 v[116:119],a[4:7],v[68:71],v[116:119]
rtr a[170:171],v11,56064
m16 v[148:151],a[4:7],v[72:75],v[148:151]
rtr a[172:173],v11,55048
m16 v[180:183],a[4:7],v[76:79],v[180:183]
m16 v[120:123],a[8:11],v[68:71],v[120:123]
rtr a[174:175],v11,56072
buffer_load_dwordx4 v210, s[56:59], s45 offen offset:2048 lds
m16 v[152:155],a[8:11],v[72:75],v[152:155]
rtr a[176:177],v11,55296
m16 v[184:187],a[8:11],v[76:79],v[184:187]
rtr a[178:179],v11,56320
m16 v[124:127],a[12:15],v[68:71],v[124:127]
v_add_u32 v211, 0x10800, v211
buffer_load_dwordx4 a[112:115], v211, s[24:27], 0 offen offset:0 sc1
m16 v[156:159],a[12:15],v[72:75],v[156:159]
rtr a[180:181],v11,55304
m16 v[188:191],a[12:15],v[76:79],v[188:191]
rtr a[182:183],v11,56328
m16 v[128:131],a[16:19],v[68:71],v[128:131]
rtr a[184:185],v11,55552
m16 v[160:163],a[16:19],v[72:75],v[160:163]
m16 v[192:195],a[16:19],v[76:79],v[192:195]
rtr a[186:187],v11,56576
buffer_load_dwordx4 v210, s[56:59], s46 offen offset:3072 lds
m16 v[132:135],a[20:23],v[68:71],v[132:135]
rtr a[188:189],v11,55560
buffer_load_dwordx4 a[116:119], v211, s[24:27], 0 offen offset:1024 sc1
m16 v[164:167],a[20:23],v[72:75],v[164:167]
rtr a[190:191],v11,56584
m16 v[196:199],a[20:23],v[76:79],v[196:199]
m16 v[136:139],a[24:27],v[68:71],v[136:139]
m16 v[168:171],a[24:27],v[72:75],v[168:171]
m16 v[200:203],a[24:27],v[76:79],v[200:203]
m16 v[140:143],a[28:31],v[68:71],v[140:143]
m16 v[172:175],a[28:31],v[72:75],v[172:175]
m16 v[204:207],a[28:31],v[76:79],v[204:207]
s_waitcnt vmcnt(13) lgkmcnt(0)
s_barrier
s_cmp_lg_u32 s36, 0
s_cbranch_scc1 La_nosig
v_mov_b32 v1, s71
v_mov_b32 v2, 1
s_mov_b64 exec, 1
buffer_store_dword v2, v1, s[24:27], 0 offen sc1
s_mov_b64 exec, -1
s_nop 3
La_nosig:
m16 v[112:115],a[192:195],v[80:83],v[112:115]
rtr a[224:225],v12,0
v_add_u32 v210, 0x20000, v210
m16 v[144:147],a[192:195],v[84:87],v[144:147]
rtr a[226:227],v12,1024
buffer_load_dwordx4 a[120:123], v211, s[24:27], 0 offen offset:2048 sc1
m16 v[176:179],a[192:195],v[88:91],v[176:179]
rtr a[228:229],v12,8
m16 v[116:119],a[196:199],v[80:83],v[116:119]
rtr a[230:231],v12,1032
m16 v[148:151],a[196:199],v[84:87],v[148:151]
m16 v[180:183],a[196:199],v[88:91],v[180:183]
rtr a[232:233],v12,256
m16 v[120:123],a[200:203],v[80:83],v[120:123]
rtr a[234:235],v12,1280
buffer_load_dwordx4 a[124:127], v211, s[24:27], s47 offen offset:0 sc1
m16 v[152:155],a[200:203],v[84:87],v[152:155]
rtr a[236:237],v12,264
s_add_u32 m0, s70, 101376
m16 v[184:187],a[200:203],v[88:91],v[184:187]
m16 v[124:127],a[204:207],v[80:83],v[124:127]
rtr a[238:239],v12,1288
m16 v[156:159],a[204:207],v[84:87],v[156:159]
rtr a[240:241],v12,512
m16 v[188:191],a[204:207],v[88:91],v[188:191]
rtr a[242:243],v12,1536
m16 v[128:131],a[208:211],v[80:83],v[128:131]
buffer_load_dwordx4 a[128:131], v211, s[24:27], s47 offen offset:1024 sc1
m16 v[160:163],a[208:211],v[84:87],v[160:163]
rtr a[244:245],v12,520
m16 v[192:195],a[208:211],v[88:91],v[192:195]
rtr a[246:247],v12,1544
m16 v[132:135],a[212:215],v[80:83],v[132:135]
rtr a[248:249],v12,768
buffer_load_dwordx4 v210, s[56:59], 0 offen offset:0 lds
m16 v[164:167],a[212:215],v[84:87],v[164:167]
m16 v[196:199],a[212:215],v[88:91],v[196:199]
rtr a[250:251],v12,1792
buffer_load_dwordx4 a[132:135], v211, s[24:27], s47 offen offset:2048 sc1
m16 v[136:139],a[216:219],v[80:83],v[136:139]
rtr a[252:253],v12,776
m16 v[168:171],a[216:219],v[84:87],v[168:171]
rtr a[254:255],v12,1800
m16 v[200:203],a[216:219],v[88:91],v[200:203]
m16 v[140:143],a[220:223],v[80:83],v[140:143]
rtr a[0:1],v12,4096
m16 v[172:175],a[220:223],v[84:87],v[172:175]
rtr a[2:3],v12,5120
m16 v[204:207],a[220:223],v[88:91],v[204:207]
rtr a[4:5],v12,4104
buffer_load_dwordx4 v210, s[56:59], s44 offen offset:1024 lds
m16 v[112:115],a[160:163],v[92:95],v[112:115]
v_add_u32 v211, 0x5800, v211
buffer_load_dwordx4 a[136:139], v211, s[24:27], 0 offen offset:0 sc1
rtr a[6:7],v12,5128
m16 v[144:147],a[160:163],v[96:99],v[144:147]
m16 v[176:179],a[160:163],v[100:103],v[176:179]
rtr a[8:9],v12,4352
m16 v[116:119],a[164:167],v[92:95],v[116:119]
rtr a[10:11],v12,5376
m16 v[148:151],a[164:167],v[96:99],v[148:151]
rtr a[12:13],v12,4360
m16 v[180:183],a[164:167],v[100:103],v[180:183]
buffer_load_dwordx4 a[140:143], v211, s[24:27], 0 offen offset:1024 sc1
m16 v[120:123],a[168:171],v[92:95],v[120:123]
rtr a[14:15],v12,5384
buffer_load_dwordx4 v210, s[56:59], s45 offen offset:2048 lds
m16 v[152:155],a[168:171],v[96:99],v[152:155]
rtr a[16:17],v12,4608
m16 v[184:187],a[168:171],v[100:103],v[184:187]
rtr a[18:19],v12,5632
m16 v[124:127],a[172:175],v[92:95],v[124:127]
m16 v[156:159],a[172:175],v[96:99],v[156:159]
rtr a[20:21],v12,4616
buffer_load_dwordx4 a[144:147], v211, s[24:27], 0 offen offset:2048 sc1
m16 v[188:191],a[172:175],v[100:103],v[188:191]
rtr a[22:23],v12,5640
m16 v[128:131],a[176:179],v[92:95],v[128:131]
rtr a[24:25],v12,4864
m16 v[160:163],a[176:179],v[96:99],v[160:163]
m16 v[192:195],a[176:179],v[100:103],v[192:195]
rtr a[26:27],v12,5888
buffer_load_dwordx4 v210, s[56:59], s46 offen offset:3072 lds
m16 v[132:135],a[180:183],v[92:95],v[132:135]
rtr a[28:29],v12,4872
m16 v[164:167],a[180:183],v[96:99],v[164:167]
rtr a[30:31],v12,5896
buffer_load_dwordx4 a[148:151], v211, s[24:27], s47 offen offset:0 sc1
m16 v[196:199],a[180:183],v[100:103],v[196:199]
m16 v[136:139],a[184:187],v[92:95],v[136:139]
m16 v[168:171],a[184:187],v[96:99],v[168:171]
m16 v[200:203],a[184:187],v[100:103],v[200:203]
m16 v[140:143],a[188:191],v[92:95],v[140:143]
m16 v[172:175],a[188:191],v[96:99],v[172:175]
m16 v[204:207],a[188:191],v[100:103],v[204:207]
s_waitcnt vmcnt(16) lgkmcnt(0)
m16 v[112:115],a[224:227],v[104:107],v[112:115]
rtr a[192:193],v10,0
v_add_u32 v210, 0xffca0000, v210
m16 v[144:147],a[224:227],v[108:111],v[144:147]
rtr a[194:195],v10,1024
buffer_load_dwordx4 a[152:155], v211, s[24:27], s47 offen offset:1024 sc1
m16 v[176:179],a[224:227],a[96:99],v[176:179]
rtr a[196:197],v10,8
m16 v[116:119],a[228:231],v[104:107],v[116:119]
rtr a[198:199],v10,1032
m16 v[148:151],a[228:231],v[108:111],v[148:151]
m16 v[180:183],a[228:231],a[96:99],v[180:183]
rtr a[200:201],v10,256
m16 v[120:123],a[232:235],v[104:107],v[120:123]
rtr a[202:203],v10,1280
m16 v[152:155],a[232:235],v[108:111],v[152:155]
rtr a[204:205],v10,264
s_add_u32 m0, s70, 84480
m16 v[184:187],a[232:235],a[96:99],v[184:187]
buffer_load_dwordx4 a[156:159], v211, s[24:27], s47 offen offset:2048 sc1
m16 v[124:127],a[236:239],v[104:107],v[124:127]
rtr a[206:207],v10,1288
m16 v[156:159],a[236:239],v[108:111],v[156:159]
rtr a[208:209],v10,512
m16 v[188:191],a[236:239],a[96:99],v[188:191]
rtr a[210:211],v10,1536
m16 v[128:131],a[240:243],v[104:107],v[128:131]
m16 v[160:163],a[240:243],v[108:111],v[160:163]
rtr a[212:213],v10,520
v_add_u32 v211, 0x10800, v211
buffer_load_dwordx4 a[32:35], v211, s[24:27], 0 offen offset:0 sc1
m16 v[192:195],a[240:243],a[96:99],v[192:195]
rtr a[214:215],v10,1544
m16 v[132:135],a[244:247],v[104:107],v[132:135]
rtr a[216:217],v10,768
buffer_load_dwordx4 v210, s[56:59], 0 offen offset:0 lds
m16 v[164:167],a[244:247],v[108:111],v[164:167]
m16 v[196:199],a[244:247],a[96:99],v[196:199]
rtr a[218:219],v10,1792
m16 v[136:139],a[248:251],v[104:107],v[136:139]
rtr a[220:221],v10,776
m16 v[168:171],a[248:251],v[108:111],v[168:171]
rtr a[222:223],v10,1800
m16 v[200:203],a[248:251],a[96:99],v[200:203]
buffer_load_dwordx4 a[36:39], v211, s[24:27], 0 offen offset:1024 sc1
m16 v[140:143],a[252:255],v[104:107],v[140:143]
rtr a[160:161],v10,4096
m16 v[172:175],a[252:255],v[108:111],v[172:175]
rtr a[162:163],v10,5120
m16 v[204:207],a[252:255],a[96:99],v[204:207]
rtr a[164:165],v10,4104
buffer_load_dwordx4 v210, s[56:59], s44 offen offset:1024 lds
m16 v[112:115],a[0:3],a[100:103],v[112:115]
rtr a[166:167],v10,5128
m16 v[144:147],a[0:3],a[104:107],v[144:147]
m16 v[176:179],a[0:3],a[108:111],v[176:179]
rtr a[168:169],v10,4352
buffer_load_dwordx4 a[40:43], v211, s[24:27], 0 offen offset:2048 sc1
m16 v[116:119],a[4:7],a[100:103],v[116:119]
rtr a[170:171],v10,5376
m16 v[148:151],a[4:7],a[104:107],v[148:151]
rtr a[172:173],v10,4360
m16 v[180:183],a[4:7],a[108:111],v[180:183]
m16 v[120:123],a[8:11],a[100:103],v[120:123]
rtr a[174:175],v10,5384
buffer_load_dwordx4 v210, s[56:59], s45 offen offset:2048 lds
m16 v[152:155],a[8:11],a[104:107],v[152:155]
rtr a[176:177],v10,4608
m16 v[184:187],a[8:11],a[108:111],v[184:187]
rtr a[178:179],v10,5632
m16 v[124:127],a[12:15],a[100:103],v[124:127]
buffer_load_dwordx4 a[44:47], v211, s[24:27], s47 offen offset:0 sc1
m16 v[156:159],a[12:15],a[104:107],v[156:159]
rtr a[180:181],v10,4616
m16 v[188:191],a[12:15],a[108:111],v[188:191]
rtr a[182:183],v10,5640
m16 v[128:131],a[16:19],a[100:103],v[128:131]
rtr a[184:185],v10,4864
m16 v[160:163],a[16:19],a[104:107],v[160:163]
m16 v[192:195],a[16:19],a[108:111],v[192:195]
rtr a[186:187],v10,5888
buffer_load_dwordx4 v210, s[56:59], s46 offen offset:3072 lds
m16 v[132:135],a[20:23],a[100:103],v[132:135]
rtr a[188:189],v10,4872
buffer_load_dwordx4 a[48:51], v211, s[24:27], s47 offen offset:1024 sc1
m16 v[164:167],a[20:23],a[104:107],v[164:167]
rtr a[190:191],v10,5896
m16 v[196:199],a[20:23],a[108:111],v[196:199]
m16 v[136:139],a[24:27],a[100:103],v[136:139]
m16 v[168:171],a[24:27],a[104:107],v[168:171]
m16 v[200:203],a[24:27],a[108:111],v[200:203]
m16 v[140:143],a[28:31],a[100:103],v[140:143]
m16 v[172:175],a[28:31],a[104:107],v[172:175]
m16 v[204:207],a[28:31],a[108:111],v[204:207]
s_waitcnt vmcnt(18) lgkmcnt(0)
s_barrier
m16 v[112:115],a[192:195],a[112:115],v[112:115]
rtr a[224:225],v10,33792
v_add_u32 v210, 0x20000, v210
m16 v[144:147],a[192:195],a[116:119],v[144:147]
rtr a[226:227],v10,34816
buffer_load_dwordx4 a[52:55], v211, s[24:27], s47 offen offset:2048 sc1
m16 v[176:179],a[192:195],a[120:123],v[176:179]
rtr a[228:229],v10,33800
m16 v[116:119],a[196:199],a[112:115],v[116:119]
rtr a[230:231],v10,34824
m16 v[148:151],a[196:199],a[116:119],v[148:151]
m16 v[180:183],a[196:199],a[120:123],v[180:183]
rtr a[232:233],v10,34048
m16 v[120:123],a[200:203],a[112:115],v[120:123]
rtr a[234:235],v10,35072
s_add_u32 m0, s70, 118272
m16 v[152:155],a[200:203],a[116:119],v[152:155]
v_add_u32 v211, 0x5800, v211
buffer_load_dwordx4 a[56:59], v211, s[24:27], 0 offen offset:0 sc1
rtr a[236:237],v10,34056
m16 v[184:187],a[200:203],a[120:123],v[184:187]
m16 v[124:127],a[204:207],a[112:115],v[124:127]
rtr a[238:239],v10,35080
m16 v[156:159],a[204:207],a[116:119],v[156:159]
rtr a[240:241],v10,34304
m16 v[188:191],a[204:207],a[120:123],v[188:191]
rtr a[242:243],v10,35328
m16 v[128:131],a[208:211],a[112:115],v[128:131]
buffer_load_dwordx4 a[60:63], v211, s[24:27], 0 offen offset:1024 sc1
m16 v[160:163],a[208:211],a[116:119],v[160:163]
rtr a[244:245],v10,34312
buffer_load_dwordx4 v210, s[56:59], 0 offen offset:0 lds
m16 v[192:195],a[208:211],a[120:123],v[192:195]
rtr a[246:247],v10,35336
m16 v[132:135],a[212:215],a[112:115],v[132:135]
rtr a[248:249],v10,34560
m16 v[164:167],a[212:215],a[116:119],v[164:167]
m16 v[196:199],a[212:215],a[120:123],v[196:199]
rtr a[250:251],v10,35584
buffer_load_dwordx4 a[64:67], v211, s[24:27], 0 offen offset:2048 sc1
m16 v[136:139],a[216:219],a[112:115],v[136:139]
rtr a[252:253],v10,34568
m16 v[168:171],a[216:219],a[116:119],v[168:171]
rtr a[254:255],v10,35592
buffer_load_dwordx4 v210, s[56:59], s44 offen offset:1024 lds
m16 v[200:203],a[216:219],a[120:123],v[200:203]
m16 v[140:143],a[220:223],a[112:115],v[140:143]
rtr a[0:1],v10,37888
m16 v[172:175],a[220:223],a[116:119],v[172:175]
rtr a[2:3],v10,38912
m16 v[204:207],a[220:223],a[120:123],v[204:207]
rtr a[4:5],v10,37896
buffer_load_dwordx4 a[68:71], v211, s[24:27], s47 offen offset:0 sc1
m16 v[112:115],a[160:163],a[124:127],v[112:115]
rtr a[6:7],v10,38920
m16 v[144:147],a[160:163],a[128:131],v[144:147]
m16 v[176:179],a[160:163],a[132:135],v[176:179]
rtr a[8:9],v10,38144
buffer_load_dwordx4 v210, s[56:59], s45 offen offset:2048 lds
m16 v[116:119],a[164:167],a[124:127],v[116:119]
rtr a[10:11],v10,39168
m16 v[148:151],a[164:167],a[128:131],v[148:151]
rtr a[12:13],v10,38152
m16 v[180:183],a[164:167],a[132:135],v[180:183]
buffer_load_dwordx4 a[72:75], v211, s[24:27], s47 offen offset:1024 sc1
m16 v[120:123],a[168:171],a[124:127],v[120:123]
rtr a[14:15],v10,39176
m16 v[152:155],a[168:171],a[128:131],v[152:155]
rtr a[16:17],v10,38400
m16 v[184:187],a[168:171],a[132:135],v[184:187]
rtr a[18:19],v10,39424
buffer_load_dwordx4 v210, s[56:59], s46 offen offset:3072 lds
m16 v[124:127],a[172:175],a[124:127],v[124:127]
m16 v[156:159],a[172:175],a[128:131],v[156:159]
rtr a[20:21],v10,38408
buffer_load_dwordx4 a[76:79], v211, s[24:27], s47 offen offset:2048 sc1
m16 v[188:191],a[172:175],a[132:135],v[188:191]
rtr a[22:23],v10,39432
m16 v[128:131],a[176:179],a[124:127],v[128:131]
rtr a[24:25],v10,38656
m16 v[160:163],a[176:179],a[128:131],v[160:163]
m16 v[192:195],a[176:179],a[132:135],v[192:195]
rtr a[26:27],v10,39680
m16 v[132:135],a[180:183],a[124:127],v[132:135]
rtr a[28:29],v10,38664
buffer_load_dword v254, v13, s[24:27], 0 offen sc1
m16 v[164:167],a[180:183],a[128:131],v[164:167]
rtr a[30:31],v10,39688
v_add_u32 v211, 0x10800, v211
buffer_load_dwordx4 a[80:83], v211, s[24:27], 0 offen offset:0 sc1
m16 v[196:199],a[180:183],a[132:135],v[196:199]
m16 v[136:139],a[184:187],a[124:127],v[136:139]
m16 v[168:171],a[184:187],a[128:131],v[168:171]
m16 v[200:203],a[184:187],a[132:135],v[200:203]
m16 v[140:143],a[188:191],a[124:127],v[140:143]
m16 v[172:175],a[188:191],a[128:131],v[172:175]
m16 v[204:207],a[188:191],a[132:135],v[204:207]
s_waitcnt vmcnt(22) lgkmcnt(0)
m16 v[112:115],a[224:227],a[136:139],v[112:115]
rtr a[192:193],v10,16896
v_add_u32 v210, 0x60000, v210
m16 v[144:147],a[224:227],a[140:143],v[144:147]
rtr a[194:195],v10,17920
buffer_load_dwordx4 a[84:87], v211, s[24:27], 0 offen offset:1024 sc1
m16 v[176:179],a[224:227],a[144:147],v[176:179]
rtr a[196:197],v10,16904
m16 v[116:119],a[228:231],a[136:139],v[116:119]
rtr a[198:199],v10,17928
m16 v[148:151],a[228:231],a[140:143],v[148:151]
m16 v[180:183],a[228:231],a[144:147],v[180:183]
rtr a[200:201],v10,17152
m16 v[120:123],a[232:235],a[136:139],v[120:123]
rtr a[202:203],v10,18176
m16 v[152:155],a[232:235],a[140:143],v[152:155]
rtr a[204:205],v10,17160
s_add_u32 m0, s70, 147424
m16 v[184:187],a[232:235],a[144:147],v[184:187]
buffer_load_dwordx4 a[88:91], v211, s[24:27], 0 offen offset:2048 sc1
m16 v[124:127],a[236:239],a[136:139],v[124:127]
rtr a[206:207],v10,18184
m16 v[156:159],a[236:239],a[140:143],v[156:159]
rtr a[208:209],v10,17408
m16 v[188:191],a[236:239],a[144:147],v[188:191]
rtr a[210:211],v10,18432
m16 v[128:131],a[240:243],a[136:139],v[128:131]
m16 v[160:163],a[240:243],a[140:143],v[160:163]
rtr a[212:213],v10,17416
buffer_load_dwordx4 a[92:95], v211, s[24:27], s47 offen offset:0 sc1
m16 v[192:195],a[240:243],a[144:147],v[192:195]
rtr a[214:215],v10,18440
m16 v[132:135],a[244:247],a[136:139],v[132:135]
rtr a[216:217],v10,17664
buffer_load_dwordx4 v210, s[56:59], 0 offen offset:0 lds
m16 v[164:167],a[244:247],a[140:143],v[164:167]
m16 v[196:199],a[244:247],a[144:147],v[196:199]
rtr a[218:219],v10,18688
m16 v[136:139],a[248:251],a[136:139],v[136:139]
rtr a[220:221],v10,17672
m16 v[168:171],a[248:251],a[140:143],v[168:171]
rtr a[222:223],v10,18696
m16 v[200:203],a[248:251],a[144:147],v[200:203]
buffer_load_dwordx4 v[16:19], v211, s[24:27], s47 offen offset:1024 sc1
m16 v[140:143],a[252:255],a[136:139],v[140:143]
rtr a[160:161],v10,20992
m16 v[172:175],a[252:255],a[140:143],v[172:175]
rtr a[162:163],v10,22016
m16 v[204:207],a[252:255],a[144:147],v[204:207]
rtr a[164:165],v10,21000
buffer_load_dwordx4 v210, s[56:59], s44 offen offset:1024 lds
m16 v[112:115],a[0:3],a[148:151],v[112:115]
rtr a[166:167],v10,22024
m16 v[144:147],a[0:3],a[152:155],v[144:147]
m16 v[176:179],a[0:3],a[156:159],v[176:179]
rtr a[168:169],v10,21248
buffer_load_dwordx4 v[20:23], v211, s[24:27], s47 offen offset:2048 sc1
m16 v[116:119],a[4:7],a[148:151],v[116:119]
rtr a[170:171],v10,22272
m16 v[148:151],a[4:7],a[152:155],v[148:151]
rtr a[172:173],v10,21256
m16 v[180:183],a[4:7],a[156:159],v[180:183]
m16 v[120:123],a[8:11],a[148:151],v[120:123]
rtr a[174:175],v10,22280
buffer_load_dwordx4 v210, s[56:59], s45 offen offset:2048 lds
m16 v[152:155],a[8:11],a[152:155],v[152:155]
rtr a[176:177],v10,21504
m16 v[184:187],a[8:11],a[156:159],v[184:187]
rtr a[178:179],v10,22528
m16 v[124:127],a[12:15],a[148:151],v[124:127]
v_add_u32 v211, 0x5800, v211
buffer_load_dwordx4 v[24:27], v211, s[24:27], 0 offen offset:0 sc1
m16 v[156:159],a[12:15],a[152:155],v[156:159]
rtr a[180:181],v10,21512
m16 v[188:191],a[12:15],a[156:159],v[188:191]
rtr a[182:183],v10,22536
m16 v[128:131],a[16:19],a[148:151],v[128:131]
rtr a[184:185],v10,21760
m16 v[160:163],a[16:19],a[152:155],v[160:163]
m16 v[192:195],a[16:19],a[156:159],v[192:195]
rtr a[186:187],v10,22784
buffer_load_dwordx4 v210, s[56:59], s46 offen offset:3072 lds
m16 v[132:135],a[20:23],a[148:151],v[132:135]
rtr a[188:189],v10,21768
buffer_load_dwordx4 v[28:31], v211, s[24:27], 0 offen offset:1024 sc1
m16 v[164:167],a[20:23],a[152:155],v[164:167]
rtr a[190:191],v10,22792
m16 v[196:199],a[20:23],a[156:159],v[196:199]
m16 v[136:139],a[24:27],a[148:151],v[136:139]
m16 v[168:171],a[24:27],a[152:155],v[168:171]
m16 v[200:203],a[24:27],a[156:159],v[200:203]
m16 v[140:143],a[28:31],a[148:151],v[140:143]
m16 v[172:175],a[28:31],a[152:155],v[172:175]
m16 v[204:207],a[28:31],a[156:159],v[204:207]
s_waitcnt vmcnt(23) lgkmcnt(0)
s_barrier
s_waitcnt vmcnt(12)
v_cmp_ne_u32 vcc, 1, v254
s_mov_b32 s28, 0
s_nop 0
s_cmp_eq_u64 vcc, 0
s_cbranch_scc1 La_p1_ok
s_mov_b32 s29, 20000
La_p1:
s_sleep 2
buffer_load_dword v254, v13, s[24:27], 0 offen sc1
s_waitcnt vmcnt(0)
s_sub_u32 s29, s29, 1
s_cmp_eq_u32 s29, 0
s_cbranch_scc1 La_p1_ok
v_cmp_ne_u32 vcc, 1, v254
s_mov_b32 s28, 0
s_nop 0
s_cmp_eq_u64 vcc, 0
s_cbranch_scc0 La_p1
La_p1_ok:
m16 v[112:115],a[192:195],a[32:35],v[112:115]
rtr a[224:225],v11,0
v_add_u32 v210, 0x20000, v210
m16 v[144:147],a[192:195],a[36:39],v[144:147]
rtr a[226:227],v11,1024
buffer_load_dwordx4 v[32:35], v211, s[24:27], 0 offen offset:2048 sc1
m16 v[176:179],a[192:195],a[40:43],v[176:179]
rtr a[228:229],v11,8
m16 v[116:119],a[196:199],a[32:35],v[116:119]
rtr a[230:231],v11,1032
m16 v[148:151],a[196:199],a[36:39],v[148:151]
m16 v[180:183],a[196:199],a[40:43],v[180:183]
rtr a[232:233],v11,256
m16 v[120:123],a[200:203],a[32:35],v[120:123]
rtr a[234:235],v11,1280
buffer_load_dwordx4 v[36:39], v211, s[24:27], s47 offen offset:0 sc1
m16 v[152:155],a[200:203],a[36:39],v[152:155]
rtr a[236:237],v11,264
s_add_u32 m0, s70, 0
m16 v[184:187],a[200:203],a[40:43],v[184:187]
m16 v[124:127],a[204:207],a[32:35],v[124:127]
rtr a[238:239],v11,1288
m16 v[156:159],a[204:207],a[36:39],v[156:159]
rtr a[240:241],v11,512
m16 v[188:191],a[204:207],a[40:43],v[188:191]
rtr a[242:243],v11,1536
m16 v[128:131],a[208:211],a[32:35],v[128:131]
buffer_load_dwordx4 v[40:43], v211, s[24:27], s47 offen offset:1024 sc1
m16 v[160:163],a[208:211],a[36:39],v[160:163]
rtr a[244:245],v11,520
m16 v[192:195],a[208:211],a[40:43],v[192:195]
rtr a[246:247],v11,1544
m16 v[132:135],a[212:215],a[32:35],v[132:135]
rtr a[248:249],v11,768
buffer_load_dwordx4 v210, s[56:59], 0 offen offset:0 lds
m16 v[164:167],a[212:215],a[36:39],v[164:167]
m16 v[196:199],a[212:215],a[40:43],v[196:199]
rtr a[250:251],v11,1792
buffer_load_dwordx4 v[44:47], v211, s[24:27], s47 offen offset:2048 sc1
m16 v[136:139],a[216:219],a[32:35],v[136:139]
rtr a[252:253],v11,776
m16 v[168:171],a[216:219],a[36:39],v[168:171]
rtr a[254:255],v11,1800
m16 v[200:203],a[216:219],a[40:43],v[200:203]
m16 v[140:143],a[220:223],a[32:35],v[140:143]
rtr a[0:1],v11,4096
m16 v[172:175],a[220:223],a[36:39],v[172:175]
rtr a[2:3],v11,5120
m16 v[204:207],a[220:223],a[40:43],v[204:207]
rtr a[4:5],v11,4104
buffer_load_dwordx4 v210, s[56:59], s44 offen offset:1024 lds
m16 v[112:115],a[160:163],a[44:47],v[112:115]
v_add_u32 v211, 0xfff6b800, v211
buffer_load_dwordx4 v[48:51], v211, s[24:27], 0 offen offset:0 sc1
rtr a[6:7],v11,5128
m16 v[144:147],a[160:163],a[48:51],v[144:147]
m16 v[176:179],a[160:163],a[52:55],v[176:179]
rtr a[8:9],v11,4352
m16 v[116:119],a[164:167],a[44:47],v[116:119]
rtr a[10:11],v11,5376
m16 v[148:151],a[164:167],a[48:51],v[148:151]
rtr a[12:13],v11,4360
m16 v[180:183],a[164:167],a[52:55],v[180:183]
buffer_load_dwordx4 v[52:55], v211, s[24:27], 0 offen offset:1024 sc1
m16 v[120:123],a[168:171],a[44:47],v[120:123]
rtr a[14:15],v11,5384
buffer_load_dwordx4 v210, s[56:59], s45 offen offset:2048 lds
m16 v[152:155],a[168:171],a[48:51],v[152:155]
rtr a[16:17],v11,4608
m16 v[184:187],a[168:171],a[52:55],v[184:187]
rtr a[18:19],v11,5632
m16 v[124:127],a[172:175],a[44:47],v[124:127]
m16 v[156:159],a[172:175],a[48:51],v[156:159]
rtr a[20:21],v11,4616
buffer_load_dwordx4 v[56:59], v211, s[24:27], 0 offen offset:2048 sc1
m16 v[188:191],a[172:175],a[52:55],v[188:191]
rtr a[22:23],v11,5640
m16 v[128:131],a[176:179],a[44:47],v[128:131]
rtr a[24:25],v11,4864
m16 v[160:163],a[176:179],a[48:51],v[160:163]
m16 v[192:195],a[176:179],a[52:55],v[192:195]
rtr a[26:27],v11,5888
buffer_load_dwordx4 v210, s[56:59], s46 offen offset:3072 lds
m16 v[132:135],a[180:183],a[44:47],v[132:135]
rtr a[28:29],v11,4872
m16 v[164:167],a[180:183],a[48:51],v[164:167]
rtr a[30:31],v11,5896
buffer_load_dwordx4 v[60:63], v211, s[24:27], s47 offen offset:0 sc1
m16 v[196:199],a[180:183],a[52:55],v[196:199]
m16 v[136:139],a[184:187],a[44:47],v[136:139]
m16 v[168:171],a[184:187],a[48:51],v[168:171]
m16 v[200:203],a[184:187],a[52:55],v[200:203]
m16 v[140:143],a[188:191],a[44:47],v[140:143]
m16 v[172:175],a[188:191],a[48:51],v[172:175]
m16 v[204:207],a[188:191],a[52:55],v[204:207]
s_waitcnt lgkmcnt(0)
m16 v[112:115],a[224:227],a[56:59],v[112:115]
rtr a[192:193],v10,50688
v_add_u32 v210, 0x60000, v210
m16 v[144:147],a[224:227],a[60:63],v[144:147]
rtr a[194:195],v10,51712
buffer_load_dwordx4 v[64:67], v211, s[24:27], s47 offen offset:1024 sc1
m16 v[176:179],a[224:227],a[64:67],v[176:179]
rtr a[196:197],v10,50696
m16 v[116:119],a[228:231],a[56:59],v[116:119]
rtr a[198:199],v10,51720
m16 v[148:151],a[228:231],a[60:63],v[148:151]
m16 v[180:183],a[228:231],a[64:67],v[180:183]
rtr a[200:201],v10,50944
m16 v[120:123],a[232:235],a[56:59],v[120:123]
rtr a[202:203],v10,51968
m16 v[152:155],a[232:235],a[60:63],v[152:155]
rtr a[204:205],v10,50952
s_add_u32 m0, s70, 33792
m16 v[184:187],a[232:235],a[64:67],v[184:187]
buffer_load_dwordx4 v[68:71], v211, s[24:27], s47 offen offset:2048 sc1
m16 v[124:127],a[236:239],a[56:59],v[124:127]
rtr a[206:207],v10,51976
m16 v[156:159],a[236:239],a[60:63],v[156:159]
rtr a[208:209],v10,51200
m16 v[188:191],a[236:239],a[64:67],v[188:191]
rtr a[210:211],v10,52224
m16 v[128:131],a[240:243],a[56:59],v[128:131]
m16 v[160:163],a[240:243],a[60:63],v[160:163]
rtr a[212:213],v10,51208
v_add_u32 v211, 0x5800, v211
buffer_load_dwordx4 v[72:75], v211, s[24:27], 0 offen offset:0 sc1
m16 v[192:195],a[240:243],a[64:67],v[192:195]
rtr a[214:215],v10,52232
m16 v[132:135],a[244:247],a[56:59],v[132:135]
rtr a[216:217],v10,51456
buffer_load_dwordx4 v210, s[56:59], 0 offen offset:0 lds
m16 v[164:167],a[244:247],a[60:63],v[164:167]
m16 v[196:199],a[244:247],a[64:67],v[196:199]
rtr a[218:219],v10,52480
m16 v[136:139],a[248:251],a[56:59],v[136:139]
rtr a[220:221],v10,51464
m16 v[168:171],a[248:251],a[60:63],v[168:171]
rtr a[222:223],v10,52488
m16 v[200:203],a[248:251],a[64:67],v[200:203]
buffer_load_dwordx4 v[76:79], v211, s[24:27], 0 offen offset:1024 sc1
m16 v[140:143],a[252:255],a[56:59],v[140:143]
rtr a[160:161],v10,54784
m16 v[172:175],a[252:255],a[60:63],v[172:175]
rtr a[162:163],v10,55808
m16 v[204:207],a[252:255],a[64:67],v[204:207]
rtr a[164:165],v10,54792
buffer_load_dwordx4 v210, s[56:59], s44 offen offset:1024 lds
m16 v[112:115],a[0:3],a[68:71],v[112:115]
rtr a[166:167],v10,55816
m16 v[144:147],a[0:3],a[72:75],v[144:147]
m16 v[176:179],a[0:3],a[76:79],v[176:179]
rtr a[168:169],v10,55040
buffer_load_dwordx4 v[80:83], v211, s[24:27], 0 offen offset:2048 sc1
m16 v[116:119],a[4:7],a[68:71],v[116:119]
rtr a[170:171],v10,56064
m16 v[148:151],a[4:7],a[72:75],v[148:151]
rtr a[172:173],v10,55048
m16 v[180:183],a[4:7],a[76:79],v[180:183]
m16 v[120:123],a[8:11],a[68:71],v[120:123]
rtr a[174:175],v10,56072
buffer_load_dwordx4 v210, s[56:59], s45 offen offset:2048 lds
m16 v[152:155],a[8:11],a[72:75],v[152:155]
rtr a[176:177],v10,55296
m16 v[184:187],a[8:11],a[76:79],v[184:187]
rtr a[178:179],v10,56320
m16 v[124:127],a[12:15],a[68:71],v[124:127]
buffer_load_dwordx4 v[84:87], v211, s[24:27], s47 offen offset:0 sc1
m16 v[156:159],a[12:15],a[72:75],v[156:159]
rtr a[180:181],v10,55304
m16 v[188:191],a[12:15],a[76:79],v[188:191]
rtr a[182:183],v10,56328
m16 v[128:131],a[16:19],a[68:71],v[128:131]
rtr a[184:185],v10,55552
m16 v[160:163],a[16:19],a[72:75],v[160:163]
m16 v[192:195],a[16:19],a[76:79],v[192:195]
rtr a[186:187],v10,56576
buffer_load_dwordx4 v210, s[56:59], s46 offen offset:3072 lds
m16 v[132:135],a[20:23],a[68:71],v[132:135]
rtr a[188:189],v10,55560
buffer_load_dwordx4 v[88:91], v211, s[24:27], s47 offen offset:1024 sc1
m16 v[164:167],a[20:23],a[72:75],v[164:167]
rtr a[190:191],v10,56584
m16 v[196:199],a[20:23],a[76:79],v[196:199]
m16 v[136:139],a[24:27],a[68:71],v[136:139]
m16 v[168:171],a[24:27],a[72:75],v[168:171]
m16 v[200:203],a[24:27],a[76:79],v[200:203]
m16 v[140:143],a[28:31],a[68:71],v[140:143]
m16 v[172:175],a[28:31],a[72:75],v[172:175]
m16 v[204:207],a[28:31],a[76:79],v[204:207]
s_waitcnt vmcnt(27) lgkmcnt(0)
s_barrier
m16 v[112:115],a[192:195],a[80:83],v[112:115]
rtr a[224:225],v11,33792
v_add_u32 v210, 0x20000, v210
m16 v[144:147],a[192:195],a[84:87],v[144:147]
rtr a[226:227],v11,34816
buffer_load_dwordx4 v[92:95], v211, s[24:27], s47 offen offset:2048 sc1
m16 v[176:179],a[192:195],a[88:91],v[176:179]
rtr a[228:229],v11,33800
m16 v[116:119],a[196:199],a[80:83],v[116:119]
rtr a[230:231],v11,34824
m16 v[148:151],a[196:199],a[84:87],v[148:151]
m16 v[180:183],a[196:199],a[88:91],v[180:183]
rtr a[232:233],v11,34048
m16 v[120:123],a[200:203],a[80:83],v[120:123]
rtr a[234:235],v11,35072
v_add_u32 v211, 0x10800, v211
buffer_load_dwordx4 v[96:99], v211, s[24:27], 0 offen offset:0 sc1
m16 v[152:155],a[200:203],a[84:87],v[152:155]
rtr a[236:237],v11,34056
s_add_u32 m0, s70, 16896
m16 v[184:187],a[200:203],a[88:91],v[184:187]
m16 v[124:127],a[204:207],a[80:83],v[124:127]
rtr a[238:239],v11,35080
m16 v[156:159],a[204:207],a[84:87],v[156:159]
rtr a[240:241],v11,34304
m16 v[188:191],a[204:207],a[88:91],v[188:191]
rtr a[242:243],v11,35328
m16 v[128:131],a[208:211],a[80:83],v[128:131]
buffer_load_dwordx4 v[100:103], v211, s[24:27], 0 offen offset:1024 sc1
m16 v[160:163],a[208:211],a[84:87],v[160:163]
rtr a[244:245],v11,34312
m16 v[192:195],a[208:211],a[88:91],v[192:195]
rtr a[246:247],v11,35336
m16 v[132:135],a[212:215],a[80:83],v[132:135]
rtr a[248:249],v11,34560
buffer_load_dwordx4 v210, s[56:59], 0 offen offset:0 lds
m16 v[164:167],a[212:215],a[84:87],v[164:167]
m16 v[196:199],a[212:215],a[88:91],v[196:199]
rtr a[250:251],v11,35584
buffer_load_dwordx4 v[104:107], v211, s[24:27], 0 offen offset:2048 sc1
m16 v[136:139],a[216:219],a[80:83],v[136:139]
rtr a[252:253],v11,34568
m16 v[168:171],a[216:219],a[84:87],v[168:171]
rtr a[254:255],v11,35592
m16 v[200:203],a[216:219],a[88:91],v[200:203]
m16 v[140:143],a[220:223],a[80:83],v[140:143]
rtr a[0:1],v11,37888
m16 v[172:175],a[220:223],a[84:87],v[172:175]
rtr a[2:3],v11,38912
m16 v[204:207],a[220:223],a[88:91],v[204:207]
rtr a[4:5],v11,37896
buffer_load_dwordx4 v210, s[56:59], s44 offen offset:1024 lds
m16 v[112:115],a[160:163],a[92:95],v[112:115]
buffer_load_dwordx4 v[108:111], v211, s[24:27], s47 offen offset:0 sc1
rtr a[6:7],v11,38920
m16 v[144:147],a[160:163],v[16:19],v[144:147]
m16 v[176:179],a[160:163],v[20:23],v[176:179]
rtr a[8:9],v11,38144
m16 v[116:119],a[164:167],a[92:95],v[116:119]
rtr a[10:11],v11,39168
m16 v[148:151],a[164:167],v[16:19],v[148:151]
rtr a[12:13],v11,38152
m16 v[180:183],a[164:167],v[20:23],v[180:183]
buffer_load_dwordx4 a[96:99], v211, s[24:27], s47 offen offset:1024 sc1
m16 v[120:123],a[168:171],a[92:95],v[120:123]
rtr a[14:15],v11,39176
buffer_load_dwordx4 v210, s[56:59], s45 offen offset:2048 lds
m16 v[152:155],a[168:171],v[16:19],v[152:155]
rtr a[16:17],v11,38400
m16 v[184:187],a[168:171],v[20:23],v[184:187]
rtr a[18:19],v11,39424
m16 v[124:127],a[172:175],a[92:95],v[124:127]
m16 v[156:159],a[172:175],v[16:19],v[156:159]
rtr a[20:21],v11,38408
buffer_load_dwordx4 a[100:103], v211, s[24:27], s47 offen offset:2048 sc1
m16 v[188:191],a[172:175],v[20:23],v[188:191]
rtr a[22:23],v11,39432
m16 v[128:131],a[176:179],a[92:95],v[128:131]
rtr a[24:25],v11,38656
m16 v[160:163],a[176:179],v[16:19],v[160:163]
m16 v[192:195],a[176:179],v[20:23],v[192:195]
rtr a[26:27],v11,39680
buffer_load_dwordx4 v210, s[56:59], s46 offen offset:3072 lds
m16 v[132:135],a[180:183],a[92:95],v[132:135]
rtr a[28:29],v11,38664
m16 v[164:167],a[180:183],v[16:19],v[164:167]
rtr a[30:31],v11,39688
v_add_u32 v211, 0x5800, v211
buffer_load_dwordx4 a[104:107], v211, s[24:27], 0 offen offset:0 sc1
m16 v[196:199],a[180:183],v[20:23],v[196:199]
m16 v[136:139],a[184:187],a[92:95],v[136:139]
m16 v[168:171],a[184:187],v[16:19],v[168:171]
m16 v[200:203],a[184:187],v[20:23],v[200:203]
m16 v[140:143],a[188:191],a[92:95],v[140:143]
m16 v[172:175],a[188:191],v[16:19],v[172:175]
m16 v[204:207],a[188:191],v[20:23],v[204:207]
s_waitcnt vmcnt(30) lgkmcnt(0)
m16 v[112:115],a[224:227],v[24:27],v[112:115]
rtr a[192:193],v11,16896
v_add_u32 v210, 0x60000, v210
m16 v[144:147],a[224:227],v[28:31],v[144:147]
rtr a[194:195],v11,17920
buffer_load_dwordx4 a[108:111], v211, s[24:27], 0 offen offset:1024 sc1
m16 v[176:179],a[224:227],v[32:35],v[176:179]
rtr a[196:197],v11,16904
m16 v[116:119],a[228:231],v[24:27],v[116:119]
rtr a[198:199],v11,17928
m16 v[148:151],a[228:231],v[28:31],v[148:151]
m16 v[180:183],a[228:231],v[32:35],v[180:183]
rtr a[200:201],v11,17152
m16 v[120:123],a[232:235],v[24:27],v[120:123]
rtr a[202:203],v11,18176
m16 v[152:155],a[232:235],v[28:31],v[152:155]
rtr a[204:205],v11,17160
s_add_u32 m0, s70, 67584
m16 v[184:187],a[232:235],v[32:35],v[184:187]
buffer_load_dwordx4 a[112:115], v211, s[24:27], 0 offen offset:2048 sc1
m16 v[124:127],a[236:239],v[24:27],v[124:127]
rtr a[206:207],v11,18184
m16 v[156:159],a[236:239],v[28:31],v[156:159]
rtr a[208:209],v11,17408
m16 v[188:191],a[236:239],v[32:35],v[188:191]
rtr a[210:211],v11,18432
m16 v[128:131],a[240:243],v[24:27],v[128:131]
m16 v[160:163],a[240:243],v[28:31],v[160:163]
rtr a[212:213],v11,17416
buffer_load_dwordx4 a[116:119], v211, s[24:27], s47 offen offset:0 sc1
m16 v[192:195],a[240:243],v[32:35],v[192:195]
rtr a[214:215],v11,18440
m16 v[132:135],a[244:247],v[24:27],v[132:135]
rtr a[216:217],v11,17664
buffer_load_dwordx4 v210, s[56:59], 0 offen offset:0 lds
m16 v[164:167],a[244:247],v[28:31],v[164:167]
m16 v[196:199],a[244:247],v[32:35],v[196:199]
rtr a[218:219],v11,18688
m16 v[136:139],a[248:251],v[24:27],v[136:139]
rtr a[220:221],v11,17672
m16 v[168:171],a[248:251],v[28:31],v[168:171]
rtr a[222:223],v11,18696
m16 v[200:203],a[248:251],v[32:35],v[200:203]
buffer_load_dwordx4 a[120:123], v211, s[24:27], s47 offen offset:1024 sc1
m16 v[140:143],a[252:255],v[24:27],v[140:143]
rtr a[160:161],v11,20992
m16 v[172:175],a[252:255],v[28:31],v[172:175]
rtr a[162:163],v11,22016
m16 v[204:207],a[252:255],v[32:35],v[204:207]
rtr a[164:165],v11,21000
buffer_load_dwordx4 v210, s[56:59], s44 offen offset:1024 lds
m16 v[112:115],a[0:3],v[36:39],v[112:115]
rtr a[166:167],v11,22024
m16 v[144:147],a[0:3],v[40:43],v[144:147]
m16 v[176:179],a[0:3],v[44:47],v[176:179]
rtr a[168:169],v11,21248
buffer_load_dwordx4 a[124:127], v211, s[24:27], s47 offen offset:2048 sc1
m16 v[116:119],a[4:7],v[36:39],v[116:119]
rtr a[170:171],v11,22272
m16 v[148:151],a[4:7],v[40:43],v[148:151]
rtr a[172:173],v11,21256
m16 v[180:183],a[4:7],v[44:47],v[180:183]
m16 v[120:123],a[8:11],v[36:39],v[120:123]
rtr a[174:175],v11,22280
buffer_load_dwordx4 v210, s[56:59], s45 offen offset:2048 lds
m16 v[152:155],a[8:11],v[40:43],v[152:155]
rtr a[176:177],v11,21504
m16 v[184:187],a[8:11],v[44:47],v[184:187]
rtr a[178:179],v11,22528
m16 v[124:127],a[12:15],v[36:39],v[124:127]
v_add_u32 v211, 0x10800, v211
buffer_load_dwordx4 a[128:131], v211, s[24:27], 0 offen offset:0 sc1
m16 v[156:159],a[12:15],v[40:43],v[156:159]
rtr a[180:181],v11,21512
m16 v[188:191],a[12:15],v[44:47],v[188:191]
rtr a[182:183],v11,22536
m16 v[128:131],a[16:19],v[36:39],v[128:131]
rtr a[184:185],v11,21760
m16 v[160:163],a[16:19],v[40:43],v[160:163]
m16 v[192:195],a[16:19],v[44:47],v[192:195]
rtr a[186:187],v11,22784
buffer_load_dwordx4 v210, s[56:59], s46 offen offset:3072 lds
m16 v[132:135],a[20:23],v[36:39],v[132:135]
rtr a[188:189],v11,21768
buffer_load_dwordx4 a[132:135], v211, s[24:27], 0 offen offset:1024 sc1
m16 v[164:167],a[20:23],v[40:43],v[164:167]
rtr a[190:191],v11,22792
m16 v[196:199],a[20:23],v[44:47],v[196:199]
m16 v[136:139],a[24:27],v[36:39],v[136:139]
m16 v[168:171],a[24:27],v[40:43],v[168:171]
m16 v[200:203],a[24:27],v[44:47],v[200:203]
m16 v[140:143],a[28:31],v[36:39],v[140:143]
m16 v[172:175],a[28:31],v[40:43],v[172:175]
m16 v[204:207],a[28:31],v[44:47],v[204:207]
s_waitcnt vmcnt(32) lgkmcnt(0)
s_barrier
m16 v[112:115],a[192:195],v[48:51],v[112:115]
rtr a[224:225],v11,50688
v_add_u32 v210, 0x20000, v210
m16 v[144:147],a[192:195],v[52:55],v[144:147]
rtr a[226:227],v11,51712
buffer_load_dwordx4 a[136:139], v211, s[24:27], 0 offen offset:2048 sc1
m16 v[176:179],a[192:195],v[56:59],v[176:179]
rtr a[228:229],v11,50696
m16 v[116:119],a[196:199],v[48:51],v[116:119]
rtr a[230:231],v11,51720
m16 v[148:151],a[196:199],v[52:55],v[148:151]
m16 v[180:183],a[196:199],v[56:59],v[180:183]
rtr a[232:233],v11,50944
m16 v[120:123],a[200:203],v[48:51],v[120:123]
rtr a[234:235],v11,51968
buffer_load_dwordx4 a[140:143], v211, s[24:27], s47 offen offset:0 sc1
m16 v[152:155],a[200:203],v[52:55],v[152:155]
rtr a[236:237],v11,50952
s_add_u32 m0, s70, 50688
m16 v[184:187],a[200:203],v[56:59],v[184:187]
m16 v[124:127],a[204:207],v[48:51],v[124:127]
rtr a[238:239],v11,51976
m16 v[156:159],a[204:207],v[52:55],v[156:159]
rtr a[240:241],v11,51200
m16 v[188:191],a[204:207],v[56:59],v[188:191]
rtr a[242:243],v11,52224
m16 v[128:131],a[208:211],v[48:51],v[128:131]
buffer_load_dwordx4 a[144:147], v211, s[24:27], s47 offen offset:1024 sc1
m16 v[160:163],a[208:211],v[52:55],v[160:163]
rtr a[244:245],v11,51208
m16 v[192:195],a[208:211],v[56:59],v[192:195]
rtr a[246:247],v11,52232
m16 v[132:135],a[212:215],v[48:51],v[132:135]
rtr a[248:249],v11,51456
buffer_load_dwordx4 v210, s[56:59], 0 offen offset:0 lds
m16 v[164:167],a[212:215],v[52:55],v[164:167]
m16 v[196:199],a[212:215],v[56:59],v[196:199]
rtr a[250:251],v11,52480
buffer_load_dwordx4 a[148:151], v211, s[24:27], s47 offen offset:2048 sc1
m16 v[136:139],a[216:219],v[48:51],v[136:139]
rtr a[252:253],v11,51464
m16 v[168:171],a[216:219],v[52:55],v[168:171]
rtr a[254:255],v11,52488
m16 v[200:203],a[216:219],v[56:59],v[200:203]
m16 v[140:143],a[220:223],v[48:51],v[140:143]
rtr a[0:1],v11,54784
m16 v[172:175],a[220:223],v[52:55],v[172:175]
rtr a[2:3],v11,55808
m16 v[204:207],a[220:223],v[56:59],v[204:207]
rtr a[4:5],v11,54792
buffer_load_dwordx4 v210, s[56:59], s44 offen offset:1024 lds
m16 v[112:115],a[160:163],v[60:63],v[112:115]
v_add_u32 v211, 0x5800, v211
buffer_load_dwordx4 a[152:155], v211, s[24:27], 0 offen offset:0 sc1
rtr a[6:7],v11,55816
m16 v[144:147],a[160:163],v[64:67],v[144:147]
m16 v[176:179],a[160:163],v[68:71],v[176:179]
rtr a[8:9],v11,55040
m16 v[116:119],a[164:167],v[60:63],v[116:119]
rtr a[10:11],v11,56064
m16 v[148:151],a[164:167],v[64:67],v[148:151]
rtr a[12:13],v11,55048
m16 v[180:183],a[164:167],v[68:71],v[180:183]
buffer_load_dwordx4 a[156:159], v211, s[24:27], 0 offen offset:1024 sc1
m16 v[120:123],a[168:171],v[60:63],v[120:123]
rtr a[14:15],v11,56072
buffer_load_dwordx4 v210, s[56:59], s45 offen offset:2048 lds
m16 v[152:155],a[168:171],v[64:67],v[152:155]
rtr a[16:17],v11,55296
m16 v[184:187],a[168:171],v[68:71],v[184:187]
rtr a[18:19],v11,56320
m16 v[124:127],a[172:175],v[60:63],v[124:127]
m16 v[156:159],a[172:175],v[64:67],v[156:159]
rtr a[20:21],v11,55304
buffer_load_dwordx4 a[32:35], v211, s[24:27], 0 offen offset:2048 sc1
m16 v[188:191],a[172:175],v[68:71],v[188:191]
rtr a[22:23],v11,56328
m16 v[128:131],a[176:179],v[60:63],v[128:131]
rtr a[24:25],v11,55552
m16 v[160:163],a[176:179],v[64:67],v[160:163]
m16 v[192:195],a[176:179],v[68:71],v[192:195]
rtr a[26:27],v11,56576
buffer_load_dwordx4 v210, s[56:59], s46 offen offset:3072 lds
m16 v[132:135],a[180:183],v[60:63],v[132:135]
rtr a[28:29],v11,55560
m16 v[164:167],a[180:183],v[64:67],v[164:167]
rtr a[30:31],v11,56584
buffer_load_dwordx4 a[36:39], v211, s[24:27], s47 offen offset:0 sc1
m16 v[196:199],a[180:183],v[68:71],v[196:199]
m16 v[136:139],a[184:187],v[60:63],v[136:139]
m16 v[168:171],a[184:187],v[64:67],v[168:171]
m16 v[200:203],a[184:187],v[68:71],v[200:203]
m16 v[140:143],a[188:191],v[60:63],v[140:143]
m16 v[172:175],a[188:191],v[64:67],v[172:175]
m16 v[204:207],a[188:191],v[68:71],v[204:207]
s_waitcnt vmcnt(34) lgkmcnt(0)
m16 v[112:115],a[224:227],v[72:75],v[112:115]
rtr a[192:193],v12,0
v_add_u32 v210, 0x60000, v210
m16 v[144:147],a[224:227],v[76:79],v[144:147]
rtr a[194:195],v12,1024
buffer_load_dwordx4 a[40:43], v211, s[24:27], s47 offen offset:1024 sc1
m16 v[176:179],a[224:227],v[80:83],v[176:179]
rtr a[196:197],v12,8
m16 v[116:119],a[228:231],v[72:75],v[116:119]
rtr a[198:199],v12,1032
m16 v[148:151],a[228:231],v[76:79],v[148:151]
m16 v[180:183],a[228:231],v[80:83],v[180:183]
rtr a[200:201],v12,256
m16 v[120:123],a[232:235],v[72:75],v[120:123]
rtr a[202:203],v12,1280
m16 v[152:155],a[232:235],v[76:79],v[152:155]
rtr a[204:205],v12,264
s_add_u32 m0, s70, 101376
m16 v[184:187],a[232:235],v[80:83],v[184:187]
buffer_load_dwordx4 a[44:47], v211, s[24:27], s47 offen offset:2048 sc1
m16 v[124:127],a[236:239],v[72:75],v[124:127]
rtr a[206:207],v12,1288
m16 v[156:159],a[236:239],v[76:79],v[156:159]
rtr a[208:209],v12,512
m16 v[188:191],a[236:239],v[80:83],v[188:191]
rtr a[210:211],v12,1536
m16 v[128:131],a[240:243],v[72:75],v[128:131]
m16 v[160:163],a[240:243],v[76:79],v[160:163]
rtr a[212:213],v12,520
v_add_u32 v211, 0x10800, v211
buffer_load_dwordx4 a[48:51], v211, s[24:27], 0 offen offset:0 sc1
m16 v[192:195],a[240:243],v[80:83],v[192:195]
rtr a[214:215],v12,1544
m16 v[132:135],a[244:247],v[72:75],v[132:135]
rtr a[216:217],v12,768
buffer_load_dwordx4 v210, s[56:59], 0 offen offset:0 lds
m16 v[164:167],a[244:247],v[76:79],v[164:167]
m16 v[196:199],a[244:247],v[80:83],v[196:199]
rtr a[218:219],v12,1792
m16 v[136:139],a[248:251],v[72:75],v[136:139]
rtr a[220:221],v12,776
m16 v[168:171],a[248:251],v[76:79],v[168:171]
rtr a[222:223],v12,1800
m16 v[200:203],a[248:251],v[80:83],v[200:203]
buffer_load_dwordx4 a[52:55], v211, s[24:27], 0 offen offset:1024 sc1
m16 v[140:143],a[252:255],v[72:75],v[140:143]
rtr a[160:161],v12,4096
m16 v[172:175],a[252:255],v[76:79],v[172:175]
rtr a[162:163],v12,5120
m16 v[204:207],a[252:255],v[80:83],v[204:207]
rtr a[164:165],v12,4104
buffer_load_dwordx4 v210, s[56:59], s44 offen offset:1024 lds
m16 v[112:115],a[0:3],v[84:87],v[112:115]
rtr a[166:167],v12,5128
m16 v[144:147],a[0:3],v[88:91],v[144:147]
m16 v[176:179],a[0:3],v[92:95],v[176:179]
rtr a[168:169],v12,4352
buffer_load_dwordx4 a[56:59], v211, s[24:27], 0 offen offset:2048 sc1
m16 v[116:119],a[4:7],v[84:87],v[116:119]
rtr a[170:171],v12,5376
m16 v[148:151],a[4:7],v[88:91],v[148:151]
rtr a[172:173],v12,4360
m16 v[180:183],a[4:7],v[92:95],v[180:183]
m16 v[120:123],a[8:11],v[84:87],v[120:123]
rtr a[174:175],v12,5384
buffer_load_dwordx4 v210, s[56:59], s45 offen offset:2048 lds
m16 v[152:155],a[8:11],v[88:91],v[152:155]
rtr a[176:177],v12,4608
m16 v[184:187],a[8:11],v[92:95],v[184:187]
rtr a[178:179],v12,5632
m16 v[124:127],a[12:15],v[84:87],v[124:127]
buffer_load_dwordx4 a[60:63], v211, s[24:27], s47 offen offset:0 sc1
m16 v[156:159],a[12:15],v[88:91],v[156:159]
rtr a[180:181],v12,4616
m16 v[188:191],a[12:15],v[92:95],v[188:191]
rtr a[182:183],v12,5640
m16 v[128:131],a[16:19],v[84:87],v[128:131]
rtr a[184:185],v12,4864
m16 v[160:163],a[16:19],v[88:91],v[160:163]
m16 v[192:195],a[16:19],v[92:95],v[192:195]
rtr a[186:187],v12,5888
buffer_load_dwordx4 v210, s[56:59], s46 offen offset:3072 lds
m16 v[132:135],a[20:23],v[84:87],v[132:135]
rtr a[188:189],v12,4872
buffer_load_dwordx4 a[64:67], v211, s[24:27], s47 offen offset:1024 sc1
m16 v[164:167],a[20:23],v[88:91],v[164:167]
rtr a[190:191],v12,5896
m16 v[196:199],a[20:23],v[92:95],v[196:199]
m16 v[136:139],a[24:27],v[84:87],v[136:139]
m16 v[168:171],a[24:27],v[88:91],v[168:171]
m16 v[200:203],a[24:27],v[92:95],v[200:203]
m16 v[140:143],a[28:31],v[84:87],v[140:143]
m16 v[172:175],a[28:31],v[88:91],v[172:175]
m16 v[204:207],a[28:31],v[92:95],v[204:207]
s_waitcnt vmcnt(36) lgkmcnt(0)
s_barrier
m16 v[112:115],a[192:195],v[96:99],v[112:115]
rtr a[224:225],v10,0
v_add_u32 v210, 0x20000, v210
m16 v[144:147],a[192:195],v[100:103],v[144:147]
rtr a[226:227],v10,1024
buffer_load_dwordx4 a[68:71], v211, s[24:27], s47 offen offset:2048 sc1
m16 v[176:179],a[192:195],v[104:107],v[176:179]
rtr a[228:229],v10,8
m16 v[116:119],a[196:199],v[96:99],v[116:119]
rtr a[230:231],v10,1032
m16 v[148:151],a[196:199],v[100:103],v[148:151]
m16 v[180:183],a[196:199],v[104:107],v[180:183]
rtr a[232:233],v10,256
m16 v[120:123],a[200:203],v[96:99],v[120:123]
rtr a[234:235],v10,1280
v_add_u32 v211, 0x5800, v211
buffer_load_dwordx4 a[72:75], v211, s[24:27], 0 offen offset:0 sc1
m16 v[152:155],a[200:203],v[100:103],v[152:155]
rtr a[236:237],v10,264
s_add_u32 m0, s70, 84480
m16 v[184:187],a[200:203],v[104:107],v[184:187]
m16 v[124:127],a[204:207],v[96:99],v[124:127]
rtr a[238:239],v10,1288
m16 v[156:159],a[204:207],v[100:103],v[156:159]
rtr a[240:241],v10,512
m16 v[188:191],a[204:207],v[104:107],v[188:191]
rtr a[242:243],v10,1536
m16 v[128:131],a[208:211],v[96:99],v[128:131]
buffer_load_dwordx4 a[76:79], v211, s[24:27], 0 offen offset:1024 sc1
m16 v[160:163],a[208:211],v[100:103],v[160:163]
rtr a[244:245],v10,520
m16 v[192:195],a[208:211],v[104:107],v[192:195]
rtr a[246:247],v10,1544
m16 v[132:135],a[212:215],v[96:99],v[132:135]
rtr a[248:249],v10,768
buffer_load_dwordx4 v210, s[56:59], 0 offen offset:0 lds
m16 v[164:167],a[212:215],v[100:103],v[164:167]
m16 v[196:199],a[212:215],v[104:107],v[196:199]
rtr a[250:251],v10,1792
buffer_load_dwordx4 a[80:83], v211, s[24:27], 0 offen offset:2048 sc1
m16 v[136:139],a[216:219],v[96:99],v[136:139]
rtr a[252:253],v10,776
m16 v[168:171],a[216:219],v[100:103],v[168:171]
rtr a[254:255],v10,1800
m16 v[200:203],a[216:219],v[104:107],v[200:203]
m16 v[140:143],a[220:223],v[96:99],v[140:143]
rtr a[0:1],v10,4096
m16 v[172:175],a[220:223],v[100:103],v[172:175]
rtr a[2:3],v10,5120
m16 v[204:207],a[220:223],v[104:107],v[204:207]
rtr a[4:5],v10,4104
buffer_load_dwordx4 v210, s[56:59], s44 offen offset:1024 lds
m16 v[112:115],a[160:163],v[108:111],v[112:115]
buffer_load_dwordx4 a[84:87], v211, s[24:27], s47 offen offset:0 sc1
rtr a[6:7],v10,5128
m16 v[144:147],a[160:163],a[96:99],v[144:147]
m16 v[176:179],a[160:163],a[100:103],v[176:179]
rtr a[8:9],v10,4352
m16 v[116:119],a[164:167],v[108:111],v[116:119]
rtr a[10:11],v10,5376
m16 v[148:151],a[164:167],a[96:99],v[148:151]
rtr a[12:13],v10,4360
m16 v[180:183],a[164:167],a[100:103],v[180:183]
buffer_load_dwordx4 a[88:91], v211, s[24:27], s47 offen offset:1024 sc1
m16 v[120:123],a[168:171],v[108:111],v[120:123]
rtr a[14:15],v10,5384
buffer_load_dwordx4 v210, s[56:59], s45 offen offset:2048 lds
m16 v[152:155],a[168:171],a[96:99],v[152:155]
rtr a[16:17],v10,4608
m16 v[184:187],a[168:171],a[100:103],v[184:187]
rtr a[18:19],v10,5632
m16 v[124:127],a[172:175],v[108:111],v[124:127]
m16 v[156:159],a[172:175],a[96:99],v[156:159]
rtr a[20:21],v10,4616
buffer_load_dwordx4 a[92:95], v211, s[24:27], s47 offen offset:2048 sc1
m16 v[188:191],a[172:175],a[100:103],v[188:191]
rtr a[22:23],v10,5640
m16 v[128:131],a[176:179],v[108:111],v[128:131]
rtr a[24:25],v10,4864
m16 v[160:163],a[176:179],a[96:99],v[160:163]
m16 v[192:195],a[176:179],a[100:103],v[192:195]
rtr a[26:27],v10,5888
buffer_load_dwordx4 v210, s[56:59], s46 offen offset:3072 lds
m16 v[132:135],a[180:183],v[108:111],v[132:135]
rtr a[28:29],v10,4872
m16 v[164:167],a[180:183],a[96:99],v[164:167]
rtr a[30:31],v10,5896
v_add_u32 v211, 0x10800, v211
buffer_load_dwordx4 v[16:19], v211, s[24:27], 0 offen offset:0 sc1
m16 v[196:199],a[180:183],a[100:103],v[196:199]
m16 v[136:139],a[184:187],v[108:111],v[136:139]
m16 v[168:171],a[184:187],a[96:99],v[168:171]
m16 v[200:203],a[184:187],a[100:103],v[200:203]
m16 v[140:143],a[188:191],v[108:111],v[140:143]
m16 v[172:175],a[188:191],a[96:99],v[172:175]
m16 v[204:207],a[188:191],a[100:103],v[204:207]
s_waitcnt vmcnt(39) lgkmcnt(0)
m16 v[112:115],a[224:227],a[104:107],v[112:115]
rtr a[192:193],v10,33792
v_add_u32 v210, 2883584, v8
m16 v[144:147],a[224:227],a[108:111],v[144:147]
rtr a[194:195],v10,34816
buffer_load_dwordx4 v[20:23], v211, s[24:27], 0 offen offset:1024 sc1
m16 v[176:179],a[224:227],a[112:115],v[176:179]
rtr a[196:197],v10,33800
m16 v[116:119],a[228:231],a[104:107],v[116:119]
rtr a[198:199],v10,34824
m16 v[148:151],a[228:231],a[108:111],v[148:151]
m16 v[180:183],a[228:231],a[112:115],v[180:183]
rtr a[200:201],v10,34048
m16 v[120:123],a[232:235],a[104:107],v[120:123]
rtr a[202:203],v10,35072
m16 v[152:155],a[232:235],a[108:111],v[152:155]
rtr a[204:205],v10,34056
s_add_u32 m0, s70, 118272
m16 v[184:187],a[232:235],a[112:115],v[184:187]
buffer_load_dwordx4 v[24:27], v211, s[24:27], 0 offen offset:2048 sc1
m16 v[124:127],a[236:239],a[104:107],v[124:127]
rtr a[206:207],v10,35080
m16 v[156:159],a[236:239],a[108:111],v[156:159]
rtr a[208:209],v10,34304
m16 v[188:191],a[236:239],a[112:115],v[188:191]
rtr a[210:211],v10,35328
m16 v[128:131],a[240:243],a[104:107],v[128:131]
m16 v[160:163],a[240:243],a[108:111],v[160:163]
rtr a[212:213],v10,34312
buffer_load_dwordx4 v[28:31], v211, s[24:27], s47 offen offset:0 sc1
m16 v[192:195],a[240:243],a[112:115],v[192:195]
rtr a[214:215],v10,35336
m16 v[132:135],a[244:247],a[104:107],v[132:135]
rtr a[216:217],v10,34560
buffer_load_dwordx4 v210, s[56:59], 0 offen offset:0 lds
m16 v[164:167],a[244:247],a[108:111],v[164:167]
m16 v[196:199],a[244:247],a[112:115],v[196:199]
rtr a[218:219],v10,35584
m16 v[136:139],a[248:251],a[104:107],v[136:139]
rtr a[220:221],v10,34568
m16 v[168:171],a[248:251],a[108:111],v[168:171]
rtr a[222:223],v10,35592
m16 v[200:203],a[248:251],a[112:115],v[200:203]
buffer_load_dwordx4 v[32:35], v211, s[24:27], s47 offen offset:1024 sc1
m16 v[140:143],a[252:255],a[104:107],v[140:143]
rtr a[160:161],v10,37888
m16 v[172:175],a[252:255],a[108:111],v[172:175]
rtr a[162:163],v10,38912
m16 v[204:207],a[252:255],a[112:115],v[204:207]
rtr a[164:165],v10,37896
buffer_load_dwordx4 v210, s[56:59], s44 offen offset:1024 lds
m16 v[112:115],a[0:3],a[116:119],v[112:115]
rtr a[166:167],v10,38920
m16 v[144:147],a[0:3],a[120:123],v[144:147]
m16 v[176:179],a[0:3],a[124:127],v[176:179]
rtr a[168:169],v10,38144
buffer_load_dwordx4 v[36:39], v211, s[24:27], s47 offen offset:2048 sc1
m16 v[116:119],a[4:7],a[116:119],v[116:119]
rtr a[170:171],v10,39168
m16 v[148:151],a[4:7],a[120:123],v[148:151]
rtr a[172:173],v10,38152
m16 v[180:183],a[4:7],a[124:127],v[180:183]
m16 v[120:123],a[8:11],a[116:119],v[120:123]
rtr a[174:175],v10,39176
buffer_load_dwordx4 v210, s[56:59], s45 offen offset:2048 lds
m16 v[152:155],a[8:11],a[120:123],v[152:155]
rtr a[176:177],v10,38400
m16 v[184:187],a[8:11],a[124:127],v[184:187]
rtr a[178:179],v10,39424
m16 v[124:127],a[12:15],a[116:119],v[124:127]
v_add_u32 v211, 0x5800, v211
buffer_load_dwordx4 v[40:43], v211, s[24:27], 0 offen offset:0 sc1
m16 v[156:159],a[12:15],a[120:123],v[156:159]
rtr a[180:181],v10,38408
m16 v[188:191],a[12:15],a[124:127],v[188:191]
rtr a[182:183],v10,39432
m16 v[128:131],a[16:19],a[116:119],v[128:131]
rtr a[184:185],v10,38656
m16 v[160:163],a[16:19],a[120:123],v[160:163]
m16 v[192:195],a[16:19],a[124:127],v[192:195]
rtr a[186:187],v10,39680
buffer_load_dwordx4 v210, s[56:59], s46 offen offset:3072 lds
m16 v[132:135],a[20:23],a[116:119],v[132:135]
rtr a[188:189],v10,38664
buffer_load_dwordx4 v[44:47], v211, s[24:27], 0 offen offset:1024 sc1
m16 v[164:167],a[20:23],a[120:123],v[164:167]
rtr a[190:191],v10,39688
m16 v[196:199],a[20:23],a[124:127],v[196:199]
m16 v[136:139],a[24:27],a[116:119],v[136:139]
m16 v[168:171],a[24:27],a[120:123],v[168:171]
m16 v[200:203],a[24:27],a[124:127],v[200:203]
m16 v[140:143],a[28:31],a[116:119],v[140:143]
m16 v[172:175],a[28:31],a[120:123],v[172:175]
m16 v[204:207],a[28:31],a[124:127],v[204:207]
s_waitcnt vmcnt(41) lgkmcnt(0)
s_barrier
m16 v[112:115],a[192:195],a[128:131],v[112:115]
rtr a[224:225],v10,16896
v_add_u32 v210, 0x80000, v210
v_lshlrev_b32 v1, 4, v0
m16 v[144:147],a[192:195],a[132:135],v[144:147]
rtr a[226:227],v10,17920
buffer_load_dwordx4 v[48:51], v211, s[24:27], 0 offen offset:2048 sc1
s_mul_i32 s28, s36, 6144
m16 v[176:179],a[192:195],a[136:139],v[176:179]
rtr a[228:229],v10,16904
v_add_u32 v1, s28, v1
s_xor_b32 s29, s3, 1
m16 v[116:119],a[196:199],a[128:131],v[116:119]
rtr a[230:231],v10,17928
s_mul_i32 s29, s29, 22528
v_add_u32 v2, s29, v1
m16 v[148:151],a[196:199],a[132:135],v[148:151]
s_mul_i32 s29, s3, 22528
v_add_u32 v1, s29, v1
v_and_b32 v14, 15, v0
m16 v[180:183],a[196:199],a[136:139],v[180:183]
rtr a[232:233],v10,17152
v_mul_u32_u24 v14, 144, v14
v_lshrrev_b32 v4, 4, v0
m16 v[120:123],a[200:203],a[128:131],v[120:123]
rtr a[234:235],v10,18176
buffer_load_dwordx4 v[52:55], v211, s[24:27], s47 offen offset:0 sc1
m16 v[152:155],a[200:203],a[132:135],v[152:155]
rtr a[236:237],v10,17160
s_add_u32 m0, s70, 147424
m16 v[184:187],a[200:203],a[136:139],v[184:187]
v_lshl_add_u32 v14, v4, 4, v14
s_add_u32 s29, s28, 118272
m16 v[124:127],a[204:207],a[128:131],v[124:127]
rtr a[238:239],v10,18184
s_lshl_b32 s60, s36, 10
m16 v[156:159],a[204:207],a[132:135],v[156:159]
rtr a[240:241],v10,17408
s_add_u32 s29, s29, s60
m16 v[188:191],a[204:207],a[136:139],v[188:191]
rtr a[242:243],v10,18432
v_add_u32 v14, s29, v14
m16 v[128:131],a[208:211],a[128:131],v[128:131]
buffer_load_dwordx4 v[56:59], v211, s[24:27], s47 offen offset:1024 sc1
v_lshrrev_b32 v4, 3, v0
m16 v[160:163],a[208:211],a[132:135],v[160:163]
rtr a[244:245],v10,17416
v_and_b32 v3, 7, v0
m16 v[192:195],a[208:211],a[136:139],v[192:195]
rtr a[246:247],v10,18440
v_lshlrev_b32 v3, 4, v3
m16 v[132:135],a[212:215],a[128:131],v[132:135]
rtr a[248:249],v10,17664
buffer_load_dwordx4 v210, s[56:59], 0 offen offset:0 lds
m16 v[164:167],a[212:215],a[132:135],v[164:167]
v_mul_u32_u24 v15, 144, v4
v_add3_u32 v15, v15, v3, s29
m16 v[196:199],a[212:215],a[136:139],v[196:199]
rtr a[250:251],v10,18688
buffer_load_dwordx4 v[60:63], v211, s[24:27], s47 offen offset:2048 sc1
m16 v[136:139],a[216:219],a[128:131],v[136:139]
rtr a[252:253],v10,17672
v_lshl_add_u32 v3, v4, 12, v3
m16 v[168:171],a[216:219],a[132:135],v[168:171]
rtr a[254:255],v10,18696
s_mov_b32 s66, 32768
m16 v[200:203],a[216:219],a[136:139],v[200:203]
s_mov_b32 s67, 98304
s_mov_b32 s68, 163840
m16 v[140:143],a[220:223],a[128:131],v[140:143]
rtr a[0:1],v10,20992
s_mul_i32 s28, s37, 720896
m16 v[172:175],a[220:223],a[132:135],v[172:175]
rtr a[2:3],v10,22016
s_lshl_b32 s29, s31, 11
m16 v[204:207],a[220:223],a[136:139],v[204:207]
rtr a[4:5],v10,21000
buffer_load_dwordx4 v210, s[56:59], s44 offen offset:1024 lds
m16 v[112:115],a[160:163],a[140:143],v[112:115]
v_add_u32 v211, 495616, v7
buffer_load_dwordx4 v[64:67], v211, s[24:27], 0 offen offset:0 sc1
rtr a[6:7],v10,22024
m16 v[144:147],a[160:163],a[144:147],v[144:147]
s_add_u32 s28, s28, s29
s_lshl_b32 s29, s38, 8
m16 v[176:179],a[160:163],a[148:151],v[176:179]
rtr a[8:9],v10,21248
s_add_u32 s28, s28, s29
m16 v[116:119],a[164:167],a[140:143],v[116:119]
rtr a[10:11],v10,22272
s_lshl_b32 s29, s3, 7
m16 v[148:151],a[164:167],a[144:147],v[148:151]
rtr a[12:13],v10,21256
s_add_u32 s28, s28, s29
m16 v[180:183],a[164:167],a[148:151],v[180:183]
buffer_load_dwordx4 v[68:71], v211, s[24:27], 0 offen offset:1024 sc1
s_mul_i32 s29, s36, 196608
m16 v[120:123],a[168:171],a[140:143],v[120:123]
rtr a[14:15],v10,22280
buffer_load_dwordx4 v210, s[56:59], s45 offen offset:2048 lds
m16 v[152:155],a[168:171],a[144:147],v[152:155]
rtr a[16:17],v10,21504
s_add_u32 s28, s28, s29
m16 v[184:187],a[168:171],a[148:151],v[184:187]
rtr a[18:19],v10,22528
v_add_u32 v3, s28, v3
m16 v[124:127],a[172:175],a[140:143],v[124:127]
s_mul_i32 s61, s38, 45056
s_add_u32 s61, s61, 1572864
m16 v[156:159],a[172:175],a[144:147],v[156:159]
rtr a[20:21],v10,21512
buffer_load_dwordx4 v[72:75], v211, s[24:27], 0 offen offset:2048 sc1
m16 v[188:191],a[172:175],a[148:151],v[188:191]
rtr a[22:23],v10,22536
v_add_u32 v1, s61, v1
m16 v[128:131],a[176:179],a[140:143],v[128:131]
rtr a[24:25],v10,21760
v_add_u32 v2, s61, v2
m16 v[160:163],a[176:179],a[144:147],v[160:163]
s_mov_b32 s60, 1966080
s_lshl_b32 s61, s38, 1
m16 v[192:195],a[176:179],a[148:151],v[192:195]
rtr a[26:27],v10,22784
buffer_load_dwordx4 v210, s[56:59], s46 offen offset:3072 lds
m16 v[132:135],a[180:183],a[140:143],v[132:135]
rtr a[28:29],v10,21768
s_add_u32 s61, s61, s3
m16 v[164:167],a[180:183],a[144:147],v[164:167]
rtr a[30:31],v10,22792
buffer_load_dwordx4 v[76:79], v211, s[24:27], s47 offen offset:0 sc1
m16 v[196:199],a[180:183],a[148:151],v[196:199]
s_lshl_b32 s61, s61, 2
s_add_u32 s61, s61, s36
m16 v[136:139],a[184:187],a[140:143],v[136:139]
s_lshl_b32 s61, s61, 7
s_add_u32 s60, s60, s61
m16 v[168:171],a[184:187],a[144:147],v[168:171]
v_mov_b32 v9, s60
s_xor_b32 s60, s60, 512
m16 v[200:203],a[184:187],a[148:151],v[200:203]
v_mov_b32 v4, s60
v_mov_b32 v5, 1
m16 v[140:143],a[188:191],a[140:143],v[140:143]
s_mov_b32 s62, 2048
s_mov_b32 s63, 4096
m16 v[172:175],a[188:191],a[144:147],v[172:175]
s_mov_b32 s64, 65536
s_mov_b32 s65, 131072
m16 v[204:207],a[188:191],a[148:151],v[204:207]
s_waitcnt vmcnt(44) lgkmcnt(0)
m16 v[112:115],a[224:227],a[152:155],v[112:115]
rtr a[192:193],v11,0
v_add_u32 v210, 0x80000, v210
m16 v[144:147],a[224:227],a[156:159],v[144:147]
rtr a[194:195],v11,1024
buffer_load_dwordx4 v[80:83], v211, s[24:27], s47 offen offset:1024 sc1
m16 v[176:179],a[224:227],a[32:35],v[176:179]
rtr a[196:197],v11,8
m16 v[116:119],a[228:231],a[152:155],v[116:119]
rtr a[198:199],v11,1032
m16 v[148:151],a[228:231],a[156:159],v[148:151]
m16 v[180:183],a[228:231],a[32:35],v[180:183]
rtr a[200:201],v11,256
m16 v[120:123],a[232:235],a[152:155],v[120:123]
rtr a[202:203],v11,1280
m16 v[152:155],a[232:235],a[156:159],v[152:155]
rtr a[204:205],v11,264
s_add_u32 m0, s70, 0
m16 v[184:187],a[232:235],a[32:35],v[184:187]
buffer_load_dwordx4 v[84:87], v211, s[24:27], s47 offen offset:2048 sc1
m16 v[124:127],a[236:239],a[152:155],v[124:127]
rtr a[206:207],v11,1288
m16 v[156:159],a[236:239],a[156:159],v[156:159]
rtr a[208:209],v11,512
m16 v[188:191],a[236:239],a[32:35],v[188:191]
rtr a[210:211],v11,1536
m16 v[128:131],a[240:243],a[152:155],v[128:131]
m16 v[160:163],a[240:243],a[156:159],v[160:163]
rtr a[212:213],v11,520
buffer_load_dwordx4 v[88:91], v211, s[24:27], s4 offen offset:0 sc1
m16 v[192:195],a[240:243],a[32:35],v[192:195]
rtr a[214:215],v11,1544
m16 v[132:135],a[244:247],a[152:155],v[132:135]
rtr a[216:217],v11,768
buffer_load_dwordx4 v210, s[56:59], 0 offen offset:0 lds
m16 v[164:167],a[244:247],a[156:159],v[164:167]
m16 v[196:199],a[244:247],a[32:35],v[196:199]
rtr a[218:219],v11,1792
m16 v[136:139],a[248:251],a[152:155],v[136:139]
rtr a[220:221],v11,776
m16 v[168:171],a[248:251],a[156:159],v[168:171]
rtr a[222:223],v11,1800
m16 v[200:203],a[248:251],a[32:35],v[200:203]
buffer_load_dwordx4 v[92:95], v211, s[24:27], s4 offen offset:1024 sc1
m16 v[140:143],a[252:255],a[152:155],v[140:143]
rtr a[160:161],v11,4096
m16 v[172:175],a[252:255],a[156:159],v[172:175]
rtr a[162:163],v11,5120
m16 v[204:207],a[252:255],a[32:35],v[204:207]
rtr a[164:165],v11,4104
buffer_load_dwordx4 v210, s[56:59], s44 offen offset:1024 lds
m16 v[112:115],a[0:3],a[36:39],v[112:115]
rtr a[166:167],v11,5128
m16 v[144:147],a[0:3],a[40:43],v[144:147]
m16 v[176:179],a[0:3],a[44:47],v[176:179]
rtr a[168:169],v11,4352
buffer_load_dwordx4 v[96:99], v211, s[24:27], s4 offen offset:2048 sc1
m16 v[116:119],a[4:7],a[36:39],v[116:119]
rtr a[170:171],v11,5376
m16 v[148:151],a[4:7],a[40:43],v[148:151]
rtr a[172:173],v11,4360
m16 v[180:183],a[4:7],a[44:47],v[180:183]
m16 v[120:123],a[8:11],a[36:39],v[120:123]
rtr a[174:175],v11,5384
buffer_load_dwordx4 v210, s[56:59], s45 offen offset:2048 lds
m16 v[152:155],a[8:11],a[40:43],v[152:155]
rtr a[176:177],v11,4608
m16 v[184:187],a[8:11],a[44:47],v[184:187]
rtr a[178:179],v11,5632
m16 v[124:127],a[12:15],a[36:39],v[124:127]
buffer_load_dwordx4 v[100:103], v211, s[24:27], s5 offen offset:0 sc1
m16 v[156:159],a[12:15],a[40:43],v[156:159]
rtr a[180:181],v11,4616
m16 v[188:191],a[12:15],a[44:47],v[188:191]
rtr a[182:183],v11,5640
m16 v[128:131],a[16:19],a[36:39],v[128:131]
rtr a[184:185],v11,4864
m16 v[160:163],a[16:19],a[40:43],v[160:163]
m16 v[192:195],a[16:19],a[44:47],v[192:195]
rtr a[186:187],v11,5888
buffer_load_dwordx4 v210, s[56:59], s46 offen offset:3072 lds
m16 v[132:135],a[20:23],a[36:39],v[132:135]
rtr a[188:189],v11,4872
buffer_load_dwordx4 v[104:107], v211, s[24:27], s5 offen offset:1024 sc1
m16 v[164:167],a[20:23],a[40:43],v[164:167]
rtr a[190:191],v11,5896
m16 v[196:199],a[20:23],a[44:47],v[196:199]
m16 v[136:139],a[24:27],a[36:39],v[136:139]
m16 v[168:171],a[24:27],a[40:43],v[168:171]
m16 v[200:203],a[24:27],a[44:47],v[200:203]
m16 v[140:143],a[28:31],a[36:39],v[140:143]
m16 v[172:175],a[28:31],a[40:43],v[172:175]
m16 v[204:207],a[28:31],a[44:47],v[204:207]
s_waitcnt vmcnt(45) lgkmcnt(0)
s_barrier
m16 v[112:115],a[192:195],a[48:51],v[112:115]
rtr a[224:225],v10,50688
v_add_u32 v210, s6, v210
m16 v[144:147],a[192:195],a[52:55],v[144:147]
rtr a[226:227],v10,51712
buffer_load_dwordx4 v[108:111], v211, s[24:27], s5 offen offset:2048 sc1
m16 v[176:179],a[192:195],a[56:59],v[176:179]
rtr a[228:229],v10,50696
m16 v[116:119],a[196:199],a[48:51],v[116:119]
rtr a[230:231],v10,51720
m16 v[148:151],a[196:199],a[52:55],v[148:151]
m16 v[180:183],a[196:199],a[56:59],v[180:183]
rtr a[232:233],v10,50944
m16 v[120:123],a[200:203],a[48:51],v[120:123]
rtr a[234:235],v10,51968
v_add_u32 v211, 0x16000, v211
buffer_load_dwordx4 a[96:99], v211, s[24:27], 0 offen offset:0 sc1
m16 v[152:155],a[200:203],a[52:55],v[152:155]
rtr a[236:237],v10,50952
s_add_u32 m0, s70, 33792
m16 v[184:187],a[200:203],a[56:59],v[184:187]
m16 v[124:127],a[204:207],a[48:51],v[124:127]
rtr a[238:239],v10,51976
m16 v[156:159],a[204:207],a[52:55],v[156:159]
rtr a[240:241],v10,51200
m16 v[188:191],a[204:207],a[56:59],v[188:191]
rtr a[242:243],v10,52224
buffer_load_dwordx4 a[100:103], v211, s[24:27], 0 offen offset:1024 sc1
m16 v[128:131],a[208:211],a[48:51],v[128:131]
m16 v[160:163],a[208:211],a[52:55],v[160:163]
rtr a[244:245],v10,51208
m16 v[192:195],a[208:211],a[56:59],v[192:195]
rtr a[246:247],v10,52232
m16 v[132:135],a[212:215],a[48:51],v[132:135]
rtr a[248:249],v10,51456
buffer_load_dwordx4 v210, s[56:59], 0 offen offset:0 lds
m16 v[164:167],a[212:215],a[52:55],v[164:167]
buffer_load_dwordx4 a[104:107], v211, s[24:27], 0 offen offset:2048 sc1
m16 v[196:199],a[212:215],a[56:59],v[196:199]
rtr a[250:251],v10,52480
m16 v[136:139],a[216:219],a[48:51],v[136:139]
rtr a[252:253],v10,51464
m16 v[168:171],a[216:219],a[52:55],v[168:171]
rtr a[254:255],v10,52488
m16 v[200:203],a[216:219],a[56:59],v[200:203]
m16 v[140:143],a[220:223],a[48:51],v[140:143]
rtr a[0:1],v10,54784
buffer_load_dwordx4 a[108:111], v211, s[24:27], s47 offen offset:0 sc1
m16 v[172:175],a[220:223],a[52:55],v[172:175]
rtr a[2:3],v10,55808
m16 v[204:207],a[220:223],a[56:59],v[204:207]
rtr a[4:5],v10,54792
buffer_load_dwordx4 v210, s[56:59], s44 offen offset:1024 lds
m16 v[112:115],a[160:163],a[60:63],v[112:115]
rtr a[6:7],v10,55816
m16 v[144:147],a[160:163],a[64:67],v[144:147]
m16 v[176:179],a[160:163],a[68:71],v[176:179]
rtr a[8:9],v10,55040
buffer_load_dwordx4 a[112:115], v211, s[24:27], s47 offen offset:1024 sc1
m16 v[116:119],a[164:167],a[60:63],v[116:119]
rtr a[10:11],v10,56064
m16 v[148:151],a[164:167],a[64:67],v[148:151]
rtr a[12:13],v10,55048
m16 v[180:183],a[164:167],a[68:71],v[180:183]
m16 v[120:123],a[168:171],a[60:63],v[120:123]
rtr a[14:15],v10,56072
buffer_load_dwordx4 v210, s[56:59], s45 offen offset:2048 lds
m16 v[152:155],a[168:171],a[64:67],v[152:155]
rtr a[16:17],v10,55296
buffer_load_dwordx4 a[116:119], v211, s[24:27], s47 offen offset:2048 sc1
m16 v[184:187],a[168:171],a[68:71],v[184:187]
rtr a[18:19],v10,56320
m16 v[124:127],a[172:175],a[60:63],v[124:127]
m16 v[156:159],a[172:175],a[64:67],v[156:159]
rtr a[20:21],v10,55304
m16 v[188:191],a[172:175],a[68:71],v[188:191]
rtr a[22:23],v10,56328
m16 v[128:131],a[176:179],a[60:63],v[128:131]
rtr a[24:25],v10,55552
buffer_load_dwordx4 a[120:123], v211, s[24:27], s4 offen offset:0 sc1
m16 v[160:163],a[176:179],a[64:67],v[160:163]
m16 v[192:195],a[176:179],a[68:71],v[192:195]
rtr a[26:27],v10,56576
buffer_load_dwordx4 v210, s[56:59], s46 offen offset:3072 lds
m16 v[132:135],a[180:183],a[60:63],v[132:135]
rtr a[28:29],v10,55560
m16 v[164:167],a[180:183],a[64:67],v[164:167]
rtr a[30:31],v10,56584
m16 v[196:199],a[180:183],a[68:71],v[196:199]
buffer_load_dwordx4 a[124:127], v211, s[24:27], s4 offen offset:1024 sc1
m16 v[136:139],a[184:187],a[60:63],v[136:139]
m16 v[168:171],a[184:187],a[64:67],v[168:171]
m16 v[200:203],a[184:187],a[68:71],v[200:203]
m16 v[140:143],a[188:191],a[60:63],v[140:143]
m16 v[172:175],a[188:191],a[64:67],v[172:175]
m16 v[204:207],a[188:191],a[68:71],v[204:207]
s_waitcnt vmcnt(49) lgkmcnt(0)
m16 v[112:115],a[224:227],a[72:75],v[112:115]
rtr a[192:193],v11,33792
v_add_u32 v210, 0x80000, v210
m16 v[144:147],a[224:227],a[76:79],v[144:147]
rtr a[194:195],v11,34816
buffer_load_dwordx4 a[128:131], v211, s[24:27], s4 offen offset:2048 sc1
m16 v[176:179],a[224:227],a[80:83],v[176:179]
rtr a[196:197],v11,33800
m16 v[116:119],a[228:231],a[72:75],v[116:119]
rtr a[198:199],v11,34824
m16 v[148:151],a[228:231],a[76:79],v[148:151]
m16 v[180:183],a[228:231],a[80:83],v[180:183]
rtr a[200:201],v11,34048
m16 v[120:123],a[232:235],a[72:75],v[120:123]
rtr a[202:203],v11,35072
buffer_load_dwordx4 a[132:135], v211, s[24:27], s5 offen offset:0 sc1
m16 v[152:155],a[232:235],a[76:79],v[152:155]
rtr a[204:205],v11,34056
s_add_u32 m0, s70, 16896
m16 v[184:187],a[232:235],a[80:83],v[184:187]
m16 v[124:127],a[236:239],a[72:75],v[124:127]
rtr a[206:207],v11,35080
m16 v[156:159],a[236:239],a[76:79],v[156:159]
rtr a[208:209],v11,34304
m16 v[188:191],a[236:239],a[80:83],v[188:191]
rtr a[210:211],v11,35328
buffer_load_dwordx4 a[136:139], v211, s[24:27], s5 offen offset:1024 sc1
m16 v[128:131],a[240:243],a[72:75],v[128:131]
m16 v[160:163],a[240:243],a[76:79],v[160:163]
rtr a[212:213],v11,34312
m16 v[192:195],a[240:243],a[80:83],v[192:195]
rtr a[214:215],v11,35336
m16 v[132:135],a[244:247],a[72:75],v[132:135]
rtr a[216:217],v11,34560
buffer_load_dwordx4 v210, s[56:59], 0 offen offset:0 lds
m16 v[164:167],a[244:247],a[76:79],v[164:167]
buffer_load_dwordx4 a[140:143], v211, s[24:27], s5 offen offset:2048 sc1
m16 v[196:199],a[244:247],a[80:83],v[196:199]
rtr a[218:219],v11,35584
m16 v[136:139],a[248:251],a[72:75],v[136:139]
rtr a[220:221],v11,34568
m16 v[168:171],a[248:251],a[76:79],v[168:171]
rtr a[222:223],v11,35592
m16 v[200:203],a[248:251],a[80:83],v[200:203]
m16 v[140:143],a[252:255],a[72:75],v[140:143]
rtr a[160:161],v11,37888
v_add_u32 v211, 0x16000, v211
buffer_load_dwordx4 a[144:147], v211, s[24:27], 0 offen offset:0 sc1
m16 v[172:175],a[252:255],a[76:79],v[172:175]
rtr a[162:163],v11,38912
m16 v[204:207],a[252:255],a[80:83],v[204:207]
rtr a[164:165],v11,37896
buffer_load_dwordx4 v210, s[56:59], s44 offen offset:1024 lds
m16 v[112:115],a[0:3],a[84:87],v[112:115]
rtr a[166:167],v11,38920
m16 v[144:147],a[0:3],a[88:91],v[144:147]
m16 v[176:179],a[0:3],a[92:95],v[176:179]
rtr a[168:169],v11,38144
buffer_load_dwordx4 a[148:151], v211, s[24:27], 0 offen offset:1024 sc1
m16 v[116:119],a[4:7],a[84:87],v[116:119]
rtr a[170:171],v11,39168
m16 v[148:151],a[4:7],a[88:91],v[148:151]
rtr a[172:173],v11,38152
m16 v[180:183],a[4:7],a[92:95],v[180:183]
m16 v[120:123],a[8:11],a[84:87],v[120:123]
rtr a[174:175],v11,39176
buffer_load_dwordx4 v210, s[56:59], s45 offen offset:2048 lds
m16 v[152:155],a[8:11],a[88:91],v[152:155]
rtr a[176:177],v11,38400
buffer_load_dwordx4 a[152:155], v211, s[24:27], 0 offen offset:2048 sc1
m16 v[184:187],a[8:11],a[92:95],v[184:187]
rtr a[178:179],v11,39424
m16 v[124:127],a[12:15],a[84:87],v[124:127]
m16 v[156:159],a[12:15],a[88:91],v[156:159]
rtr a[180:181],v11,38408
m16 v[188:191],a[12:15],a[92:95],v[188:191]
rtr a[182:183],v11,39432
m16 v[128:131],a[16:19],a[84:87],v[128:131]
rtr a[184:185],v11,38656
buffer_load_dwordx4 a[156:159], v211, s[24:27], s47 offen offset:0 sc1
m16 v[160:163],a[16:19],a[88:91],v[160:163]
m16 v[192:195],a[16:19],a[92:95],v[192:195]
rtr a[186:187],v11,39680
buffer_load_dwordx4 v210, s[56:59], s46 offen offset:3072 lds
m16 v[132:135],a[20:23],a[84:87],v[132:135]
rtr a[188:189],v11,38664
m16 v[164:167],a[20:23],a[88:91],v[164:167]
rtr a[190:191],v11,39688
m16 v[196:199],a[20:23],a[92:95],v[196:199]
buffer_load_dwordx4 a[32:35], v211, s[24:27], s47 offen offset:1024 sc1
m16 v[136:139],a[24:27],a[84:87],v[136:139]
m16 v[168:171],a[24:27],a[88:91],v[168:171]
m16 v[200:203],a[24:27],a[92:95],v[200:203]
m16 v[140:143],a[28:31],a[84:87],v[140:143]
m16 v[172:175],a[28:31],a[88:91],v[172:175]
m16 v[204:207],a[28:31],a[92:95],v[204:207]
s_waitcnt vmcnt(50) lgkmcnt(0)
s_barrier
m16 v[112:115],a[192:195],v[16:19],v[112:115]
rtr a[224:225],v11,16896
v_add_u32 v210, 0x80000, v210
m16 v[144:147],a[192:195],v[20:23],v[144:147]
rtr a[226:227],v11,17920
buffer_load_dwordx4 a[36:39], v211, s[24:27], s47 offen offset:2048 sc1
m16 v[176:179],a[192:195],v[24:27],v[176:179]
rtr a[228:229],v11,16904
m16 v[116:119],a[196:199],v[16:19],v[116:119]
rtr a[230:231],v11,17928
m16 v[148:151],a[196:199],v[20:23],v[148:151]
m16 v[180:183],a[196:199],v[24:27],v[180:183]
rtr a[232:233],v11,17152
m16 v[120:123],a[200:203],v[16:19],v[120:123]
rtr a[234:235],v11,18176
buffer_load_dwordx4 a[40:43], v211, s[24:27], s4 offen offset:0 sc1
m16 v[152:155],a[200:203],v[20:23],v[152:155]
rtr a[236:237],v11,17160
s_add_u32 m0, s70, 67584
m16 v[184:187],a[200:203],v[24:27],v[184:187]
m16 v[124:127],a[204:207],v[16:19],v[124:127]
rtr a[238:239],v11,18184
m16 v[156:159],a[204:207],v[20:23],v[156:159]
rtr a[240:241],v11,17408
m16 v[188:191],a[204:207],v[24:27],v[188:191]
rtr a[242:243],v11,18432
buffer_load_dwordx4 a[44:47], v211, s[24:27], s4 offen offset:1024 sc1
m16 v[128:131],a[208:211],v[16:19],v[128:131]
m16 v[160:163],a[208:211],v[20:23],v[160:163]
rtr a[244:245],v11,17416
m16 v[192:195],a[208:211],v[24:27],v[192:195]
rtr a[246:247],v11,18440
m16 v[132:135],a[212:215],v[16:19],v[132:135]
rtr a[248:249],v11,17664
buffer_load_dwordx4 v210, s[56:59], 0 offen offset:0 lds
m16 v[164:167],a[212:215],v[20:23],v[164:167]
buffer_load_dwordx4 a[48:51], v211, s[24:27], s4 offen offset:2048 sc1
m16 v[196:199],a[212:215],v[24:27],v[196:199]
rtr a[250:251],v11,18688
m16 v[136:139],a[216:219],v[16:19],v[136:139]
rtr a[252:253],v11,17672
m16 v[168:171],a[216:219],v[20:23],v[168:171]
rtr a[254:255],v11,18696
m16 v[200:203],a[216:219],v[24:27],v[200:203]
m16 v[140:143],a[220:223],v[16:19],v[140:143]
rtr a[0:1],v11,20992
buffer_load_dwordx4 a[52:55], v211, s[24:27], s5 offen offset:0 sc1
m16 v[172:175],a[220:223],v[20:23],v[172:175]
rtr a[2:3],v11,22016
m16 v[204:207],a[220:223],v[24:27],v[204:207]
rtr a[4:5],v11,21000
buffer_load_dwordx4 v210, s[56:59], s44 offen offset:1024 lds
m16 v[112:115],a[160:163],v[28:31],v[112:115]
rtr a[6:7],v11,22024
m16 v[144:147],a[160:163],v[32:35],v[144:147]
m16 v[176:179],a[160:163],v[36:39],v[176:179]
rtr a[8:9],v11,21248
buffer_load_dwordx4 a[56:59], v211, s[24:27], s5 offen offset:1024 sc1
m16 v[116:119],a[164:167],v[28:31],v[116:119]
rtr a[10:11],v11,22272
m16 v[148:151],a[164:167],v[32:35],v[148:151]
rtr a[12:13],v11,21256
m16 v[180:183],a[164:167],v[36:39],v[180:183]
m16 v[120:123],a[168:171],v[28:31],v[120:123]
rtr a[14:15],v11,22280
buffer_load_dwordx4 v210, s[56:59], s45 offen offset:2048 lds
m16 v[152:155],a[168:171],v[32:35],v[152:155]
rtr a[16:17],v11,21504
buffer_load_dwordx4 a[60:63], v211, s[24:27], s5 offen offset:2048 sc1
m16 v[184:187],a[168:171],v[36:39],v[184:187]
rtr a[18:19],v11,22528
m16 v[124:127],a[172:175],v[28:31],v[124:127]
m16 v[156:159],a[172:175],v[32:35],v[156:159]
rtr a[20:21],v11,21512
m16 v[188:191],a[172:175],v[36:39],v[188:191]
rtr a[22:23],v11,22536
m16 v[128:131],a[176:179],v[28:31],v[128:131]
rtr a[24:25],v11,21760
v_add_u32 v211, s7, v211
buffer_load_dwordx4 a[64:67], v211, s[24:27], 0 offen offset:0 sc1
m16 v[160:163],a[176:179],v[32:35],v[160:163]
m16 v[192:195],a[176:179],v[36:39],v[192:195]
rtr a[26:27],v11,22784
buffer_load_dwordx4 v210, s[56:59], s46 offen offset:3072 lds
m16 v[132:135],a[180:183],v[28:31],v[132:135]
rtr a[28:29],v11,21768
m16 v[164:167],a[180:183],v[32:35],v[164:167]
rtr a[30:31],v11,22792
m16 v[196:199],a[180:183],v[36:39],v[196:199]
buffer_load_dwordx4 a[68:71], v211, s[24:27], 0 offen offset:1024 sc1
m16 v[136:139],a[184:187],v[28:31],v[136:139]
m16 v[168:171],a[184:187],v[32:35],v[168:171]
m16 v[200:203],a[184:187],v[36:39],v[200:203]
m16 v[140:143],a[188:191],v[28:31],v[140:143]
m16 v[172:175],a[188:191],v[32:35],v[172:175]
m16 v[204:207],a[188:191],v[36:39],v[204:207]
s_waitcnt vmcnt(57) lgkmcnt(0)
m16 v[112:115],a[224:227],v[40:43],v[112:115]
rtr a[192:193],v11,50688
m16 v[144:147],a[224:227],v[44:47],v[144:147]
rtr a[194:195],v11,51712
buffer_load_dwordx4 a[72:75], v211, s[24:27], 0 offen offset:2048 sc1
m16 v[176:179],a[224:227],v[48:51],v[176:179]
rtr a[196:197],v11,50696
m16 v[116:119],a[228:231],v[40:43],v[116:119]
rtr a[198:199],v11,51720
m16 v[148:151],a[228:231],v[44:47],v[148:151]
m16 v[180:183],a[228:231],v[48:51],v[180:183]
rtr a[200:201],v11,50944
m16 v[120:123],a[232:235],v[40:43],v[120:123]
rtr a[202:203],v11,51968
buffer_load_dwordx4 a[76:79], v211, s[24:27], s47 offen offset:0 sc1
m16 v[152:155],a[232:235],v[44:47],v[152:155]
rtr a[204:205],v11,50952
m16 v[184:187],a[232:235],v[48:51],v[184:187]
m16 v[124:127],a[236:239],v[40:43],v[124:127]
rtr a[206:207],v11,51976
m16 v[156:159],a[236:239],v[44:47],v[156:159]
rtr a[208:209],v11,51200
m16 v[188:191],a[236:239],v[48:51],v[188:191]
rtr a[210:211],v11,52224
buffer_load_dwordx4 a[80:83], v211, s[24:27], s47 offen offset:1024 sc1
m16 v[128:131],a[240:243],v[40:43],v[128:131]
m16 v[160:163],a[240:243],v[44:47],v[160:163]
rtr a[212:213],v11,51208
m16 v[192:195],a[240:243],v[48:51],v[192:195]
rtr a[214:215],v11,52232
m16 v[132:135],a[244:247],v[40:43],v[132:135]
rtr a[216:217],v11,51456
m16 v[164:167],a[244:247],v[44:47],v[164:167]
buffer_load_dwordx4 a[84:87], v211, s[24:27], s47 offen offset:2048 sc1
m16 v[196:199],a[244:247],v[48:51],v[196:199]
rtr a[218:219],v11,52480
m16 v[136:139],a[248:251],v[40:43],v[136:139]
rtr a[220:221],v11,51464
m16 v[168:171],a[248:251],v[44:47],v[168:171]
rtr a[222:223],v11,52488
m16 v[200:203],a[248:251],v[48:51],v[200:203]
m16 v[140:143],a[252:255],v[40:43],v[140:143]
rtr a[160:161],v11,54784
buffer_load_dwordx4 a[88:91], v211, s[24:27], s4 offen offset:0 sc1
m16 v[172:175],a[252:255],v[44:47],v[172:175]
rtr a[162:163],v11,55808
m16 v[204:207],a[252:255],v[48:51],v[204:207]
rtr a[164:165],v11,54792
m16 v[112:115],a[0:3],v[52:55],v[112:115]
rtr a[166:167],v11,55816
m16 v[144:147],a[0:3],v[56:59],v[144:147]
m16 v[176:179],a[0:3],v[60:63],v[176:179]
rtr a[168:169],v11,55040
buffer_load_dwordx4 a[92:95], v211, s[24:27], s4 offen offset:1024 sc1
m16 v[116:119],a[4:7],v[52:55],v[116:119]
rtr a[170:171],v11,56064
m16 v[148:151],a[4:7],v[56:59],v[148:151]
rtr a[172:173],v11,55048
m16 v[180:183],a[4:7],v[60:63],v[180:183]
m16 v[120:123],a[8:11],v[52:55],v[120:123]
rtr a[174:175],v11,56072
m16 v[152:155],a[8:11],v[56:59],v[152:155]
rtr a[176:177],v11,55296
buffer_load_dwordx4 v[16:19], v211, s[24:27], s4 offen offset:2048 sc1
m16 v[184:187],a[8:11],v[60:63],v[184:187]
rtr a[178:179],v11,56320
m16 v[124:127],a[12:15],v[52:55],v[124:127]
m16 v[156:159],a[12:15],v[56:59],v[156:159]
rtr a[180:181],v11,55304
m16 v[188:191],a[12:15],v[60:63],v[188:191]
rtr a[182:183],v11,56328
m16 v[128:131],a[16:19],v[52:55],v[128:131]
rtr a[184:185],v11,55552
buffer_load_dwordx4 v[20:23], v211, s[24:27], s5 offen offset:0 sc1
m16 v[160:163],a[16:19],v[56:59],v[160:163]
m16 v[192:195],a[16:19],v[60:63],v[192:195]
rtr a[186:187],v11,56576
m16 v[132:135],a[20:23],v[52:55],v[132:135]
rtr a[188:189],v11,55560
m16 v[164:167],a[20:23],v[56:59],v[164:167]
rtr a[190:191],v11,56584
m16 v[196:199],a[20:23],v[60:63],v[196:199]
buffer_load_dwordx4 v[24:27], v211, s[24:27], s5 offen offset:1024 sc1
m16 v[136:139],a[24:27],v[52:55],v[136:139]
m16 v[168:171],a[24:27],v[56:59],v[168:171]
m16 v[200:203],a[24:27],v[60:63],v[200:203]
m16 v[140:143],a[28:31],v[52:55],v[140:143]
m16 v[172:175],a[28:31],v[56:59],v[172:175]
m16 v[204:207],a[28:31],v[60:63],v[204:207]
s_waitcnt vmcnt(47) lgkmcnt(0)
s_barrier
m16 v[112:115],a[192:195],v[64:67],v[112:115]
rtr a[224:225],v12,0
m16 v[144:147],a[192:195],v[68:71],v[144:147]
rtr a[226:227],v12,1024
buffer_load_dwordx4 v[28:31], v211, s[24:27], s5 offen offset:2048 sc1
m16 v[176:179],a[192:195],v[72:75],v[176:179]
rtr a[228:229],v12,8
m16 v[116:119],a[196:199],v[64:67],v[116:119]
rtr a[230:231],v12,1032
m16 v[148:151],a[196:199],v[68:71],v[148:151]
cvt v128,v128,v129
cvt v129,v130,v131
m16 v[180:183],a[196:199],v[72:75],v[180:183]
rtr a[232:233],v12,256
cvt v130,v132,v133
m16 v[120:123],a[200:203],v[64:67],v[120:123]
rtr a[234:235],v12,1280
v_add_u32 v211, 0x16000, v211
buffer_load_dwordx4 v[32:35], v211, s[24:27], 0 offen offset:0 sc1
m16 v[152:155],a[200:203],v[68:71],v[152:155]
cvt v131,v134,v135
rtr a[236:237],v12,264
m16 v[184:187],a[200:203],v[72:75],v[184:187]
buffer_store_dwordx4 v[128:131], v1, s[24:27], 0 offen offset:0 sc1
cvt v132,v136,v137
m16 v[124:127],a[204:207],v[64:67],v[124:127]
cvt v133,v138,v139
rtr a[238:239],v12,1288
m16 v[156:159],a[204:207],v[68:71],v[156:159]
cvt v134,v140,v141
rtr a[240:241],v12,512
m16 v[188:191],a[204:207],v[72:75],v[188:191]
cvt v135,v142,v143
buffer_store_dwordx4 v[132:135], v1, s[24:27], 0 offen offset:1024 sc1
m16 v[112:115],a[208:211],v[76:79],v[112:115]
rtr a[242:243],v12,1536
buffer_load_dwordx4 v[36:39], v211, s[24:27], 0 offen offset:1024 sc1
cvt v160,v160,v161
m16 v[144:147],a[208:211],v[80:83],v[144:147]
cvt v161,v162,v163
rtr a[244:245],v12,520
m16 v[176:179],a[208:211],v[84:87],v[176:179]
cvt v162,v164,v165
cvt v163,v166,v167
m16 v[116:119],a[212:215],v[76:79],v[116:119]
rtr a[246:247],v12,1544
buffer_store_dwordx4 v[160:163], v1, s[24:27], s62 offen offset:0 sc1
m16 v[148:151],a[212:215],v[80:83],v[148:151]
rtr a[248:249],v12,768
cvt v164,v168,v169
m16 v[180:183],a[212:215],v[84:87],v[180:183]
buffer_load_dwordx4 v[40:43], v211, s[24:27], 0 offen offset:2048 sc1
cvt v165,v170,v171
m16 v[120:123],a[216:219],v[76:79],v[120:123]
rtr a[250:251],v12,1792
cvt v166,v172,v173
cvt v167,v174,v175
m16 v[152:155],a[216:219],v[80:83],v[152:155]
rtr a[252:253],v12,776
buffer_store_dwordx4 v[164:167], v1, s[24:27], s62 offen offset:1024 sc1
m16 v[184:187],a[216:219],v[84:87],v[184:187]
rtr a[254:255],v12,1800
cvt v192,v192,v193
m16 v[124:127],a[220:223],v[76:79],v[124:127]
cvt v193,v194,v195
cvt v194,v196,v197
m16 v[156:159],a[220:223],v[80:83],v[156:159]
rtr a[0:1],v12,4096
buffer_load_dwordx4 v[44:47], v211, s[24:27], s47 offen offset:0 sc1
cvt v195,v198,v199
m16 v[188:191],a[220:223],v[84:87],v[188:191]
rtr a[2:3],v12,5120
buffer_store_dwordx4 v[192:195], v1, s[24:27], s63 offen offset:0 sc1
m16 v[112:115],a[160:163],v[88:91],v[112:115]
rtr a[4:5],v12,4104
cvt v196,v200,v201
cvt v197,v202,v203
m16 v[144:147],a[160:163],v[92:95],v[144:147]
rtr a[6:7],v12,5128
cvt v198,v204,v205
m16 v[176:179],a[160:163],v[96:99],v[176:179]
cvt v199,v206,v207
rtr a[8:9],v12,4352
m16 v[116:119],a[164:167],v[88:91],v[116:119]
buffer_load_dwordx4 v[48:51], v211, s[24:27], s47 offen offset:1024 sc1
buffer_store_dwordx4 v[196:199], v1, s[24:27], s63 offen offset:1024 sc1
m16 v[148:151],a[164:167],v[92:95],v[148:151]
rtr a[10:11],v12,5376
rtr a[12:13],v12,4360
m16 v[180:183],a[164:167],v[96:99],v[180:183]
m16 v[120:123],a[168:171],v[88:91],v[120:123]
rtr a[14:15],v12,5384
m16 v[152:155],a[168:171],v[92:95],v[152:155]
rtr a[16:17],v12,4608
buffer_load_dwordx4 v[52:55], v211, s[24:27], s47 offen offset:2048 sc1
m16 v[184:187],a[168:171],v[96:99],v[184:187]
rtr a[18:19],v12,5632
m16 v[124:127],a[172:175],v[88:91],v[124:127]
m16 v[156:159],a[172:175],v[92:95],v[156:159]
rtr a[20:21],v12,4616
m16 v[188:191],a[172:175],v[96:99],v[188:191]
rtr a[22:23],v12,5640
m16 v[112:115],a[176:179],v[100:103],v[112:115]
rtr a[24:25],v12,4864
buffer_load_dwordx4 v[56:59], v211, s[24:27], s4 offen offset:0 sc1
m16 v[144:147],a[176:179],v[104:107],v[144:147]
m16 v[176:179],a[176:179],v[108:111],v[176:179]
rtr a[26:27],v12,5888
m16 v[116:119],a[180:183],v[100:103],v[116:119]
rtr a[28:29],v12,4872
m16 v[148:151],a[180:183],v[104:107],v[148:151]
rtr a[30:31],v12,5896
m16 v[180:183],a[180:183],v[108:111],v[180:183]
buffer_load_dwordx4 v[60:63], v211, s[24:27], s4 offen offset:1024 sc1
m16 v[120:123],a[184:187],v[100:103],v[120:123]
m16 v[152:155],a[184:187],v[104:107],v[152:155]
m16 v[184:187],a[184:187],v[108:111],v[184:187]
m16 v[124:127],a[188:191],v[100:103],v[124:127]
m16 v[156:159],a[188:191],v[104:107],v[156:159]
m16 v[188:191],a[188:191],v[108:111],v[188:191]
s_waitcnt vmcnt(45) lgkmcnt(0)
m16 v[112:115],a[224:227],a[96:99],v[112:115]
rtr a[192:193],v10,0
m16 v[144:147],a[224:227],a[100:103],v[144:147]
rtr a[194:195],v10,1024
buffer_load_dwordx4 v[64:67], v211, s[24:27], s4 offen offset:2048 sc1
m16 v[176:179],a[224:227],a[104:107],v[176:179]
rtr a[196:197],v10,8
m16 v[116:119],a[228:231],a[96:99],v[116:119]
rtr a[198:199],v10,1032
m16 v[148:151],a[228:231],a[100:103],v[148:151]
m16 v[180:183],a[228:231],a[104:107],v[180:183]
rtr a[200:201],v10,256
m16 v[120:123],a[232:235],a[96:99],v[120:123]
rtr a[202:203],v10,1280
buffer_load_dwordx4 v[68:71], v211, s[24:27], s5 offen offset:0 sc1
m16 v[152:155],a[232:235],a[100:103],v[152:155]
rtr a[204:205],v10,264
m16 v[184:187],a[232:235],a[104:107],v[184:187]
m16 v[124:127],a[236:239],a[96:99],v[124:127]
rtr a[206:207],v10,1288
m16 v[156:159],a[236:239],a[100:103],v[156:159]
rtr a[208:209],v10,512
m16 v[188:191],a[236:239],a[104:107],v[188:191]
rtr a[210:211],v10,1536
buffer_load_dwordx4 v[72:75], v211, s[24:27], s5 offen offset:1024 sc1
m16 v[112:115],a[240:243],a[108:111],v[112:115]
m16 v[144:147],a[240:243],a[112:115],v[144:147]
rtr a[212:213],v10,520
m16 v[176:179],a[240:243],a[116:119],v[176:179]
rtr a[214:215],v10,1544
m16 v[116:119],a[244:247],a[108:111],v[116:119]
rtr a[216:217],v10,768
m16 v[148:151],a[244:247],a[112:115],v[148:151]
buffer_load_dwordx4 v[76:79], v211, s[24:27], s5 offen offset:2048 sc1
m16 v[180:183],a[244:247],a[116:119],v[180:183]
rtr a[218:219],v10,1792
m16 v[120:123],a[248:251],a[108:111],v[120:123]
rtr a[220:221],v10,776
m16 v[152:155],a[248:251],a[112:115],v[152:155]
rtr a[222:223],v10,1800
m16 v[184:187],a[248:251],a[116:119],v[184:187]
m16 v[124:127],a[252:255],a[108:111],v[124:127]
rtr a[160:161],v10,4096
v_add_u32 v211, 0x16000, v211
buffer_load_dwordx4 v[80:83], v211, s[24:27], 0 offen offset:0 sc1
m16 v[156:159],a[252:255],a[112:115],v[156:159]
rtr a[162:163],v10,5120
m16 v[188:191],a[252:255],a[116:119],v[188:191]
rtr a[164:165],v10,4104
m16 v[112:115],a[0:3],a[120:123],v[112:115]
rtr a[166:167],v10,5128
m16 v[144:147],a[0:3],a[124:127],v[144:147]
m16 v[176:179],a[0:3],a[128:131],v[176:179]
rtr a[168:169],v10,4352
buffer_load_dwordx4 v[84:87], v211, s[24:27], 0 offen offset:1024 sc1
m16 v[116:119],a[4:7],a[120:123],v[116:119]
rtr a[170:171],v10,5376
m16 v[148:151],a[4:7],a[124:127],v[148:151]
rtr a[172:173],v10,4360
m16 v[180:183],a[4:7],a[128:131],v[180:183]
m16 v[120:123],a[8:11],a[120:123],v[120:123]
rtr a[174:175],v10,5384
m16 v[152:155],a[8:11],a[124:127],v[152:155]
rtr a[176:177],v10,4608
buffer_load_dwordx4 v[88:91], v211, s[24:27], 0 offen offset:2048 sc1
m16 v[184:187],a[8:11],a[128:131],v[184:187]
rtr a[178:179],v10,5632
m16 v[124:127],a[12:15],a[120:123],v[124:127]
m16 v[156:159],a[12:15],a[124:127],v[156:159]
rtr a[180:181],v10,4616
m16 v[188:191],a[12:15],a[128:131],v[188:191]
rtr a[182:183],v10,5640
m16 v[112:115],a[16:19],a[132:135],v[112:115]
rtr a[184:185],v10,4864
buffer_load_dwordx4 v[92:95], v211, s[24:27], s47 offen offset:0 sc1
m16 v[144:147],a[16:19],a[136:139],v[144:147]
m16 v[176:179],a[16:19],a[140:143],v[176:179]
rtr a[186:187],v10,5888
m16 v[116:119],a[20:23],a[132:135],v[116:119]
rtr a[188:189],v10,4872
m16 v[148:151],a[20:23],a[136:139],v[148:151]
rtr a[190:191],v10,5896
m16 v[180:183],a[20:23],a[140:143],v[180:183]
buffer_load_dwordx4 v[96:99], v211, s[24:27], s47 offen offset:1024 sc1
m16 v[120:123],a[24:27],a[132:135],v[120:123]
m16 v[152:155],a[24:27],a[136:139],v[152:155]
m16 v[184:187],a[24:27],a[140:143],v[184:187]
m16 v[124:127],a[28:31],a[132:135],v[124:127]
m16 v[156:159],a[28:31],a[136:139],v[156:159]
m16 v[188:191],a[28:31],a[140:143],v[188:191]
s_waitcnt vmcnt(36) lgkmcnt(0)
s_barrier
m16 v[112:115],a[192:195],a[144:147],v[112:115]
rtr a[224:225],v10,33792
m16 v[144:147],a[192:195],a[148:151],v[144:147]
rtr a[226:227],v10,34816
buffer_load_dwordx4 v[100:103], v211, s[24:27], s47 offen offset:2048 sc1
m16 v[176:179],a[192:195],a[152:155],v[176:179]
rtr a[228:229],v10,33800
m16 v[116:119],a[196:199],a[144:147],v[116:119]
rtr a[230:231],v10,34824
m16 v[148:151],a[196:199],a[148:151],v[148:151]
m16 v[180:183],a[196:199],a[152:155],v[180:183]
rtr a[232:233],v10,34048
m16 v[120:123],a[200:203],a[144:147],v[120:123]
rtr a[234:235],v10,35072
buffer_load_dwordx4 v[104:107], v211, s[24:27], s4 offen offset:0 sc1
m16 v[152:155],a[200:203],a[148:151],v[152:155]
rtr a[236:237],v10,34056
m16 v[184:187],a[200:203],a[152:155],v[184:187]
m16 v[124:127],a[204:207],a[144:147],v[124:127]
rtr a[238:239],v10,35080
m16 v[156:159],a[204:207],a[148:151],v[156:159]
rtr a[240:241],v10,34304
m16 v[188:191],a[204:207],a[152:155],v[188:191]
rtr a[242:243],v10,35328
buffer_load_dwordx4 v[108:111], v211, s[24:27], s4 offen offset:1024 sc1
m16 v[112:115],a[208:211],a[156:159],v[112:115]
s_waitcnt vmcnt(15)
s_mov_b64 exec, 1
buffer_store_dword v5, v4, s[24:27], 0 offen sc1
s_mov_b64 exec, -1
s_nop 3
m16 v[144:147],a[208:211],a[32:35],v[144:147]
rtr a[244:245],v10,34312
m16 v[176:179],a[208:211],a[36:39],v[176:179]
rtr a[246:247],v10,35336
m16 v[116:119],a[212:215],a[156:159],v[116:119]
rtr a[248:249],v10,34560
m16 v[148:151],a[212:215],a[32:35],v[148:151]
buffer_load_dwordx4 a[96:99], v211, s[24:27], s4 offen offset:2048 sc1
m16 v[180:183],a[212:215],a[36:39],v[180:183]
rtr a[250:251],v10,35584
m16 v[120:123],a[216:219],a[156:159],v[120:123]
rtr a[252:253],v10,34568
m16 v[152:155],a[216:219],a[32:35],v[152:155]
rtr a[254:255],v10,35592
m16 v[184:187],a[216:219],a[36:39],v[184:187]
m16 v[124:127],a[220:223],a[156:159],v[124:127]
rtr a[0:1],v10,37888
buffer_load_dwordx4 a[100:103], v211, s[24:27], s5 offen offset:0 sc1
m16 v[156:159],a[220:223],a[32:35],v[156:159]
rtr a[2:3],v10,38912
m16 v[188:191],a[220:223],a[36:39],v[188:191]
rtr a[4:5],v10,37896
m16 v[112:115],a[160:163],a[40:43],v[112:115]
rtr a[6:7],v10,38920
m16 v[144:147],a[160:163],a[44:47],v[144:147]
m16 v[176:179],a[160:163],a[48:51],v[176:179]
rtr a[8:9],v10,38144
buffer_load_dwordx4 a[104:107], v211, s[24:27], s5 offen offset:1024 sc1
m16 v[116:119],a[164:167],a[40:43],v[116:119]
rtr a[10:11],v10,39168
m16 v[148:151],a[164:167],a[44:47],v[148:151]
rtr a[12:13],v10,38152
m16 v[180:183],a[164:167],a[48:51],v[180:183]
m16 v[120:123],a[168:171],a[40:43],v[120:123]
rtr a[14:15],v10,39176
m16 v[152:155],a[168:171],a[44:47],v[152:155]
rtr a[16:17],v10,38400
buffer_load_dwordx4 a[108:111], v211, s[24:27], s5 offen offset:2048 sc1
m16 v[184:187],a[168:171],a[48:51],v[184:187]
rtr a[18:19],v10,39424
m16 v[124:127],a[172:175],a[40:43],v[124:127]
m16 v[156:159],a[172:175],a[44:47],v[156:159]
rtr a[20:21],v10,38408
m16 v[188:191],a[172:175],a[48:51],v[188:191]
rtr a[22:23],v10,39432
m16 v[112:115],a[176:179],a[52:55],v[112:115]
rtr a[24:25],v10,38656
m16 v[144:147],a[176:179],a[56:59],v[144:147]
m16 v[176:179],a[176:179],a[60:63],v[176:179]
rtr a[26:27],v10,39680
m16 v[116:119],a[180:183],a[52:55],v[116:119]
rtr a[28:29],v10,38664
m16 v[148:151],a[180:183],a[56:59],v[148:151]
rtr a[30:31],v10,39688
m16 v[180:183],a[180:183],a[60:63],v[180:183]
m16 v[120:123],a[184:187],a[52:55],v[120:123]
m16 v[152:155],a[184:187],a[56:59],v[152:155]
m16 v[184:187],a[184:187],a[60:63],v[184:187]
m16 v[124:127],a[188:191],a[52:55],v[124:127]
m16 v[156:159],a[188:191],a[56:59],v[156:159]
m16 v[188:191],a[188:191],a[60:63],v[188:191]
s_waitcnt lgkmcnt(0)
m16 v[112:115],a[224:227],a[64:67],v[112:115]
rtr a[192:193],v10,16896
m16 v[144:147],a[224:227],a[68:71],v[144:147]
rtr a[194:195],v10,17920
m16 v[176:179],a[224:227],a[72:75],v[176:179]
rtr a[196:197],v10,16904
m16 v[116:119],a[228:231],a[64:67],v[116:119]
rtr a[198:199],v10,17928
m16 v[148:151],a[228:231],a[68:71],v[148:151]
m16 v[180:183],a[228:231],a[72:75],v[180:183]
rtr a[200:201],v10,17152
m16 v[120:123],a[232:235],a[64:67],v[120:123]
rtr a[202:203],v10,18176
m16 v[152:155],a[232:235],a[68:71],v[152:155]
rtr a[204:205],v10,17160
m16 v[184:187],a[232:235],a[72:75],v[184:187]
m16 v[124:127],a[236:239],a[64:67],v[124:127]
rtr a[206:207],v10,18184
m16 v[156:159],a[236:239],a[68:71],v[156:159]
rtr a[208:209],v10,17408
m16 v[188:191],a[236:239],a[72:75],v[188:191]
rtr a[210:211],v10,18432
m16 v[112:115],a[240:243],a[76:79],v[112:115]
m16 v[144:147],a[240:243],a[80:83],v[144:147]
rtr a[212:213],v10,17416
m16 v[176:179],a[240:243],a[84:87],v[176:179]
rtr a[214:215],v10,18440
m16 v[116:119],a[244:247],a[76:79],v[116:119]
rtr a[216:217],v10,17664
m16 v[148:151],a[244:247],a[80:83],v[148:151]
m16 v[180:183],a[244:247],a[84:87],v[180:183]
rtr a[218:219],v10,18688
m16 v[120:123],a[248:251],a[76:79],v[120:123]
buffer_load_dword v254, v9, s[24:27], 0 offen sc1
rtr a[220:221],v10,17672
m16 v[152:155],a[248:251],a[80:83],v[152:155]
rtr a[222:223],v10,18696
m16 v[184:187],a[248:251],a[84:87],v[184:187]
m16 v[124:127],a[252:255],a[76:79],v[124:127]
rtr a[160:161],v10,20992
m16 v[156:159],a[252:255],a[80:83],v[156:159]
rtr a[162:163],v10,22016
m16 v[188:191],a[252:255],a[84:87],v[188:191]
rtr a[164:165],v10,21000
m16 v[112:115],a[0:3],a[88:91],v[112:115]
rtr a[166:167],v10,22024
m16 v[144:147],a[0:3],a[92:95],v[144:147]
m16 v[176:179],a[0:3],v[16:19],v[176:179]
rtr a[168:169],v10,21248
m16 v[116:119],a[4:7],a[88:91],v[116:119]
rtr a[170:171],v10,22272
m16 v[148:151],a[4:7],a[92:95],v[148:151]
rtr a[172:173],v10,21256
m16 v[180:183],a[4:7],v[16:19],v[180:183]
m16 v[120:123],a[8:11],a[88:91],v[120:123]
rtr a[174:175],v10,22280
m16 v[152:155],a[8:11],a[92:95],v[152:155]
rtr a[176:177],v10,21504
m16 v[184:187],a[8:11],v[16:19],v[184:187]
rtr a[178:179],v10,22528
m16 v[124:127],a[12:15],a[88:91],v[124:127]
m16 v[156:159],a[12:15],a[92:95],v[156:159]
rtr a[180:181],v10,21512
m16 v[188:191],a[12:15],v[16:19],v[188:191]
rtr a[182:183],v10,22536
m16 v[112:115],a[16:19],v[20:23],v[112:115]
rtr a[184:185],v10,21760
m16 v[144:147],a[16:19],v[24:27],v[144:147]
m16 v[176:179],a[16:19],v[28:31],v[176:179]
rtr a[186:187],v10,22784
m16 v[116:119],a[20:23],v[20:23],v[116:119]
rtr a[188:189],v10,21768
m16 v[148:151],a[20:23],v[24:27],v[148:151]
rtr a[190:191],v10,22792
m16 v[180:183],a[20:23],v[28:31],v[180:183]
m16 v[120:123],a[24:27],v[20:23],v[120:123]
m16 v[152:155],a[24:27],v[24:27],v[152:155]
m16 v[184:187],a[24:27],v[28:31],v[184:187]
m16 v[124:127],a[28:31],v[20:23],v[124:127]
m16 v[156:159],a[28:31],v[24:27],v[156:159]
m16 v[188:191],a[28:31],v[28:31],v[188:191]
s_waitcnt vmcnt(14) lgkmcnt(0)
s_barrier
m16 v[112:115],a[192:195],v[32:35],v[112:115]
rtr a[224:225],v11,0
m16 v[144:147],a[192:195],v[36:39],v[144:147]
rtr a[226:227],v11,1024
m16 v[176:179],a[192:195],v[40:43],v[176:179]
rtr a[228:229],v11,8
m16 v[116:119],a[196:199],v[32:35],v[116:119]
rtr a[230:231],v11,1032
m16 v[148:151],a[196:199],v[36:39],v[148:151]
m16 v[180:183],a[196:199],v[40:43],v[180:183]
rtr a[232:233],v11,256
m16 v[120:123],a[200:203],v[32:35],v[120:123]
rtr a[234:235],v11,1280
m16 v[152:155],a[200:203],v[36:39],v[152:155]
rtr a[236:237],v11,264
m16 v[184:187],a[200:203],v[40:43],v[184:187]
m16 v[124:127],a[204:207],v[32:35],v[124:127]
rtr a[238:239],v11,1288
s_waitcnt vmcnt(0)
v_cmp_ne_u32 vcc, 1, v254
s_mov_b32 s28, 0
s_nop 0
s_cmp_eq_u64 vcc, 0
s_cbranch_scc1 La_p2_ok
s_mov_b32 s29, 20000
La_p2:
s_sleep 2
buffer_load_dword v254, v9, s[24:27], 0 offen sc1
s_waitcnt vmcnt(0)
s_sub_u32 s29, s29, 1
s_cmp_eq_u32 s29, 0
s_cbranch_scc1 La_p2_ok
v_cmp_ne_u32 vcc, 1, v254
s_mov_b32 s28, 0
s_nop 0
s_cmp_eq_u64 vcc, 0
s_cbranch_scc0 La_p2
La_p2_ok:
m16 v[156:159],a[204:207],v[36:39],v[156:159]
rtr a[240:241],v11,512
buffer_load_dwordx4 v[136:139], v2, s[24:27], 0 offen offset:0 sc1
m16 v[188:191],a[204:207],v[40:43],v[188:191]
rtr a[242:243],v11,1536
m16 v[112:115],a[208:211],v[44:47],v[112:115]
buffer_load_dwordx4 v[140:143], v2, s[24:27], 0 offen offset:1024 sc1
m16 v[144:147],a[208:211],v[48:51],v[144:147]
buffer_load_dwordx4 v[168:171], v2, s[24:27], s62 offen offset:0 sc1
rtr a[244:245],v11,520
m16 v[176:179],a[208:211],v[52:55],v[176:179]
rtr a[246:247],v11,1544
buffer_load_dwordx4 v[172:175], v2, s[24:27], s62 offen offset:1024 sc1
m16 v[116:119],a[212:215],v[44:47],v[116:119]
rtr a[248:249],v11,768
buffer_load_dwordx4 v[200:203], v2, s[24:27], s63 offen offset:0 sc1
m16 v[148:151],a[212:215],v[48:51],v[148:151]
buffer_load_dwordx4 v[204:207], v2, s[24:27], s63 offen offset:1024 sc1
m16 v[180:183],a[212:215],v[52:55],v[180:183]
rtr a[250:251],v11,1792
m16 v[120:123],a[216:219],v[44:47],v[120:123]
rtr a[252:253],v11,776
m16 v[152:155],a[216:219],v[48:51],v[152:155]
rtr a[254:255],v11,1800
m16 v[184:187],a[216:219],v[52:55],v[184:187]
m16 v[124:127],a[220:223],v[44:47],v[124:127]
rtr a[0:1],v11,4096
m16 v[156:159],a[220:223],v[48:51],v[156:159]
rtr a[2:3],v11,5120
m16 v[188:191],a[220:223],v[52:55],v[188:191]
rtr a[4:5],v11,4104
m16 v[112:115],a[160:163],v[56:59],v[112:115]
rtr a[6:7],v11,5128
m16 v[144:147],a[160:163],v[60:63],v[144:147]
m16 v[176:179],a[160:163],v[64:67],v[176:179]
rtr a[8:9],v11,4352
m16 v[116:119],a[164:167],v[56:59],v[116:119]
rtr a[10:11],v11,5376
m16 v[148:151],a[164:167],v[60:63],v[148:151]
rtr a[12:13],v11,4360
m16 v[180:183],a[164:167],v[64:67],v[180:183]
m16 v[120:123],a[168:171],v[56:59],v[120:123]
rtr a[14:15],v11,5384
m16 v[152:155],a[168:171],v[60:63],v[152:155]
rtr a[16:17],v11,4608
m16 v[184:187],a[168:171],v[64:67],v[184:187]
rtr a[18:19],v11,5632
m16 v[124:127],a[172:175],v[56:59],v[124:127]
m16 v[156:159],a[172:175],v[60:63],v[156:159]
rtr a[20:21],v11,4616
m16 v[188:191],a[172:175],v[64:67],v[188:191]
rtr a[22:23],v11,5640
m16 v[112:115],a[176:179],v[68:71],v[112:115]
rtr a[24:25],v11,4864
m16 v[144:147],a[176:179],v[72:75],v[144:147]
m16 v[176:179],a[176:179],v[76:79],v[176:179]
rtr a[26:27],v11,5888
m16 v[116:119],a[180:183],v[68:71],v[116:119]
rtr a[28:29],v11,4872
m16 v[148:151],a[180:183],v[72:75],v[148:151]
rtr a[30:31],v11,5896
m16 v[180:183],a[180:183],v[76:79],v[180:183]
m16 v[120:123],a[184:187],v[68:71],v[120:123]
m16 v[152:155],a[184:187],v[72:75],v[152:155]
m16 v[184:187],a[184:187],v[76:79],v[184:187]
m16 v[124:127],a[188:191],v[68:71],v[124:127]
m16 v[156:159],a[188:191],v[72:75],v[156:159]
m16 v[188:191],a[188:191],v[76:79],v[188:191]
s_waitcnt lgkmcnt(0)
m16 v[112:115],a[224:227],v[80:83],v[112:115]
m16 v[116:119],a[228:231],v[80:83],v[116:119]
s_waitcnt vmcnt(4)
v_lshlrev_b32 v128, 16, v136
m16 v[120:123],a[232:235],v[80:83],v[120:123]
v_and_b32 v129, 0xffff0000, v136
v_lshlrev_b32 v130, 16, v137
v_and_b32 v131, 0xffff0000, v137
m16 v[124:127],a[236:239],v[80:83],v[124:127]
v_lshlrev_b32 v132, 16, v138
v_and_b32 v133, 0xffff0000, v138
v_lshlrev_b32 v134, 16, v139
m16 v[112:115],a[240:243],v[92:95],v[112:115]
v_and_b32 v135, 0xffff0000, v139
v_lshlrev_b32 v136, 16, v140
v_and_b32 v137, 0xffff0000, v140
m16 v[116:119],a[244:247],v[92:95],v[116:119]
v_lshlrev_b32 v138, 16, v141
v_and_b32 v139, 0xffff0000, v141
v_lshlrev_b32 v140, 16, v142
m16 v[120:123],a[248:251],v[92:95],v[120:123]
v_and_b32 v141, 0xffff0000, v142
v_lshlrev_b32 v142, 16, v143
m16 v[124:127],a[252:255],v[92:95],v[124:127]
v_and_b32 v143, 0xffff0000, v143
s_waitcnt vmcnt(2)
v_lshlrev_b32 v160, 16, v168
m16 v[112:115],a[0:3],v[104:107],v[112:115]
v_and_b32 v161, 0xffff0000, v168
v_lshlrev_b32 v162, 16, v169
v_and_b32 v163, 0xffff0000, v169
m16 v[116:119],a[4:7],v[104:107],v[116:119]
v_lshlrev_b32 v164, 16, v170
v_and_b32 v165, 0xffff0000, v170
v_lshlrev_b32 v166, 16, v171
m16 v[120:123],a[8:11],v[104:107],v[120:123]
v_and_b32 v167, 0xffff0000, v171
v_lshlrev_b32 v168, 16, v172
v_and_b32 v169, 0xffff0000, v172
m16 v[124:127],a[12:15],v[104:107],v[124:127]
v_lshlrev_b32 v170, 16, v173
v_and_b32 v171, 0xffff0000, v173
m16 v[112:115],a[16:19],a[100:103],v[112:115]
v_lshlrev_b32 v172, 16, v174
v_and_b32 v173, 0xffff0000, v174
v_lshlrev_b32 v174, 16, v175
m16 v[116:119],a[20:23],a[100:103],v[116:119]
v_and_b32 v175, 0xffff0000, v175
s_waitcnt vmcnt(0)
v_lshlrev_b32 v192, 16, v200
m16 v[120:123],a[24:27],a[100:103],v[120:123]
v_and_b32 v193, 0xffff0000, v200
v_lshlrev_b32 v194, 16, v201
v_and_b32 v195, 0xffff0000, v201
m16 v[124:127],a[28:31],a[100:103],v[124:127]
v_lshlrev_b32 v196, 16, v202
v_and_b32 v197, 0xffff0000, v202
v_lshlrev_b32 v198, 16, v203
m16 v[144:147],a[224:227],v[84:87],v[144:147]
v_and_b32 v199, 0xffff0000, v203
v_lshlrev_b32 v200, 16, v204
m16 v[148:151],a[228:231],v[84:87],v[148:151]
v_and_b32 v201, 0xffff0000, v204
v_lshlrev_b32 v202, 16, v205
v_and_b32 v203, 0xffff0000, v205
m16 v[152:155],a[232:235],v[84:87],v[152:155]
v_lshlrev_b32 v204, 16, v206
v_and_b32 v205, 0xffff0000, v206
v_lshlrev_b32 v206, 16, v207
m16 v[156:159],a[236:239],v[84:87],v[156:159]
v_add_f32 v112, v112, v128
v_add_f32 v113, v113, v129
v_add_f32 v114, v114, v130
m16 v[144:147],a[240:243],v[96:99],v[144:147]
v_add_f32 v115, v115, v131
v_add_f32 v116, v116, v132
v_add_f32 v117, v117, v133
m16 v[148:151],a[244:247],v[96:99],v[148:151]
v_add_f32 v118, v118, v134
v_add_f32 v119, v119, v135
m16 v[152:155],a[248:251],v[96:99],v[152:155]
v_add_f32 v120, v120, v136
v_add_f32 v121, v121, v137
v_add_f32 v122, v122, v138
m16 v[156:159],a[252:255],v[96:99],v[156:159]
v_add_f32 v123, v123, v139
v_add_f32 v124, v124, v140
v_add_f32 v125, v125, v141
m16 v[144:147],a[0:3],v[108:111],v[144:147]
v_add_f32 v126, v126, v142
v_add_f32 v127, v127, v143
cvt v208,v112,v113
m16 v[148:151],a[4:7],v[108:111],v[148:151]
cvt v209,v114,v115
cvt v210,v116,v117
m16 v[152:155],a[8:11],v[108:111],v[152:155]
cvt v211,v118,v119
m16 v[156:159],a[12:15],v[108:111],v[156:159]
cvt v212,v120,v121
cvt v213,v122,v123
m16 v[144:147],a[16:19],a[104:107],v[144:147]
cvt v214,v124,v125
cvt v215,v126,v127
m16 v[148:151],a[20:23],a[104:107],v[148:151]
ds_write_b128 v14, v[208:211] offset:0
ds_write_b128 v14, v[212:215] offset:64
m16 v[152:155],a[24:27],a[104:107],v[152:155]
r128 v[128:131],v15,0
r128 v[132:135],v15,1152
m16 v[156:159],a[28:31],a[104:107],v[156:159]
v_and_b32 v207, 0xffff0000, v207
m16 v[176:179],a[224:227],v[88:91],v[176:179]
m16 v[180:183],a[228:231],v[88:91],v[180:183]
m16 v[184:187],a[232:235],v[88:91],v[184:187]
m16 v[188:191],a[236:239],v[88:91],v[188:191]
v_add_f32 v144, v144, v160
v_add_f32 v145, v145, v161
v_add_f32 v146, v146, v162
m16 v[176:179],a[240:243],v[100:103],v[176:179]
v_add_f32 v147, v147, v163
v_add_f32 v148, v148, v164
m16 v[180:183],a[244:247],v[100:103],v[180:183]
v_add_f32 v149, v149, v165
v_add_f32 v150, v150, v166
v_add_f32 v151, v151, v167
m16 v[184:187],a[248:251],v[100:103],v[184:187]
v_add_f32 v152, v152, v168
v_add_f32 v153, v153, v169
v_add_f32 v154, v154, v170
m16 v[188:191],a[252:255],v[100:103],v[188:191]
v_add_f32 v155, v155, v171
v_add_f32 v156, v156, v172
v_add_f32 v157, v157, v173
m16 v[176:179],a[0:3],a[96:99],v[176:179]
v_add_f32 v158, v158, v174
v_add_f32 v159, v159, v175
cvt v216,v144,v145
m16 v[180:183],a[4:7],a[96:99],v[180:183]
cvt v217,v146,v147
m16 v[184:187],a[8:11],a[96:99],v[184:187]
cvt v218,v148,v149
cvt v219,v150,v151
m16 v[188:191],a[12:15],a[96:99],v[188:191]
cvt v220,v152,v153
cvt v221,v154,v155
m16 v[176:179],a[16:19],a[108:111],v[176:179]
cvt v222,v156,v157
cvt v223,v158,v159
m16 v[180:183],a[20:23],a[108:111],v[180:183]
ds_write_b128 v14, v[216:219] offset:2304
ds_write_b128 v14, v[220:223] offset:2368
m16 v[184:187],a[24:27],a[108:111],v[184:187]
r128 v[160:163],v15,2304
r128 v[164:167],v15,3456
m16 v[188:191],a[28:31],a[108:111],v[188:191]
s_waitcnt lgkmcnt(4)
buffer_store_dwordx4 v[128:131], v3, s[48:51], 0 offen
buffer_store_dwordx4 v[132:135], v3, s[48:51], s66 offen
v_pk_add_f32 v[176:177], v[176:177], v[192:193]
v_pk_add_f32 v[178:179], v[178:179], v[194:195]
v_pk_add_f32 v[180:181], v[180:181], v[196:197]
v_pk_add_f32 v[182:183], v[182:183], v[198:199]
v_pk_add_f32 v[184:185], v[184:185], v[200:201]
v_pk_add_f32 v[186:187], v[186:187], v[202:203]
v_pk_add_f32 v[188:189], v[188:189], v[204:205]
v_pk_add_f32 v[190:191], v[190:191], v[206:207]
cvt v224,v176,v177
cvt v225,v178,v179
cvt v226,v180,v181
cvt v227,v182,v183
cvt v228,v184,v185
cvt v229,v186,v187
cvt v230,v188,v189
cvt v231,v190,v191
ds_write_b128 v14, v[224:227] offset:4608
ds_write_b128 v14, v[228:231] offset:4672
r128 v[192:195],v15,4608
r128 v[196:199],v15,5760
s_waitcnt lgkmcnt(4)
buffer_store_dwordx4 v[160:163], v3, s[48:51], s64 offen
buffer_store_dwordx4 v[164:167], v3, s[48:51], s67 offen
s_waitcnt lgkmcnt(0)
buffer_store_dwordx4 v[192:195], v3, s[48:51], s65 offen
buffer_store_dwordx4 v[196:199], v3, s[48:51], s68 offen
concat_heads__mha_block_cached__gqa_block_cached__near_ridge_kernel_end:
s_endpgm
concat_heads__mha_block_cached__gqa_block_cached__near_ridge_kernel_codeend:
.section .rodata,"a"
.p2align 6
.amdhsa_kernel concat_heads__mha_block_cached__gqa_block_cached__near_ridge_kernel
  .amdhsa_next_free_vgpr 512
  .amdhsa_next_free_sgpr 102
  .amdhsa_accum_offset 256
  .amdhsa_group_segment_fixed_size 0
  .amdhsa_kernarg_size 104
  .amdhsa_user_sgpr_count 2
  .amdhsa_user_sgpr_kernarg_segment_ptr 1
  .amdhsa_system_sgpr_workgroup_id_x 1
.end_amdhsa_kernel
```
